```python
import torch

def _softmax(x, axis=-1):
    return torch.softmax(x, dim=axis)
def _gelu(x):
    return torch.nn.functional.gelu(x, approximate="tanh")
def _silu(x):
    return torch.nn.functional.silu(x)
def _sigmoid(x):
    return torch.sigmoid(x)
def _layernorm(x, axis=-1, eps=1e-5):
    m = x.mean(dim=axis, keepdim=True)
    v = x.var(dim=axis, keepdim=True, unbiased=False)
    return (x - m) / torch.sqrt(v + eps)
def _scatter_add(tgt, idx, src, axis=0):
    return tgt.clone().index_add_(axis, idx, src)
def _segment_sum(src, seg, n):
    out = torch.zeros((n,) + src.shape[1:], dtype=src.dtype)
    return out.index_add_(0, seg, src)
def _pad(x, pw):
    flat = tuple(v for pair in reversed(pw) for v in pair)
    return torch.nn.functional.pad(x, flat)

kernel_name = 'gated_mix__grouped_kv_mqa__spectral_gfnet__prompt'

def setup_inputs():

    _w = (lambda a: (lambda t: t.to(torch.bfloat16) if t.is_floating_point() else t)(torch.as_tensor(a)))
    def _A_setup():
        B, S, D, H = 1, 2048, 640, 32
        Dh = D // H
        return {
            "x": _w((lambda *s: torch.randn(*s, dtype=torch.bfloat16) * 0.05)(B, S, D)),
            "wq": _w((lambda *s: torch.randn(*s, dtype=torch.bfloat16) * 0.8)(D, H * Dh)),
            "wk": _w((lambda *s: torch.randn(*s, dtype=torch.bfloat16) * 0.8)(D, Dh)),
            "wv": _w((lambda *s: torch.randn(*s, dtype=torch.bfloat16) * 0.05)(D, Dh)),
            "wo": _w((lambda *s: torch.randn(*s, dtype=torch.bfloat16) * 0.05)(H * Dh, D)),
        }
    _A_in = _A_setup()

    def _B_setup():
        B, S, D = 1, 2048, 640
        Df = D // 2 + 1
        return {
            "x": _w((lambda *s: torch.randn(*s, dtype=torch.bfloat16) * 0.05)(B, S, D)),
            "w_r": _w((lambda *s: torch.randn(*s, dtype=torch.bfloat16) * 0.8)(S, Df) * 0.02),
            "w_i": _w((lambda *s: torch.randn(*s, dtype=torch.bfloat16) * 0.8)(S, Df) * 0.02),
        }
    _B_in = _B_setup()

    return {
        "A_x": _A_in["x"],
        "A_wq": _A_in["wq"],
        "A_wk": _A_in["wk"],
        "A_wv": _A_in["wv"],
        "A_wo": _A_in["wo"],
        "B_x": _B_in["x"],
        "B_w_r": _B_in["w_r"],
        "B_w_i": _B_in["w_i"],
        "gate_w": _w((lambda *s: torch.randn(*s, dtype=torch.bfloat16) * 0.05)(640) * 16.0),
    }

def reference(A_x, A_wq, A_wk, A_wv, A_wo, B_x, B_w_r, B_w_i, gate_w):
    def _A_ref(x, wq, wk, wv, wo):
        B, S, D = x.shape
        H = 32
        Dh = D // H
        q = (lambda x, *d: x.permute(*d))((x @ wq).reshape(B, S, H, Dh), 0, 2, 1, 3)
        k = x @ wk
        v = x @ wv
        scores = torch.einsum("bhqd,bkd->bhqk", q, k) * (Dh ** -0.5)
        p = _softmax(scores, axis=-1)
        o = torch.einsum("bhqk,bkd->bhqd", p, v)
        return (lambda x, *d: x.permute(*d))(o, 0, 2, 1, 3).reshape(B, S, H * Dh) @ wo

    def _B_ref(x, w_r, w_i):
        B, S, D = x.shape
        X = (lambda x, axes=(-2,-1): torch.fft.rfft2(x.float(), dim=axes))(x, axes=(-2, -1))
        W = w_r + 1j * w_i
        X = X * W
        y = (lambda x, s, axes=(-2,-1): torch.fft.irfft2(x, s=s, dim=axes).to(torch.bfloat16))(X, (S, D), axes=(-2, -1))
        return y

    x = A_x
    g = _sigmoid((x * gate_w).sum(-1, keepdims=True))
    a = _A_ref(x, A_wq, A_wk, A_wv, A_wo)
    b = _B_ref(x, B_w_r, B_w_i)
    return g * a + (1 - g) * b
```

```asm
; @launch grid=(256,1,1) block=(512,1,1) lds=163840
.amdgcn_target "amdgcn-amd-amdhsa--gfx950"
.text
.globl gated_mix__grouped_kv_mqa__spectral_gfnet__prompt_kernel
.p2align 8
.type gated_mix__grouped_kv_mqa__spectral_gfnet__prompt_kernel,@function
gated_mix__grouped_kv_mqa__spectral_gfnet__prompt_kernel:
  s_cmp_ge_u32 s2, 256
  s_cbranch_scc1 gated_mix__grouped_kv_mqa__spectral_gfnet__prompt_kernel_end
  s_load_dwordx8 s[48:55], s[0:1], 0
  s_load_dwordx2 s[56:57], s[0:1], 32
  s_load_dwordx4 s[60:63], s[0:1], 48
  s_load_dwordx4 s[64:67], s[0:1], 64
  s_load_dwordx2 s[68:69], s[0:1], 88
  v_and_b32 v1, 63, v0
  v_lshrrev_b32 v2, 6, v0
  s_lshr_b32 s74, s2, 3
  s_and_b32 s45, s74, 28
  s_and_b32 s75, s2, 3
  s_or_b32 s45, s45, s75
  s_and_b32 s46, s2, 4
  s_and_b32 s75, s74, 3
  s_or_b32 s46, s46, s75
  v_readfirstlane_b32 s44, v2
  s_getpc_b64 s[72:73]
gated_mix__grouped_kv_mqa__spectral_gfnet__prompt_kernel_pc:
  s_add_u32 s72, s72, gated_mix__grouped_kv_mqa__spectral_gfnet__prompt_kernel_tbl-gated_mix__grouped_kv_mqa__spectral_gfnet__prompt_kernel_pc
  s_addc_u32 s73, s73, 0
  s_waitcnt lgkmcnt(0)
  s_mov_b32 s4, s48
  s_mov_b32 s5, s49
  s_mov_b32 s6, 2621440
  s_mov_b32 s7, 0x20000
  s_mov_b32 s8, s50
  s_mov_b32 s9, s51
  s_mov_b32 s10, 819200
  s_mov_b32 s11, 0x20000
  s_mov_b32 s12, s52
  s_mov_b32 s13, s53
  s_mov_b32 s14, 25600
  s_mov_b32 s15, 0x20000
  s_mov_b32 s16, s54
  s_mov_b32 s17, s55
  s_mov_b32 s18, 25600
  s_mov_b32 s19, 0x20000
  s_mov_b32 s20, s56
  s_mov_b32 s21, s57
  s_mov_b32 s22, 819200
  s_mov_b32 s23, 0x20000
  s_mov_b32 s24, s60
  s_mov_b32 s25, s61
  s_mov_b32 s26, 1314816
  s_mov_b32 s27, 0x20000
  s_mov_b32 s28, s62
  s_mov_b32 s29, s63
  s_mov_b32 s30, 1314816
  s_mov_b32 s31, 0x20000
  s_mov_b32 s32, s64
  s_mov_b32 s33, s65
  s_mov_b32 s34, 1280
  s_mov_b32 s35, 0x20000
  s_mov_b32 s36, s66
  s_mov_b32 s37, s67
  s_mov_b32 s38, 2621440
  s_mov_b32 s39, 0x20000
  s_mov_b32 s40, s68
  s_mov_b32 s41, s69
  s_mov_b32 s42, 16777216
  s_mov_b32 s43, 0x20000
  s_load_dword s47, s[40:41], 0
  s_lshl_b32 s48, s2, 2
  s_add_u32 s48, s48, 89088
  v_mov_b32 v3, s48
  v_mov_b32 v5, s73
  v_add_co_u32 v4, vcc, s72, v3
  v_addc_co_u32 v5, vcc, 0, v5, vcc
  global_load_dword v252, v[4:5], off
  s_lshr_b32 s48, s45, 3
  s_add_u32 s48, s48, s46
  s_mul_i32 s49, s48, 52
  s_lshr_b32 s49, s49, 8
  s_mul_i32 s49, s49, 5
  s_sub_u32 s80, s48, s49
  s_add_u32 s81, s80, 1
  s_cmp_eq_u32 s81, 5
  s_cselect_b32 s81, 0, s81
  s_add_u32 s82, s81, 1
  s_cmp_eq_u32 s82, 5
  s_cselect_b32 s82, 0, s82
  s_add_u32 s83, s82, 1
  s_cmp_eq_u32 s83, 5
  s_cselect_b32 s83, 0, s83
  s_add_u32 s84, s83, 1
  s_cmp_eq_u32 s84, 5
  s_cselect_b32 s84, 0, s84
  s_mul_i32 s85, s44, 2176
  s_mul_i32 s86, s44, 3072
  s_mov_b32 s48, 252645136
  s_mul_i32 s49, s45, 81920
  s_mul_i32 s50, s44, 136
  s_add_u32 s51, s50, 0
  v_add_u32 v3, s51, v1
  v_mul_hi_u32 v4, v3, s48
  v_mul_u32_u24 v5, 17, v4
  v_sub_u32 v5, v3, v5
  v_min_u32 v5, 15, v5
  v_mul_u32_u24 v4, 1280, v4
  v_lshlrev_b32 v5, 4, v5
  v_add3_u32 v236, v4, v5, s49
  s_add_u32 s51, s50, 64
  v_add_u32 v3, s51, v1
  v_mul_hi_u32 v4, v3, s48
  v_mul_u32_u24 v5, 17, v4
  v_sub_u32 v5, v3, v5
  v_min_u32 v5, 15, v5
  v_mul_u32_u24 v4, 1280, v4
  v_lshlrev_b32 v5, 4, v5
  v_add3_u32 v237, v4, v5, s49
  s_add_u32 s51, s50, 128
  v_add_u32 v3, s51, v1
  v_mul_hi_u32 v4, v3, s48
  v_mul_u32_u24 v5, 17, v4
  v_sub_u32 v5, v3, v5
  v_min_u32 v5, 15, v5
  v_mul_u32_u24 v4, 1280, v4
  v_lshlrev_b32 v5, 4, v5
  v_add3_u32 v238, v4, v5, s49
  s_mov_b32 s48, 357913942
  s_mul_i32 s49, s46, 160
  s_and_b32 s49, s49, 0xffffffc0
  s_mul_i32 s50, s44, 192
  s_add_u32 s51, s50, 0
  v_add_u32 v3, s51, v1
  v_mul_hi_u32 v4, v3, s48
  v_mul_u32_u24 v5, 12, v4
  v_sub_u32 v5, v3, v5
  v_mul_u32_u24 v4, 1280, v4
  v_lshlrev_b32 v5, 4, v5
  v_add3_u32 v240, v4, v5, s49
  s_add_u32 s51, s50, 64
  v_add_u32 v3, s51, v1
  v_mul_hi_u32 v4, v3, s48
  v_mul_u32_u24 v5, 12, v4
  v_sub_u32 v5, v3, v5
  v_mul_u32_u24 v4, 1280, v4
  v_lshlrev_b32 v5, 4, v5
  v_add3_u32 v241, v4, v5, s49
  s_add_u32 s51, s50, 128
  v_add_u32 v3, s51, v1
  v_mul_hi_u32 v4, v3, s48
  v_mul_u32_u24 v5, 12, v4
  v_sub_u32 v5, v3, v5
  v_mul_u32_u24 v4, 1280, v4
  v_lshlrev_b32 v5, 4, v5
  v_add3_u32 v242, v4, v5, s49
  s_cmp_eq_u32 s46, 0
  s_cbranch_scc1 gated_mix__grouped_kv_mqa__spectral_gfnet__prompt_kernel_KV1
  s_lshr_b32 s48, s2, 6
  s_and_b32 s49, s2, 63
  s_lshr_b32 s50, s48, 1
  s_and_b32 s51, s48, 1
  s_lshl_b32 s50, s50, 4
  s_lshl_b32 s51, s51, 2
  s_add_u32 s50, s50, s51
  s_lshr_b32 s51, s44, 2
  s_lshl_b32 s51, s51, 3
  s_add_u32 s50, s50, s51
  s_and_b32 s51, s44, 3
  s_add_u32 s50, s50, s51
  s_lshl_b32 s50, s50, 6
  s_add_u32 s50, s50, s49
  s_mul_i32 s50, s50, 1280
  v_lshlrev_b32 v3, 4, v1
  s_mul_i32 s51, s44, 1296
  s_add_u32 m0, s51, 138240
  s_nop 0
  buffer_load_dwordx4 v3, s[4:7], s50 offen lds
  s_add_u32 m0, s51, 139264
  s_add_u32 s50, s50, 1024
  s_mov_b64 exec, 0xffff
  buffer_load_dwordx4 v3, s[4:7], s50 offen lds
  s_mov_b64 exec, -1
  s_add_u32 s48, s44, 0
  s_min_u32 s48, s48, 12
  s_lshl_b32 s48, s48, 10
  v_add_u32 v4, s48, v3
  v_mov_b32 v5, s73
  v_add_co_u32 v4, vcc, s72, v4
  v_addc_co_u32 v5, vcc, 0, v5, vcc
  s_add_u32 m0, s48, 148608
  s_nop 0
  global_load_lds_dwordx4 v[4:5], off
  s_add_u32 s48, s44, 8
  s_min_u32 s48, s48, 12
  s_lshl_b32 s48, s48, 10
  v_add_u32 v4, s48, v3
  v_mov_b32 v5, s73
  v_add_co_u32 v4, vcc, s72, v4
  v_addc_co_u32 v5, vcc, 0, v5, vcc
  s_add_u32 m0, s48, 148608
  s_nop 0
  global_load_lds_dwordx4 v[4:5], off
  s_and_b32 s48, s2, 31
  s_lshr_b32 s49, s2, 5
  s_lshl_b32 s50, s49, 8
  s_add_u32 s50, s50, s48
  s_lshl_b32 s51, s44, 1
  s_and_b32 s51, s51, 7
  s_lshl_b32 s51, s51, 5
  s_add_u32 s50, s50, s51
  s_cmp_ge_u32 s44, 4
  s_cbranch_scc1 gated_mix__grouped_kv_mqa__spectral_gfnet__prompt_kernel_wi3
  s_add_u32 s52, s50, 0
  s_mul_i32 s52, s52, 642
  s_and_b32 s52, s52, 0xfffffffc
  s_lshl_b32 s53, s44, 1
  s_add_u32 s53, s53, 0
  s_mul_i32 s53, s53, 672
  s_add_u32 m0, s53, 83968
  s_mov_b32 exec_lo, -1
  s_mov_b32 exec_hi, 0x1ff
  buffer_load_dwordx4 v3, s[24:27], s52 offen lds
  s_mov_b64 exec, -1
  s_add_u32 s52, s50, 32
  s_mul_i32 s52, s52, 642
  s_and_b32 s52, s52, 0xfffffffc
  s_lshl_b32 s53, s44, 1
  s_add_u32 s53, s53, 1
  s_mul_i32 s53, s53, 672
  s_add_u32 m0, s53, 83968
  s_mov_b32 exec_lo, -1
  s_mov_b32 exec_hi, 0x1ff
  buffer_load_dwordx4 v3, s[24:27], s52 offen lds
  s_mov_b64 exec, -1
  s_branch gated_mix__grouped_kv_mqa__spectral_gfnet__prompt_kernel_wd4
gated_mix__grouped_kv_mqa__spectral_gfnet__prompt_kernel_wi3:
  s_add_u32 s52, s50, 0
  s_mul_i32 s52, s52, 642
  s_and_b32 s52, s52, 0xfffffffc
  s_lshl_b32 s53, s44, 1
  s_add_u32 s53, s53, 0
  s_mul_i32 s53, s53, 672
  s_add_u32 m0, s53, 83968
  s_mov_b32 exec_lo, -1
  s_mov_b32 exec_hi, 0x1ff
  buffer_load_dwordx4 v3, s[28:31], s52 offen lds
  s_mov_b64 exec, -1
  s_add_u32 s52, s50, 32
  s_mul_i32 s52, s52, 642
  s_and_b32 s52, s52, 0xfffffffc
  s_lshl_b32 s53, s44, 1
  s_add_u32 s53, s53, 1
  s_mul_i32 s53, s53, 672
  s_add_u32 m0, s53, 83968
  s_mov_b32 exec_lo, -1
  s_mov_b32 exec_hi, 0x1ff
  buffer_load_dwordx4 v3, s[28:31], s52 offen lds
  s_mov_b64 exec, -1
gated_mix__grouped_kv_mqa__spectral_gfnet__prompt_kernel_wd4:
  s_mul_i32 s51, s44, 160
  v_lshlrev_b32 v3, 4, v1
  v_add_u32 v3, s51, v3
  s_add_u32 m0, s51, 161920
  s_mov_b64 exec, 0x3ff
  buffer_load_dwordx4 v3, s[32:35], 0 offen lds
  s_mov_b64 exec, -1
  s_add_u32 m0, s85, 0
  s_lshl_b32 s52, s80, 8
  buffer_load_dwordx4 v236, s[4:7], s52 offen lds
  s_add_u32 m0, s85, 1024
  s_lshl_b32 s52, s80, 8
  buffer_load_dwordx4 v237, s[4:7], s52 offen lds
  s_add_u32 m0, s85, 2048
  s_lshl_b32 s52, s80, 8
  s_mov_b64 exec, 0xff
  buffer_load_dwordx4 v238, s[4:7], s52 offen lds
  s_mov_b64 exec, -1
  s_mul_i32 s52, s80, 163840
  s_add_u32 m0, s86, 17408
  s_nop 0
  buffer_load_dwordx4 v240, s[8:11], s52 offen lds
  s_mul_i32 s52, s80, 163840
  s_add_u32 m0, s86, 18432
  s_nop 0
  buffer_load_dwordx4 v241, s[8:11], s52 offen lds
  s_mul_i32 s52, s80, 163840
  s_add_u32 m0, s86, 19456
  s_nop 0
  buffer_load_dwordx4 v242, s[8:11], s52 offen lds
  s_add_u32 m0, s85, 41984
  s_lshl_b32 s52, s81, 8
  buffer_load_dwordx4 v236, s[4:7], s52 offen lds
  s_add_u32 m0, s85, 43008
  s_lshl_b32 s52, s81, 8
  buffer_load_dwordx4 v237, s[4:7], s52 offen lds
  s_add_u32 m0, s85, 44032
  s_lshl_b32 s52, s81, 8
  s_mov_b64 exec, 0xff
  buffer_load_dwordx4 v238, s[4:7], s52 offen lds
  s_mov_b64 exec, -1
  s_mul_i32 s52, s81, 163840
  s_add_u32 m0, s86, 59392
  s_nop 0
  buffer_load_dwordx4 v240, s[8:11], s52 offen lds
  s_mul_i32 s52, s81, 163840
  s_add_u32 m0, s86, 60416
  s_nop 0
  buffer_load_dwordx4 v241, s[8:11], s52 offen lds
  s_mul_i32 s52, s81, 163840
  s_add_u32 m0, s86, 61440
  s_nop 0
  buffer_load_dwordx4 v242, s[8:11], s52 offen lds
  s_waitcnt lgkmcnt(0)
  s_add_u32 s47, s47, 1
  s_waitcnt vmcnt(13)
  s_barrier
  v_lshlrev_b32 v3, 4, v1
  v_add_u32 v3, 148608, v3
  ds_read_b128 v[100:103], v3 offset:0
  ds_read_b128 v[108:111], v3 offset:1024
  ds_read_b128 v[104:107], v3 offset:2048
  ds_read_b128 v[112:115], v3 offset:3072
  ds_read_b128 v[116:119], v3 offset:4096
  ds_read_b128 v[128:131], v3 offset:5120
  ds_read_b128 v[120:123], v3 offset:6144
  ds_read_b128 v[132:135], v3 offset:7168
  ds_read_b128 v[124:127], v3 offset:8192
  ds_read_b128 v[136:139], v3 offset:9216
  ds_read_b128 v[140:143], v3 offset:10240
  ds_read_b128 v[144:147], v3 offset:11264
  ds_read_b128 v[148:151], v3 offset:12288
  s_and_b32 s48, s2, 1
  s_lshl_b32 s48, s48, 1
  s_add_u32 s48, s48, 83968
  v_min_u32 v3, 0x140, v0
  v_lshlrev_b32 v3, 1, v3
  v_add_u32 v3, s48, v3
  ds_read_u16 v160, v3 offset:0
  ds_read_u16 v161, v3 offset:672
  ds_read_u16 v162, v3 offset:1344
  ds_read_u16 v163, v3 offset:2016
  ds_read_u16 v164, v3 offset:2688
  ds_read_u16 v165, v3 offset:3360
  ds_read_u16 v166, v3 offset:4032
  ds_read_u16 v167, v3 offset:4704
  ds_read_u16 v168, v3 offset:5376
  ds_read_u16 v169, v3 offset:6048
  ds_read_u16 v170, v3 offset:6720
  ds_read_u16 v171, v3 offset:7392
  ds_read_u16 v172, v3 offset:8064
  ds_read_u16 v173, v3 offset:8736
  ds_read_u16 v174, v3 offset:9408
  ds_read_u16 v175, v3 offset:10080
  v_and_b32 v3, 31, v1
  v_lshrrev_b32 v4, 5, v1
  v_and_b32 v8, 15, v1
  v_lshrrev_b32 v9, 2, v8
  v_lshl_add_u32 v9, v4, 3, v9
  v_mul_u32_u24 v9, 40, v9
  v_and_b32 v8, 3, v8
  v_lshl_add_u32 v9, v8, 3, v9
  v_bfe_u32 v8, v1, 4, 1
  v_lshl_add_u32 v9, v8, 5, v9
  s_mul_i32 s51, s44, 1296
  s_add_u32 s51, s51, 138240
  v_add_u32 v9, s51, v9
  ds_read_b64_tr_b16 v[16:17], v9 offset:0
  ds_read_b64_tr_b16 v[18:19], v9 offset:160
  ds_read_b64_tr_b16 v[20:21], v9 offset:640
  ds_read_b64_tr_b16 v[22:23], v9 offset:800
  v_cmp_eq_u32 s[62:63], 0, v4
  s_waitcnt lgkmcnt(0)
  v_mfma_f32_32x32x16_bf16 v[24:39], v[16:19], v[100:103], 0
  v_mfma_f32_32x32x16_bf16 v[40:55], v[16:19], v[108:111], 0
  v_mfma_f32_32x32x16_bf16 v[24:39], v[20:23], v[104:107], v[24:39]
  v_mfma_f32_32x32x16_bf16 v[40:55], v[20:23], v[112:115], v[40:55]
  s_nop 15
  v_pk_mul_f32 v[56:57], v[24:25], v[116:117]
  v_pk_mul_f32 v[68:69], v[40:41], v[116:117]
  v_pk_fma_f32 v[56:57], v[40:41], v[128:129], v[56:57]
  v_pk_fma_f32 v[68:69], v[24:25], v[128:129], v[68:69] neg_lo:[1,0,0] neg_hi:[1,0,0]
  v_pk_mul_f32 v[58:59], v[26:27], v[118:119]
  v_pk_mul_f32 v[70:71], v[42:43], v[118:119]
  v_pk_fma_f32 v[58:59], v[42:43], v[130:131], v[58:59]
  v_pk_fma_f32 v[70:71], v[26:27], v[130:131], v[70:71] neg_lo:[1,0,0] neg_hi:[1,0,0]
  v_pk_mul_f32 v[60:61], v[28:29], v[120:121]
  v_pk_mul_f32 v[72:73], v[44:45], v[120:121]
  v_pk_fma_f32 v[60:61], v[44:45], v[132:133], v[60:61]
  v_pk_fma_f32 v[72:73], v[28:29], v[132:133], v[72:73] neg_lo:[1,0,0] neg_hi:[1,0,0]
  v_pk_mul_f32 v[62:63], v[30:31], v[122:123]
  v_pk_mul_f32 v[74:75], v[46:47], v[122:123]
  v_pk_fma_f32 v[62:63], v[46:47], v[134:135], v[62:63]
  v_pk_fma_f32 v[74:75], v[30:31], v[134:135], v[74:75] neg_lo:[1,0,0] neg_hi:[1,0,0]
  v_pk_mul_f32 v[64:65], v[32:33], v[124:125]
  v_pk_mul_f32 v[76:77], v[48:49], v[124:125]
  v_pk_fma_f32 v[64:65], v[48:49], v[136:137], v[64:65]
  v_pk_fma_f32 v[76:77], v[32:33], v[136:137], v[76:77] neg_lo:[1,0,0] neg_hi:[1,0,0]
  v_pk_mul_f32 v[66:67], v[34:35], v[126:127]
  v_pk_mul_f32 v[78:79], v[50:51], v[126:127]
  v_pk_fma_f32 v[66:67], v[50:51], v[138:139], v[66:67]
  v_pk_fma_f32 v[78:79], v[34:35], v[138:139], v[78:79] neg_lo:[1,0,0] neg_hi:[1,0,0]
  v_cvt_pk_bf16_f32 v80, v56, v57
  v_cvt_pk_bf16_f32 v86, v68, v69
  v_cvt_pk_bf16_f32 v81, v58, v59
  v_cvt_pk_bf16_f32 v87, v70, v71
  v_cvt_pk_bf16_f32 v82, v60, v61
  v_cvt_pk_bf16_f32 v88, v72, v73
  v_cvt_pk_bf16_f32 v83, v62, v63
  v_cvt_pk_bf16_f32 v89, v74, v75
  v_cvt_pk_bf16_f32 v84, v64, v65
  v_cvt_pk_bf16_f32 v90, v76, v77
  v_cvt_pk_bf16_f32 v85, v66, v67
  v_cvt_pk_bf16_f32 v91, v78, v79
  v_cndmask_b32 v84, 0, v84, s[62:63]
  v_cndmask_b32 v90, 0, v90, s[62:63]
  v_cndmask_b32 v85, 0, v85, s[62:63]
  v_cndmask_b32 v91, 0, v91, s[62:63]
  s_nop 1
  v_mfma_f32_32x32x16_bf16 v[176:191], v[140:143], v[80:83], 0
  v_mfma_f32_32x32x16_bf16 v[176:191], v[144:147], v[86:89], v[176:191]
  v_mfma_f32_32x32x8_bf16 v[176:191], v[148:149], v[84:85], v[176:191]
  v_mfma_f32_32x32x8_bf16 v[176:191], v[150:151], v[90:91], v[176:191]
  s_nop 15
  v_cvt_pk_bf16_f32 v56, v176, v177
  v_cvt_pk_bf16_f32 v57, v178, v179
  v_cvt_pk_bf16_f32 v58, v180, v181
  v_cvt_pk_bf16_f32 v59, v182, v183
  v_cvt_pk_bf16_f32 v60, v184, v185
  v_cvt_pk_bf16_f32 v61, v186, v187
  v_and_b32 v3, 31, v1
  v_lshrrev_b32 v4, 5, v1
  v_lshl_add_u32 v10, v4, 6, v3
  v_lshlrev_b32 v10, 2, v10
  s_mul_i32 s51, s44, 1296
  s_add_u32 s51, s51, 138240
  v_add_u32 v10, s51, v10
  ds_write_b32 v10, v56 offset:0
  ds_write_b32 v10, v57 offset:128
  ds_write_b32 v10, v58 offset:512
  ds_write_b32 v10, v59 offset:640
  s_mov_b32 exec_hi, 1
  ds_write_b32 v10, v60 offset:1024
  s_mov_b32 exec_hi, 0
  ds_write_b32 v10, v61 offset:1152
  s_mov_b64 exec, -1
  s_waitcnt lgkmcnt(0)
  s_barrier
  v_cmp_gt_u32 vcc, 0x141, v0
  s_and_saveexec_b64 s[56:57], vcc
  v_lshlrev_b32 v3, 2, v0
  v_add_u32 v3, 138240, v3
  ds_read_b32 v16, v3 offset:0
  ds_read_b32 v17, v3 offset:1296
  ds_read_b32 v18, v3 offset:2592
  ds_read_b32 v19, v3 offset:3888
  ds_read_b32 v20, v3 offset:5184
  ds_read_b32 v21, v3 offset:6480
  ds_read_b32 v22, v3 offset:7776
  ds_read_b32 v23, v3 offset:9072
  v_cmp_eq_u32 vcc, 0, v0
  v_mov_b32 v4, 0x140
  v_cmp_eq_u32 s[58:59], v4, v0
  s_or_b64 vcc, vcc, s[58:59]
  v_mov_b32 v5, 1.0
  v_mov_b32 v6, 0.5
  v_cndmask_b32 v5, v5, v6, vcc
  v_lshlrev_b32 v160, 16, v160
  v_lshlrev_b32 v168, 16, v168
  v_mul_f32 v160, v160, v5
  v_mul_f32 v168, v168, v5
  v_cvt_pk_bf16_f32 v160, v160, v168
  v_lshlrev_b32 v161, 16, v161
  v_lshlrev_b32 v169, 16, v169
  v_mul_f32 v161, v161, v5
  v_mul_f32 v169, v169, v5
  v_cvt_pk_bf16_f32 v161, v161, v169
  v_lshlrev_b32 v162, 16, v162
  v_lshlrev_b32 v170, 16, v170
  v_mul_f32 v162, v162, v5
  v_mul_f32 v170, v170, v5
  v_cvt_pk_bf16_f32 v162, v162, v170
  v_lshlrev_b32 v163, 16, v163
  v_lshlrev_b32 v171, 16, v171
  v_mul_f32 v163, v163, v5
  v_mul_f32 v171, v171, v5
  v_cvt_pk_bf16_f32 v163, v163, v171
  v_lshlrev_b32 v164, 16, v164
  v_lshlrev_b32 v172, 16, v172
  v_mul_f32 v164, v164, v5
  v_mul_f32 v172, v172, v5
  v_cvt_pk_bf16_f32 v164, v164, v172
  v_lshlrev_b32 v165, 16, v165
  v_lshlrev_b32 v173, 16, v173
  v_mul_f32 v165, v165, v5
  v_mul_f32 v173, v173, v5
  v_cvt_pk_bf16_f32 v165, v165, v173
  v_lshlrev_b32 v166, 16, v166
  v_lshlrev_b32 v174, 16, v174
  v_mul_f32 v166, v166, v5
  v_mul_f32 v174, v174, v5
  v_cvt_pk_bf16_f32 v166, v166, v174
  v_lshlrev_b32 v167, 16, v167
  v_lshlrev_b32 v175, 16, v175
  v_mul_f32 v167, v167, v5
  v_mul_f32 v175, v175, v5
  v_cvt_pk_bf16_f32 v167, v167, v175
  s_mul_i32 s50, s2, 20736
  s_add_u32 s50, s50, 4194304
  v_lshlrev_b32 v4, 4, v0
  s_add_u32 s51, s50, 10368
  buffer_store_dwordx4 v[160:163], v4, s[40:43], s51 offen sc1
  s_add_u32 s51, s50, 15552
  buffer_store_dwordx4 v[164:167], v4, s[40:43], s51 offen sc1
  s_mov_b32 s52, 0x05040100
  s_mov_b32 s53, 0x07060302
  s_waitcnt lgkmcnt(0)
  v_perm_b32 v24, v17, v16, s52
  v_perm_b32 v28, v17, v16, s53
  v_perm_b32 v25, v19, v18, s52
  v_perm_b32 v29, v19, v18, s53
  v_perm_b32 v26, v21, v20, s52
  v_perm_b32 v30, v21, v20, s53
  v_perm_b32 v27, v23, v22, s52
  v_perm_b32 v31, v23, v22, s53
  buffer_store_dwordx4 v[24:27], v4, s[40:43], s50 offen sc1
  s_add_u32 s51, s50, 5184
  buffer_store_dwordx4 v[28:31], v4, s[40:43], s51 offen sc1
  s_mov_b64 exec, s[56:57]
  s_and_b32 s48, s44, 1
  s_lshr_b32 s49, s44, 1
  v_and_b32 v3, 31, v1
  v_lshrrev_b32 v4, 5, v1
  s_lshl_b32 s51, s48, 5
  v_add_u32 v5, s51, v3
  v_mul_u32_u24 v5, 272, v5
  v_lshl_add_u32 v8, v4, 4, v5
  v_and_b32 v5, 15, v1
  v_lshrrev_b32 v6, 2, v5
  v_lshl_add_u32 v6, v4, 3, v6
  v_mul_u32_u24 v6, 192, v6
  v_and_b32 v5, 3, v5
  v_lshlrev_b32 v5, 3, v5
  v_bfe_u32 v7, v1, 4, 1
  v_lshlrev_b32 v7, 5, v7
  v_add3_u32 v6, v6, v5, v7
  s_mul_i32 s51, s49, 40
  s_and_b32 s52, s46, 1
  s_lshl_b32 s52, s52, 5
  s_add_u32 s51, s51, s52
  v_add_u32 v9, s51, v6
  s_lshl_b32 s51, s49, 5
  s_add_u32 s51, s51, 161920
  v_lshl_add_u32 v14, v4, 4, s51
  s_lshl_b32 s60, s49, 5
  v_add_u32 v10, s60, v8
  s_waitcnt vmcnt(10)
  s_barrier
  v_add_u32 v12, 0, v8
  v_add_u32 v13, 17408, v9
  ds_read_b128 v[48:51], v12 offset:0
  ds_read_b64_tr_b16 v[64:65], v13 offset:0
  ds_read_b64_tr_b16 v[66:67], v13 offset:768
  s_lshl_b32 s51, s80, 8
  v_add_u32 v15, s51, v14
  v_add_u32 v11, 0, v10
  ds_read_b128 v[176:179], v15 offset:0
  ds_read_b128 v[184:187], v11 offset:0
  ds_read_b128 v[180:183], v15 offset:128
  ds_read_b128 v[188:191], v11 offset:128
  ds_read_b128 v[52:55], v12 offset:32
  ds_read_b64_tr_b16 v[68:69], v13 offset:3072
  ds_read_b64_tr_b16 v[70:71], v13 offset:3840
  ds_read_b128 v[56:59], v12 offset:64
  ds_read_b64_tr_b16 v[72:73], v13 offset:6144
  ds_read_b64_tr_b16 v[74:75], v13 offset:6912
  ds_read_b128 v[60:63], v12 offset:96
  ds_read_b64_tr_b16 v[76:77], v13 offset:9216
  ds_read_b64_tr_b16 v[78:79], v13 offset:9984
  s_waitcnt lgkmcnt(13)
  v_mfma_f32_32x32x16_bf16 v[16:31], v[64:67], v[48:51], 0
  s_add_u32 m0, s85, 83968
  s_lshl_b32 s52, s82, 8
  buffer_load_dwordx4 v236, s[4:7], s52 offen lds
  s_add_u32 m0, s85, 84992
  s_lshl_b32 s52, s82, 8
  buffer_load_dwordx4 v237, s[4:7], s52 offen lds
  ds_read_b128 v[48:51], v12 offset:128
  ds_read_b64_tr_b16 v[64:65], v13 offset:12288
  ds_read_b64_tr_b16 v[66:67], v13 offset:13056
  s_waitcnt lgkmcnt(9)
  v_mfma_f32_32x32x16_bf16 v[16:31], v[68:71], v[52:55], v[16:31]
  s_add_u32 m0, s85, 86016
  s_lshl_b32 s52, s82, 8
  s_mov_b64 exec, 0xff
  buffer_load_dwordx4 v238, s[4:7], s52 offen lds
  s_mov_b64 exec, -1
  ds_read_b128 v[52:55], v12 offset:160
  ds_read_b64_tr_b16 v[68:69], v13 offset:15360
  ds_read_b64_tr_b16 v[70:71], v13 offset:16128
  s_waitcnt lgkmcnt(9)
  v_mfma_f32_32x32x16_bf16 v[16:31], v[72:75], v[56:59], v[16:31]
  v_mfma_f32_32x32x16_bf16 v[32:47], v[176:179], v[184:187], 0
  s_mul_i32 s52, s82, 163840
  s_add_u32 m0, s86, 101376
  s_nop 0
  buffer_load_dwordx4 v240, s[8:11], s52 offen lds
  ds_read_b128 v[56:59], v12 offset:192
  ds_read_b64_tr_b16 v[72:73], v13 offset:18432
  ds_read_b64_tr_b16 v[74:75], v13 offset:19200
  s_waitcnt lgkmcnt(9)
  v_mfma_f32_32x32x16_bf16 v[16:31], v[76:79], v[60:63], v[16:31]
  s_mul_i32 s52, s82, 163840
  s_add_u32 m0, s86, 102400
  s_nop 0
  buffer_load_dwordx4 v241, s[8:11], s52 offen lds
  ds_read_b128 v[60:63], v12 offset:224
  ds_read_b64_tr_b16 v[76:77], v13 offset:21504
  ds_read_b64_tr_b16 v[78:79], v13 offset:22272
  s_waitcnt lgkmcnt(9)
  v_mfma_f32_32x32x16_bf16 v[16:31], v[64:67], v[48:51], v[16:31]
  v_mfma_f32_32x32x16_bf16 v[32:47], v[180:183], v[188:191], v[32:47]
  s_mul_i32 s52, s82, 163840
  s_add_u32 m0, s86, 103424
  s_nop 0
  buffer_load_dwordx4 v242, s[8:11], s52 offen lds
  s_waitcnt vmcnt(10) lgkmcnt(0)
  s_barrier
  v_add_u32 v12, 41984, v8
  v_add_u32 v13, 59392, v9
  ds_read_b128 v[48:51], v12 offset:0
  ds_read_b64_tr_b16 v[64:65], v13 offset:0
  ds_read_b64_tr_b16 v[66:67], v13 offset:768
  s_lshl_b32 s51, s81, 8
  v_add_u32 v15, s51, v14
  v_add_u32 v11, 41984, v10
  ds_read_b128 v[192:195], v15 offset:0
  ds_read_b128 v[200:203], v11 offset:0
  ds_read_b128 v[196:199], v15 offset:128
  ds_read_b128 v[204:207], v11 offset:128
  v_mfma_f32_32x32x16_bf16 v[16:31], v[68:71], v[52:55], v[16:31]
  s_add_u32 m0, s85, 0
  s_lshl_b32 s52, s83, 8
  buffer_load_dwordx4 v236, s[4:7], s52 offen lds
  ds_read_b128 v[52:55], v12 offset:32
  ds_read_b64_tr_b16 v[68:69], v13 offset:3072
  ds_read_b64_tr_b16 v[70:71], v13 offset:3840
  v_mfma_f32_32x32x16_bf16 v[16:31], v[72:75], v[56:59], v[16:31]
  s_add_u32 m0, s85, 1024
  s_lshl_b32 s52, s83, 8
  buffer_load_dwordx4 v237, s[4:7], s52 offen lds
  ds_read_b128 v[56:59], v12 offset:64
  ds_read_b64_tr_b16 v[72:73], v13 offset:6144
  ds_read_b64_tr_b16 v[74:75], v13 offset:6912
  v_mfma_f32_32x32x16_bf16 v[16:31], v[76:79], v[60:63], v[16:31]
  s_add_u32 m0, s85, 2048
  s_lshl_b32 s52, s83, 8
  s_mov_b64 exec, 0xff
  buffer_load_dwordx4 v238, s[4:7], s52 offen lds
  s_mov_b64 exec, -1
  ds_read_b128 v[60:63], v12 offset:96
  ds_read_b64_tr_b16 v[76:77], v13 offset:9216
  ds_read_b64_tr_b16 v[78:79], v13 offset:9984
  s_waitcnt lgkmcnt(13)
  v_mfma_f32_32x32x16_bf16 v[16:31], v[64:67], v[48:51], v[16:31]
  s_mul_i32 s52, s83, 163840
  s_add_u32 m0, s86, 17408
  s_nop 0
  buffer_load_dwordx4 v240, s[8:11], s52 offen lds
  ds_read_b128 v[48:51], v12 offset:128
  ds_read_b64_tr_b16 v[64:65], v13 offset:12288
  ds_read_b64_tr_b16 v[66:67], v13 offset:13056
  s_waitcnt lgkmcnt(9)
  v_mfma_f32_32x32x16_bf16 v[16:31], v[68:71], v[52:55], v[16:31]
  s_mul_i32 s52, s83, 163840
  s_add_u32 m0, s86, 18432
  s_nop 0
  buffer_load_dwordx4 v241, s[8:11], s52 offen lds
  ds_read_b128 v[52:55], v12 offset:160
  ds_read_b64_tr_b16 v[68:69], v13 offset:15360
  ds_read_b64_tr_b16 v[70:71], v13 offset:16128
  s_waitcnt lgkmcnt(9)
  v_mfma_f32_32x32x16_bf16 v[16:31], v[72:75], v[56:59], v[16:31]
  v_mfma_f32_32x32x16_bf16 v[32:47], v[192:195], v[200:203], v[32:47]
  s_mul_i32 s52, s83, 163840
  s_add_u32 m0, s86, 19456
  s_nop 0
  buffer_load_dwordx4 v242, s[8:11], s52 offen lds
  ds_read_b128 v[56:59], v12 offset:192
  ds_read_b64_tr_b16 v[72:73], v13 offset:18432
  ds_read_b64_tr_b16 v[74:75], v13 offset:19200
  s_waitcnt lgkmcnt(9)
  v_mfma_f32_32x32x16_bf16 v[16:31], v[76:79], v[60:63], v[16:31]
  ds_read_b128 v[60:63], v12 offset:224
  ds_read_b64_tr_b16 v[76:77], v13 offset:21504
  ds_read_b64_tr_b16 v[78:79], v13 offset:22272
  s_waitcnt lgkmcnt(9)
  v_mfma_f32_32x32x16_bf16 v[16:31], v[64:67], v[48:51], v[16:31]
  v_mfma_f32_32x32x16_bf16 v[32:47], v[196:199], v[204:207], v[32:47]
  s_waitcnt vmcnt(6) lgkmcnt(0)
  s_barrier
  s_cmp_lg_u32 s44, 0
  s_cbranch_scc1 gated_mix__grouped_kv_mqa__spectral_gfnet__prompt_kernel_FX5
  s_mov_b32 s74, s2
  s_lshl_b32 s54, s74, 2
  s_add_u32 s54, s54, 8192
  v_mov_b32 v5, s47
  v_mov_b32 v6, 0
  s_mov_b64 s[56:57], exec
  s_mov_b64 exec, 1
  buffer_store_dword v5, v6, s[40:43], s54 offen sc1
  s_mov_b64 exec, s[56:57]
gated_mix__grouped_kv_mqa__spectral_gfnet__prompt_kernel_FX5:
  v_add_u32 v12, 83968, v8
  v_add_u32 v13, 101376, v9
  ds_read_b128 v[48:51], v12 offset:0
  ds_read_b64_tr_b16 v[64:65], v13 offset:0
  ds_read_b64_tr_b16 v[66:67], v13 offset:768
  s_lshl_b32 s51, s82, 8
  v_add_u32 v15, s51, v14
  v_add_u32 v11, 83968, v10
  ds_read_b128 v[176:179], v15 offset:0
  ds_read_b128 v[184:187], v11 offset:0
  ds_read_b128 v[180:183], v15 offset:128
  ds_read_b128 v[188:191], v11 offset:128
  v_mfma_f32_32x32x16_bf16 v[16:31], v[68:71], v[52:55], v[16:31]
  s_add_u32 m0, s85, 41984
  s_lshl_b32 s52, s84, 8
  buffer_load_dwordx4 v236, s[4:7], s52 offen lds
  ds_read_b128 v[52:55], v12 offset:32
  ds_read_b64_tr_b16 v[68:69], v13 offset:3072
  ds_read_b64_tr_b16 v[70:71], v13 offset:3840
  v_mfma_f32_32x32x16_bf16 v[16:31], v[72:75], v[56:59], v[16:31]
  s_add_u32 m0, s85, 43008
  s_lshl_b32 s52, s84, 8
  buffer_load_dwordx4 v237, s[4:7], s52 offen lds
  ds_read_b128 v[56:59], v12 offset:64
  ds_read_b64_tr_b16 v[72:73], v13 offset:6144
  ds_read_b64_tr_b16 v[74:75], v13 offset:6912
  v_mfma_f32_32x32x16_bf16 v[16:31], v[76:79], v[60:63], v[16:31]
  s_add_u32 m0, s85, 44032
  s_lshl_b32 s52, s84, 8
  s_mov_b64 exec, 0xff
  buffer_load_dwordx4 v238, s[4:7], s52 offen lds
  s_mov_b64 exec, -1
  ds_read_b128 v[60:63], v12 offset:96
  ds_read_b64_tr_b16 v[76:77], v13 offset:9216
  ds_read_b64_tr_b16 v[78:79], v13 offset:9984
  s_waitcnt lgkmcnt(13)
  v_mfma_f32_32x32x16_bf16 v[16:31], v[64:67], v[48:51], v[16:31]
  s_mul_i32 s52, s84, 163840
  s_add_u32 m0, s86, 59392
  s_nop 0
  buffer_load_dwordx4 v240, s[8:11], s52 offen lds
  ds_read_b128 v[48:51], v12 offset:128
  ds_read_b64_tr_b16 v[64:65], v13 offset:12288
  ds_read_b64_tr_b16 v[66:67], v13 offset:13056
  s_waitcnt lgkmcnt(9)
  v_mfma_f32_32x32x16_bf16 v[16:31], v[68:71], v[52:55], v[16:31]
  s_mul_i32 s52, s84, 163840
  s_add_u32 m0, s86, 60416
  s_nop 0
  buffer_load_dwordx4 v241, s[8:11], s52 offen lds
  ds_read_b128 v[52:55], v12 offset:160
  ds_read_b64_tr_b16 v[68:69], v13 offset:15360
  ds_read_b64_tr_b16 v[70:71], v13 offset:16128
  s_waitcnt lgkmcnt(9)
  v_mfma_f32_32x32x16_bf16 v[16:31], v[72:75], v[56:59], v[16:31]
  v_mfma_f32_32x32x16_bf16 v[32:47], v[176:179], v[184:187], v[32:47]
  s_mul_i32 s52, s84, 163840
  s_add_u32 m0, s86, 61440
  s_nop 0
  buffer_load_dwordx4 v242, s[8:11], s52 offen lds
  ds_read_b128 v[56:59], v12 offset:192
  ds_read_b64_tr_b16 v[72:73], v13 offset:18432
  ds_read_b64_tr_b16 v[74:75], v13 offset:19200
  s_waitcnt lgkmcnt(9)
  v_mfma_f32_32x32x16_bf16 v[16:31], v[76:79], v[60:63], v[16:31]
  ds_read_b128 v[60:63], v12 offset:224
  ds_read_b64_tr_b16 v[76:77], v13 offset:21504
  ds_read_b64_tr_b16 v[78:79], v13 offset:22272
  s_waitcnt lgkmcnt(9)
  v_mfma_f32_32x32x16_bf16 v[16:31], v[64:67], v[48:51], v[16:31]
  v_mfma_f32_32x32x16_bf16 v[32:47], v[180:183], v[188:191], v[32:47]
  s_waitcnt vmcnt(6) lgkmcnt(0)
  s_barrier
  v_add_u32 v12, 0, v8
  v_add_u32 v13, 17408, v9
  ds_read_b128 v[48:51], v12 offset:0
  ds_read_b64_tr_b16 v[64:65], v13 offset:0
  ds_read_b64_tr_b16 v[66:67], v13 offset:768
  s_lshl_b32 s51, s83, 8
  v_add_u32 v15, s51, v14
  v_add_u32 v11, 0, v10
  ds_read_b128 v[192:195], v15 offset:0
  ds_read_b128 v[200:203], v11 offset:0
  ds_read_b128 v[196:199], v15 offset:128
  ds_read_b128 v[204:207], v11 offset:128
  v_mfma_f32_32x32x16_bf16 v[16:31], v[68:71], v[52:55], v[16:31]
  ds_read_b128 v[52:55], v12 offset:32
  ds_read_b64_tr_b16 v[68:69], v13 offset:3072
  ds_read_b64_tr_b16 v[70:71], v13 offset:3840
  v_mfma_f32_32x32x16_bf16 v[16:31], v[72:75], v[56:59], v[16:31]
  ds_read_b128 v[56:59], v12 offset:64
  ds_read_b64_tr_b16 v[72:73], v13 offset:6144
  ds_read_b64_tr_b16 v[74:75], v13 offset:6912
  v_mfma_f32_32x32x16_bf16 v[16:31], v[76:79], v[60:63], v[16:31]
  ds_read_b128 v[60:63], v12 offset:96
  ds_read_b64_tr_b16 v[76:77], v13 offset:9216
  ds_read_b64_tr_b16 v[78:79], v13 offset:9984
  s_waitcnt lgkmcnt(13)
  v_mfma_f32_32x32x16_bf16 v[16:31], v[64:67], v[48:51], v[16:31]
  ds_read_b128 v[48:51], v12 offset:128
  ds_read_b64_tr_b16 v[64:65], v13 offset:12288
  ds_read_b64_tr_b16 v[66:67], v13 offset:13056
  s_waitcnt lgkmcnt(9)
  v_mfma_f32_32x32x16_bf16 v[16:31], v[68:71], v[52:55], v[16:31]
  ds_read_b128 v[52:55], v12 offset:160
  ds_read_b64_tr_b16 v[68:69], v13 offset:15360
  ds_read_b64_tr_b16 v[70:71], v13 offset:16128
  s_waitcnt lgkmcnt(9)
  v_mfma_f32_32x32x16_bf16 v[16:31], v[72:75], v[56:59], v[16:31]
  v_mfma_f32_32x32x16_bf16 v[32:47], v[192:195], v[200:203], v[32:47]
  ds_read_b128 v[56:59], v12 offset:192
  ds_read_b64_tr_b16 v[72:73], v13 offset:18432
  ds_read_b64_tr_b16 v[74:75], v13 offset:19200
  s_waitcnt lgkmcnt(9)
  v_mfma_f32_32x32x16_bf16 v[16:31], v[76:79], v[60:63], v[16:31]
  ds_read_b128 v[60:63], v12 offset:224
  ds_read_b64_tr_b16 v[76:77], v13 offset:21504
  ds_read_b64_tr_b16 v[78:79], v13 offset:22272
  s_waitcnt lgkmcnt(9)
  v_mfma_f32_32x32x16_bf16 v[16:31], v[64:67], v[48:51], v[16:31]
  v_mfma_f32_32x32x16_bf16 v[32:47], v[196:199], v[204:207], v[32:47]
  s_waitcnt vmcnt(0) lgkmcnt(0)
  s_barrier
  v_add_u32 v12, 41984, v8
  v_add_u32 v13, 59392, v9
  ds_read_b128 v[48:51], v12 offset:0
  ds_read_b64_tr_b16 v[64:65], v13 offset:0
  ds_read_b64_tr_b16 v[66:67], v13 offset:768
  s_lshl_b32 s51, s84, 8
  v_add_u32 v15, s51, v14
  v_add_u32 v11, 41984, v10
  ds_read_b128 v[176:179], v15 offset:0
  ds_read_b128 v[184:187], v11 offset:0
  ds_read_b128 v[180:183], v15 offset:128
  ds_read_b128 v[188:191], v11 offset:128
  v_mfma_f32_32x32x16_bf16 v[16:31], v[68:71], v[52:55], v[16:31]
  ds_read_b128 v[52:55], v12 offset:32
  ds_read_b64_tr_b16 v[68:69], v13 offset:3072
  ds_read_b64_tr_b16 v[70:71], v13 offset:3840
  v_mfma_f32_32x32x16_bf16 v[16:31], v[72:75], v[56:59], v[16:31]
  ds_read_b128 v[56:59], v12 offset:64
  ds_read_b64_tr_b16 v[72:73], v13 offset:6144
  ds_read_b64_tr_b16 v[74:75], v13 offset:6912
  v_mfma_f32_32x32x16_bf16 v[16:31], v[76:79], v[60:63], v[16:31]
  ds_read_b128 v[60:63], v12 offset:96
  ds_read_b64_tr_b16 v[76:77], v13 offset:9216
  ds_read_b64_tr_b16 v[78:79], v13 offset:9984
  s_waitcnt lgkmcnt(13)
  v_mfma_f32_32x32x16_bf16 v[16:31], v[64:67], v[48:51], v[16:31]
  ds_read_b128 v[48:51], v12 offset:128
  ds_read_b64_tr_b16 v[64:65], v13 offset:12288
  ds_read_b64_tr_b16 v[66:67], v13 offset:13056
  s_waitcnt lgkmcnt(9)
  v_mfma_f32_32x32x16_bf16 v[16:31], v[68:71], v[52:55], v[16:31]
  ds_read_b128 v[52:55], v12 offset:160
  ds_read_b64_tr_b16 v[68:69], v13 offset:15360
  ds_read_b64_tr_b16 v[70:71], v13 offset:16128
  s_waitcnt lgkmcnt(9)
  v_mfma_f32_32x32x16_bf16 v[16:31], v[72:75], v[56:59], v[16:31]
  v_mfma_f32_32x32x16_bf16 v[32:47], v[176:179], v[184:187], v[32:47]
  ds_read_b128 v[56:59], v12 offset:192
  ds_read_b64_tr_b16 v[72:73], v13 offset:18432
  ds_read_b64_tr_b16 v[74:75], v13 offset:19200
  s_waitcnt lgkmcnt(9)
  v_mfma_f32_32x32x16_bf16 v[16:31], v[76:79], v[60:63], v[16:31]
  ds_read_b128 v[60:63], v12 offset:224
  ds_read_b64_tr_b16 v[76:77], v13 offset:21504
  ds_read_b64_tr_b16 v[78:79], v13 offset:22272
  s_waitcnt lgkmcnt(9)
  v_mfma_f32_32x32x16_bf16 v[16:31], v[64:67], v[48:51], v[16:31]
  v_mfma_f32_32x32x16_bf16 v[32:47], v[180:183], v[188:191], v[32:47]
  s_waitcnt lgkmcnt(6)
  v_mfma_f32_32x32x16_bf16 v[16:31], v[68:71], v[52:55], v[16:31]
  s_waitcnt lgkmcnt(3)
  v_mfma_f32_32x32x16_bf16 v[16:31], v[72:75], v[56:59], v[16:31]
  s_waitcnt lgkmcnt(0)
  v_mfma_f32_32x32x16_bf16 v[16:31], v[76:79], v[60:63], v[16:31]
  s_cmp_lg_u32 s44, 7
  s_cbranch_scc1 gated_mix__grouped_kv_mqa__spectral_gfnet__prompt_kernel_kp6
  s_and_b32 s53, s2, 7
  s_lshl_b32 s53, s53, 7
  s_add_u32 s53, s53, 4096
  s_mov_b64 s[56:57], exec
  s_mov_b64 exec, 0xffffffff
  v_lshlrev_b32 v4, 2, v1
gated_mix__grouped_kv_mqa__spectral_gfnet__prompt_kernel_poll7:
  buffer_load_dword v5, v4, s[40:43], s53 offen sc1
  s_waitcnt vmcnt(0)
  v_cmp_ne_u32 vcc, s47, v5
  s_cbranch_vccz gated_mix__grouped_kv_mqa__spectral_gfnet__prompt_kernel_polld8
  s_sleep 2
  s_branch gated_mix__grouped_kv_mqa__spectral_gfnet__prompt_kernel_poll7
gated_mix__grouped_kv_mqa__spectral_gfnet__prompt_kernel_polld8:
  s_mov_b64 exec, s[56:57]
gated_mix__grouped_kv_mqa__spectral_gfnet__prompt_kernel_kp6:
  s_branch gated_mix__grouped_kv_mqa__spectral_gfnet__prompt_kernel_JQ2
gated_mix__grouped_kv_mqa__spectral_gfnet__prompt_kernel_KV1:
  s_mul_i32 s51, s44, 160
  v_lshlrev_b32 v3, 4, v1
  v_add_u32 v3, s51, v3
  s_add_u32 m0, s51, 161920
  s_mov_b64 exec, 0x3ff
  buffer_load_dwordx4 v3, s[32:35], 0 offen lds
  s_mov_b64 exec, -1
  s_mul_i32 s51, s44, 3200
  v_lshlrev_b32 v3, 4, v1
  v_add_u32 v3, s51, v3
  s_add_u32 m0, s51, 87040
  s_nop 0
  buffer_load_dwordx4 v3, s[12:15], 0 offen lds
  v_add_u32 v3, 1024, v3
  s_add_u32 m0, s51, 88064
  s_nop 0
  buffer_load_dwordx4 v3, s[12:15], 0 offen lds
  v_add_u32 v3, 1024, v3
  s_add_u32 m0, s51, 89088
  s_nop 0
  buffer_load_dwordx4 v3, s[12:15], 0 offen lds
  v_add_u32 v3, 1024, v3
  s_add_u32 m0, s51, 90112
  s_mov_b64 exec, 0xff
  buffer_load_dwordx4 v3, s[12:15], 0 offen lds
  s_mov_b64 exec, -1
  s_mul_i32 s51, s44, 3200
  v_lshlrev_b32 v3, 4, v1
  v_add_u32 v3, s51, v3
  s_add_u32 m0, s51, 112640
  s_nop 0
  buffer_load_dwordx4 v3, s[16:19], 0 offen lds
  v_add_u32 v3, 1024, v3
  s_add_u32 m0, s51, 113664
  s_nop 0
  buffer_load_dwordx4 v3, s[16:19], 0 offen lds
  v_add_u32 v3, 1024, v3
  s_add_u32 m0, s51, 114688
  s_nop 0
  buffer_load_dwordx4 v3, s[16:19], 0 offen lds
  v_add_u32 v3, 1024, v3
  s_add_u32 m0, s51, 115712
  s_mov_b64 exec, 0xff
  buffer_load_dwordx4 v3, s[16:19], 0 offen lds
  s_mov_b64 exec, -1
  s_add_u32 m0, s85, 0
  s_lshl_b32 s52, s80, 8
  buffer_load_dwordx4 v236, s[4:7], s52 offen lds
  s_add_u32 m0, s85, 1024
  s_lshl_b32 s52, s80, 8
  buffer_load_dwordx4 v237, s[4:7], s52 offen lds
  s_add_u32 m0, s85, 2048
  s_lshl_b32 s52, s80, 8
  s_mov_b64 exec, 0xff
  buffer_load_dwordx4 v238, s[4:7], s52 offen lds
  s_mov_b64 exec, -1
  s_add_u32 m0, s85, 17408
  s_lshl_b32 s52, s81, 8
  buffer_load_dwordx4 v236, s[4:7], s52 offen lds
  s_add_u32 m0, s85, 18432
  s_lshl_b32 s52, s81, 8
  buffer_load_dwordx4 v237, s[4:7], s52 offen lds
  s_add_u32 m0, s85, 19456
  s_lshl_b32 s52, s81, 8
  s_mov_b64 exec, 0xff
  buffer_load_dwordx4 v238, s[4:7], s52 offen lds
  s_mov_b64 exec, -1
  s_add_u32 m0, s85, 34816
  s_lshl_b32 s52, s82, 8
  buffer_load_dwordx4 v236, s[4:7], s52 offen lds
  s_add_u32 m0, s85, 35840
  s_lshl_b32 s52, s82, 8
  buffer_load_dwordx4 v237, s[4:7], s52 offen lds
  s_add_u32 m0, s85, 36864
  s_lshl_b32 s52, s82, 8
  s_mov_b64 exec, 0xff
  buffer_load_dwordx4 v238, s[4:7], s52 offen lds
  s_mov_b64 exec, -1
  s_add_u32 m0, s85, 52224
  s_lshl_b32 s52, s83, 8
  buffer_load_dwordx4 v236, s[4:7], s52 offen lds
  s_add_u32 m0, s85, 53248
  s_lshl_b32 s52, s83, 8
  buffer_load_dwordx4 v237, s[4:7], s52 offen lds
  s_add_u32 m0, s85, 54272
  s_lshl_b32 s52, s83, 8
  s_mov_b64 exec, 0xff
  buffer_load_dwordx4 v238, s[4:7], s52 offen lds
  s_mov_b64 exec, -1
  s_add_u32 m0, s85, 69632
  s_lshl_b32 s52, s84, 8
  buffer_load_dwordx4 v236, s[4:7], s52 offen lds
  s_add_u32 m0, s85, 70656
  s_lshl_b32 s52, s84, 8
  buffer_load_dwordx4 v237, s[4:7], s52 offen lds
  s_add_u32 m0, s85, 71680
  s_lshl_b32 s52, s84, 8
  s_mov_b64 exec, 0xff
  buffer_load_dwordx4 v238, s[4:7], s52 offen lds
  s_mov_b64 exec, -1
  s_waitcnt lgkmcnt(0)
  s_add_u32 s47, s47, 1
  s_and_b32 s48, s44, 1
  s_bfe_u32 s49, s44, 0x10001
  s_lshr_b32 s50, s44, 2
  v_and_b32 v3, 31, v1
  v_lshrrev_b32 v4, 5, v1
  s_lshl_b32 s51, s48, 5
  v_add_u32 v5, s51, v3
  v_mul_u32_u24 v5, 272, v5
  v_lshlrev_b32 v6, 4, v4
  s_lshl_b32 s51, s50, 7
  v_add3_u32 v12, v5, v6, s51
  v_and_b32 v5, 15, v1
  v_lshrrev_b32 v6, 2, v5
  v_lshl_add_u32 v6, v4, 3, v6
  v_mul_u32_u24 v6, 40, v6
  v_and_b32 v5, 3, v5
  v_lshlrev_b32 v5, 3, v5
  v_bfe_u32 v7, v1, 4, 1
  v_lshlrev_b32 v7, 5, v7
  v_add3_u32 v6, v6, v5, v7
  s_mul_i32 s51, s49, 25600
  s_mul_i32 s52, s50, 2560
  s_add_u32 s51, s51, s52
  s_add_u32 s51, s51, 87040
  v_add_u32 v13, s51, v6
  s_cmp_eq_u32 s49, 1
  s_cbranch_scc1 gated_mix__grouped_kv_mqa__spectral_gfnet__prompt_kernel_V9
  s_waitcnt vmcnt(12)
  s_barrier
  s_mul_i32 s51, s80, 5120
  v_add_u32 v14, s51, v13
  ds_read_b128 v[32:35], v12 offset:0
  ds_read_b64_tr_b16 v[48:49], v14 offset:0
  ds_read_b64_tr_b16 v[50:51], v14 offset:160
  ds_read_b128 v[36:39], v12 offset:32
  ds_read_b64_tr_b16 v[52:53], v14 offset:640
  ds_read_b64_tr_b16 v[54:55], v14 offset:800
  ds_read_b128 v[40:43], v12 offset:64
  ds_read_b64_tr_b16 v[56:57], v14 offset:1280
  ds_read_b64_tr_b16 v[58:59], v14 offset:1440
  ds_read_b128 v[44:47], v12 offset:96
  ds_read_b64_tr_b16 v[60:61], v14 offset:1920
  ds_read_b64_tr_b16 v[62:63], v14 offset:2080
  s_waitcnt lgkmcnt(9)
  v_mfma_f32_32x32x16_bf16 v[16:31], v[48:51], v[32:35], 0
  s_waitcnt lgkmcnt(6)
  v_mfma_f32_32x32x16_bf16 v[16:31], v[52:55], v[36:39], v[16:31]
  s_waitcnt lgkmcnt(3)
  v_mfma_f32_32x32x16_bf16 v[16:31], v[56:59], v[40:43], v[16:31]
  s_waitcnt lgkmcnt(0)
  v_mfma_f32_32x32x16_bf16 v[16:31], v[60:63], v[44:47], v[16:31]
  s_waitcnt vmcnt(9)
  s_barrier
  s_mul_i32 s51, s81, 5120
  v_add_u32 v14, s51, v13
  v_add_u32 v12, 17408, v12
  ds_read_b128 v[32:35], v12 offset:0
  ds_read_b64_tr_b16 v[48:49], v14 offset:0
  ds_read_b64_tr_b16 v[50:51], v14 offset:160
  ds_read_b128 v[36:39], v12 offset:32
  ds_read_b64_tr_b16 v[52:53], v14 offset:640
  ds_read_b64_tr_b16 v[54:55], v14 offset:800
  ds_read_b128 v[40:43], v12 offset:64
  ds_read_b64_tr_b16 v[56:57], v14 offset:1280
  ds_read_b64_tr_b16 v[58:59], v14 offset:1440
  ds_read_b128 v[44:47], v12 offset:96
  ds_read_b64_tr_b16 v[60:61], v14 offset:1920
  ds_read_b64_tr_b16 v[62:63], v14 offset:2080
  s_waitcnt lgkmcnt(9)
  v_mfma_f32_32x32x16_bf16 v[16:31], v[48:51], v[32:35], v[16:31]
  s_waitcnt lgkmcnt(6)
  v_mfma_f32_32x32x16_bf16 v[16:31], v[52:55], v[36:39], v[16:31]
  s_waitcnt lgkmcnt(3)
  v_mfma_f32_32x32x16_bf16 v[16:31], v[56:59], v[40:43], v[16:31]
  s_waitcnt lgkmcnt(0)
  v_mfma_f32_32x32x16_bf16 v[16:31], v[60:63], v[44:47], v[16:31]
  s_waitcnt vmcnt(6)
  s_barrier
  s_mul_i32 s51, s82, 5120
  v_add_u32 v14, s51, v13
  v_add_u32 v12, 17408, v12
  ds_read_b128 v[32:35], v12 offset:0
  ds_read_b64_tr_b16 v[48:49], v14 offset:0
  ds_read_b64_tr_b16 v[50:51], v14 offset:160
  ds_read_b128 v[36:39], v12 offset:32
  ds_read_b64_tr_b16 v[52:53], v14 offset:640
  ds_read_b64_tr_b16 v[54:55], v14 offset:800
  ds_read_b128 v[40:43], v12 offset:64
  ds_read_b64_tr_b16 v[56:57], v14 offset:1280
  ds_read_b64_tr_b16 v[58:59], v14 offset:1440
  ds_read_b128 v[44:47], v12 offset:96
  ds_read_b64_tr_b16 v[60:61], v14 offset:1920
  ds_read_b64_tr_b16 v[62:63], v14 offset:2080
  s_waitcnt lgkmcnt(9)
  v_mfma_f32_32x32x16_bf16 v[16:31], v[48:51], v[32:35], v[16:31]
  s_waitcnt lgkmcnt(6)
  v_mfma_f32_32x32x16_bf16 v[16:31], v[52:55], v[36:39], v[16:31]
  s_waitcnt lgkmcnt(3)
  v_mfma_f32_32x32x16_bf16 v[16:31], v[56:59], v[40:43], v[16:31]
  s_waitcnt lgkmcnt(0)
  v_mfma_f32_32x32x16_bf16 v[16:31], v[60:63], v[44:47], v[16:31]
  s_waitcnt vmcnt(3)
  s_barrier
  s_mul_i32 s51, s83, 5120
  v_add_u32 v14, s51, v13
  v_add_u32 v12, 17408, v12
  ds_read_b128 v[32:35], v12 offset:0
  ds_read_b64_tr_b16 v[48:49], v14 offset:0
  ds_read_b64_tr_b16 v[50:51], v14 offset:160
  ds_read_b128 v[36:39], v12 offset:32
  ds_read_b64_tr_b16 v[52:53], v14 offset:640
  ds_read_b64_tr_b16 v[54:55], v14 offset:800
  ds_read_b128 v[40:43], v12 offset:64
  ds_read_b64_tr_b16 v[56:57], v14 offset:1280
  ds_read_b64_tr_b16 v[58:59], v14 offset:1440
  ds_read_b128 v[44:47], v12 offset:96
  ds_read_b64_tr_b16 v[60:61], v14 offset:1920
  ds_read_b64_tr_b16 v[62:63], v14 offset:2080
  s_waitcnt lgkmcnt(9)
  v_mfma_f32_32x32x16_bf16 v[16:31], v[48:51], v[32:35], v[16:31]
  s_waitcnt lgkmcnt(6)
  v_mfma_f32_32x32x16_bf16 v[16:31], v[52:55], v[36:39], v[16:31]
  s_waitcnt lgkmcnt(3)
  v_mfma_f32_32x32x16_bf16 v[16:31], v[56:59], v[40:43], v[16:31]
  s_waitcnt lgkmcnt(0)
  v_mfma_f32_32x32x16_bf16 v[16:31], v[60:63], v[44:47], v[16:31]
  s_waitcnt vmcnt(0)
  s_barrier
  s_mul_i32 s51, s84, 5120
  v_add_u32 v14, s51, v13
  v_add_u32 v12, 17408, v12
  ds_read_b128 v[32:35], v12 offset:0
  ds_read_b64_tr_b16 v[48:49], v14 offset:0
  ds_read_b64_tr_b16 v[50:51], v14 offset:160
  ds_read_b128 v[36:39], v12 offset:32
  ds_read_b64_tr_b16 v[52:53], v14 offset:640
  ds_read_b64_tr_b16 v[54:55], v14 offset:800
  ds_read_b128 v[40:43], v12 offset:64
  ds_read_b64_tr_b16 v[56:57], v14 offset:1280
  ds_read_b64_tr_b16 v[58:59], v14 offset:1440
  ds_read_b128 v[44:47], v12 offset:96
  ds_read_b64_tr_b16 v[60:61], v14 offset:1920
  ds_read_b64_tr_b16 v[62:63], v14 offset:2080
  s_waitcnt lgkmcnt(9)
  v_mfma_f32_32x32x16_bf16 v[16:31], v[48:51], v[32:35], v[16:31]
  s_waitcnt lgkmcnt(6)
  v_mfma_f32_32x32x16_bf16 v[16:31], v[52:55], v[36:39], v[16:31]
  s_waitcnt lgkmcnt(3)
  v_mfma_f32_32x32x16_bf16 v[16:31], v[56:59], v[40:43], v[16:31]
  s_waitcnt lgkmcnt(0)
  v_mfma_f32_32x32x16_bf16 v[16:31], v[60:63], v[44:47], v[16:31]
  s_branch gated_mix__grouped_kv_mqa__spectral_gfnet__prompt_kernel_J10
gated_mix__grouped_kv_mqa__spectral_gfnet__prompt_kernel_V9:
  s_waitcnt vmcnt(12)
  s_barrier
  s_mul_i32 s51, s80, 5120
  v_add_u32 v14, s51, v13
  ds_read_b128 v[32:35], v12 offset:0
  ds_read_b64_tr_b16 v[48:49], v14 offset:0
  ds_read_b64_tr_b16 v[50:51], v14 offset:160
  ds_read_b128 v[36:39], v12 offset:32
  ds_read_b64_tr_b16 v[52:53], v14 offset:640
  ds_read_b64_tr_b16 v[54:55], v14 offset:800
  ds_read_b128 v[40:43], v12 offset:64
  ds_read_b64_tr_b16 v[56:57], v14 offset:1280
  ds_read_b64_tr_b16 v[58:59], v14 offset:1440
  ds_read_b128 v[44:47], v12 offset:96
  ds_read_b64_tr_b16 v[60:61], v14 offset:1920
  ds_read_b64_tr_b16 v[62:63], v14 offset:2080
  s_waitcnt lgkmcnt(9)
  v_mfma_f32_32x32x16_bf16 v[16:31], v[32:35], v[48:51], 0
  s_waitcnt lgkmcnt(6)
  v_mfma_f32_32x32x16_bf16 v[16:31], v[36:39], v[52:55], v[16:31]
  s_waitcnt lgkmcnt(3)
  v_mfma_f32_32x32x16_bf16 v[16:31], v[40:43], v[56:59], v[16:31]
  s_waitcnt lgkmcnt(0)
  v_mfma_f32_32x32x16_bf16 v[16:31], v[44:47], v[60:63], v[16:31]
  s_waitcnt vmcnt(9)
  s_barrier
  s_mul_i32 s51, s81, 5120
  v_add_u32 v14, s51, v13
  v_add_u32 v12, 17408, v12
  ds_read_b128 v[32:35], v12 offset:0
  ds_read_b64_tr_b16 v[48:49], v14 offset:0
  ds_read_b64_tr_b16 v[50:51], v14 offset:160
  ds_read_b128 v[36:39], v12 offset:32
  ds_read_b64_tr_b16 v[52:53], v14 offset:640
  ds_read_b64_tr_b16 v[54:55], v14 offset:800
  ds_read_b128 v[40:43], v12 offset:64
  ds_read_b64_tr_b16 v[56:57], v14 offset:1280
  ds_read_b64_tr_b16 v[58:59], v14 offset:1440
  ds_read_b128 v[44:47], v12 offset:96
  ds_read_b64_tr_b16 v[60:61], v14 offset:1920
  ds_read_b64_tr_b16 v[62:63], v14 offset:2080
  s_waitcnt lgkmcnt(9)
  v_mfma_f32_32x32x16_bf16 v[16:31], v[32:35], v[48:51], v[16:31]
  s_waitcnt lgkmcnt(6)
  v_mfma_f32_32x32x16_bf16 v[16:31], v[36:39], v[52:55], v[16:31]
  s_waitcnt lgkmcnt(3)
  v_mfma_f32_32x32x16_bf16 v[16:31], v[40:43], v[56:59], v[16:31]
  s_waitcnt lgkmcnt(0)
  v_mfma_f32_32x32x16_bf16 v[16:31], v[44:47], v[60:63], v[16:31]
  s_waitcnt vmcnt(6)
  s_barrier
  s_mul_i32 s51, s82, 5120
  v_add_u32 v14, s51, v13
  v_add_u32 v12, 17408, v12
  ds_read_b128 v[32:35], v12 offset:0
  ds_read_b64_tr_b16 v[48:49], v14 offset:0
  ds_read_b64_tr_b16 v[50:51], v14 offset:160
  ds_read_b128 v[36:39], v12 offset:32
  ds_read_b64_tr_b16 v[52:53], v14 offset:640
  ds_read_b64_tr_b16 v[54:55], v14 offset:800
  ds_read_b128 v[40:43], v12 offset:64
  ds_read_b64_tr_b16 v[56:57], v14 offset:1280
  ds_read_b64_tr_b16 v[58:59], v14 offset:1440
  ds_read_b128 v[44:47], v12 offset:96
  ds_read_b64_tr_b16 v[60:61], v14 offset:1920
  ds_read_b64_tr_b16 v[62:63], v14 offset:2080
  s_waitcnt lgkmcnt(9)
  v_mfma_f32_32x32x16_bf16 v[16:31], v[32:35], v[48:51], v[16:31]
  s_waitcnt lgkmcnt(6)
  v_mfma_f32_32x32x16_bf16 v[16:31], v[36:39], v[52:55], v[16:31]
  s_waitcnt lgkmcnt(3)
  v_mfma_f32_32x32x16_bf16 v[16:31], v[40:43], v[56:59], v[16:31]
  s_waitcnt lgkmcnt(0)
  v_mfma_f32_32x32x16_bf16 v[16:31], v[44:47], v[60:63], v[16:31]
  s_waitcnt vmcnt(3)
  s_barrier
  s_mul_i32 s51, s83, 5120
  v_add_u32 v14, s51, v13
  v_add_u32 v12, 17408, v12
  ds_read_b128 v[32:35], v12 offset:0
  ds_read_b64_tr_b16 v[48:49], v14 offset:0
  ds_read_b64_tr_b16 v[50:51], v14 offset:160
  ds_read_b128 v[36:39], v12 offset:32
  ds_read_b64_tr_b16 v[52:53], v14 offset:640
  ds_read_b64_tr_b16 v[54:55], v14 offset:800
  ds_read_b128 v[40:43], v12 offset:64
  ds_read_b64_tr_b16 v[56:57], v14 offset:1280
  ds_read_b64_tr_b16 v[58:59], v14 offset:1440
  ds_read_b128 v[44:47], v12 offset:96
  ds_read_b64_tr_b16 v[60:61], v14 offset:1920
  ds_read_b64_tr_b16 v[62:63], v14 offset:2080
  s_waitcnt lgkmcnt(9)
  v_mfma_f32_32x32x16_bf16 v[16:31], v[32:35], v[48:51], v[16:31]
  s_waitcnt lgkmcnt(6)
  v_mfma_f32_32x32x16_bf16 v[16:31], v[36:39], v[52:55], v[16:31]
  s_waitcnt lgkmcnt(3)
  v_mfma_f32_32x32x16_bf16 v[16:31], v[40:43], v[56:59], v[16:31]
  s_waitcnt lgkmcnt(0)
  v_mfma_f32_32x32x16_bf16 v[16:31], v[44:47], v[60:63], v[16:31]
  s_waitcnt vmcnt(0)
  s_barrier
  s_mul_i32 s51, s84, 5120
  v_add_u32 v14, s51, v13
  v_add_u32 v12, 17408, v12
  ds_read_b128 v[32:35], v12 offset:0
  ds_read_b64_tr_b16 v[48:49], v14 offset:0
  ds_read_b64_tr_b16 v[50:51], v14 offset:160
  ds_read_b128 v[36:39], v12 offset:32
  ds_read_b64_tr_b16 v[52:53], v14 offset:640
  ds_read_b64_tr_b16 v[54:55], v14 offset:800
  ds_read_b128 v[40:43], v12 offset:64
  ds_read_b64_tr_b16 v[56:57], v14 offset:1280
  ds_read_b64_tr_b16 v[58:59], v14 offset:1440
  ds_read_b128 v[44:47], v12 offset:96
  ds_read_b64_tr_b16 v[60:61], v14 offset:1920
  ds_read_b64_tr_b16 v[62:63], v14 offset:2080
  s_waitcnt lgkmcnt(9)
  v_mfma_f32_32x32x16_bf16 v[16:31], v[32:35], v[48:51], v[16:31]
  s_waitcnt lgkmcnt(6)
  v_mfma_f32_32x32x16_bf16 v[16:31], v[36:39], v[52:55], v[16:31]
  s_waitcnt lgkmcnt(3)
  v_mfma_f32_32x32x16_bf16 v[16:31], v[40:43], v[56:59], v[16:31]
  s_waitcnt lgkmcnt(0)
  v_mfma_f32_32x32x16_bf16 v[16:31], v[44:47], v[60:63], v[16:31]
gated_mix__grouped_kv_mqa__spectral_gfnet__prompt_kernel_J10:
  s_barrier
  s_mul_i32 s52, s80, 163840
  s_add_u32 m0, s86, 87040
  s_nop 0
  buffer_load_dwordx4 v240, s[8:11], s52 offen lds
  s_mul_i32 s52, s80, 163840
  s_add_u32 m0, s86, 88064
  s_nop 0
  buffer_load_dwordx4 v241, s[8:11], s52 offen lds
  s_mul_i32 s52, s80, 163840
  s_add_u32 m0, s86, 89088
  s_nop 0
  buffer_load_dwordx4 v242, s[8:11], s52 offen lds
  s_and_b32 s51, s44, 3
  s_lshl_b32 s51, s51, 12
  s_add_u32 s51, s51, 111616
  v_lshlrev_b32 v5, 4, v1
  v_add_u32 v5, s51, v5
  s_cmp_eq_u32 s50, 0
  s_cbranch_scc1 gated_mix__grouped_kv_mqa__spectral_gfnet__prompt_kernel_R11
  ds_write_b128 v5, v[16:19] offset:0
  ds_write_b128 v5, v[20:23] offset:1024
  ds_write_b128 v5, v[24:27] offset:2048
  ds_write_b128 v5, v[28:31] offset:3072
  s_waitcnt lgkmcnt(0)
  s_barrier
  s_branch gated_mix__grouped_kv_mqa__spectral_gfnet__prompt_kernel_E12
gated_mix__grouped_kv_mqa__spectral_gfnet__prompt_kernel_R11:
  s_barrier
  ds_read_b128 v[32:35], v5 offset:0
  ds_read_b128 v[36:39], v5 offset:1024
  ds_read_b128 v[40:43], v5 offset:2048
  ds_read_b128 v[44:47], v5 offset:3072
  s_waitcnt lgkmcnt(0)
  v_add_f32 v16, v16, v32
  v_add_f32 v17, v17, v33
  v_add_f32 v18, v18, v34
  v_add_f32 v19, v19, v35
  v_add_f32 v20, v20, v36
  v_add_f32 v21, v21, v37
  v_add_f32 v22, v22, v38
  v_add_f32 v23, v23, v39
  v_add_f32 v24, v24, v40
  v_add_f32 v25, v25, v41
  v_add_f32 v26, v26, v42
  v_add_f32 v27, v27, v43
  v_add_f32 v28, v28, v44
  v_add_f32 v29, v29, v45
  v_add_f32 v30, v30, v46
  v_add_f32 v31, v31, v47
  s_lshl_b32 s51, s45, 1
  s_add_u32 s51, s51, s48
  s_lshl_b32 s52, s51, 12
  s_add_u32 s52, s52, 65536
  s_cmp_eq_u32 s49, 1
  s_cbranch_scc1 gated_mix__grouped_kv_mqa__spectral_gfnet__prompt_kernel_FV13
  v_cvt_pk_bf16_f32 v48, v16, v17
  v_cvt_pk_bf16_f32 v49, v18, v19
  v_cvt_pk_bf16_f32 v50, v20, v21
  v_cvt_pk_bf16_f32 v51, v22, v23
  v_cvt_pk_bf16_f32 v52, v24, v25
  v_cvt_pk_bf16_f32 v53, v26, v27
  v_cmp_gt_u32 vcc, 32, v1
  s_nop 1
  v_cndmask_b32 v52, 0, v52, vcc
  v_cndmask_b32 v53, 0, v53, vcc
  v_lshlrev_b32 v6, 4, v1
  v_lshlrev_b32 v7, 3, v1
  buffer_store_dwordx4 v[48:51], v6, s[40:43], s52 offen sc1
  buffer_store_dwordx2 v[52:53], v7, s[40:43], s52 offen offset:3072 sc1
  v_mul_f32 v54, v16, v16
  v_fmac_f32 v54, v17, v17
  v_fmac_f32 v54, v18, v18
  v_fmac_f32 v54, v19, v19
  v_fmac_f32 v54, v20, v20
  v_fmac_f32 v54, v21, v21
  v_fmac_f32 v54, v22, v22
  v_fmac_f32 v54, v23, v23
  v_mul_f32 v55, v24, v24
  v_fmac_f32 v55, v25, v25
  v_fmac_f32 v55, v26, v26
  v_fmac_f32 v55, v27, v27
  v_cndmask_b32 v55, 0, v55, vcc
  v_add_f32 v54, v54, v55
  v_mov_b32 v55, v54
  s_nop 1
  v_permlane32_swap_b32 v54, v55
  s_nop 1
  v_add_f32 v54, v54, v55
  s_nop 1
  v_max_f32_dpp v54, v54, v54 row_shr:1 row_mask:0xf bank_mask:0xf
  s_nop 1
  v_max_f32_dpp v54, v54, v54 row_shr:2 row_mask:0xf bank_mask:0xf
  s_nop 1
  v_max_f32_dpp v54, v54, v54 row_shr:4 row_mask:0xf bank_mask:0xf
  s_nop 1
  v_max_f32_dpp v54, v54, v54 row_shr:8 row_mask:0xf bank_mask:0xf
  s_nop 1
  v_max_f32_dpp v54, v54, v54 row_bcast:15 row_mask:0xa bank_mask:0xf
  s_nop 0
  v_readlane_b32 s53, v54, 31
  s_lshl_b32 s55, s51, 3
  s_add_u32 s55, s55, 335872
  v_mov_b32 v57, s53
  v_mov_b32 v7, 0
  s_mov_b64 exec, 1
  buffer_store_dword v57, v7, s[40:43], s55 offen sc1
  s_mov_b64 exec, -1
  s_branch gated_mix__grouped_kv_mqa__spectral_gfnet__prompt_kernel_E12
gated_mix__grouped_kv_mqa__spectral_gfnet__prompt_kernel_FV13:
  v_cvt_pk_bf16_f32 v48, v16, v17
  v_cvt_pk_bf16_f32 v49, v18, v19
  v_cvt_pk_bf16_f32 v50, v20, v21
  v_cvt_pk_bf16_f32 v51, v22, v23
  v_cvt_pk_bf16_f32 v52, v24, v25
  v_cvt_pk_bf16_f32 v53, v26, v27
  v_cvt_pk_bf16_f32 v54, v28, v29
  v_cvt_pk_bf16_f32 v55, v30, v31
  v_and_b32 v7, 31, v1
  v_cmp_eq_u32 vcc, 20, v7
  v_cmp_lt_u32 s[58:59], 20, v7
  v_mov_b32 v6, 0x3f803f80
  v_cndmask_b32 v48, v48, v6, vcc
  v_cndmask_b32 v48, v48, 0, s[58:59]
  v_cndmask_b32 v49, v49, v6, vcc
  v_cndmask_b32 v49, v49, 0, s[58:59]
  v_cndmask_b32 v50, v50, v6, vcc
  v_cndmask_b32 v50, v50, 0, s[58:59]
  v_cndmask_b32 v51, v51, v6, vcc
  v_cndmask_b32 v51, v51, 0, s[58:59]
  v_cndmask_b32 v52, v52, v6, vcc
  v_cndmask_b32 v52, v52, 0, s[58:59]
  v_cndmask_b32 v53, v53, v6, vcc
  v_cndmask_b32 v53, v53, 0, s[58:59]
  v_cndmask_b32 v54, v54, v6, vcc
  v_cndmask_b32 v54, v54, 0, s[58:59]
  v_cndmask_b32 v55, v55, v6, vcc
  v_cndmask_b32 v55, v55, 0, s[58:59]
  v_lshlrev_b32 v6, 4, v1
  buffer_store_dwordx4 v[48:51], v6, s[40:43], s52 offen offset:1024 sc1
  buffer_store_dwordx4 v[52:55], v6, s[40:43], s52 offen offset:2048 sc1
  v_and_b32 v56, 0x7fffffff, v16
  v_max_f32 v56, v56, abs(v17)
  v_max_f32 v56, v56, abs(v18)
  v_max_f32 v56, v56, abs(v19)
  v_max_f32 v56, v56, abs(v20)
  v_max_f32 v56, v56, abs(v21)
  v_max_f32 v56, v56, abs(v22)
  v_max_f32 v56, v56, abs(v23)
  v_max_f32 v56, v56, abs(v24)
  v_max_f32 v56, v56, abs(v25)
  v_max_f32 v56, v56, abs(v26)
  v_max_f32 v56, v56, abs(v27)
  v_max_f32 v56, v56, abs(v28)
  v_max_f32 v56, v56, abs(v29)
  v_max_f32 v56, v56, abs(v30)
  v_max_f32 v56, v56, abs(v31)
  v_cmp_gt_u32 vcc, 20, v7
  s_nop 1
  v_cndmask_b32 v56, 0, v56, vcc
  v_mov_b32 v57, v56
  s_nop 1
  v_permlane32_swap_b32 v56, v57
  s_nop 1
  v_max_f32 v56, v56, v57
  s_nop 1
  v_max_f32_dpp v56, v56, v56 row_shr:1 row_mask:0xf bank_mask:0xf
  s_nop 1
  v_max_f32_dpp v56, v56, v56 row_shr:2 row_mask:0xf bank_mask:0xf
  s_nop 1
  v_max_f32_dpp v56, v56, v56 row_shr:4 row_mask:0xf bank_mask:0xf
  s_nop 1
  v_max_f32_dpp v56, v56, v56 row_shr:8 row_mask:0xf bank_mask:0xf
  s_nop 1
  v_max_f32_dpp v56, v56, v56 row_bcast:15 row_mask:0xa bank_mask:0xf
  s_nop 0
  v_readlane_b32 s53, v56, 31
  s_lshl_b32 s55, s51, 3
  s_add_u32 s55, s55, 335876
  v_mov_b32 v57, s53
  v_mov_b32 v7, 0
  s_mov_b64 exec, 1
  buffer_store_dword v57, v7, s[40:43], s55 offen sc1
  s_mov_b64 exec, -1
gated_mix__grouped_kv_mqa__spectral_gfnet__prompt_kernel_E12:
  s_lshr_b32 s48, s2, 6
  s_and_b32 s49, s2, 63
  s_lshr_b32 s50, s48, 1
  s_and_b32 s51, s48, 1
  s_lshl_b32 s50, s50, 4
  s_lshl_b32 s51, s51, 2
  s_add_u32 s50, s50, s51
  s_lshr_b32 s51, s44, 2
  s_lshl_b32 s51, s51, 3
  s_add_u32 s50, s50, s51
  s_and_b32 s51, s44, 3
  s_add_u32 s50, s50, s51
  s_lshl_b32 s50, s50, 6
  s_add_u32 s50, s50, s49
  s_mul_i32 s50, s50, 1280
  v_lshlrev_b32 v3, 4, v1
  s_mul_i32 s51, s44, 1296
  s_add_u32 m0, s51, 138240
  s_nop 0
  buffer_load_dwordx4 v3, s[4:7], s50 offen lds
  s_add_u32 m0, s51, 139264
  s_add_u32 s50, s50, 1024
  s_mov_b64 exec, 0xffff
  buffer_load_dwordx4 v3, s[4:7], s50 offen lds
  s_mov_b64 exec, -1
  s_add_u32 s48, s44, 0
  s_min_u32 s48, s48, 12
  s_lshl_b32 s48, s48, 10
  v_add_u32 v4, s48, v3
  v_mov_b32 v5, s73
  v_add_co_u32 v4, vcc, s72, v4
  v_addc_co_u32 v5, vcc, 0, v5, vcc
  s_add_u32 m0, s48, 148608
  s_nop 0
  global_load_lds_dwordx4 v[4:5], off
  s_add_u32 s48, s44, 8
  s_min_u32 s48, s48, 12
  s_lshl_b32 s48, s48, 10
  v_add_u32 v4, s48, v3
  v_mov_b32 v5, s73
  v_add_co_u32 v4, vcc, s72, v4
  v_addc_co_u32 v5, vcc, 0, v5, vcc
  s_add_u32 m0, s48, 148608
  s_nop 0
  global_load_lds_dwordx4 v[4:5], off
  s_and_b32 s48, s2, 31
  s_lshr_b32 s49, s2, 5
  s_lshl_b32 s50, s49, 8
  s_add_u32 s50, s50, s48
  s_mul_i32 s50, s50, 642
  v_min_u32 v3, 0x140, v0
  v_lshlrev_b32 v4, 1, v3
  s_add_u32 s52, s50, 0
  buffer_load_ushort v160, v4, s[24:27], s52 offen
  buffer_load_ushort v168, v4, s[28:31], s52 offen
  s_add_u32 s52, s50, 20544
  buffer_load_ushort v161, v4, s[24:27], s52 offen
  buffer_load_ushort v169, v4, s[28:31], s52 offen
  s_add_u32 s52, s50, 41088
  buffer_load_ushort v162, v4, s[24:27], s52 offen
  buffer_load_ushort v170, v4, s[28:31], s52 offen
  s_add_u32 s52, s50, 61632
  buffer_load_ushort v163, v4, s[24:27], s52 offen
  buffer_load_ushort v171, v4, s[28:31], s52 offen
  s_add_u32 s52, s50, 82176
  buffer_load_ushort v164, v4, s[24:27], s52 offen
  buffer_load_ushort v172, v4, s[28:31], s52 offen
  s_add_u32 s52, s50, 102720
  buffer_load_ushort v165, v4, s[24:27], s52 offen
  buffer_load_ushort v173, v4, s[28:31], s52 offen
  s_add_u32 s52, s50, 123264
  buffer_load_ushort v166, v4, s[24:27], s52 offen
  buffer_load_ushort v174, v4, s[28:31], s52 offen
  s_add_u32 s52, s50, 143808
  buffer_load_ushort v167, v4, s[24:27], s52 offen
  buffer_load_ushort v175, v4, s[28:31], s52 offen
  s_waitcnt vmcnt(20)
  s_barrier
  s_cmp_lg_u32 s44, 0
  s_cbranch_scc1 gated_mix__grouped_kv_mqa__spectral_gfnet__prompt_kernel_P14
  s_lshl_b32 s54, s45, 2
  s_add_u32 s54, s54, 4096
  v_mov_b32 v5, s47
  v_lshlrev_b32 v6, 7, v1
  s_mov_b64 exec, 0xff
  buffer_store_dword v5, v6, s[40:43], s54 offen sc1
  s_mov_b64 exec, -1
gated_mix__grouped_kv_mqa__spectral_gfnet__prompt_kernel_P14:
  s_mul_i32 s52, s81, 163840
  s_add_u32 m0, s86, 111616
  s_nop 0
  buffer_load_dwordx4 v240, s[8:11], s52 offen lds
  s_mul_i32 s52, s81, 163840
  s_add_u32 m0, s86, 112640
  s_nop 0
  buffer_load_dwordx4 v241, s[8:11], s52 offen lds
  s_mul_i32 s52, s81, 163840
  s_add_u32 m0, s86, 113664
  s_nop 0
  buffer_load_dwordx4 v242, s[8:11], s52 offen lds
  s_waitcnt vmcnt(4)
  s_barrier
  v_lshlrev_b32 v3, 4, v1
  v_add_u32 v3, 148608, v3
  ds_read_b128 v[100:103], v3 offset:0
  ds_read_b128 v[108:111], v3 offset:1024
  ds_read_b128 v[104:107], v3 offset:2048
  ds_read_b128 v[112:115], v3 offset:3072
  ds_read_b128 v[116:119], v3 offset:4096
  ds_read_b128 v[128:131], v3 offset:5120
  ds_read_b128 v[120:123], v3 offset:6144
  ds_read_b128 v[132:135], v3 offset:7168
  ds_read_b128 v[124:127], v3 offset:8192
  ds_read_b128 v[136:139], v3 offset:9216
  ds_read_b128 v[140:143], v3 offset:10240
  ds_read_b128 v[144:147], v3 offset:11264
  ds_read_b128 v[148:151], v3 offset:12288
  v_and_b32 v3, 31, v1
  v_lshrrev_b32 v4, 5, v1
  v_and_b32 v8, 15, v1
  v_lshrrev_b32 v9, 2, v8
  v_lshl_add_u32 v9, v4, 3, v9
  v_mul_u32_u24 v9, 40, v9
  v_and_b32 v8, 3, v8
  v_lshl_add_u32 v9, v8, 3, v9
  v_bfe_u32 v8, v1, 4, 1
  v_lshl_add_u32 v9, v8, 5, v9
  s_mul_i32 s51, s44, 1296
  s_add_u32 s51, s51, 138240
  v_add_u32 v9, s51, v9
  ds_read_b64_tr_b16 v[16:17], v9 offset:0
  ds_read_b64_tr_b16 v[18:19], v9 offset:160
  ds_read_b64_tr_b16 v[20:21], v9 offset:640
  ds_read_b64_tr_b16 v[22:23], v9 offset:800
  v_cmp_eq_u32 s[62:63], 0, v4
  s_waitcnt lgkmcnt(0)
  v_mfma_f32_32x32x16_bf16 v[24:39], v[16:19], v[100:103], 0
  v_mfma_f32_32x32x16_bf16 v[40:55], v[16:19], v[108:111], 0
  v_mfma_f32_32x32x16_bf16 v[24:39], v[20:23], v[104:107], v[24:39]
  v_mfma_f32_32x32x16_bf16 v[40:55], v[20:23], v[112:115], v[40:55]
  s_nop 15
  v_pk_mul_f32 v[56:57], v[24:25], v[116:117]
  v_pk_mul_f32 v[68:69], v[40:41], v[116:117]
  v_pk_fma_f32 v[56:57], v[40:41], v[128:129], v[56:57]
  v_pk_fma_f32 v[68:69], v[24:25], v[128:129], v[68:69] neg_lo:[1,0,0] neg_hi:[1,0,0]
  v_pk_mul_f32 v[58:59], v[26:27], v[118:119]
  v_pk_mul_f32 v[70:71], v[42:43], v[118:119]
  v_pk_fma_f32 v[58:59], v[42:43], v[130:131], v[58:59]
  v_pk_fma_f32 v[70:71], v[26:27], v[130:131], v[70:71] neg_lo:[1,0,0] neg_hi:[1,0,0]
  v_pk_mul_f32 v[60:61], v[28:29], v[120:121]
  v_pk_mul_f32 v[72:73], v[44:45], v[120:121]
  v_pk_fma_f32 v[60:61], v[44:45], v[132:133], v[60:61]
  v_pk_fma_f32 v[72:73], v[28:29], v[132:133], v[72:73] neg_lo:[1,0,0] neg_hi:[1,0,0]
  v_pk_mul_f32 v[62:63], v[30:31], v[122:123]
  v_pk_mul_f32 v[74:75], v[46:47], v[122:123]
  v_pk_fma_f32 v[62:63], v[46:47], v[134:135], v[62:63]
  v_pk_fma_f32 v[74:75], v[30:31], v[134:135], v[74:75] neg_lo:[1,0,0] neg_hi:[1,0,0]
  v_pk_mul_f32 v[64:65], v[32:33], v[124:125]
  v_pk_mul_f32 v[76:77], v[48:49], v[124:125]
  v_pk_fma_f32 v[64:65], v[48:49], v[136:137], v[64:65]
  v_pk_fma_f32 v[76:77], v[32:33], v[136:137], v[76:77] neg_lo:[1,0,0] neg_hi:[1,0,0]
  v_pk_mul_f32 v[66:67], v[34:35], v[126:127]
  v_pk_mul_f32 v[78:79], v[50:51], v[126:127]
  v_pk_fma_f32 v[66:67], v[50:51], v[138:139], v[66:67]
  v_pk_fma_f32 v[78:79], v[34:35], v[138:139], v[78:79] neg_lo:[1,0,0] neg_hi:[1,0,0]
  v_cvt_pk_bf16_f32 v80, v56, v57
  v_cvt_pk_bf16_f32 v86, v68, v69
  v_cvt_pk_bf16_f32 v81, v58, v59
  v_cvt_pk_bf16_f32 v87, v70, v71
  v_cvt_pk_bf16_f32 v82, v60, v61
  v_cvt_pk_bf16_f32 v88, v72, v73
  v_cvt_pk_bf16_f32 v83, v62, v63
  v_cvt_pk_bf16_f32 v89, v74, v75
  v_cvt_pk_bf16_f32 v84, v64, v65
  v_cvt_pk_bf16_f32 v90, v76, v77
  v_cvt_pk_bf16_f32 v85, v66, v67
  v_cvt_pk_bf16_f32 v91, v78, v79
  v_cndmask_b32 v84, 0, v84, s[62:63]
  v_cndmask_b32 v90, 0, v90, s[62:63]
  v_cndmask_b32 v85, 0, v85, s[62:63]
  v_cndmask_b32 v91, 0, v91, s[62:63]
  s_nop 1
  v_mfma_f32_32x32x16_bf16 v[176:191], v[140:143], v[80:83], 0
  v_mfma_f32_32x32x16_bf16 v[176:191], v[144:147], v[86:89], v[176:191]
  v_mfma_f32_32x32x8_bf16 v[176:191], v[148:149], v[84:85], v[176:191]
  v_mfma_f32_32x32x8_bf16 v[176:191], v[150:151], v[90:91], v[176:191]
  s_nop 15
  v_cvt_pk_bf16_f32 v56, v176, v177
  v_cvt_pk_bf16_f32 v57, v178, v179
  v_cvt_pk_bf16_f32 v58, v180, v181
  v_cvt_pk_bf16_f32 v59, v182, v183
  v_cvt_pk_bf16_f32 v60, v184, v185
  v_cvt_pk_bf16_f32 v61, v186, v187
  v_and_b32 v3, 31, v1
  v_lshrrev_b32 v4, 5, v1
  v_lshl_add_u32 v10, v4, 6, v3
  v_lshlrev_b32 v10, 2, v10
  s_mul_i32 s51, s44, 1296
  s_add_u32 s51, s51, 138240
  v_add_u32 v10, s51, v10
  ds_write_b32 v10, v56 offset:0
  ds_write_b32 v10, v57 offset:128
  ds_write_b32 v10, v58 offset:512
  ds_write_b32 v10, v59 offset:640
  s_mov_b32 exec_hi, 1
  ds_write_b32 v10, v60 offset:1024
  s_mov_b32 exec_hi, 0
  ds_write_b32 v10, v61 offset:1152
  s_mov_b64 exec, -1
  s_waitcnt lgkmcnt(0)
  s_barrier
  v_cmp_gt_u32 vcc, 0x141, v0
  s_and_saveexec_b64 s[56:57], vcc
  v_lshlrev_b32 v3, 2, v0
  v_add_u32 v3, 138240, v3
  ds_read_b32 v16, v3 offset:0
  ds_read_b32 v17, v3 offset:1296
  ds_read_b32 v18, v3 offset:2592
  ds_read_b32 v19, v3 offset:3888
  ds_read_b32 v20, v3 offset:5184
  ds_read_b32 v21, v3 offset:6480
  ds_read_b32 v22, v3 offset:7776
  ds_read_b32 v23, v3 offset:9072
  v_cmp_eq_u32 vcc, 0, v0
  v_mov_b32 v4, 0x140
  v_cmp_eq_u32 s[58:59], v4, v0
  s_or_b64 vcc, vcc, s[58:59]
  v_mov_b32 v5, 1.0
  v_mov_b32 v6, 0.5
  v_cndmask_b32 v5, v5, v6, vcc
  v_lshlrev_b32 v160, 16, v160
  v_lshlrev_b32 v168, 16, v168
  v_mul_f32 v160, v160, v5
  v_mul_f32 v168, v168, v5
  v_cvt_pk_bf16_f32 v160, v160, v168
  v_lshlrev_b32 v161, 16, v161
  v_lshlrev_b32 v169, 16, v169
  v_mul_f32 v161, v161, v5
  v_mul_f32 v169, v169, v5
  v_cvt_pk_bf16_f32 v161, v161, v169
  v_lshlrev_b32 v162, 16, v162
  v_lshlrev_b32 v170, 16, v170
  v_mul_f32 v162, v162, v5
  v_mul_f32 v170, v170, v5
  v_cvt_pk_bf16_f32 v162, v162, v170
  v_lshlrev_b32 v163, 16, v163
  v_lshlrev_b32 v171, 16, v171
  v_mul_f32 v163, v163, v5
  v_mul_f32 v171, v171, v5
  v_cvt_pk_bf16_f32 v163, v163, v171
  v_lshlrev_b32 v164, 16, v164
  v_lshlrev_b32 v172, 16, v172
  v_mul_f32 v164, v164, v5
  v_mul_f32 v172, v172, v5
  v_cvt_pk_bf16_f32 v164, v164, v172
  v_lshlrev_b32 v165, 16, v165
  v_lshlrev_b32 v173, 16, v173
  v_mul_f32 v165, v165, v5
  v_mul_f32 v173, v173, v5
  v_cvt_pk_bf16_f32 v165, v165, v173
  v_lshlrev_b32 v166, 16, v166
  v_lshlrev_b32 v174, 16, v174
  v_mul_f32 v166, v166, v5
  v_mul_f32 v174, v174, v5
  v_cvt_pk_bf16_f32 v166, v166, v174
  v_lshlrev_b32 v167, 16, v167
  v_lshlrev_b32 v175, 16, v175
  v_mul_f32 v167, v167, v5
  v_mul_f32 v175, v175, v5
  v_cvt_pk_bf16_f32 v167, v167, v175
  s_mul_i32 s50, s2, 20736
  s_add_u32 s50, s50, 4194304
  v_lshlrev_b32 v4, 4, v0
  s_add_u32 s51, s50, 10368
  buffer_store_dwordx4 v[160:163], v4, s[40:43], s51 offen sc1
  s_add_u32 s51, s50, 15552
  buffer_store_dwordx4 v[164:167], v4, s[40:43], s51 offen sc1
  s_mov_b32 s52, 0x05040100
  s_mov_b32 s53, 0x07060302
  s_waitcnt lgkmcnt(0)
  v_perm_b32 v24, v17, v16, s52
  v_perm_b32 v28, v17, v16, s53
  v_perm_b32 v25, v19, v18, s52
  v_perm_b32 v29, v19, v18, s53
  v_perm_b32 v26, v21, v20, s52
  v_perm_b32 v30, v21, v20, s53
  v_perm_b32 v27, v23, v22, s52
  v_perm_b32 v31, v23, v22, s53
  buffer_store_dwordx4 v[24:27], v4, s[40:43], s50 offen sc1
  s_add_u32 s51, s50, 5184
  buffer_store_dwordx4 v[28:31], v4, s[40:43], s51 offen sc1
  s_mov_b64 exec, s[56:57]
  s_and_b32 s48, s44, 1
  s_lshr_b32 s49, s44, 1
  v_and_b32 v3, 31, v1
  v_lshrrev_b32 v4, 5, v1
  s_lshl_b32 s51, s48, 5
  v_add_u32 v5, s51, v3
  v_mul_u32_u24 v5, 272, v5
  v_lshl_add_u32 v8, v4, 4, v5
  v_and_b32 v5, 15, v1
  v_lshrrev_b32 v6, 2, v5
  v_lshl_add_u32 v6, v4, 3, v6
  v_mul_u32_u24 v6, 192, v6
  v_and_b32 v5, 3, v5
  v_lshlrev_b32 v5, 3, v5
  v_bfe_u32 v7, v1, 4, 1
  v_lshlrev_b32 v7, 5, v7
  v_add3_u32 v6, v6, v5, v7
  s_mul_i32 s51, s49, 40
  s_and_b32 s52, s46, 1
  s_lshl_b32 s52, s52, 5
  s_add_u32 s51, s51, s52
  v_add_u32 v9, s51, v6
  s_lshl_b32 s51, s49, 5
  s_add_u32 s51, s51, 161920
  v_lshl_add_u32 v14, v4, 4, s51
  s_lshl_b32 s60, s49, 5
  v_add_u32 v10, s60, v8
  s_waitcnt vmcnt(4)
  s_barrier
  v_add_u32 v12, 0, v8
  v_add_u32 v13, 87040, v9
  ds_read_b128 v[48:51], v12 offset:0
  ds_read_b64_tr_b16 v[64:65], v13 offset:0
  ds_read_b64_tr_b16 v[66:67], v13 offset:768
  s_lshl_b32 s51, s80, 8
  v_add_u32 v15, s51, v14
  v_add_u32 v11, 0, v10
  ds_read_b128 v[176:179], v15 offset:0
  ds_read_b128 v[184:187], v11 offset:0
  ds_read_b128 v[180:183], v15 offset:128
  ds_read_b128 v[188:191], v11 offset:128
  ds_read_b128 v[52:55], v12 offset:32
  ds_read_b64_tr_b16 v[68:69], v13 offset:3072
  ds_read_b64_tr_b16 v[70:71], v13 offset:3840
  ds_read_b128 v[56:59], v12 offset:64
  ds_read_b64_tr_b16 v[72:73], v13 offset:6144
  ds_read_b64_tr_b16 v[74:75], v13 offset:6912
  ds_read_b128 v[60:63], v12 offset:96
  ds_read_b64_tr_b16 v[76:77], v13 offset:9216
  ds_read_b64_tr_b16 v[78:79], v13 offset:9984
  s_waitcnt lgkmcnt(13)
  v_mfma_f32_32x32x16_bf16 v[16:31], v[64:67], v[48:51], 0
  s_mul_i32 s52, s82, 163840
  s_add_u32 m0, s86, 136192
  s_nop 0
  buffer_load_dwordx4 v240, s[8:11], s52 offen lds
  ds_read_b128 v[48:51], v12 offset:128
  ds_read_b64_tr_b16 v[64:65], v13 offset:12288
  ds_read_b64_tr_b16 v[66:67], v13 offset:13056
  s_waitcnt lgkmcnt(9)
  v_mfma_f32_32x32x16_bf16 v[16:31], v[68:71], v[52:55], v[16:31]
  s_mul_i32 s52, s82, 163840
  s_add_u32 m0, s86, 137216
  s_nop 0
  buffer_load_dwordx4 v241, s[8:11], s52 offen lds
  ds_read_b128 v[52:55], v12 offset:160
  ds_read_b64_tr_b16 v[68:69], v13 offset:15360
  ds_read_b64_tr_b16 v[70:71], v13 offset:16128
  s_waitcnt lgkmcnt(9)
  v_mfma_f32_32x32x16_bf16 v[16:31], v[72:75], v[56:59], v[16:31]
  v_mfma_f32_32x32x16_bf16 v[32:47], v[176:179], v[184:187], 0
  s_mul_i32 s52, s82, 163840
  s_add_u32 m0, s86, 138240
  s_nop 0
  buffer_load_dwordx4 v242, s[8:11], s52 offen lds
  ds_read_b128 v[56:59], v12 offset:192
  ds_read_b64_tr_b16 v[72:73], v13 offset:18432
  ds_read_b64_tr_b16 v[74:75], v13 offset:19200
  s_waitcnt lgkmcnt(9)
  v_mfma_f32_32x32x16_bf16 v[16:31], v[76:79], v[60:63], v[16:31]
  ds_read_b128 v[60:63], v12 offset:224
  ds_read_b64_tr_b16 v[76:77], v13 offset:21504
  ds_read_b64_tr_b16 v[78:79], v13 offset:22272
  s_waitcnt lgkmcnt(9)
  v_mfma_f32_32x32x16_bf16 v[16:31], v[64:67], v[48:51], v[16:31]
  v_mfma_f32_32x32x16_bf16 v[32:47], v[180:183], v[188:191], v[32:47]
  s_waitcnt vmcnt(7) lgkmcnt(0)
  s_barrier
  v_add_u32 v12, 17408, v8
  v_add_u32 v13, 111616, v9
  ds_read_b128 v[48:51], v12 offset:0
  ds_read_b64_tr_b16 v[64:65], v13 offset:0
  ds_read_b64_tr_b16 v[66:67], v13 offset:768
  s_lshl_b32 s51, s81, 8
  v_add_u32 v15, s51, v14
  v_add_u32 v11, 17408, v10
  ds_read_b128 v[192:195], v15 offset:0
  ds_read_b128 v[200:203], v11 offset:0
  ds_read_b128 v[196:199], v15 offset:128
  ds_read_b128 v[204:207], v11 offset:128
  v_mfma_f32_32x32x16_bf16 v[16:31], v[68:71], v[52:55], v[16:31]
  s_mul_i32 s52, s83, 163840
  s_add_u32 m0, s86, 87040
  s_nop 0
  buffer_load_dwordx4 v240, s[8:11], s52 offen lds
  ds_read_b128 v[52:55], v12 offset:32
  ds_read_b64_tr_b16 v[68:69], v13 offset:3072
  ds_read_b64_tr_b16 v[70:71], v13 offset:3840
  v_mfma_f32_32x32x16_bf16 v[16:31], v[72:75], v[56:59], v[16:31]
  s_mul_i32 s52, s83, 163840
  s_add_u32 m0, s86, 88064
  s_nop 0
  buffer_load_dwordx4 v241, s[8:11], s52 offen lds
  ds_read_b128 v[56:59], v12 offset:64
  ds_read_b64_tr_b16 v[72:73], v13 offset:6144
  ds_read_b64_tr_b16 v[74:75], v13 offset:6912
  v_mfma_f32_32x32x16_bf16 v[16:31], v[76:79], v[60:63], v[16:31]
  s_mul_i32 s52, s83, 163840
  s_add_u32 m0, s86, 89088
  s_nop 0
  buffer_load_dwordx4 v242, s[8:11], s52 offen lds
  ds_read_b128 v[60:63], v12 offset:96
  ds_read_b64_tr_b16 v[76:77], v13 offset:9216
  ds_read_b64_tr_b16 v[78:79], v13 offset:9984
  s_waitcnt lgkmcnt(13)
  v_mfma_f32_32x32x16_bf16 v[16:31], v[64:67], v[48:51], v[16:31]
  ds_read_b128 v[48:51], v12 offset:128
  ds_read_b64_tr_b16 v[64:65], v13 offset:12288
  ds_read_b64_tr_b16 v[66:67], v13 offset:13056
  s_waitcnt lgkmcnt(9)
  v_mfma_f32_32x32x16_bf16 v[16:31], v[68:71], v[52:55], v[16:31]
  ds_read_b128 v[52:55], v12 offset:160
  ds_read_b64_tr_b16 v[68:69], v13 offset:15360
  ds_read_b64_tr_b16 v[70:71], v13 offset:16128
  s_waitcnt lgkmcnt(9)
  v_mfma_f32_32x32x16_bf16 v[16:31], v[72:75], v[56:59], v[16:31]
  v_mfma_f32_32x32x16_bf16 v[32:47], v[192:195], v[200:203], v[32:47]
  ds_read_b128 v[56:59], v12 offset:192
  ds_read_b64_tr_b16 v[72:73], v13 offset:18432
  ds_read_b64_tr_b16 v[74:75], v13 offset:19200
  s_waitcnt lgkmcnt(9)
  v_mfma_f32_32x32x16_bf16 v[16:31], v[76:79], v[60:63], v[16:31]
  ds_read_b128 v[60:63], v12 offset:224
  ds_read_b64_tr_b16 v[76:77], v13 offset:21504
  ds_read_b64_tr_b16 v[78:79], v13 offset:22272
  s_waitcnt lgkmcnt(9)
  v_mfma_f32_32x32x16_bf16 v[16:31], v[64:67], v[48:51], v[16:31]
  v_mfma_f32_32x32x16_bf16 v[32:47], v[196:199], v[204:207], v[32:47]
  s_waitcnt vmcnt(3) lgkmcnt(0)
  s_barrier
  s_cmp_lg_u32 s44, 0
  s_cbranch_scc1 gated_mix__grouped_kv_mqa__spectral_gfnet__prompt_kernel_FX15
  s_mov_b32 s74, s2
  s_lshl_b32 s54, s74, 2
  s_add_u32 s54, s54, 8192
  v_mov_b32 v5, s47
  v_mov_b32 v6, 0
  s_mov_b64 s[56:57], exec
  s_mov_b64 exec, 1
  buffer_store_dword v5, v6, s[40:43], s54 offen sc1
  s_mov_b64 exec, s[56:57]
gated_mix__grouped_kv_mqa__spectral_gfnet__prompt_kernel_FX15:
  v_add_u32 v12, 34816, v8
  v_add_u32 v13, 136192, v9
  ds_read_b128 v[48:51], v12 offset:0
  ds_read_b64_tr_b16 v[64:65], v13 offset:0
  ds_read_b64_tr_b16 v[66:67], v13 offset:768
  s_lshl_b32 s51, s82, 8
  v_add_u32 v15, s51, v14
  v_add_u32 v11, 34816, v10
  ds_read_b128 v[176:179], v15 offset:0
  ds_read_b128 v[184:187], v11 offset:0
  ds_read_b128 v[180:183], v15 offset:128
  ds_read_b128 v[188:191], v11 offset:128
  v_mfma_f32_32x32x16_bf16 v[16:31], v[68:71], v[52:55], v[16:31]
  s_mul_i32 s52, s84, 163840
  s_add_u32 m0, s86, 111616
  s_nop 0
  buffer_load_dwordx4 v240, s[8:11], s52 offen lds
  ds_read_b128 v[52:55], v12 offset:32
  ds_read_b64_tr_b16 v[68:69], v13 offset:3072
  ds_read_b64_tr_b16 v[70:71], v13 offset:3840
  v_mfma_f32_32x32x16_bf16 v[16:31], v[72:75], v[56:59], v[16:31]
  s_mul_i32 s52, s84, 163840
  s_add_u32 m0, s86, 112640
  s_nop 0
  buffer_load_dwordx4 v241, s[8:11], s52 offen lds
  ds_read_b128 v[56:59], v12 offset:64
  ds_read_b64_tr_b16 v[72:73], v13 offset:6144
  ds_read_b64_tr_b16 v[74:75], v13 offset:6912
  v_mfma_f32_32x32x16_bf16 v[16:31], v[76:79], v[60:63], v[16:31]
  s_mul_i32 s52, s84, 163840
  s_add_u32 m0, s86, 113664
  s_nop 0
  buffer_load_dwordx4 v242, s[8:11], s52 offen lds
  ds_read_b128 v[60:63], v12 offset:96
  ds_read_b64_tr_b16 v[76:77], v13 offset:9216
  ds_read_b64_tr_b16 v[78:79], v13 offset:9984
  s_waitcnt lgkmcnt(13)
  v_mfma_f32_32x32x16_bf16 v[16:31], v[64:67], v[48:51], v[16:31]
  ds_read_b128 v[48:51], v12 offset:128
  ds_read_b64_tr_b16 v[64:65], v13 offset:12288
  ds_read_b64_tr_b16 v[66:67], v13 offset:13056
  s_waitcnt lgkmcnt(9)
  v_mfma_f32_32x32x16_bf16 v[16:31], v[68:71], v[52:55], v[16:31]
  ds_read_b128 v[52:55], v12 offset:160
  ds_read_b64_tr_b16 v[68:69], v13 offset:15360
  ds_read_b64_tr_b16 v[70:71], v13 offset:16128
  s_waitcnt lgkmcnt(9)
  v_mfma_f32_32x32x16_bf16 v[16:31], v[72:75], v[56:59], v[16:31]
  v_mfma_f32_32x32x16_bf16 v[32:47], v[176:179], v[184:187], v[32:47]
  ds_read_b128 v[56:59], v12 offset:192
  ds_read_b64_tr_b16 v[72:73], v13 offset:18432
  ds_read_b64_tr_b16 v[74:75], v13 offset:19200
  s_waitcnt lgkmcnt(9)
  v_mfma_f32_32x32x16_bf16 v[16:31], v[76:79], v[60:63], v[16:31]
  ds_read_b128 v[60:63], v12 offset:224
  ds_read_b64_tr_b16 v[76:77], v13 offset:21504
  ds_read_b64_tr_b16 v[78:79], v13 offset:22272
  s_waitcnt lgkmcnt(9)
  v_mfma_f32_32x32x16_bf16 v[16:31], v[64:67], v[48:51], v[16:31]
  v_mfma_f32_32x32x16_bf16 v[32:47], v[180:183], v[188:191], v[32:47]
  s_waitcnt vmcnt(3) lgkmcnt(0)
  s_barrier
  v_add_u32 v12, 52224, v8
  v_add_u32 v13, 87040, v9
  ds_read_b128 v[48:51], v12 offset:0
  ds_read_b64_tr_b16 v[64:65], v13 offset:0
  ds_read_b64_tr_b16 v[66:67], v13 offset:768
  s_lshl_b32 s51, s83, 8
  v_add_u32 v15, s51, v14
  v_add_u32 v11, 52224, v10
  ds_read_b128 v[192:195], v15 offset:0
  ds_read_b128 v[200:203], v11 offset:0
  ds_read_b128 v[196:199], v15 offset:128
  ds_read_b128 v[204:207], v11 offset:128
  v_mfma_f32_32x32x16_bf16 v[16:31], v[68:71], v[52:55], v[16:31]
  ds_read_b128 v[52:55], v12 offset:32
  ds_read_b64_tr_b16 v[68:69], v13 offset:3072
  ds_read_b64_tr_b16 v[70:71], v13 offset:3840
  v_mfma_f32_32x32x16_bf16 v[16:31], v[72:75], v[56:59], v[16:31]
  ds_read_b128 v[56:59], v12 offset:64
  ds_read_b64_tr_b16 v[72:73], v13 offset:6144
  ds_read_b64_tr_b16 v[74:75], v13 offset:6912
  v_mfma_f32_32x32x16_bf16 v[16:31], v[76:79], v[60:63], v[16:31]
  ds_read_b128 v[60:63], v12 offset:96
  ds_read_b64_tr_b16 v[76:77], v13 offset:9216
  ds_read_b64_tr_b16 v[78:79], v13 offset:9984
  s_waitcnt lgkmcnt(13)
  v_mfma_f32_32x32x16_bf16 v[16:31], v[64:67], v[48:51], v[16:31]
  ds_read_b128 v[48:51], v12 offset:128
  ds_read_b64_tr_b16 v[64:65], v13 offset:12288
  ds_read_b64_tr_b16 v[66:67], v13 offset:13056
  s_waitcnt lgkmcnt(9)
  v_mfma_f32_32x32x16_bf16 v[16:31], v[68:71], v[52:55], v[16:31]
  ds_read_b128 v[52:55], v12 offset:160
  ds_read_b64_tr_b16 v[68:69], v13 offset:15360
  ds_read_b64_tr_b16 v[70:71], v13 offset:16128
  s_waitcnt lgkmcnt(9)
  v_mfma_f32_32x32x16_bf16 v[16:31], v[72:75], v[56:59], v[16:31]
  v_mfma_f32_32x32x16_bf16 v[32:47], v[192:195], v[200:203], v[32:47]
  ds_read_b128 v[56:59], v12 offset:192
  ds_read_b64_tr_b16 v[72:73], v13 offset:18432
  ds_read_b64_tr_b16 v[74:75], v13 offset:19200
  s_waitcnt lgkmcnt(9)
  v_mfma_f32_32x32x16_bf16 v[16:31], v[76:79], v[60:63], v[16:31]
  ds_read_b128 v[60:63], v12 offset:224
  ds_read_b64_tr_b16 v[76:77], v13 offset:21504
  ds_read_b64_tr_b16 v[78:79], v13 offset:22272
  s_waitcnt lgkmcnt(9)
  v_mfma_f32_32x32x16_bf16 v[16:31], v[64:67], v[48:51], v[16:31]
  v_mfma_f32_32x32x16_bf16 v[32:47], v[196:199], v[204:207], v[32:47]
  s_waitcnt vmcnt(0) lgkmcnt(0)
  s_barrier
  v_add_u32 v12, 69632, v8
  v_add_u32 v13, 111616, v9
  ds_read_b128 v[48:51], v12 offset:0
  ds_read_b64_tr_b16 v[64:65], v13 offset:0
  ds_read_b64_tr_b16 v[66:67], v13 offset:768
  s_lshl_b32 s51, s84, 8
  v_add_u32 v15, s51, v14
  v_add_u32 v11, 69632, v10
  ds_read_b128 v[176:179], v15 offset:0
  ds_read_b128 v[184:187], v11 offset:0
  ds_read_b128 v[180:183], v15 offset:128
  ds_read_b128 v[188:191], v11 offset:128
  v_mfma_f32_32x32x16_bf16 v[16:31], v[68:71], v[52:55], v[16:31]
  ds_read_b128 v[52:55], v12 offset:32
  ds_read_b64_tr_b16 v[68:69], v13 offset:3072
  ds_read_b64_tr_b16 v[70:71], v13 offset:3840
  v_mfma_f32_32x32x16_bf16 v[16:31], v[72:75], v[56:59], v[16:31]
  ds_read_b128 v[56:59], v12 offset:64
  ds_read_b64_tr_b16 v[72:73], v13 offset:6144
  ds_read_b64_tr_b16 v[74:75], v13 offset:6912
  v_mfma_f32_32x32x16_bf16 v[16:31], v[76:79], v[60:63], v[16:31]
  ds_read_b128 v[60:63], v12 offset:96
  ds_read_b64_tr_b16 v[76:77], v13 offset:9216
  ds_read_b64_tr_b16 v[78:79], v13 offset:9984
  s_waitcnt lgkmcnt(13)
  v_mfma_f32_32x32x16_bf16 v[16:31], v[64:67], v[48:51], v[16:31]
  ds_read_b128 v[48:51], v12 offset:128
  ds_read_b64_tr_b16 v[64:65], v13 offset:12288
  ds_read_b64_tr_b16 v[66:67], v13 offset:13056
  s_waitcnt lgkmcnt(9)
  v_mfma_f32_32x32x16_bf16 v[16:31], v[68:71], v[52:55], v[16:31]
  ds_read_b128 v[52:55], v12 offset:160
  ds_read_b64_tr_b16 v[68:69], v13 offset:15360
  ds_read_b64_tr_b16 v[70:71], v13 offset:16128
  s_waitcnt lgkmcnt(9)
  v_mfma_f32_32x32x16_bf16 v[16:31], v[72:75], v[56:59], v[16:31]
  v_mfma_f32_32x32x16_bf16 v[32:47], v[176:179], v[184:187], v[32:47]
  ds_read_b128 v[56:59], v12 offset:192
  ds_read_b64_tr_b16 v[72:73], v13 offset:18432
  ds_read_b64_tr_b16 v[74:75], v13 offset:19200
  s_waitcnt lgkmcnt(9)
  v_mfma_f32_32x32x16_bf16 v[16:31], v[76:79], v[60:63], v[16:31]
  ds_read_b128 v[60:63], v12 offset:224
  ds_read_b64_tr_b16 v[76:77], v13 offset:21504
  ds_read_b64_tr_b16 v[78:79], v13 offset:22272
  s_waitcnt lgkmcnt(9)
  v_mfma_f32_32x32x16_bf16 v[16:31], v[64:67], v[48:51], v[16:31]
  v_mfma_f32_32x32x16_bf16 v[32:47], v[180:183], v[188:191], v[32:47]
  s_waitcnt lgkmcnt(6)
  v_mfma_f32_32x32x16_bf16 v[16:31], v[68:71], v[52:55], v[16:31]
  s_waitcnt lgkmcnt(3)
  v_mfma_f32_32x32x16_bf16 v[16:31], v[72:75], v[56:59], v[16:31]
  s_waitcnt lgkmcnt(0)
  v_mfma_f32_32x32x16_bf16 v[16:31], v[76:79], v[60:63], v[16:31]
  s_cmp_lg_u32 s44, 7
  s_cbranch_scc1 gated_mix__grouped_kv_mqa__spectral_gfnet__prompt_kernel_kp16
  s_and_b32 s53, s2, 7
  s_lshl_b32 s53, s53, 7
  s_add_u32 s53, s53, 4096
  s_mov_b64 s[56:57], exec
  s_mov_b64 exec, 0xffffffff
  v_lshlrev_b32 v4, 2, v1
gated_mix__grouped_kv_mqa__spectral_gfnet__prompt_kernel_poll17:
  buffer_load_dword v5, v4, s[40:43], s53 offen sc1
  s_waitcnt vmcnt(0)
  v_cmp_ne_u32 vcc, s47, v5
  s_cbranch_vccz gated_mix__grouped_kv_mqa__spectral_gfnet__prompt_kernel_polld18
  s_sleep 2
  s_branch gated_mix__grouped_kv_mqa__spectral_gfnet__prompt_kernel_poll17
gated_mix__grouped_kv_mqa__spectral_gfnet__prompt_kernel_polld18:
  s_mov_b64 exec, s[56:57]
gated_mix__grouped_kv_mqa__spectral_gfnet__prompt_kernel_kp16:
gated_mix__grouped_kv_mqa__spectral_gfnet__prompt_kernel_JQ2:
  s_nop 15
  s_mov_b32 s50, 0x3ea52b5c
  v_mul_f32 v16, s50, v16
  v_mul_f32 v17, s50, v17
  v_mul_f32 v18, s50, v18
  v_mul_f32 v19, s50, v19
  v_mul_f32 v20, s50, v20
  v_mul_f32 v21, s50, v21
  v_mul_f32 v22, s50, v22
  v_mul_f32 v23, s50, v23
  v_mul_f32 v24, s50, v24
  v_mul_f32 v25, s50, v25
  v_mul_f32 v26, s50, v26
  v_mul_f32 v27, s50, v27
  v_cvt_pk_bf16_f32 v48, v16, v17
  v_cvt_pk_bf16_f32 v49, v18, v19
  v_cvt_pk_bf16_f32 v50, v20, v21
  v_cvt_pk_bf16_f32 v51, v22, v23
  v_cvt_pk_bf16_f32 v52, v24, v25
  v_cvt_pk_bf16_f32 v53, v26, v27
  v_cmp_gt_u32 vcc, 32, v1
  v_mul_f32 v54, v16, v16
  v_fmac_f32 v54, v17, v17
  v_fmac_f32 v54, v18, v18
  v_fmac_f32 v54, v19, v19
  v_fmac_f32 v54, v20, v20
  v_fmac_f32 v54, v21, v21
  v_fmac_f32 v54, v22, v22
  v_fmac_f32 v54, v23, v23
  v_mul_f32 v55, v24, v24
  v_fmac_f32 v55, v25, v25
  v_fmac_f32 v55, v26, v26
  v_fmac_f32 v55, v27, v27
  v_cndmask_b32 v55, 0, v55, vcc
  v_cndmask_b32 v52, 0, v52, vcc
  v_cndmask_b32 v53, 0, v53, vcc
  v_add_f32 v54, v54, v55
  v_mov_b32 v55, v54
  s_nop 1
  v_permlane32_swap_b32 v54, v55
  s_nop 1
  v_add_f32 v54, v54, v55
  s_nop 1
  v_max_f32_dpp v54, v54, v54 row_shr:1 row_mask:0xf bank_mask:0xf
  s_nop 1
  v_max_f32_dpp v54, v54, v54 row_shr:2 row_mask:0xf bank_mask:0xf
  s_nop 1
  v_max_f32_dpp v54, v54, v54 row_shr:4 row_mask:0xf bank_mask:0xf
  s_nop 1
  v_max_f32_dpp v54, v54, v54 row_shr:8 row_mask:0xf bank_mask:0xf
  s_nop 1
  v_max_f32_dpp v54, v54, v54 row_bcast:15 row_mask:0xa bank_mask:0xf
  s_nop 1
  v_readlane_b32 s50, v54, 31
  s_barrier
  s_lshl_b32 s51, s44, 10
  v_lshlrev_b32 v3, 4, v1
  v_add_u32 v3, s51, v3
  ds_write_b128 v3, v[48:51] offset:0
  s_lshl_b32 s51, s44, 8
  v_lshlrev_b32 v4, 3, v1
  v_add_u32 v4, s51, v4
  v_cmp_gt_u32 vcc, 32, v1
  v_mov_b32 v7, 2048
  s_nop 0
  v_cndmask_b32 v4, v7, v4, vcc
  ds_write_b64 v4, v[52:53] offset:8192
  s_lshl_b32 s51, s44, 2
  s_add_u32 s51, s51, 10272
  v_mov_b32 v5, s51
  v_mov_b32 v6, s50
  ds_write_b32 v5, v6
  s_lshr_b32 s51, s44, 1
  s_lshl_b32 s51, s51, 8
  s_and_b32 s52, s44, 1
  s_lshl_b32 s52, s52, 7
  s_add_u32 s51, s51, s52
  s_add_u32 s51, s51, 10368
  v_lshlrev_b32 v5, 2, v1
  v_add_u32 v5, s51, v5
  s_mov_b32 exec_hi, 0
  ds_write_b32 v5, v32
  s_mov_b64 exec, -1
  v_lshlrev_b32 v248, 4, v1
  v_lshlrev_b32 v249, 3, v1
  s_lshl_b32 s90, s44, 15
  s_add_u32 s90, s90, 65536
  s_cmp_lt_u32 s44, 2
  s_cbranch_scc1 gated_mix__grouped_kv_mqa__spectral_gfnet__prompt_kernel_ekv19
  s_waitcnt lgkmcnt(0)
  v_lshlrev_b32 v5, 3, v1
  s_mov_b32 s48, 335872
  buffer_load_dwordx2 v[20:21], v5, s[40:43], s48 offen sc1
  v_mov_b32 v72, 0
  v_mov_b32 v73, 0
  v_mov_b32 v74, 0
  v_mov_b32 v75, 0
  v_mov_b32 v76, 0
  v_mov_b32 v77, 0
  v_mov_b32 v78, 0
  v_mov_b32 v79, 0
  v_mov_b32 v56, 0
  v_mov_b32 v57, 0
  s_add_u32 s51, s90, 0
  buffer_load_dwordx4 v[24:27], v248, s[40:43], s51 offen
  s_mov_b32 exec_hi, 0
  buffer_load_dwordx2 v[56:57], v249, s[40:43], s51 offen offset:3072
  s_mov_b32 exec_lo, 0x1fffff
  s_mov_b32 exec_hi, 0x1fffff
  buffer_load_dwordx4 v[72:75], v248, s[40:43], s51 offen offset:1024
  buffer_load_dwordx4 v[76:79], v248, s[40:43], s51 offen offset:2048
  s_mov_b64 exec, -1
  v_mov_b32 v80, 0
  v_mov_b32 v81, 0
  v_mov_b32 v82, 0
  v_mov_b32 v83, 0
  v_mov_b32 v84, 0
  v_mov_b32 v85, 0
  v_mov_b32 v86, 0
  v_mov_b32 v87, 0
  v_mov_b32 v58, 0
  v_mov_b32 v59, 0
  s_add_u32 s51, s90, 4096
  buffer_load_dwordx4 v[28:31], v248, s[40:43], s51 offen
  s_mov_b32 exec_hi, 0
  buffer_load_dwordx2 v[58:59], v249, s[40:43], s51 offen offset:3072
  s_mov_b32 exec_lo, 0x1fffff
  s_mov_b32 exec_hi, 0x1fffff
  buffer_load_dwordx4 v[80:83], v248, s[40:43], s51 offen offset:1024
  buffer_load_dwordx4 v[84:87], v248, s[40:43], s51 offen offset:2048
  s_mov_b64 exec, -1
  v_mov_b32 v88, 0
  v_mov_b32 v89, 0
  v_mov_b32 v90, 0
  v_mov_b32 v91, 0
  v_mov_b32 v92, 0
  v_mov_b32 v93, 0
  v_mov_b32 v94, 0
  v_mov_b32 v95, 0
  v_mov_b32 v60, 0
  v_mov_b32 v61, 0
  s_add_u32 s51, s90, 8192
  buffer_load_dwordx4 v[32:35], v248, s[40:43], s51 offen
  s_mov_b32 exec_hi, 0
  buffer_load_dwordx2 v[60:61], v249, s[40:43], s51 offen offset:3072
  s_mov_b32 exec_lo, 0x1fffff
  s_mov_b32 exec_hi, 0x1fffff
  buffer_load_dwordx4 v[88:91], v248, s[40:43], s51 offen offset:1024
  buffer_load_dwordx4 v[92:95], v248, s[40:43], s51 offen offset:2048
  s_mov_b64 exec, -1
  v_mov_b32 v96, 0
  v_mov_b32 v97, 0
  v_mov_b32 v98, 0
  v_mov_b32 v99, 0
  v_mov_b32 v100, 0
  v_mov_b32 v101, 0
  v_mov_b32 v102, 0
  v_mov_b32 v103, 0
  v_mov_b32 v62, 0
  v_mov_b32 v63, 0
  s_add_u32 s51, s90, 12288
  buffer_load_dwordx4 v[36:39], v248, s[40:43], s51 offen
  s_mov_b32 exec_hi, 0
  buffer_load_dwordx2 v[62:63], v249, s[40:43], s51 offen offset:3072
  s_mov_b32 exec_lo, 0x1fffff
  s_mov_b32 exec_hi, 0x1fffff
  buffer_load_dwordx4 v[96:99], v248, s[40:43], s51 offen offset:1024
  buffer_load_dwordx4 v[100:103], v248, s[40:43], s51 offen offset:2048
  s_mov_b64 exec, -1
gated_mix__grouped_kv_mqa__spectral_gfnet__prompt_kernel_ekv19:
  v_mov_b32 v6, 0xff800000
  v_lshlrev_b32 v5, 2, v1
  s_lshl_b32 s51, s44, 7
  v_add_u32 v5, s51, v5
  s_mov_b32 exec_hi, 0
  ds_write_b32 v5, v6 offset:54400
  s_mov_b64 exec, -1
  v_mov_b32 v16, 0
  v_mov_b32 v17, 0
  v_mov_b32 v18, 0
  v_mov_b32 v19, 0
  v_lshlrev_b32 v5, 4, v0
  v_add_u32 v5, 11392, v5
  ds_write_b128 v5, v[16:19] offset:0
  ds_write_b128 v5, v[16:19] offset:8192
  ds_write_b128 v5, v[16:19] offset:16384
  ds_write_b128 v5, v[16:19] offset:24576
  ds_write_b128 v5, v[16:19] offset:32768
  v_cmp_gt_u32 vcc, 128, v0
  s_and_saveexec_b64 s[56:57], vcc
  ds_write_b128 v5, v[16:19] offset:40960
  s_mov_b64 exec, s[56:57]
  v_lshlrev_b32 v5, 2, v1
  v_add_u32 v5, 10304, v5
  s_mov_b64 exec, 0xffff
  ds_write_b32 v5, v16
  s_mov_b64 exec, -1
  s_waitcnt lgkmcnt(0)
  s_barrier
  s_cmp_lt_u32 s44, 2
  s_cbranch_scc0 gated_mix__grouped_kv_mqa__spectral_gfnet__prompt_kernel_kv20
  v_readfirstlane_b32 s61, v252
  s_and_b32 s48, s61, 511
  s_cmp_eq_u32 s48, 511
  s_cbranch_scc1 gated_mix__grouped_kv_mqa__spectral_gfnet__prompt_kernel_noc22
  v_lshlrev_b32 v6, 4, v1
  s_mov_b32 s53, 8192
  buffer_load_dwordx4 v[8:11], v6, s[40:43], s53 offen sc1
  v_lshlrev_b32 v3, 4, v1
  s_mul_i32 s48, s44, 31744
  s_add_u32 s49, s48, 13312
  v_add_u32 v3, s49, v3
  v_mov_b32 v5, s73
  v_add_co_u32 v4, vcc, s72, v3
  v_addc_co_u32 v5, vcc, 0, v5, vcc
  s_add_u32 m0, s48, 60544
  s_nop 0
  global_load_lds_dwordx4 v[4:5], off
  s_add_u32 m0, s48, 61568
  v_add_co_u32 v4, vcc, 0x400, v4
  v_addc_co_u32 v5, vcc, 0, v5, vcc
  global_load_lds_dwordx4 v[4:5], off
  s_add_u32 m0, s48, 62592
  v_add_co_u32 v4, vcc, 0x400, v4
  v_addc_co_u32 v5, vcc, 0, v5, vcc
  global_load_lds_dwordx4 v[4:5], off
  s_add_u32 m0, s48, 63616
  v_add_co_u32 v4, vcc, 0x400, v4
  v_addc_co_u32 v5, vcc, 0, v5, vcc
  global_load_lds_dwordx4 v[4:5], off
  s_add_u32 m0, s48, 64640
  v_add_co_u32 v4, vcc, 0x400, v4
  v_addc_co_u32 v5, vcc, 0, v5, vcc
  global_load_lds_dwordx4 v[4:5], off
  s_add_u32 m0, s48, 65664
  v_add_co_u32 v4, vcc, 0x400, v4
  v_addc_co_u32 v5, vcc, 0, v5, vcc
  global_load_lds_dwordx4 v[4:5], off
  s_add_u32 m0, s48, 66688
  v_add_co_u32 v4, vcc, 0x400, v4
  v_addc_co_u32 v5, vcc, 0, v5, vcc
  global_load_lds_dwordx4 v[4:5], off
  s_add_u32 m0, s48, 67712
  v_add_co_u32 v4, vcc, 0x400, v4
  v_addc_co_u32 v5, vcc, 0, v5, vcc
  global_load_lds_dwordx4 v[4:5], off
  s_add_u32 m0, s48, 68736
  v_add_co_u32 v4, vcc, 0x400, v4
  v_addc_co_u32 v5, vcc, 0, v5, vcc
  global_load_lds_dwordx4 v[4:5], off
  s_add_u32 m0, s48, 69760
  v_add_co_u32 v4, vcc, 0x400, v4
  v_addc_co_u32 v5, vcc, 0, v5, vcc
  global_load_lds_dwordx4 v[4:5], off
  s_add_u32 m0, s48, 70784
  v_add_co_u32 v4, vcc, 0x400, v4
  v_addc_co_u32 v5, vcc, 0, v5, vcc
  global_load_lds_dwordx4 v[4:5], off
  s_add_u32 m0, s48, 71808
  v_add_co_u32 v4, vcc, 0x400, v4
  v_addc_co_u32 v5, vcc, 0, v5, vcc
  global_load_lds_dwordx4 v[4:5], off
  s_add_u32 m0, s48, 72832
  v_add_co_u32 v4, vcc, 0x400, v4
  v_addc_co_u32 v5, vcc, 0, v5, vcc
  global_load_lds_dwordx4 v[4:5], off
  s_add_u32 m0, s48, 73856
  v_add_co_u32 v4, vcc, 0x400, v4
  v_addc_co_u32 v5, vcc, 0, v5, vcc
  global_load_lds_dwordx4 v[4:5], off
  s_add_u32 m0, s48, 74880
  v_add_co_u32 v4, vcc, 0x400, v4
  v_addc_co_u32 v5, vcc, 0, v5, vcc
  global_load_lds_dwordx4 v[4:5], off
  s_add_u32 m0, s48, 75904
  v_add_co_u32 v4, vcc, 0x400, v4
  v_addc_co_u32 v5, vcc, 0, v5, vcc
  global_load_lds_dwordx4 v[4:5], off
  s_add_u32 m0, s48, 76928
  v_add_co_u32 v4, vcc, 0x400, v4
  v_addc_co_u32 v5, vcc, 0, v5, vcc
  global_load_lds_dwordx4 v[4:5], off
  s_add_u32 m0, s48, 77952
  v_add_co_u32 v4, vcc, 0x400, v4
  v_addc_co_u32 v5, vcc, 0, v5, vcc
  global_load_lds_dwordx4 v[4:5], off
  s_add_u32 m0, s48, 78976
  v_add_co_u32 v4, vcc, 0x400, v4
  v_addc_co_u32 v5, vcc, 0, v5, vcc
  global_load_lds_dwordx4 v[4:5], off
  s_add_u32 m0, s48, 80000
  v_add_co_u32 v4, vcc, 0x400, v4
  v_addc_co_u32 v5, vcc, 0, v5, vcc
  global_load_lds_dwordx4 v[4:5], off
  s_add_u32 m0, s48, 81024
  v_add_co_u32 v4, vcc, 0x400, v4
  v_addc_co_u32 v5, vcc, 0, v5, vcc
  global_load_lds_dwordx4 v[4:5], off
  s_add_u32 m0, s48, 82048
  v_add_co_u32 v4, vcc, 0x400, v4
  v_addc_co_u32 v5, vcc, 0, v5, vcc
  global_load_lds_dwordx4 v[4:5], off
  s_add_u32 m0, s48, 83072
  v_add_co_u32 v4, vcc, 0x400, v4
  v_addc_co_u32 v5, vcc, 0, v5, vcc
  global_load_lds_dwordx4 v[4:5], off
  s_add_u32 m0, s48, 84096
  v_add_co_u32 v4, vcc, 0x400, v4
  v_addc_co_u32 v5, vcc, 0, v5, vcc
  global_load_lds_dwordx4 v[4:5], off
  s_add_u32 m0, s48, 85120
  v_add_co_u32 v4, vcc, 0x400, v4
  v_addc_co_u32 v5, vcc, 0, v5, vcc
  global_load_lds_dwordx4 v[4:5], off
  s_add_u32 m0, s48, 86144
  v_add_co_u32 v4, vcc, 0x400, v4
  v_addc_co_u32 v5, vcc, 0, v5, vcc
  global_load_lds_dwordx4 v[4:5], off
  s_add_u32 m0, s48, 87168
  v_add_co_u32 v4, vcc, 0x400, v4
  v_addc_co_u32 v5, vcc, 0, v5, vcc
  global_load_lds_dwordx4 v[4:5], off
  s_add_u32 m0, s48, 88192
  v_add_co_u32 v4, vcc, 0x400, v4
  v_addc_co_u32 v5, vcc, 0, v5, vcc
  global_load_lds_dwordx4 v[4:5], off
  s_add_u32 m0, s48, 89216
  v_add_co_u32 v4, vcc, 0x400, v4
  v_addc_co_u32 v5, vcc, 0, v5, vcc
  global_load_lds_dwordx4 v[4:5], off
  s_add_u32 m0, s48, 90240
  v_add_co_u32 v4, vcc, 0x400, v4
  v_addc_co_u32 v5, vcc, 0, v5, vcc
  global_load_lds_dwordx4 v[4:5], off
  s_add_u32 m0, s48, 91264
  v_add_co_u32 v4, vcc, 0x400, v4
  v_addc_co_u32 v5, vcc, 0, v5, vcc
  global_load_lds_dwordx4 v[4:5], off
  s_waitcnt vmcnt(31)
  v_xor_b32 v8, s47, v8
  v_xor_b32 v9, s47, v9
  v_xor_b32 v10, s47, v10
  v_xor_b32 v11, s47, v11
  v_or_b32 v8, v8, v9
  v_or_b32 v10, v10, v11
  v_or_b32 v8, v8, v10
  v_cmp_ne_u32 vcc, 0, v8
  s_cbranch_vccz gated_mix__grouped_kv_mqa__spectral_gfnet__prompt_kernel_fxok26
  s_mov_b32 s53, 8192
  s_mov_b64 s[56:57], exec
  v_lshlrev_b32 v4, 4, v1
gated_mix__grouped_kv_mqa__spectral_gfnet__prompt_kernel_poll27:
  buffer_load_dwordx4 v[6:9], v4, s[40:43], s53 offen sc1
  s_waitcnt vmcnt(0)
  v_xor_b32 v6, s47, v6
  v_xor_b32 v7, s47, v7
  v_xor_b32 v8, s47, v8
  v_xor_b32 v9, s47, v9
  v_or_b32 v6, v6, v7
  v_or_b32 v8, v8, v9
  v_or_b32 v6, v6, v8
  v_cmp_ne_u32 vcc, 0, v6
  s_cbranch_vccz gated_mix__grouped_kv_mqa__spectral_gfnet__prompt_kernel_polld28
  s_sleep 8
  s_branch gated_mix__grouped_kv_mqa__spectral_gfnet__prompt_kernel_poll27
gated_mix__grouped_kv_mqa__spectral_gfnet__prompt_kernel_polld28:
  s_mov_b64 exec, s[56:57]
gated_mix__grouped_kv_mqa__spectral_gfnet__prompt_kernel_fxok26:
  v_readfirstlane_b32 s61, v252
  s_mul_i32 s48, s44, 9
  s_lshr_b32 s61, s61, s48
  s_and_b32 s61, s61, 511
  s_cmp_lg_u32 s61, 511
  s_cbranch_scc1 gated_mix__grouped_kv_mqa__spectral_gfnet__prompt_kernel_has29
  s_waitcnt vmcnt(0)
  v_mov_b32 v5, 10332
  v_mov_b32 v6, 1
  s_mov_b64 exec, 1
  ds_add_u32 v5, v6
  s_mov_b64 exec, -1
  s_branch gated_mix__grouped_kv_mqa__spectral_gfnet__prompt_kernel_noc22
gated_mix__grouped_kv_mqa__spectral_gfnet__prompt_kernel_has29:
  s_mul_i32 s62, s44, 8192
  s_add_u32 s62, s62, 131072
  v_and_b32 v3, 31, v1
  v_lshrrev_b32 v4, 5, v1
  s_lshl_b32 s48, s61, 13
  s_lshl_b32 s50, s61, 4
  s_add_u32 s50, s50, 4194304
  v_lshl_add_u32 v8, v4, 6, v3
  s_mov_b32 s51, 20736
  v_mul_lo_u32 v8, v8, s51
  s_add_u32 s49, s50, 0
  buffer_load_dwordx4 v[16:19], v8, s[40:43], s49 offen sc1
  s_add_u32 s49, s50, 5184
  buffer_load_dwordx4 v[24:27], v8, s[40:43], s49 offen sc1
  s_add_u32 s49, s50, 2654208
  buffer_load_dwordx4 v[20:23], v8, s[40:43], s49 offen sc1
  s_add_u32 s49, s50, 2659392
  buffer_load_dwordx4 v[28:31], v8, s[40:43], s49 offen sc1
  s_add_u32 s49, s50, 663552
  buffer_load_dwordx4 v[32:35], v8, s[40:43], s49 offen sc1
  s_add_u32 s49, s50, 668736
  buffer_load_dwordx4 v[40:43], v8, s[40:43], s49 offen sc1
  s_add_u32 s49, s50, 3317760
  buffer_load_dwordx4 v[36:39], v8, s[40:43], s49 offen sc1
  s_add_u32 s49, s50, 3322944
  buffer_load_dwordx4 v[44:47], v8, s[40:43], s49 offen sc1
  v_mul_lo_u32 v9, v3, s51
  v_mul_u32_u24 v10, 5184, v4
  v_add_u32 v9, v9, v10
  s_add_u32 s49, s50, 10368
  buffer_load_dwordx4 v[48:51], v9, s[40:43], s49 offen sc1
  s_add_u32 s49, s50, 673920
  buffer_load_dwordx4 v[52:55], v9, s[40:43], s49 offen sc1
  s_add_u32 s49, s50, 1337472
  buffer_load_dwordx4 v[56:59], v9, s[40:43], s49 offen sc1
  s_add_u32 s49, s50, 2001024
  buffer_load_dwordx4 v[60:63], v9, s[40:43], s49 offen sc1
  s_add_u32 s49, s50, 2664576
  buffer_load_dwordx4 v[64:67], v9, s[40:43], s49 offen sc1
  s_add_u32 s49, s50, 3328128
  buffer_load_dwordx4 v[68:71], v9, s[40:43], s49 offen sc1
  s_add_u32 s49, s50, 3991680
  buffer_load_dwordx4 v[72:75], v9, s[40:43], s49 offen sc1
  s_add_u32 s49, s50, 4655232
  buffer_load_dwordx4 v[76:79], v9, s[40:43], s49 offen sc1
  s_waitcnt vmcnt(16)
  v_mov_b32 v5, 10332
  v_mov_b32 v6, 1
  s_mov_b64 exec, 1
  ds_add_u32 v5, v6
  s_mov_b64 exec, -1
  s_waitcnt vmcnt(0)
  v_mov_b32 v5, 10332
gated_mix__grouped_kv_mqa__spectral_gfnet__prompt_kernel_lw31:
  ds_read_b32 v6, v5
  s_waitcnt lgkmcnt(0)
  v_readfirstlane_b32 s48, v6
  s_cmp_lt_u32 s48, 2
  s_cbranch_scc0 gated_mix__grouped_kv_mqa__spectral_gfnet__prompt_kernel_lq32
  s_sleep 2
  s_branch gated_mix__grouped_kv_mqa__spectral_gfnet__prompt_kernel_lw31
gated_mix__grouped_kv_mqa__spectral_gfnet__prompt_kernel_lq32:
  s_lshl_b32 s48, s61, 13
  v_lshlrev_b32 v10, 4, v1
  v_add_u32 v10, 60544, v10
  v_add_u32 v11, 0x8000, v10
  ds_read_b128 v[176:179], v10 offset:24576
  ds_read_b128 v[180:183], v10 offset:25600
  ds_read_b128 v[184:187], v10 offset:26624
  ds_read_b128 v[188:191], v10 offset:27648
  ds_read_b128 v[192:195], v10 offset:28672
  ds_read_b128 v[196:199], v10 offset:29696
  s_waitcnt lgkmcnt(0)
  v_mfma_f32_32x32x16_bf16 v[80:95], v[16:19], v[176:179], 0
  v_mfma_f32_32x32x16_bf16 v[96:111], v[24:27], v[176:179], 0
  v_mfma_f32_32x32x16_bf16 v[80:95], v[24:27], v[180:183], v[80:95]
  v_mfma_f32_32x32x16_bf16 v[96:111], v[16:19], v[184:187], v[96:111]
  v_mfma_f32_32x32x16_bf16 v[80:95], v[20:23], v[188:191], v[80:95]
  v_mfma_f32_32x32x16_bf16 v[96:111], v[28:31], v[188:191], v[96:111]
  v_mfma_f32_32x32x16_bf16 v[80:95], v[28:31], v[192:195], v[80:95]
  v_mfma_f32_32x32x16_bf16 v[96:111], v[20:23], v[196:199], v[96:111]
  v_mfma_f32_32x32x16_bf16 v[112:127], v[32:35], v[176:179], 0
  v_mfma_f32_32x32x16_bf16 v[128:143], v[40:43], v[176:179], 0
  v_mfma_f32_32x32x16_bf16 v[112:127], v[40:43], v[180:183], v[112:127]
  v_mfma_f32_32x32x16_bf16 v[128:143], v[32:35], v[184:187], v[128:143]
  v_mfma_f32_32x32x16_bf16 v[112:127], v[36:39], v[188:191], v[112:127]
  v_mfma_f32_32x32x16_bf16 v[128:143], v[44:47], v[188:191], v[128:143]
  v_mfma_f32_32x32x16_bf16 v[112:127], v[44:47], v[192:195], v[112:127]
  v_mfma_f32_32x32x16_bf16 v[128:143], v[36:39], v[196:199], v[128:143]
  ds_read_b128 v[212:215], v10 offset:30720
  ds_read_b128 v[216:219], v10 offset:31744
  ds_read_b128 v[220:223], v11 offset:0
  ds_read_b128 v[224:227], v11 offset:1024
  s_nop 13
  s_waitcnt lgkmcnt(2)
  v_pk_mul_f32 v[228:229], v[80:81], v[212:213]
  v_pk_mul_f32 v[232:233], v[96:97], v[212:213]
  v_pk_fma_f32 v[228:229], v[96:97], v[216:217], v[228:229]
  v_pk_fma_f32 v[232:233], v[80:81], v[216:217], v[232:233] neg_lo:[1,0,0] neg_hi:[1,0,0]
  v_pk_mul_f32 v[230:231], v[82:83], v[214:215]
  v_pk_mul_f32 v[234:235], v[98:99], v[214:215]
  v_pk_fma_f32 v[230:231], v[98:99], v[218:219], v[230:231]
  v_pk_fma_f32 v[234:235], v[82:83], v[218:219], v[234:235] neg_lo:[1,0,0] neg_hi:[1,0,0]
  ds_read_b128 v[212:215], v11 offset:2048
  ds_read_b128 v[216:219], v11 offset:3072
  v_cvt_pk_bf16_f32 v144, v228, v229
  v_cvt_pk_bf16_f32 v160, v232, v233
  v_cvt_pk_bf16_f32 v145, v230, v231
  v_cvt_pk_bf16_f32 v161, v234, v235
  s_waitcnt lgkmcnt(2)
  v_pk_mul_f32 v[228:229], v[84:85], v[220:221]
  v_pk_mul_f32 v[232:233], v[100:101], v[220:221]
  v_pk_fma_f32 v[228:229], v[100:101], v[224:225], v[228:229]
  v_pk_fma_f32 v[232:233], v[84:85], v[224:225], v[232:233] neg_lo:[1,0,0] neg_hi:[1,0,0]
  v_pk_mul_f32 v[230:231], v[86:87], v[222:223]
  v_pk_mul_f32 v[234:235], v[102:103], v[222:223]
  v_pk_fma_f32 v[230:231], v[102:103], v[226:227], v[230:231]
  v_pk_fma_f32 v[234:235], v[86:87], v[226:227], v[234:235] neg_lo:[1,0,0] neg_hi:[1,0,0]
  ds_read_b128 v[220:223], v11 offset:4096
  ds_read_b128 v[224:227], v11 offset:5120
  v_cvt_pk_bf16_f32 v146, v228, v229
  v_cvt_pk_bf16_f32 v162, v232, v233
  v_cvt_pk_bf16_f32 v147, v230, v231
  v_cvt_pk_bf16_f32 v163, v234, v235
  s_waitcnt lgkmcnt(2)
  v_pk_mul_f32 v[228:229], v[88:89], v[212:213]
  v_pk_mul_f32 v[232:233], v[104:105], v[212:213]
  v_pk_fma_f32 v[228:229], v[104:105], v[216:217], v[228:229]
  v_pk_fma_f32 v[232:233], v[88:89], v[216:217], v[232:233] neg_lo:[1,0,0] neg_hi:[1,0,0]
  v_pk_mul_f32 v[230:231], v[90:91], v[214:215]
  v_pk_mul_f32 v[234:235], v[106:107], v[214:215]
  v_pk_fma_f32 v[230:231], v[106:107], v[218:219], v[230:231]
  v_pk_fma_f32 v[234:235], v[90:91], v[218:219], v[234:235] neg_lo:[1,0,0] neg_hi:[1,0,0]
  ds_read_b128 v[212:215], v11 offset:6144
  ds_read_b128 v[216:219], v11 offset:7168
  v_cvt_pk_bf16_f32 v148, v228, v229
  v_cvt_pk_bf16_f32 v164, v232, v233
  v_cvt_pk_bf16_f32 v149, v230, v231
  v_cvt_pk_bf16_f32 v165, v234, v235
  s_waitcnt lgkmcnt(2)
  v_pk_mul_f32 v[228:229], v[92:93], v[220:221]
  v_pk_mul_f32 v[232:233], v[108:109], v[220:221]
  v_pk_fma_f32 v[228:229], v[108:109], v[224:225], v[228:229]
  v_pk_fma_f32 v[232:233], v[92:93], v[224:225], v[232:233] neg_lo:[1,0,0] neg_hi:[1,0,0]
  v_pk_mul_f32 v[230:231], v[94:95], v[222:223]
  v_pk_mul_f32 v[234:235], v[110:111], v[222:223]
  v_pk_fma_f32 v[230:231], v[110:111], v[226:227], v[230:231]
  v_pk_fma_f32 v[234:235], v[94:95], v[226:227], v[234:235] neg_lo:[1,0,0] neg_hi:[1,0,0]
  ds_read_b128 v[220:223], v11 offset:8192
  ds_read_b128 v[224:227], v11 offset:9216
  v_cvt_pk_bf16_f32 v150, v228, v229
  v_cvt_pk_bf16_f32 v166, v232, v233
  v_cvt_pk_bf16_f32 v151, v230, v231
  v_cvt_pk_bf16_f32 v167, v234, v235
  s_waitcnt lgkmcnt(2)
  v_pk_mul_f32 v[228:229], v[112:113], v[212:213]
  v_pk_mul_f32 v[232:233], v[128:129], v[212:213]
  v_pk_fma_f32 v[228:229], v[128:129], v[216:217], v[228:229]
  v_pk_fma_f32 v[232:233], v[112:113], v[216:217], v[232:233] neg_lo:[1,0,0] neg_hi:[1,0,0]
  v_pk_mul_f32 v[230:231], v[114:115], v[214:215]
  v_pk_mul_f32 v[234:235], v[130:131], v[214:215]
  v_pk_fma_f32 v[230:231], v[130:131], v[218:219], v[230:231]
  v_pk_fma_f32 v[234:235], v[114:115], v[218:219], v[234:235] neg_lo:[1,0,0] neg_hi:[1,0,0]
  ds_read_b128 v[212:215], v11 offset:10240
  ds_read_b128 v[216:219], v11 offset:11264
  v_cvt_pk_bf16_f32 v152, v228, v229
  v_cvt_pk_bf16_f32 v168, v232, v233
  v_cvt_pk_bf16_f32 v153, v230, v231
  v_cvt_pk_bf16_f32 v169, v234, v235
  s_waitcnt lgkmcnt(2)
  v_pk_mul_f32 v[228:229], v[116:117], v[220:221]
  v_pk_mul_f32 v[232:233], v[132:133], v[220:221]
  v_pk_fma_f32 v[228:229], v[132:133], v[224:225], v[228:229]
  v_pk_fma_f32 v[232:233], v[116:117], v[224:225], v[232:233] neg_lo:[1,0,0] neg_hi:[1,0,0]
  v_pk_mul_f32 v[230:231], v[118:119], v[222:223]
  v_pk_mul_f32 v[234:235], v[134:135], v[222:223]
  v_pk_fma_f32 v[230:231], v[134:135], v[226:227], v[230:231]
  v_pk_fma_f32 v[234:235], v[118:119], v[226:227], v[234:235] neg_lo:[1,0,0] neg_hi:[1,0,0]
  ds_read_b128 v[220:223], v11 offset:12288
  ds_read_b128 v[224:227], v11 offset:13312
  v_cvt_pk_bf16_f32 v154, v228, v229
  v_cvt_pk_bf16_f32 v170, v232, v233
  v_cvt_pk_bf16_f32 v155, v230, v231
  v_cvt_pk_bf16_f32 v171, v234, v235
  s_waitcnt lgkmcnt(2)
  v_pk_mul_f32 v[228:229], v[120:121], v[212:213]
  v_pk_mul_f32 v[232:233], v[136:137], v[212:213]
  v_pk_fma_f32 v[228:229], v[136:137], v[216:217], v[228:229]
  v_pk_fma_f32 v[232:233], v[120:121], v[216:217], v[232:233] neg_lo:[1,0,0] neg_hi:[1,0,0]
  v_pk_mul_f32 v[230:231], v[122:123], v[214:215]
  v_pk_mul_f32 v[234:235], v[138:139], v[214:215]
  v_pk_fma_f32 v[230:231], v[138:139], v[218:219], v[230:231]
  v_pk_fma_f32 v[234:235], v[122:123], v[218:219], v[234:235] neg_lo:[1,0,0] neg_hi:[1,0,0]
  v_cvt_pk_bf16_f32 v156, v228, v229
  v_cvt_pk_bf16_f32 v172, v232, v233
  v_cvt_pk_bf16_f32 v157, v230, v231
  v_cvt_pk_bf16_f32 v173, v234, v235
  s_waitcnt lgkmcnt(0)
  v_pk_mul_f32 v[228:229], v[124:125], v[220:221]
  v_pk_mul_f32 v[232:233], v[140:141], v[220:221]
  v_pk_fma_f32 v[228:229], v[140:141], v[224:225], v[228:229]
  v_pk_fma_f32 v[232:233], v[124:125], v[224:225], v[232:233] neg_lo:[1,0,0] neg_hi:[1,0,0]
  v_pk_mul_f32 v[230:231], v[126:127], v[222:223]
  v_pk_mul_f32 v[234:235], v[142:143], v[222:223]
  v_pk_fma_f32 v[230:231], v[142:143], v[226:227], v[230:231]
  v_pk_fma_f32 v[234:235], v[126:127], v[226:227], v[234:235] neg_lo:[1,0,0] neg_hi:[1,0,0]
  v_cvt_pk_bf16_f32 v158, v228, v229
  v_cvt_pk_bf16_f32 v174, v232, v233
  v_cvt_pk_bf16_f32 v159, v230, v231
  v_cvt_pk_bf16_f32 v175, v234, v235
  s_nop 1
  ds_read_b128 v[176:179], v10 offset:0
  ds_read_b128 v[180:183], v10 offset:1024
  ds_read_b128 v[184:187], v10 offset:2048
  ds_read_b128 v[188:191], v10 offset:3072
  ds_read_b128 v[192:195], v10 offset:4096
  ds_read_b128 v[196:199], v10 offset:5120
  ds_read_b128 v[200:203], v10 offset:6144
  ds_read_b128 v[204:207], v10 offset:7168
  ds_read_b128 v[208:211], v10 offset:8192
  s_waitcnt lgkmcnt(6)
  v_mfma_f32_32x32x16_bf16 v[80:95], v[176:179], v[144:147], 0
  v_mfma_f32_32x32x16_bf16 v[96:111], v[176:179], v[160:163], 0
  v_mfma_f32_32x32x16_bf16 v[80:95], v[180:183], v[160:163], v[80:95]
  v_mfma_f32_32x32x16_bf16 v[96:111], v[184:187], v[144:147], v[96:111]
  ds_read_b128 v[176:179], v10 offset:9216
  ds_read_b128 v[180:183], v10 offset:10240
  ds_read_b128 v[184:187], v10 offset:11264
  s_waitcnt lgkmcnt(6)
  v_mfma_f32_32x32x16_bf16 v[80:95], v[188:191], v[148:151], v[80:95]
  v_mfma_f32_32x32x16_bf16 v[96:111], v[188:191], v[164:167], v[96:111]
  v_mfma_f32_32x32x16_bf16 v[80:95], v[192:195], v[164:167], v[80:95]
  v_mfma_f32_32x32x16_bf16 v[96:111], v[196:199], v[148:151], v[96:111]
  ds_read_b128 v[188:191], v10 offset:12288
  ds_read_b128 v[192:195], v10 offset:13312
  ds_read_b128 v[196:199], v10 offset:14336
  s_waitcnt lgkmcnt(6)
  v_mfma_f32_32x32x16_bf16 v[80:95], v[200:203], v[152:155], v[80:95]
  v_mfma_f32_32x32x16_bf16 v[96:111], v[200:203], v[168:171], v[96:111]
  v_mfma_f32_32x32x16_bf16 v[80:95], v[204:207], v[168:171], v[80:95]
  v_mfma_f32_32x32x16_bf16 v[96:111], v[208:211], v[152:155], v[96:111]
  ds_read_b128 v[200:203], v10 offset:15360
  ds_read_b128 v[204:207], v10 offset:16384
  ds_read_b128 v[208:211], v10 offset:17408
  s_waitcnt lgkmcnt(6)
  v_mfma_f32_32x32x16_bf16 v[80:95], v[176:179], v[156:159], v[80:95]
  v_mfma_f32_32x32x16_bf16 v[96:111], v[176:179], v[172:175], v[96:111]
  v_mfma_f32_32x32x16_bf16 v[80:95], v[180:183], v[172:175], v[80:95]
  v_mfma_f32_32x32x16_bf16 v[96:111], v[184:187], v[156:159], v[96:111]
  ds_read_b128 v[176:179], v10 offset:18432
  ds_read_b128 v[180:183], v10 offset:19456
  ds_read_b128 v[184:187], v10 offset:20480
  s_waitcnt lgkmcnt(6)
  v_mfma_f32_32x32x16_bf16 v[112:127], v[188:191], v[144:147], 0
  v_mfma_f32_32x32x16_bf16 v[128:143], v[188:191], v[160:163], 0
  v_mfma_f32_32x32x16_bf16 v[112:127], v[192:195], v[160:163], v[112:127]
  v_mfma_f32_32x32x16_bf16 v[128:143], v[196:199], v[144:147], v[128:143]
  ds_read_b128 v[188:191], v10 offset:21504
  ds_read_b128 v[192:195], v10 offset:22528
  ds_read_b128 v[196:199], v10 offset:23552
  s_waitcnt lgkmcnt(6)
  v_mfma_f32_32x32x16_bf16 v[112:127], v[200:203], v[148:151], v[112:127]
  v_mfma_f32_32x32x16_bf16 v[128:143], v[200:203], v[164:167], v[128:143]
  v_mfma_f32_32x32x16_bf16 v[112:127], v[204:207], v[164:167], v[112:127]
  v_mfma_f32_32x32x16_bf16 v[128:143], v[208:211], v[148:151], v[128:143]
  s_waitcnt lgkmcnt(3)
  v_mfma_f32_32x32x16_bf16 v[112:127], v[176:179], v[152:155], v[112:127]
  v_mfma_f32_32x32x16_bf16 v[128:143], v[176:179], v[168:171], v[128:143]
  v_mfma_f32_32x32x16_bf16 v[112:127], v[180:183], v[168:171], v[112:127]
  v_mfma_f32_32x32x16_bf16 v[128:143], v[184:187], v[152:155], v[128:143]
  s_waitcnt lgkmcnt(0)
  v_mfma_f32_32x32x16_bf16 v[112:127], v[188:191], v[156:159], v[112:127]
  v_mfma_f32_32x32x16_bf16 v[128:143], v[188:191], v[172:175], v[128:143]
  v_mfma_f32_32x32x16_bf16 v[112:127], v[192:195], v[172:175], v[112:127]
  v_mfma_f32_32x32x16_bf16 v[128:143], v[196:199], v[156:159], v[128:143]
  s_waitcnt vmcnt(0)
  s_nop 15
  v_lshlrev_b32 v212, 16, v48
  v_and_b32 v216, 0xffff0000, v48
  v_lshlrev_b32 v213, 16, v49
  v_and_b32 v217, 0xffff0000, v49
  v_lshlrev_b32 v214, 16, v50
  v_and_b32 v218, 0xffff0000, v50
  v_lshlrev_b32 v215, 16, v51
  v_and_b32 v219, 0xffff0000, v51
  v_pk_mul_f32 v[228:229], v[80:81], v[212:213]
  v_pk_mul_f32 v[232:233], v[80:81], v[216:217]
  v_pk_fma_f32 v[228:229], v[96:97], v[216:217], v[228:229] neg_lo:[1,0,0] neg_hi:[1,0,0]
  v_pk_fma_f32 v[232:233], v[96:97], v[212:213], v[232:233]
  v_pk_mul_f32 v[230:231], v[82:83], v[214:215]
  v_pk_mul_f32 v[234:235], v[82:83], v[218:219]
  v_pk_fma_f32 v[230:231], v[98:99], v[218:219], v[230:231] neg_lo:[1,0,0] neg_hi:[1,0,0]
  v_pk_fma_f32 v[234:235], v[98:99], v[214:215], v[234:235]
  v_cvt_pk_bf16_f32 v144, v228, v229
  v_cvt_pk_bf16_f32 v160, -v232, -v233
  v_cvt_pk_bf16_f32 v145, v230, v231
  v_cvt_pk_bf16_f32 v161, -v234, -v235
  v_lshlrev_b32 v212, 16, v52
  v_and_b32 v216, 0xffff0000, v52
  v_lshlrev_b32 v213, 16, v53
  v_and_b32 v217, 0xffff0000, v53
  v_lshlrev_b32 v214, 16, v54
  v_and_b32 v218, 0xffff0000, v54
  v_lshlrev_b32 v215, 16, v55
  v_and_b32 v219, 0xffff0000, v55
  v_pk_mul_f32 v[228:229], v[84:85], v[212:213]
  v_pk_mul_f32 v[232:233], v[84:85], v[216:217]
  v_pk_fma_f32 v[228:229], v[100:101], v[216:217], v[228:229] neg_lo:[1,0,0] neg_hi:[1,0,0]
  v_pk_fma_f32 v[232:233], v[100:101], v[212:213], v[232:233]
  v_pk_mul_f32 v[230:231], v[86:87], v[214:215]
  v_pk_mul_f32 v[234:235], v[86:87], v[218:219]
  v_pk_fma_f32 v[230:231], v[102:103], v[218:219], v[230:231] neg_lo:[1,0,0] neg_hi:[1,0,0]
  v_pk_fma_f32 v[234:235], v[102:103], v[214:215], v[234:235]
  v_cvt_pk_bf16_f32 v146, v228, v229
  v_cvt_pk_bf16_f32 v162, -v232, -v233
  v_cvt_pk_bf16_f32 v147, v230, v231
  v_cvt_pk_bf16_f32 v163, -v234, -v235
  v_lshlrev_b32 v212, 16, v56
  v_and_b32 v216, 0xffff0000, v56
  v_lshlrev_b32 v213, 16, v57
  v_and_b32 v217, 0xffff0000, v57
  v_lshlrev_b32 v214, 16, v58
  v_and_b32 v218, 0xffff0000, v58
  v_lshlrev_b32 v215, 16, v59
  v_and_b32 v219, 0xffff0000, v59
  v_pk_mul_f32 v[228:229], v[88:89], v[212:213]
  v_pk_mul_f32 v[232:233], v[88:89], v[216:217]
  v_pk_fma_f32 v[228:229], v[104:105], v[216:217], v[228:229] neg_lo:[1,0,0] neg_hi:[1,0,0]
  v_pk_fma_f32 v[232:233], v[104:105], v[212:213], v[232:233]
  v_pk_mul_f32 v[230:231], v[90:91], v[214:215]
  v_pk_mul_f32 v[234:235], v[90:91], v[218:219]
  v_pk_fma_f32 v[230:231], v[106:107], v[218:219], v[230:231] neg_lo:[1,0,0] neg_hi:[1,0,0]
  v_pk_fma_f32 v[234:235], v[106:107], v[214:215], v[234:235]
  v_cvt_pk_bf16_f32 v148, v228, v229
  v_cvt_pk_bf16_f32 v164, -v232, -v233
  v_cvt_pk_bf16_f32 v149, v230, v231
  v_cvt_pk_bf16_f32 v165, -v234, -v235
  v_lshlrev_b32 v212, 16, v60
  v_and_b32 v216, 0xffff0000, v60
  v_lshlrev_b32 v213, 16, v61
  v_and_b32 v217, 0xffff0000, v61
  v_lshlrev_b32 v214, 16, v62
  v_and_b32 v218, 0xffff0000, v62
  v_lshlrev_b32 v215, 16, v63
  v_and_b32 v219, 0xffff0000, v63
  v_pk_mul_f32 v[228:229], v[92:93], v[212:213]
  v_pk_mul_f32 v[232:233], v[92:93], v[216:217]
  v_pk_fma_f32 v[228:229], v[108:109], v[216:217], v[228:229] neg_lo:[1,0,0] neg_hi:[1,0,0]
  v_pk_fma_f32 v[232:233], v[108:109], v[212:213], v[232:233]
  v_pk_mul_f32 v[230:231], v[94:95], v[214:215]
  v_pk_mul_f32 v[234:235], v[94:95], v[218:219]
  v_pk_fma_f32 v[230:231], v[110:111], v[218:219], v[230:231] neg_lo:[1,0,0] neg_hi:[1,0,0]
  v_pk_fma_f32 v[234:235], v[110:111], v[214:215], v[234:235]
  v_cvt_pk_bf16_f32 v150, v228, v229
  v_cvt_pk_bf16_f32 v166, -v232, -v233
  v_cvt_pk_bf16_f32 v151, v230, v231
  v_cvt_pk_bf16_f32 v167, -v234, -v235
  v_lshlrev_b32 v212, 16, v64
  v_and_b32 v216, 0xffff0000, v64
  v_lshlrev_b32 v213, 16, v65
  v_and_b32 v217, 0xffff0000, v65
  v_lshlrev_b32 v214, 16, v66
  v_and_b32 v218, 0xffff0000, v66
  v_lshlrev_b32 v215, 16, v67
  v_and_b32 v219, 0xffff0000, v67
  v_pk_mul_f32 v[228:229], v[112:113], v[212:213]
  v_pk_mul_f32 v[232:233], v[112:113], v[216:217]
  v_pk_fma_f32 v[228:229], v[128:129], v[216:217], v[228:229] neg_lo:[1,0,0] neg_hi:[1,0,0]
  v_pk_fma_f32 v[232:233], v[128:129], v[212:213], v[232:233]
  v_pk_mul_f32 v[230:231], v[114:115], v[214:215]
  v_pk_mul_f32 v[234:235], v[114:115], v[218:219]
  v_pk_fma_f32 v[230:231], v[130:131], v[218:219], v[230:231] neg_lo:[1,0,0] neg_hi:[1,0,0]
  v_pk_fma_f32 v[234:235], v[130:131], v[214:215], v[234:235]
  v_cvt_pk_bf16_f32 v152, v228, v229
  v_cvt_pk_bf16_f32 v168, -v232, -v233
  v_cvt_pk_bf16_f32 v153, v230, v231
  v_cvt_pk_bf16_f32 v169, -v234, -v235
  v_lshlrev_b32 v212, 16, v68
  v_and_b32 v216, 0xffff0000, v68
  v_lshlrev_b32 v213, 16, v69
  v_and_b32 v217, 0xffff0000, v69
  v_lshlrev_b32 v214, 16, v70
  v_and_b32 v218, 0xffff0000, v70
  v_lshlrev_b32 v215, 16, v71
  v_and_b32 v219, 0xffff0000, v71
  v_pk_mul_f32 v[228:229], v[116:117], v[212:213]
  v_pk_mul_f32 v[232:233], v[116:117], v[216:217]
  v_pk_fma_f32 v[228:229], v[132:133], v[216:217], v[228:229] neg_lo:[1,0,0] neg_hi:[1,0,0]
  v_pk_fma_f32 v[232:233], v[132:133], v[212:213], v[232:233]
  v_pk_mul_f32 v[230:231], v[118:119], v[214:215]
  v_pk_mul_f32 v[234:235], v[118:119], v[218:219]
  v_pk_fma_f32 v[230:231], v[134:135], v[218:219], v[230:231] neg_lo:[1,0,0] neg_hi:[1,0,0]
  v_pk_fma_f32 v[234:235], v[134:135], v[214:215], v[234:235]
  v_cvt_pk_bf16_f32 v154, v228, v229
  v_cvt_pk_bf16_f32 v170, -v232, -v233
  v_cvt_pk_bf16_f32 v155, v230, v231
  v_cvt_pk_bf16_f32 v171, -v234, -v235
  v_lshlrev_b32 v212, 16, v72
  v_and_b32 v216, 0xffff0000, v72
  v_lshlrev_b32 v213, 16, v73
  v_and_b32 v217, 0xffff0000, v73
  v_lshlrev_b32 v214, 16, v74
  v_and_b32 v218, 0xffff0000, v74
  v_lshlrev_b32 v215, 16, v75
  v_and_b32 v219, 0xffff0000, v75
  v_pk_mul_f32 v[228:229], v[120:121], v[212:213]
  v_pk_mul_f32 v[232:233], v[120:121], v[216:217]
  v_pk_fma_f32 v[228:229], v[136:137], v[216:217], v[228:229] neg_lo:[1,0,0] neg_hi:[1,0,0]
  v_pk_fma_f32 v[232:233], v[136:137], v[212:213], v[232:233]
  v_pk_mul_f32 v[230:231], v[122:123], v[214:215]
  v_pk_mul_f32 v[234:235], v[122:123], v[218:219]
  v_pk_fma_f32 v[230:231], v[138:139], v[218:219], v[230:231] neg_lo:[1,0,0] neg_hi:[1,0,0]
  v_pk_fma_f32 v[234:235], v[138:139], v[214:215], v[234:235]
  v_cvt_pk_bf16_f32 v156, v228, v229
  v_cvt_pk_bf16_f32 v172, -v232, -v233
  v_cvt_pk_bf16_f32 v157, v230, v231
  v_cvt_pk_bf16_f32 v173, -v234, -v235
  v_lshlrev_b32 v212, 16, v76
  v_and_b32 v216, 0xffff0000, v76
  v_lshlrev_b32 v213, 16, v77
  v_and_b32 v217, 0xffff0000, v77
  v_lshlrev_b32 v214, 16, v78
  v_and_b32 v218, 0xffff0000, v78
  v_lshlrev_b32 v215, 16, v79
  v_and_b32 v219, 0xffff0000, v79
  v_pk_mul_f32 v[228:229], v[124:125], v[212:213]
  v_pk_mul_f32 v[232:233], v[124:125], v[216:217]
  v_pk_fma_f32 v[228:229], v[140:141], v[216:217], v[228:229] neg_lo:[1,0,0] neg_hi:[1,0,0]
  v_pk_fma_f32 v[232:233], v[140:141], v[212:213], v[232:233]
  v_pk_mul_f32 v[230:231], v[126:127], v[214:215]
  v_pk_mul_f32 v[234:235], v[126:127], v[218:219]
  v_pk_fma_f32 v[230:231], v[142:143], v[218:219], v[230:231] neg_lo:[1,0,0] neg_hi:[1,0,0]
  v_pk_fma_f32 v[234:235], v[142:143], v[214:215], v[234:235]
  v_cvt_pk_bf16_f32 v158, v228, v229
  v_cvt_pk_bf16_f32 v174, -v232, -v233
  v_cvt_pk_bf16_f32 v159, v230, v231
  v_cvt_pk_bf16_f32 v175, -v234, -v235
  s_nop 1
  ds_read_b128 v[176:179], v10 offset:0
  ds_read_b128 v[180:183], v10 offset:1024
  ds_read_b128 v[184:187], v10 offset:2048
  ds_read_b128 v[188:191], v10 offset:3072
  ds_read_b128 v[192:195], v10 offset:4096
  ds_read_b128 v[196:199], v10 offset:5120
  ds_read_b128 v[200:203], v10 offset:6144
  ds_read_b128 v[204:207], v10 offset:7168
  ds_read_b128 v[208:211], v10 offset:8192
  s_waitcnt lgkmcnt(6)
  v_mfma_f32_32x32x16_bf16 v[80:95], v[144:147], v[176:179], 0
  v_mfma_f32_32x32x16_bf16 v[96:111], v[160:163], v[176:179], 0
  v_mfma_f32_32x32x16_bf16 v[80:95], v[160:163], v[180:183], v[80:95]
  v_mfma_f32_32x32x16_bf16 v[96:111], v[144:147], v[184:187], v[96:111]
  ds_read_b128 v[176:179], v10 offset:9216
  ds_read_b128 v[180:183], v10 offset:10240
  ds_read_b128 v[184:187], v10 offset:11264
  s_waitcnt lgkmcnt(6)
  v_mfma_f32_32x32x16_bf16 v[80:95], v[148:151], v[188:191], v[80:95]
  v_mfma_f32_32x32x16_bf16 v[96:111], v[164:167], v[188:191], v[96:111]
  v_mfma_f32_32x32x16_bf16 v[80:95], v[164:167], v[192:195], v[80:95]
  v_mfma_f32_32x32x16_bf16 v[96:111], v[148:151], v[196:199], v[96:111]
  ds_read_b128 v[188:191], v10 offset:12288
  ds_read_b128 v[192:195], v10 offset:13312
  ds_read_b128 v[196:199], v10 offset:14336
  s_waitcnt lgkmcnt(6)
  v_mfma_f32_32x32x16_bf16 v[80:95], v[152:155], v[200:203], v[80:95]
  v_mfma_f32_32x32x16_bf16 v[96:111], v[168:171], v[200:203], v[96:111]
  v_mfma_f32_32x32x16_bf16 v[80:95], v[168:171], v[204:207], v[80:95]
  v_mfma_f32_32x32x16_bf16 v[96:111], v[152:155], v[208:211], v[96:111]
  ds_read_b128 v[200:203], v10 offset:15360
  ds_read_b128 v[204:207], v10 offset:16384
  ds_read_b128 v[208:211], v10 offset:17408
  s_waitcnt lgkmcnt(6)
  v_mfma_f32_32x32x16_bf16 v[80:95], v[156:159], v[176:179], v[80:95]
  v_mfma_f32_32x32x16_bf16 v[96:111], v[172:175], v[176:179], v[96:111]
  v_mfma_f32_32x32x16_bf16 v[80:95], v[172:175], v[180:183], v[80:95]
  v_mfma_f32_32x32x16_bf16 v[96:111], v[156:159], v[184:187], v[96:111]
  ds_read_b128 v[176:179], v10 offset:18432
  ds_read_b128 v[180:183], v10 offset:19456
  ds_read_b128 v[184:187], v10 offset:20480
  s_waitcnt lgkmcnt(6)
  v_mfma_f32_32x32x16_bf16 v[112:127], v[144:147], v[188:191], 0
  v_mfma_f32_32x32x16_bf16 v[128:143], v[160:163], v[188:191], 0
  v_mfma_f32_32x32x16_bf16 v[112:127], v[160:163], v[192:195], v[112:127]
  v_mfma_f32_32x32x16_bf16 v[128:143], v[144:147], v[196:199], v[128:143]
  ds_read_b128 v[188:191], v10 offset:21504
  ds_read_b128 v[192:195], v10 offset:22528
  ds_read_b128 v[196:199], v10 offset:23552
  s_waitcnt lgkmcnt(6)
  v_mfma_f32_32x32x16_bf16 v[112:127], v[148:151], v[200:203], v[112:127]
  v_mfma_f32_32x32x16_bf16 v[128:143], v[164:167], v[200:203], v[128:143]
  v_mfma_f32_32x32x16_bf16 v[112:127], v[164:167], v[204:207], v[112:127]
  v_mfma_f32_32x32x16_bf16 v[128:143], v[148:151], v[208:211], v[128:143]
  s_waitcnt lgkmcnt(3)
  v_mfma_f32_32x32x16_bf16 v[112:127], v[152:155], v[176:179], v[112:127]
  v_mfma_f32_32x32x16_bf16 v[128:143], v[168:171], v[176:179], v[128:143]
  v_mfma_f32_32x32x16_bf16 v[112:127], v[168:171], v[180:183], v[112:127]
  v_mfma_f32_32x32x16_bf16 v[128:143], v[152:155], v[184:187], v[128:143]
  s_waitcnt lgkmcnt(0)
  v_mfma_f32_32x32x16_bf16 v[112:127], v[156:159], v[188:191], v[112:127]
  v_mfma_f32_32x32x16_bf16 v[128:143], v[172:175], v[188:191], v[128:143]
  v_mfma_f32_32x32x16_bf16 v[112:127], v[172:175], v[192:195], v[112:127]
  v_mfma_f32_32x32x16_bf16 v[128:143], v[156:159], v[196:199], v[128:143]
  ds_read_b128 v[212:215], v11 offset:14336
  ds_read_b128 v[216:219], v11 offset:15360
  ds_read_b128 v[220:223], v11 offset:16384
  ds_read_b128 v[224:227], v11 offset:17408
  s_nop 13
  s_waitcnt lgkmcnt(2)
  v_pk_mul_f32 v[228:229], v[80:81], v[212:213]
  v_pk_mul_f32 v[232:233], v[96:97], v[212:213]
  v_pk_fma_f32 v[228:229], v[96:97], v[216:217], v[228:229]
  v_pk_fma_f32 v[232:233], v[80:81], v[216:217], v[232:233] neg_lo:[1,0,0] neg_hi:[1,0,0]
  v_pk_mul_f32 v[230:231], v[82:83], v[214:215]
  v_pk_mul_f32 v[234:235], v[98:99], v[214:215]
  v_pk_fma_f32 v[230:231], v[98:99], v[218:219], v[230:231]
  v_pk_fma_f32 v[234:235], v[82:83], v[218:219], v[234:235] neg_lo:[1,0,0] neg_hi:[1,0,0]
  ds_read_b128 v[212:215], v11 offset:18432
  ds_read_b128 v[216:219], v11 offset:19456
  v_cvt_pk_bf16_f32 v144, v228, v229
  v_cvt_pk_bf16_f32 v160, v232, v233
  v_cvt_pk_bf16_f32 v145, v230, v231
  v_cvt_pk_bf16_f32 v161, v234, v235
  s_waitcnt lgkmcnt(2)
  v_pk_mul_f32 v[228:229], v[84:85], v[220:221]
  v_pk_mul_f32 v[232:233], v[100:101], v[220:221]
  v_pk_fma_f32 v[228:229], v[100:101], v[224:225], v[228:229]
  v_pk_fma_f32 v[232:233], v[84:85], v[224:225], v[232:233] neg_lo:[1,0,0] neg_hi:[1,0,0]
  v_pk_mul_f32 v[230:231], v[86:87], v[222:223]
  v_pk_mul_f32 v[234:235], v[102:103], v[222:223]
  v_pk_fma_f32 v[230:231], v[102:103], v[226:227], v[230:231]
  v_pk_fma_f32 v[234:235], v[86:87], v[226:227], v[234:235] neg_lo:[1,0,0] neg_hi:[1,0,0]
  ds_read_b128 v[220:223], v11 offset:20480
  ds_read_b128 v[224:227], v11 offset:21504
  v_cvt_pk_bf16_f32 v146, v228, v229
  v_cvt_pk_bf16_f32 v162, v232, v233
  v_cvt_pk_bf16_f32 v147, v230, v231
  v_cvt_pk_bf16_f32 v163, v234, v235
  s_waitcnt lgkmcnt(2)
  v_pk_mul_f32 v[228:229], v[88:89], v[212:213]
  v_pk_mul_f32 v[232:233], v[104:105], v[212:213]
  v_pk_fma_f32 v[228:229], v[104:105], v[216:217], v[228:229]
  v_pk_fma_f32 v[232:233], v[88:89], v[216:217], v[232:233] neg_lo:[1,0,0] neg_hi:[1,0,0]
  v_pk_mul_f32 v[230:231], v[90:91], v[214:215]
  v_pk_mul_f32 v[234:235], v[106:107], v[214:215]
  v_pk_fma_f32 v[230:231], v[106:107], v[218:219], v[230:231]
  v_pk_fma_f32 v[234:235], v[90:91], v[218:219], v[234:235] neg_lo:[1,0,0] neg_hi:[1,0,0]
  ds_read_b128 v[212:215], v11 offset:22528
  ds_read_b128 v[216:219], v11 offset:23552
  v_cvt_pk_bf16_f32 v148, v228, v229
  v_cvt_pk_bf16_f32 v164, v232, v233
  v_cvt_pk_bf16_f32 v149, v230, v231
  v_cvt_pk_bf16_f32 v165, v234, v235
  s_waitcnt lgkmcnt(2)
  v_pk_mul_f32 v[228:229], v[92:93], v[220:221]
  v_pk_mul_f32 v[232:233], v[108:109], v[220:221]
  v_pk_fma_f32 v[228:229], v[108:109], v[224:225], v[228:229]
  v_pk_fma_f32 v[232:233], v[92:93], v[224:225], v[232:233] neg_lo:[1,0,0] neg_hi:[1,0,0]
  v_pk_mul_f32 v[230:231], v[94:95], v[222:223]
  v_pk_mul_f32 v[234:235], v[110:111], v[222:223]
  v_pk_fma_f32 v[230:231], v[110:111], v[226:227], v[230:231]
  v_pk_fma_f32 v[234:235], v[94:95], v[226:227], v[234:235] neg_lo:[1,0,0] neg_hi:[1,0,0]
  ds_read_b128 v[220:223], v11 offset:24576
  ds_read_b128 v[224:227], v11 offset:25600
  v_cvt_pk_bf16_f32 v150, v228, v229
  v_cvt_pk_bf16_f32 v166, v232, v233
  v_cvt_pk_bf16_f32 v151, v230, v231
  v_cvt_pk_bf16_f32 v167, v234, v235
  s_waitcnt lgkmcnt(2)
  v_pk_mul_f32 v[228:229], v[112:113], v[212:213]
  v_pk_mul_f32 v[232:233], v[128:129], v[212:213]
  v_pk_fma_f32 v[228:229], v[128:129], v[216:217], v[228:229]
  v_pk_fma_f32 v[232:233], v[112:113], v[216:217], v[232:233] neg_lo:[1,0,0] neg_hi:[1,0,0]
  v_pk_mul_f32 v[230:231], v[114:115], v[214:215]
  v_pk_mul_f32 v[234:235], v[130:131], v[214:215]
  v_pk_fma_f32 v[230:231], v[130:131], v[218:219], v[230:231]
  v_pk_fma_f32 v[234:235], v[114:115], v[218:219], v[234:235] neg_lo:[1,0,0] neg_hi:[1,0,0]
  ds_read_b128 v[212:215], v11 offset:26624
  ds_read_b128 v[216:219], v11 offset:27648
  v_cvt_pk_bf16_f32 v152, v228, v229
  v_cvt_pk_bf16_f32 v168, v232, v233
  v_cvt_pk_bf16_f32 v153, v230, v231
  v_cvt_pk_bf16_f32 v169, v234, v235
  s_waitcnt lgkmcnt(2)
  v_pk_mul_f32 v[228:229], v[116:117], v[220:221]
  v_pk_mul_f32 v[232:233], v[132:133], v[220:221]
  v_pk_fma_f32 v[228:229], v[132:133], v[224:225], v[228:229]
  v_pk_fma_f32 v[232:233], v[116:117], v[224:225], v[232:233] neg_lo:[1,0,0] neg_hi:[1,0,0]
  v_pk_mul_f32 v[230:231], v[118:119], v[222:223]
  v_pk_mul_f32 v[234:235], v[134:135], v[222:223]
  v_pk_fma_f32 v[230:231], v[134:135], v[226:227], v[230:231]
  v_pk_fma_f32 v[234:235], v[118:119], v[226:227], v[234:235] neg_lo:[1,0,0] neg_hi:[1,0,0]
  ds_read_b128 v[220:223], v11 offset:28672
  ds_read_b128 v[224:227], v11 offset:29696
  v_cvt_pk_bf16_f32 v154, v228, v229
  v_cvt_pk_bf16_f32 v170, v232, v233
  v_cvt_pk_bf16_f32 v155, v230, v231
  v_cvt_pk_bf16_f32 v171, v234, v235
  s_waitcnt lgkmcnt(2)
  v_pk_mul_f32 v[228:229], v[120:121], v[212:213]
  v_pk_mul_f32 v[232:233], v[136:137], v[212:213]
  v_pk_fma_f32 v[228:229], v[136:137], v[216:217], v[228:229]
  v_pk_fma_f32 v[232:233], v[120:121], v[216:217], v[232:233] neg_lo:[1,0,0] neg_hi:[1,0,0]
  v_pk_mul_f32 v[230:231], v[122:123], v[214:215]
  v_pk_mul_f32 v[234:235], v[138:139], v[214:215]
  v_pk_fma_f32 v[230:231], v[138:139], v[218:219], v[230:231]
  v_pk_fma_f32 v[234:235], v[122:123], v[218:219], v[234:235] neg_lo:[1,0,0] neg_hi:[1,0,0]
  v_cvt_pk_bf16_f32 v156, v228, v229
  v_cvt_pk_bf16_f32 v172, v232, v233
  v_cvt_pk_bf16_f32 v157, v230, v231
  v_cvt_pk_bf16_f32 v173, v234, v235
  s_waitcnt lgkmcnt(0)
  v_pk_mul_f32 v[228:229], v[124:125], v[220:221]
  v_pk_mul_f32 v[232:233], v[140:141], v[220:221]
  v_pk_fma_f32 v[228:229], v[140:141], v[224:225], v[228:229]
  v_pk_fma_f32 v[232:233], v[124:125], v[224:225], v[232:233] neg_lo:[1,0,0] neg_hi:[1,0,0]
  v_pk_mul_f32 v[230:231], v[126:127], v[222:223]
  v_pk_mul_f32 v[234:235], v[142:143], v[222:223]
  v_pk_fma_f32 v[230:231], v[142:143], v[226:227], v[230:231]
  v_pk_fma_f32 v[234:235], v[126:127], v[226:227], v[234:235] neg_lo:[1,0,0] neg_hi:[1,0,0]
  v_cvt_pk_bf16_f32 v158, v228, v229
  v_cvt_pk_bf16_f32 v174, v232, v233
  v_cvt_pk_bf16_f32 v159, v230, v231
  v_cvt_pk_bf16_f32 v175, v234, v235
  ds_read_b128 v[176:179], v10 offset:24576
  ds_read_b128 v[180:183], v10 offset:25600
  ds_read_b128 v[184:187], v10 offset:26624
  ds_read_b128 v[188:191], v10 offset:27648
  ds_read_b128 v[192:195], v10 offset:28672
  ds_read_b128 v[196:199], v10 offset:29696
  s_waitcnt lgkmcnt(0)
  v_mfma_f32_32x32x16_bf16 v[80:95], v[176:179], v[144:147], 0
  v_mfma_f32_32x32x16_bf16 v[96:111], v[176:179], v[160:163], 0
  v_mfma_f32_32x32x16_bf16 v[80:95], v[180:183], v[160:163], v[80:95]
  v_mfma_f32_32x32x16_bf16 v[96:111], v[184:187], v[144:147], v[96:111]
  v_mfma_f32_32x32x16_bf16 v[80:95], v[188:191], v[148:151], v[80:95]
  v_mfma_f32_32x32x16_bf16 v[96:111], v[188:191], v[164:167], v[96:111]
  v_mfma_f32_32x32x16_bf16 v[80:95], v[192:195], v[164:167], v[80:95]
  v_mfma_f32_32x32x16_bf16 v[96:111], v[196:199], v[148:151], v[96:111]
  v_mfma_f32_32x32x16_bf16 v[112:127], v[176:179], v[152:155], 0
  v_mfma_f32_32x32x16_bf16 v[128:143], v[176:179], v[168:171], 0
  v_mfma_f32_32x32x16_bf16 v[112:127], v[180:183], v[168:171], v[112:127]
  v_mfma_f32_32x32x16_bf16 v[128:143], v[184:187], v[152:155], v[128:143]
  v_mfma_f32_32x32x16_bf16 v[112:127], v[188:191], v[156:159], v[112:127]
  v_mfma_f32_32x32x16_bf16 v[128:143], v[188:191], v[172:175], v[128:143]
  v_mfma_f32_32x32x16_bf16 v[112:127], v[192:195], v[172:175], v[112:127]
  v_mfma_f32_32x32x16_bf16 v[128:143], v[196:199], v[156:159], v[128:143]
  s_nop 15
  v_and_b32 v9, 7, v3
  v_cvt_pk_bf16_f32 v16, v80, -v96
  v_cvt_pk_bf16_f32 v17, v81, -v97
  v_cvt_pk_bf16_f32 v18, v82, -v98
  v_cvt_pk_bf16_f32 v19, v83, -v99
  v_cvt_pk_bf16_f32 v20, v84, -v100
  v_cvt_pk_bf16_f32 v21, v85, -v101
  v_cvt_pk_bf16_f32 v22, v86, -v102
  v_cvt_pk_bf16_f32 v23, v87, -v103
  v_lshlrev_b32 v12, 1, v4
  v_add_u32 v12, 0, v12
  v_xor_b32 v12, v12, v9
  v_lshlrev_b32 v12, 4, v12
  v_lshl_add_u32 v12, v3, 7, v12
  v_add_u32 v12, s62, v12
  ds_write_b128 v12, v[16:19] offset:0
  v_lshlrev_b32 v12, 1, v4
  v_add_u32 v12, 1, v12
  v_xor_b32 v12, v12, v9
  v_lshlrev_b32 v12, 4, v12
  v_lshl_add_u32 v12, v3, 7, v12
  v_add_u32 v12, s62, v12
  ds_write_b128 v12, v[20:23] offset:0
  v_cvt_pk_bf16_f32 v24, v88, -v104
  v_cvt_pk_bf16_f32 v25, v89, -v105
  v_cvt_pk_bf16_f32 v26, v90, -v106
  v_cvt_pk_bf16_f32 v27, v91, -v107
  v_cvt_pk_bf16_f32 v28, v92, -v108
  v_cvt_pk_bf16_f32 v29, v93, -v109
  v_cvt_pk_bf16_f32 v30, v94, -v110
  v_cvt_pk_bf16_f32 v31, v95, -v111
  v_lshlrev_b32 v12, 1, v4
  v_add_u32 v12, 4, v12
  v_xor_b32 v12, v12, v9
  v_lshlrev_b32 v12, 4, v12
  v_lshl_add_u32 v12, v3, 7, v12
  v_add_u32 v12, s62, v12
  ds_write_b128 v12, v[24:27] offset:0
  v_lshlrev_b32 v12, 1, v4
  v_add_u32 v12, 5, v12
  v_xor_b32 v12, v12, v9
  v_lshlrev_b32 v12, 4, v12
  v_lshl_add_u32 v12, v3, 7, v12
  v_add_u32 v12, s62, v12
  ds_write_b128 v12, v[28:31] offset:0
  v_cvt_pk_bf16_f32 v32, v112, -v128
  v_cvt_pk_bf16_f32 v33, v113, -v129
  v_cvt_pk_bf16_f32 v34, v114, -v130
  v_cvt_pk_bf16_f32 v35, v115, -v131
  v_cvt_pk_bf16_f32 v36, v116, -v132
  v_cvt_pk_bf16_f32 v37, v117, -v133
  v_cvt_pk_bf16_f32 v38, v118, -v134
  v_cvt_pk_bf16_f32 v39, v119, -v135
  v_lshlrev_b32 v12, 1, v4
  v_add_u32 v12, 0, v12
  v_xor_b32 v12, v12, v9
  v_lshlrev_b32 v12, 4, v12
  v_lshl_add_u32 v12, v3, 7, v12
  v_add_u32 v12, s62, v12
  ds_write_b128 v12, v[32:35] offset:4096
  v_lshlrev_b32 v12, 1, v4
  v_add_u32 v12, 1, v12
  v_xor_b32 v12, v12, v9
  v_lshlrev_b32 v12, 4, v12
  v_lshl_add_u32 v12, v3, 7, v12
  v_add_u32 v12, s62, v12
  ds_write_b128 v12, v[36:39] offset:4096
  v_cvt_pk_bf16_f32 v40, v120, -v136
  v_cvt_pk_bf16_f32 v41, v121, -v137
  v_cvt_pk_bf16_f32 v42, v122, -v138
  v_cvt_pk_bf16_f32 v43, v123, -v139
  v_cvt_pk_bf16_f32 v44, v124, -v140
  v_cvt_pk_bf16_f32 v45, v125, -v141
  v_cvt_pk_bf16_f32 v46, v126, -v142
  v_cvt_pk_bf16_f32 v47, v127, -v143
  v_lshlrev_b32 v12, 1, v4
  v_add_u32 v12, 4, v12
  v_xor_b32 v12, v12, v9
  v_lshlrev_b32 v12, 4, v12
  v_lshl_add_u32 v12, v3, 7, v12
  v_add_u32 v12, s62, v12
  ds_write_b128 v12, v[40:43] offset:4096
  v_lshlrev_b32 v12, 1, v4
  v_add_u32 v12, 5, v12
  v_xor_b32 v12, v12, v9
  v_lshlrev_b32 v12, 4, v12
  v_lshl_add_u32 v12, v3, 7, v12
  v_add_u32 v12, s62, v12
  ds_write_b128 v12, v[44:47] offset:4096
  v_lshrrev_b32 v12, 3, v1
  v_and_b32 v13, 7, v1
  v_and_b32 v14, 7, v12
  v_xor_b32 v13, v13, v14
  v_lshlrev_b32 v13, 4, v13
  v_lshl_add_u32 v12, v12, 7, v13
  v_add_u32 v12, s62, v12
  s_waitcnt lgkmcnt(0)
  ds_read_b128 v[80:83], v12 offset:0
  ds_read_b128 v[84:87], v12 offset:1024
  ds_read_b128 v[88:91], v12 offset:2048
  ds_read_b128 v[92:95], v12 offset:3072
  ds_read_b128 v[96:99], v12 offset:4096
  ds_read_b128 v[100:103], v12 offset:5120
  ds_read_b128 v[104:107], v12 offset:6144
  ds_read_b128 v[108:111], v12 offset:7168
  v_lshlrev_b32 v8, 4, v1
  s_add_u32 s49, s48, 10485760
  s_waitcnt lgkmcnt(7)
  buffer_store_dwordx4 v[80:83], v8, s[40:43], s49 offen offset:0 sc1
  s_waitcnt lgkmcnt(6)
  buffer_store_dwordx4 v[84:87], v8, s[40:43], s49 offen offset:1024 sc1
  s_waitcnt lgkmcnt(5)
  buffer_store_dwordx4 v[88:91], v8, s[40:43], s49 offen offset:2048 sc1
  s_waitcnt lgkmcnt(4)
  buffer_store_dwordx4 v[92:95], v8, s[40:43], s49 offen offset:3072 sc1
  s_waitcnt lgkmcnt(3)
  s_add_u32 s49, s49, 4096
  buffer_store_dwordx4 v[96:99], v8, s[40:43], s49 offen offset:0 sc1
  s_waitcnt lgkmcnt(2)
  buffer_store_dwordx4 v[100:103], v8, s[40:43], s49 offen offset:1024 sc1
  s_waitcnt lgkmcnt(1)
  buffer_store_dwordx4 v[104:107], v8, s[40:43], s49 offen offset:2048 sc1
  s_waitcnt lgkmcnt(0)
  buffer_store_dwordx4 v[108:111], v8, s[40:43], s49 offen offset:3072 sc1
gated_mix__grouped_kv_mqa__spectral_gfnet__prompt_kernel_noc22:
  v_lshlrev_b32 v248, 4, v1
  v_lshlrev_b32 v249, 3, v1
  s_lshl_b32 s90, s44, 15
  s_add_u32 s90, s90, 65536
  v_mov_b32 v72, 0
  v_mov_b32 v73, 0
  v_mov_b32 v74, 0
  v_mov_b32 v75, 0
  v_mov_b32 v76, 0
  v_mov_b32 v77, 0
  v_mov_b32 v78, 0
  v_mov_b32 v79, 0
  v_mov_b32 v56, 0
  v_mov_b32 v57, 0
  s_add_u32 s51, s90, 0
  buffer_load_dwordx4 v[24:27], v248, s[40:43], s51 offen
  s_mov_b32 exec_hi, 0
  buffer_load_dwordx2 v[56:57], v249, s[40:43], s51 offen offset:3072
  s_mov_b32 exec_lo, 0x1fffff
  s_mov_b32 exec_hi, 0x1fffff
  buffer_load_dwordx4 v[72:75], v248, s[40:43], s51 offen offset:1024
  buffer_load_dwordx4 v[76:79], v248, s[40:43], s51 offen offset:2048
  s_mov_b64 exec, -1
  v_mov_b32 v80, 0
  v_mov_b32 v81, 0
  v_mov_b32 v82, 0
  v_mov_b32 v83, 0
  v_mov_b32 v84, 0
  v_mov_b32 v85, 0
  v_mov_b32 v86, 0
  v_mov_b32 v87, 0
  v_mov_b32 v58, 0
  v_mov_b32 v59, 0
  s_add_u32 s51, s90, 4096
  buffer_load_dwordx4 v[28:31], v248, s[40:43], s51 offen
  s_mov_b32 exec_hi, 0
  buffer_load_dwordx2 v[58:59], v249, s[40:43], s51 offen offset:3072
  s_mov_b32 exec_lo, 0x1fffff
  s_mov_b32 exec_hi, 0x1fffff
  buffer_load_dwordx4 v[80:83], v248, s[40:43], s51 offen offset:1024
  buffer_load_dwordx4 v[84:87], v248, s[40:43], s51 offen offset:2048
  s_mov_b64 exec, -1
  v_mov_b32 v88, 0
  v_mov_b32 v89, 0
  v_mov_b32 v90, 0
  v_mov_b32 v91, 0
  v_mov_b32 v92, 0
  v_mov_b32 v93, 0
  v_mov_b32 v94, 0
  v_mov_b32 v95, 0
  v_mov_b32 v60, 0
  v_mov_b32 v61, 0
  s_add_u32 s51, s90, 8192
  buffer_load_dwordx4 v[32:35], v248, s[40:43], s51 offen
  s_mov_b32 exec_hi, 0
  buffer_load_dwordx2 v[60:61], v249, s[40:43], s51 offen offset:3072
  s_mov_b32 exec_lo, 0x1fffff
  s_mov_b32 exec_hi, 0x1fffff
  buffer_load_dwordx4 v[88:91], v248, s[40:43], s51 offen offset:1024
  buffer_load_dwordx4 v[92:95], v248, s[40:43], s51 offen offset:2048
  s_mov_b64 exec, -1
  v_mov_b32 v96, 0
  v_mov_b32 v97, 0
  v_mov_b32 v98, 0
  v_mov_b32 v99, 0
  v_mov_b32 v100, 0
  v_mov_b32 v101, 0
  v_mov_b32 v102, 0
  v_mov_b32 v103, 0
  v_mov_b32 v62, 0
  v_mov_b32 v63, 0
  s_add_u32 s51, s90, 12288
  buffer_load_dwordx4 v[36:39], v248, s[40:43], s51 offen
  s_mov_b32 exec_hi, 0
  buffer_load_dwordx2 v[62:63], v249, s[40:43], s51 offen offset:3072
  s_mov_b32 exec_lo, 0x1fffff
  s_mov_b32 exec_hi, 0x1fffff
  buffer_load_dwordx4 v[96:99], v248, s[40:43], s51 offen offset:1024
  buffer_load_dwordx4 v[100:103], v248, s[40:43], s51 offen offset:2048
  s_mov_b64 exec, -1
  v_mov_b32 v104, 0
  v_mov_b32 v105, 0
  v_mov_b32 v106, 0
  v_mov_b32 v107, 0
  v_mov_b32 v108, 0
  v_mov_b32 v109, 0
  v_mov_b32 v110, 0
  v_mov_b32 v111, 0
  v_mov_b32 v64, 0
  v_mov_b32 v65, 0
  s_add_u32 s51, s90, 16384
  buffer_load_dwordx4 v[40:43], v248, s[40:43], s51 offen
  s_mov_b32 exec_hi, 0
  buffer_load_dwordx2 v[64:65], v249, s[40:43], s51 offen offset:3072
  s_mov_b32 exec_lo, 0x1fffff
  s_mov_b32 exec_hi, 0x1fffff
  buffer_load_dwordx4 v[104:107], v248, s[40:43], s51 offen offset:1024
  buffer_load_dwordx4 v[108:111], v248, s[40:43], s51 offen offset:2048
  s_mov_b64 exec, -1
  v_mov_b32 v112, 0
  v_mov_b32 v113, 0
  v_mov_b32 v114, 0
  v_mov_b32 v115, 0
  v_mov_b32 v116, 0
  v_mov_b32 v117, 0
  v_mov_b32 v118, 0
  v_mov_b32 v119, 0
  v_mov_b32 v66, 0
  v_mov_b32 v67, 0
  s_add_u32 s51, s90, 20480
  buffer_load_dwordx4 v[44:47], v248, s[40:43], s51 offen
  s_mov_b32 exec_hi, 0
  buffer_load_dwordx2 v[66:67], v249, s[40:43], s51 offen offset:3072
  s_mov_b32 exec_lo, 0x1fffff
  s_mov_b32 exec_hi, 0x1fffff
  buffer_load_dwordx4 v[112:115], v248, s[40:43], s51 offen offset:1024
  buffer_load_dwordx4 v[116:119], v248, s[40:43], s51 offen offset:2048
  s_mov_b64 exec, -1
  v_mov_b32 v120, 0
  v_mov_b32 v121, 0
  v_mov_b32 v122, 0
  v_mov_b32 v123, 0
  v_mov_b32 v124, 0
  v_mov_b32 v125, 0
  v_mov_b32 v126, 0
  v_mov_b32 v127, 0
  v_mov_b32 v68, 0
  v_mov_b32 v69, 0
  s_add_u32 s51, s90, 24576
  buffer_load_dwordx4 v[48:51], v248, s[40:43], s51 offen
  s_mov_b32 exec_hi, 0
  buffer_load_dwordx2 v[68:69], v249, s[40:43], s51 offen offset:3072
  s_mov_b32 exec_lo, 0x1fffff
  s_mov_b32 exec_hi, 0x1fffff
  buffer_load_dwordx4 v[120:123], v248, s[40:43], s51 offen offset:1024
  buffer_load_dwordx4 v[124:127], v248, s[40:43], s51 offen offset:2048
  s_mov_b64 exec, -1
  v_mov_b32 v128, 0
  v_mov_b32 v129, 0
  v_mov_b32 v130, 0
  v_mov_b32 v131, 0
  v_mov_b32 v132, 0
  v_mov_b32 v133, 0
  v_mov_b32 v134, 0
  v_mov_b32 v135, 0
  v_mov_b32 v70, 0
  v_mov_b32 v71, 0
  s_add_u32 s51, s90, 28672
  buffer_load_dwordx4 v[52:55], v248, s[40:43], s51 offen
  s_mov_b32 exec_hi, 0
  buffer_load_dwordx2 v[70:71], v249, s[40:43], s51 offen offset:3072
  s_mov_b32 exec_lo, 0x1fffff
  s_mov_b32 exec_hi, 0x1fffff
  buffer_load_dwordx4 v[128:131], v248, s[40:43], s51 offen offset:1024
  buffer_load_dwordx4 v[132:135], v248, s[40:43], s51 offen offset:2048
  s_mov_b64 exec, -1
  s_waitcnt vmcnt(32)
  s_mul_i32 s61, s44, 1024
  s_add_u32 s61, s61, 12288
  s_lshl_b32 s54, s2, 2
  s_add_u32 s54, s54, s61
  v_mov_b32 v5, s47
  v_mov_b32 v6, 0
  s_mov_b64 exec, 1
  buffer_store_dword v5, v6, s[40:43], s54 offen sc1
  s_mov_b64 exec, -1
  v_mov_b32 v5, 10308
  v_mov_b32 v6, 1
  s_mov_b64 exec, 1
  ds_add_u32 v5, v6
  s_mov_b64 exec, -1
  v_lshlrev_b32 v5, 3, v1
  s_mov_b32 s48, 335872
  buffer_load_dwordx2 v[20:21], v5, s[40:43], s48 offen sc1
  s_waitcnt vmcnt(0)
  s_mov_b32 s91, 0
  s_branch gated_mix__grouped_kv_mqa__spectral_gfnet__prompt_kernel_kj21
gated_mix__grouped_kv_mqa__spectral_gfnet__prompt_kernel_kv20:
  s_mov_b32 s91, 1
  s_waitcnt vmcnt(16)
gated_mix__grouped_kv_mqa__spectral_gfnet__prompt_kernel_kj21:
  v_mov_b32 v5, 10272
  ds_read_b128 v[12:15], v5
  ds_read_b128 v[16:19], v5 offset:16
  v_lshlrev_b32 v3, 4, v1
  v_add_u32 v221, 0, v3
  v_lshlrev_b32 v4, 3, v1
  v_add_u32 v222, 8192, v4
  v_cmp_gt_u32 vcc, 32, v1
  v_mov_b32 v3, 10240
  v_mov_b32 v4, 0x100
  v_cndmask_b32 v222, v3, v222, vcc
  v_cndmask_b32 v23, 0, v4, vcc
  v_and_b32 v8, 31, v1
  v_lshrrev_b32 v9, 5, v1
  v_lshlrev_b32 v8, 3, v8
  v_lshl_add_u32 v8, v9, 10, v8
  v_add_u32 v223, 11392, v8
  s_waitcnt lgkmcnt(0)
  v_max_f32 v12, v12, v13
  v_max_f32 v14, v14, v15
  v_max_f32 v16, v16, v17
  v_max_f32 v18, v18, v19
  v_max_f32 v12, v12, v14
  v_max_f32 v16, v16, v18
  v_max_f32 v12, v12, v16
  v_mov_b32 v10, v20
  s_nop 1
  v_permlane32_swap_b32 v20, v10
  s_nop 1
  v_max_f32 v20, v20, v10
  s_nop 1
  v_max_f32_dpp v20, v20, v20 row_shr:1 row_mask:0xf bank_mask:0xf
  s_nop 1
  v_max_f32_dpp v20, v20, v20 row_shr:2 row_mask:0xf bank_mask:0xf
  s_nop 1
  v_max_f32_dpp v20, v20, v20 row_shr:4 row_mask:0xf bank_mask:0xf
  s_nop 1
  v_max_f32_dpp v20, v20, v20 row_shr:8 row_mask:0xf bank_mask:0xf
  s_nop 1
  v_max_f32_dpp v20, v20, v20 row_bcast:15 row_mask:0xa bank_mask:0xf
  v_mov_b32 v10, v21
  s_nop 1
  v_permlane32_swap_b32 v21, v10
  s_nop 1
  v_max_f32 v21, v21, v10
  s_nop 1
  v_max_f32_dpp v21, v21, v21 row_shr:1 row_mask:0xf bank_mask:0xf
  s_nop 1
  v_max_f32_dpp v21, v21, v21 row_shr:2 row_mask:0xf bank_mask:0xf
  s_nop 1
  v_max_f32_dpp v21, v21, v21 row_shr:4 row_mask:0xf bank_mask:0xf
  s_nop 1
  v_max_f32_dpp v21, v21, v21 row_shr:8 row_mask:0xf bank_mask:0xf
  s_nop 1
  v_max_f32_dpp v21, v21, v21 row_bcast:15 row_mask:0xa bank_mask:0xf
  s_nop 0
  v_readlane_b32 s48, v20, 31
  v_readlane_b32 s49, v21, 31
  s_nop 1
  v_mul_f32 v12, s48, v12
  v_mov_b32 v13, 0x45610000
  v_cmp_le_f32 vcc, v12, v13
  v_mov_b32 v14, s49
  v_mov_b32 v13, 0x53800000
  v_cmp_le_f32 s[58:59], v14, v13
  s_nop 1
  s_and_b64 vcc, vcc, s[58:59]
  s_mov_b32 s71, s44
  s_lshr_b32 s92, s44, 2
  s_cbranch_vccz gated_mix__grouped_kv_mqa__spectral_gfnet__prompt_kernel_slow33
  s_cmp_eq_u32 s91, 0
  s_cbranch_scc1 gated_mix__grouped_kv_mqa__spectral_gfnet__prompt_kernel_res35
  s_lshl_b32 s49, s71, 10
  v_add_u32 v3, s49, v221
  v_mad_u32_u24 v4, s71, v23, v222
  ds_read_b128 v[208:211], v3
  ds_read_b64 v[216:217], v4
  s_waitcnt lgkmcnt(0)
  s_waitcnt vmcnt(14)
  v_mfma_f32_32x32x16_bf16 v[136:151], v[24:27], v[208:211], 0
  v_mfma_f32_32x32x8_bf16 v[136:151], v[56:57], v[216:217], v[136:151]
  s_nop 13
  v_mov_b32 v104, 0
  v_mov_b32 v105, 0
  v_mov_b32 v106, 0
  v_mov_b32 v107, 0
  v_mov_b32 v108, 0
  v_mov_b32 v109, 0
  v_mov_b32 v110, 0
  v_mov_b32 v111, 0
  v_mov_b32 v64, 0
  v_mov_b32 v65, 0
  s_add_u32 s51, s90, 16384
  buffer_load_dwordx4 v[40:43], v248, s[40:43], s51 offen
  s_mov_b32 exec_hi, 0
  buffer_load_dwordx2 v[64:65], v249, s[40:43], s51 offen offset:3072
  s_mov_b32 exec_lo, 0x1fffff
  s_mov_b32 exec_hi, 0x1fffff
  buffer_load_dwordx4 v[104:107], v248, s[40:43], s51 offen offset:1024
  buffer_load_dwordx4 v[108:111], v248, s[40:43], s51 offen offset:2048
  s_mov_b64 exec, -1
  s_waitcnt vmcnt(14)
  v_exp_f32 v136, v136
  v_exp_f32 v137, v137
  v_exp_f32 v138, v138
  v_mfma_f32_32x32x16_bf16 v[152:167], v[28:31], v[208:211], 0
  v_exp_f32 v139, v139
  v_exp_f32 v140, v140
  v_cvt_pk_bf16_f32 v168, v136, v137
  v_exp_f32 v141, v141
  v_exp_f32 v142, v142
  v_cvt_pk_bf16_f32 v169, v138, v139
  v_exp_f32 v143, v143
  v_exp_f32 v144, v144
  v_mfma_f32_32x32x8_bf16 v[152:167], v[58:59], v[216:217], v[152:167]
  v_cvt_pk_bf16_f32 v170, v140, v141
  v_exp_f32 v145, v145
  v_exp_f32 v146, v146
  v_cvt_pk_bf16_f32 v171, v142, v143
  v_exp_f32 v147, v147
  v_exp_f32 v148, v148
  v_mfma_f32_32x32x16_bf16 v[176:191], v[72:75], v[168:171], 0
  v_cvt_pk_bf16_f32 v172, v144, v145
  v_exp_f32 v149, v149
  v_exp_f32 v150, v150
  v_cvt_pk_bf16_f32 v173, v146, v147
  v_exp_f32 v151, v151
  v_mov_b32 v112, 0
  v_mov_b32 v113, 0
  v_mov_b32 v114, 0
  v_mov_b32 v115, 0
  v_mov_b32 v116, 0
  v_mov_b32 v117, 0
  v_mov_b32 v118, 0
  v_mov_b32 v119, 0
  v_mov_b32 v66, 0
  v_mov_b32 v67, 0
  s_add_u32 s51, s90, 20480
  buffer_load_dwordx4 v[44:47], v248, s[40:43], s51 offen
  s_mov_b32 exec_hi, 0
  buffer_load_dwordx2 v[66:67], v249, s[40:43], s51 offen offset:3072
  s_mov_b32 exec_lo, 0x1fffff
  s_mov_b32 exec_hi, 0x1fffff
  buffer_load_dwordx4 v[112:115], v248, s[40:43], s51 offen offset:1024
  buffer_load_dwordx4 v[116:119], v248, s[40:43], s51 offen offset:2048
  s_mov_b64 exec, -1
  s_waitcnt vmcnt(14)
  s_add_u32 s48, s71, 1
  s_and_b32 s48, s48, 7
  s_lshl_b32 s49, s48, 10
  v_add_u32 v3, s49, v221
  v_mad_u32_u24 v4, s48, v23, v222
  ds_read_b128 v[212:215], v3
  ds_read_b64 v[218:219], v4
  v_exp_f32 v152, v152
  v_exp_f32 v153, v153
  v_cvt_pk_bf16_f32 v174, v148, v149
  v_exp_f32 v154, v154
  v_cvt_pk_bf16_f32 v175, v150, v151
  v_mfma_f32_32x32x16_bf16 v[136:151], v[32:35], v[208:211], 0
  v_exp_f32 v155, v155
  v_exp_f32 v156, v156
  v_cvt_pk_bf16_f32 v168, v152, v153
  v_exp_f32 v157, v157
  v_mfma_f32_32x32x16_bf16 v[176:191], v[76:79], v[172:175], v[176:191]
  v_exp_f32 v158, v158
  v_cvt_pk_bf16_f32 v169, v154, v155
  v_exp_f32 v159, v159
  v_exp_f32 v160, v160
  v_mfma_f32_32x32x8_bf16 v[136:151], v[60:61], v[216:217], v[136:151]
  v_cvt_pk_bf16_f32 v170, v156, v157
  v_exp_f32 v161, v161
  v_exp_f32 v162, v162
  v_cvt_pk_bf16_f32 v171, v158, v159
  v_exp_f32 v163, v163
  v_exp_f32 v164, v164
  v_mfma_f32_32x32x16_bf16 v[176:191], v[80:83], v[168:171], v[176:191]
  v_cvt_pk_bf16_f32 v172, v160, v161
  v_exp_f32 v165, v165
  v_exp_f32 v166, v166
  v_cvt_pk_bf16_f32 v173, v162, v163
  v_exp_f32 v167, v167
  v_mov_b32 v120, 0
  v_mov_b32 v121, 0
  v_mov_b32 v122, 0
  v_mov_b32 v123, 0
  v_mov_b32 v124, 0
  v_mov_b32 v125, 0
  v_mov_b32 v126, 0
  v_mov_b32 v127, 0
  v_mov_b32 v68, 0
  v_mov_b32 v69, 0
  s_add_u32 s51, s90, 24576
  buffer_load_dwordx4 v[48:51], v248, s[40:43], s51 offen
  s_mov_b32 exec_hi, 0
  buffer_load_dwordx2 v[68:69], v249, s[40:43], s51 offen offset:3072
  s_mov_b32 exec_lo, 0x1fffff
  s_mov_b32 exec_hi, 0x1fffff
  buffer_load_dwordx4 v[120:123], v248, s[40:43], s51 offen offset:1024
  buffer_load_dwordx4 v[124:127], v248, s[40:43], s51 offen offset:2048
  s_mov_b64 exec, -1
  s_waitcnt vmcnt(14)
  v_exp_f32 v136, v136
  v_exp_f32 v137, v137
  v_cvt_pk_bf16_f32 v174, v164, v165
  v_exp_f32 v138, v138
  v_cvt_pk_bf16_f32 v175, v166, v167
  v_mfma_f32_32x32x16_bf16 v[152:167], v[36:39], v[208:211], 0
  v_exp_f32 v139, v139
  v_exp_f32 v140, v140
  v_cvt_pk_bf16_f32 v168, v136, v137
  v_exp_f32 v141, v141
  v_mfma_f32_32x32x16_bf16 v[176:191], v[84:87], v[172:175], v[176:191]
  v_exp_f32 v142, v142
  v_cvt_pk_bf16_f32 v169, v138, v139
  v_exp_f32 v143, v143
  v_exp_f32 v144, v144
  v_mfma_f32_32x32x8_bf16 v[152:167], v[62:63], v[216:217], v[152:167]
  v_cvt_pk_bf16_f32 v170, v140, v141
  v_exp_f32 v145, v145
  v_exp_f32 v146, v146
  v_cvt_pk_bf16_f32 v171, v142, v143
  v_exp_f32 v147, v147
  v_exp_f32 v148, v148
  v_mfma_f32_32x32x16_bf16 v[176:191], v[88:91], v[168:171], v[176:191]
  v_cvt_pk_bf16_f32 v172, v144, v145
  v_exp_f32 v149, v149
  v_exp_f32 v150, v150
  v_cvt_pk_bf16_f32 v173, v146, v147
  v_exp_f32 v151, v151
  v_mov_b32 v128, 0
  v_mov_b32 v129, 0
  v_mov_b32 v130, 0
  v_mov_b32 v131, 0
  v_mov_b32 v132, 0
  v_mov_b32 v133, 0
  v_mov_b32 v134, 0
  v_mov_b32 v135, 0
  v_mov_b32 v70, 0
  v_mov_b32 v71, 0
  s_add_u32 s51, s90, 28672
  buffer_load_dwordx4 v[52:55], v248, s[40:43], s51 offen
  s_mov_b32 exec_hi, 0
  buffer_load_dwordx2 v[70:71], v249, s[40:43], s51 offen offset:3072
  s_mov_b32 exec_lo, 0x1fffff
  s_mov_b32 exec_hi, 0x1fffff
  buffer_load_dwordx4 v[128:131], v248, s[40:43], s51 offen offset:1024
  buffer_load_dwordx4 v[132:135], v248, s[40:43], s51 offen offset:2048
  s_mov_b64 exec, -1
  s_waitcnt vmcnt(14)
  v_exp_f32 v152, v152
  v_exp_f32 v153, v153
  v_cvt_pk_bf16_f32 v174, v148, v149
  v_exp_f32 v154, v154
  v_cvt_pk_bf16_f32 v175, v150, v151
  v_mfma_f32_32x32x16_bf16 v[136:151], v[40:43], v[208:211], 0
  v_exp_f32 v155, v155
  v_exp_f32 v156, v156
  v_cvt_pk_bf16_f32 v168, v152, v153
  v_exp_f32 v157, v157
  v_mfma_f32_32x32x16_bf16 v[176:191], v[92:95], v[172:175], v[176:191]
  v_exp_f32 v158, v158
  v_cvt_pk_bf16_f32 v169, v154, v155
  v_exp_f32 v159, v159
  v_exp_f32 v160, v160
  v_mfma_f32_32x32x8_bf16 v[136:151], v[64:65], v[216:217], v[136:151]
  v_cvt_pk_bf16_f32 v170, v156, v157
  v_exp_f32 v161, v161
  v_exp_f32 v162, v162
  v_cvt_pk_bf16_f32 v171, v158, v159
  v_exp_f32 v163, v163
  v_exp_f32 v164, v164
  v_mfma_f32_32x32x16_bf16 v[176:191], v[96:99], v[168:171], v[176:191]
  v_cvt_pk_bf16_f32 v172, v160, v161
  v_exp_f32 v165, v165
  v_exp_f32 v166, v166
  v_cvt_pk_bf16_f32 v173, v162, v163
  v_exp_f32 v167, v167
  s_waitcnt vmcnt(10)
  v_exp_f32 v136, v136
  v_exp_f32 v137, v137
  v_cvt_pk_bf16_f32 v174, v164, v165
  v_exp_f32 v138, v138
  v_cvt_pk_bf16_f32 v175, v166, v167
  v_mfma_f32_32x32x16_bf16 v[152:167], v[44:47], v[208:211], 0
  v_exp_f32 v139, v139
  v_exp_f32 v140, v140
  v_cvt_pk_bf16_f32 v168, v136, v137
  v_exp_f32 v141, v141
  v_mfma_f32_32x32x16_bf16 v[176:191], v[100:103], v[172:175], v[176:191]
  v_exp_f32 v142, v142
  v_cvt_pk_bf16_f32 v169, v138, v139
  v_exp_f32 v143, v143
  v_exp_f32 v144, v144
  v_mfma_f32_32x32x8_bf16 v[152:167], v[66:67], v[216:217], v[152:167]
  v_cvt_pk_bf16_f32 v170, v140, v141
  v_exp_f32 v145, v145
  v_exp_f32 v146, v146
  v_cvt_pk_bf16_f32 v171, v142, v143
  v_exp_f32 v147, v147
  v_exp_f32 v148, v148
  v_mfma_f32_32x32x16_bf16 v[176:191], v[104:107], v[168:171], v[176:191]
  v_cvt_pk_bf16_f32 v172, v144, v145
  v_exp_f32 v149, v149
  v_exp_f32 v150, v150
  v_cvt_pk_bf16_f32 v173, v146, v147
  v_exp_f32 v151, v151
  s_mul_i32 s49, s71, 5376
  v_add_u32 v220, s49, v223
  s_waitcnt vmcnt(6)
  v_exp_f32 v152, v152
  v_exp_f32 v153, v153
  v_cvt_pk_bf16_f32 v174, v148, v149
  v_exp_f32 v154, v154
  v_cvt_pk_bf16_f32 v175, v150, v151
  v_mfma_f32_32x32x16_bf16 v[136:151], v[48:51], v[208:211], 0
  v_exp_f32 v155, v155
  v_exp_f32 v156, v156
  v_cvt_pk_bf16_f32 v168, v152, v153
  v_exp_f32 v157, v157
  v_mfma_f32_32x32x16_bf16 v[176:191], v[108:111], v[172:175], v[176:191]
  v_exp_f32 v158, v158
  v_cvt_pk_bf16_f32 v169, v154, v155
  v_exp_f32 v159, v159
  v_exp_f32 v160, v160
  v_mfma_f32_32x32x8_bf16 v[136:151], v[68:69], v[216:217], v[136:151]
  v_cvt_pk_bf16_f32 v170, v156, v157
  v_exp_f32 v161, v161
  v_exp_f32 v162, v162
  v_cvt_pk_bf16_f32 v171, v158, v159
  v_exp_f32 v163, v163
  v_exp_f32 v164, v164
  v_mfma_f32_32x32x16_bf16 v[176:191], v[112:115], v[168:171], v[176:191]
  v_cvt_pk_bf16_f32 v172, v160, v161
  v_exp_f32 v165, v165
  v_exp_f32 v166, v166
  v_cvt_pk_bf16_f32 v173, v162, v163
  v_exp_f32 v167, v167
  s_waitcnt vmcnt(2)
  v_exp_f32 v136, v136
  v_exp_f32 v137, v137
  v_cvt_pk_bf16_f32 v174, v164, v165
  v_exp_f32 v138, v138
  v_cvt_pk_bf16_f32 v175, v166, v167
  v_mfma_f32_32x32x16_bf16 v[152:167], v[52:55], v[208:211], 0
  v_exp_f32 v139, v139
  v_exp_f32 v140, v140
  v_cvt_pk_bf16_f32 v168, v136, v137
  v_exp_f32 v141, v141
  v_mfma_f32_32x32x16_bf16 v[176:191], v[116:119], v[172:175], v[176:191]
  v_exp_f32 v142, v142
  v_cvt_pk_bf16_f32 v169, v138, v139
  v_exp_f32 v143, v143
  v_exp_f32 v144, v144
  v_mfma_f32_32x32x8_bf16 v[152:167], v[70:71], v[216:217], v[152:167]
  v_cvt_pk_bf16_f32 v170, v140, v141
  v_exp_f32 v145, v145
  v_exp_f32 v146, v146
  v_cvt_pk_bf16_f32 v171, v142, v143
  v_exp_f32 v147, v147
  v_exp_f32 v148, v148
  v_mfma_f32_32x32x16_bf16 v[176:191], v[120:123], v[168:171], v[176:191]
  v_cvt_pk_bf16_f32 v172, v144, v145
  v_exp_f32 v149, v149
  v_exp_f32 v150, v150
  v_cvt_pk_bf16_f32 v173, v146, v147
  v_exp_f32 v151, v151
  s_waitcnt vmcnt(0)
  s_waitcnt lgkmcnt(0)
  v_exp_f32 v152, v152
  v_exp_f32 v153, v153
  v_cvt_pk_bf16_f32 v174, v148, v149
  v_exp_f32 v154, v154
  v_cvt_pk_bf16_f32 v175, v150, v151
  v_mfma_f32_32x32x16_bf16 v[136:151], v[24:27], v[212:215], 0
  v_exp_f32 v155, v155
  v_exp_f32 v156, v156
  v_cvt_pk_bf16_f32 v168, v152, v153
  v_exp_f32 v157, v157
  v_mfma_f32_32x32x16_bf16 v[176:191], v[124:127], v[172:175], v[176:191]
  v_exp_f32 v158, v158
  v_cvt_pk_bf16_f32 v169, v154, v155
  v_exp_f32 v159, v159
  v_exp_f32 v160, v160
  v_mfma_f32_32x32x8_bf16 v[136:151], v[56:57], v[218:219], v[136:151]
  v_cvt_pk_bf16_f32 v170, v156, v157
  v_exp_f32 v161, v161
  v_exp_f32 v162, v162
  v_cvt_pk_bf16_f32 v171, v158, v159
  v_exp_f32 v163, v163
  v_exp_f32 v164, v164
  v_mfma_f32_32x32x16_bf16 v[176:191], v[128:131], v[168:171], v[176:191]
  v_cvt_pk_bf16_f32 v172, v160, v161
  v_exp_f32 v165, v165
  v_exp_f32 v166, v166
  v_cvt_pk_bf16_f32 v173, v162, v163
  v_exp_f32 v167, v167
  s_mov_b32 s71, s48
  v_exp_f32 v136, v136
  v_exp_f32 v137, v137
  v_cvt_pk_bf16_f32 v174, v164, v165
  v_exp_f32 v138, v138
  v_cvt_pk_bf16_f32 v175, v166, v167
  v_mfma_f32_32x32x16_bf16 v[152:167], v[28:31], v[212:215], 0
  v_exp_f32 v139, v139
  v_exp_f32 v140, v140
  v_cvt_pk_bf16_f32 v168, v136, v137
  v_exp_f32 v141, v141
  v_mfma_f32_32x32x16_bf16 v[176:191], v[132:135], v[172:175], v[176:191]
  v_exp_f32 v142, v142
  v_cvt_pk_bf16_f32 v169, v138, v139
  v_exp_f32 v143, v143
  v_exp_f32 v144, v144
  v_mfma_f32_32x32x8_bf16 v[152:167], v[58:59], v[218:219], v[152:167]
  v_cvt_pk_bf16_f32 v170, v140, v141
  v_exp_f32 v145, v145
  v_exp_f32 v146, v146
  v_cvt_pk_bf16_f32 v171, v142, v143
  v_exp_f32 v147, v147
  v_exp_f32 v148, v148
  v_mfma_f32_32x32x16_bf16 v[192:207], v[72:75], v[168:171], 0
  v_cvt_pk_bf16_f32 v172, v144, v145
  v_exp_f32 v149, v149
  v_exp_f32 v150, v150
  v_cvt_pk_bf16_f32 v173, v146, v147
  v_exp_f32 v151, v151
  s_add_u32 s48, s71, 1
  s_and_b32 s48, s48, 7
  s_lshl_b32 s49, s48, 10
  v_add_u32 v3, s49, v221
  v_mad_u32_u24 v4, s48, v23, v222
  ds_read_b128 v[208:211], v3
  ds_read_b64 v[216:217], v4
  v_exp_f32 v152, v152
  v_exp_f32 v153, v153
  v_cvt_pk_bf16_f32 v174, v148, v149
  v_exp_f32 v154, v154
  v_cvt_pk_bf16_f32 v175, v150, v151
  v_mfma_f32_32x32x16_bf16 v[136:151], v[32:35], v[212:215], 0
  v_exp_f32 v155, v155
  v_exp_f32 v156, v156
  v_cvt_pk_bf16_f32 v168, v152, v153
  v_exp_f32 v157, v157
  v_mfma_f32_32x32x16_bf16 v[192:207], v[76:79], v[172:175], v[192:207]
  v_exp_f32 v158, v158
  v_cvt_pk_bf16_f32 v169, v154, v155
  v_exp_f32 v159, v159
  v_exp_f32 v160, v160
  v_mfma_f32_32x32x8_bf16 v[136:151], v[60:61], v[218:219], v[136:151]
  v_cvt_pk_bf16_f32 v170, v156, v157
  v_exp_f32 v161, v161
  v_exp_f32 v162, v162
  v_cvt_pk_bf16_f32 v171, v158, v159
  v_exp_f32 v163, v163
  v_exp_f32 v164, v164
  v_mfma_f32_32x32x16_bf16 v[192:207], v[80:83], v[168:171], v[192:207]
  v_cvt_pk_bf16_f32 v172, v160, v161
  v_exp_f32 v165, v165
  v_exp_f32 v166, v166
  v_cvt_pk_bf16_f32 v173, v162, v163
  v_exp_f32 v167, v167
  v_exp_f32 v136, v136
  v_exp_f32 v137, v137
  v_cvt_pk_bf16_f32 v174, v164, v165
  v_exp_f32 v138, v138
  v_cvt_pk_bf16_f32 v175, v166, v167
  v_mfma_f32_32x32x16_bf16 v[152:167], v[36:39], v[212:215], 0
  v_exp_f32 v139, v139
  v_exp_f32 v140, v140
  v_cvt_pk_bf16_f32 v168, v136, v137
  v_exp_f32 v141, v141
  v_mfma_f32_32x32x16_bf16 v[192:207], v[84:87], v[172:175], v[192:207]
  v_exp_f32 v142, v142
  v_cvt_pk_bf16_f32 v169, v138, v139
  v_exp_f32 v143, v143
  v_exp_f32 v144, v144
  v_mfma_f32_32x32x8_bf16 v[152:167], v[62:63], v[218:219], v[152:167]
  v_cvt_f64_f32 v[224:225], v176
  v_cvt_f64_f32 v[226:227], v177
  v_cvt_f64_f32 v[228:229], v178
  v_cvt_f64_f32 v[230:231], v179
  v_cvt_f64_f32 v[232:233], v180
  v_cvt_f64_f32 v[234:235], v181
  v_cvt_pk_bf16_f32 v170, v140, v141
  v_exp_f32 v145, v145
  v_exp_f32 v146, v146
  v_cvt_pk_bf16_f32 v171, v142, v143
  v_exp_f32 v147, v147
  v_exp_f32 v148, v148
  v_mfma_f32_32x32x16_bf16 v[192:207], v[88:91], v[168:171], v[192:207]
  ds_add_f64 v220, v[224:225] offset:0
  ds_add_f64 v220, v[226:227] offset:256
  ds_add_f64 v220, v[228:229] offset:512
  ds_add_f64 v220, v[230:231] offset:768
  ds_add_f64 v220, v[232:233] offset:2048
  ds_add_f64 v220, v[234:235] offset:2304
  v_cvt_pk_bf16_f32 v172, v144, v145
  v_exp_f32 v149, v149
  v_exp_f32 v150, v150
  v_cvt_pk_bf16_f32 v173, v146, v147
  v_exp_f32 v151, v151
  v_exp_f32 v152, v152
  v_exp_f32 v153, v153
  v_cvt_pk_bf16_f32 v174, v148, v149
  v_exp_f32 v154, v154
  v_cvt_pk_bf16_f32 v175, v150, v151
  v_mfma_f32_32x32x16_bf16 v[136:151], v[40:43], v[212:215], 0
  v_exp_f32 v155, v155
  v_exp_f32 v156, v156
  v_cvt_pk_bf16_f32 v168, v152, v153
  v_exp_f32 v157, v157
  v_mfma_f32_32x32x16_bf16 v[192:207], v[92:95], v[172:175], v[192:207]
  v_exp_f32 v158, v158
  v_cvt_pk_bf16_f32 v169, v154, v155
  v_exp_f32 v159, v159
  v_exp_f32 v160, v160
  v_mfma_f32_32x32x8_bf16 v[136:151], v[64:65], v[218:219], v[136:151]
  v_cvt_f64_f32 v[224:225], v182
  v_cvt_f64_f32 v[226:227], v183
  v_cvt_f64_f32 v[228:229], v184
  v_cvt_f64_f32 v[230:231], v185
  v_cvt_f64_f32 v[232:233], v186
  v_cvt_f64_f32 v[234:235], v187
  v_cvt_pk_bf16_f32 v170, v156, v157
  v_exp_f32 v161, v161
  v_exp_f32 v162, v162
  v_cvt_pk_bf16_f32 v171, v158, v159
  v_exp_f32 v163, v163
  v_exp_f32 v164, v164
  v_mfma_f32_32x32x16_bf16 v[192:207], v[96:99], v[168:171], v[192:207]
  ds_add_f64 v220, v[224:225] offset:2560
  ds_add_f64 v220, v[226:227] offset:2816
  ds_add_f64 v220, v[228:229] offset:4096
  s_mov_b32 exec_hi, 0
  ds_add_f64 v220, v[230:231] offset:4352
  ds_add_f64 v220, v[232:233] offset:4608
  ds_add_f64 v220, v[234:235] offset:4864
  s_mov_b64 exec, -1
  v_cvt_pk_bf16_f32 v172, v160, v161
  v_exp_f32 v165, v165
  v_exp_f32 v166, v166
  v_cvt_pk_bf16_f32 v173, v162, v163
  v_exp_f32 v167, v167
  v_exp_f32 v136, v136
  v_exp_f32 v137, v137
  v_cvt_pk_bf16_f32 v174, v164, v165
  v_exp_f32 v138, v138
  v_cvt_pk_bf16_f32 v175, v166, v167
  v_mfma_f32_32x32x16_bf16 v[152:167], v[44:47], v[212:215], 0
  v_exp_f32 v139, v139
  v_exp_f32 v140, v140
  v_cvt_pk_bf16_f32 v168, v136, v137
  v_exp_f32 v141, v141
  v_mfma_f32_32x32x16_bf16 v[192:207], v[100:103], v[172:175], v[192:207]
  v_exp_f32 v142, v142
  v_cvt_pk_bf16_f32 v169, v138, v139
  v_exp_f32 v143, v143
  v_exp_f32 v144, v144
  v_mfma_f32_32x32x8_bf16 v[152:167], v[66:67], v[218:219], v[152:167]
  v_cvt_pk_bf16_f32 v170, v140, v141
  v_exp_f32 v145, v145
  v_exp_f32 v146, v146
  v_cvt_pk_bf16_f32 v171, v142, v143
  v_exp_f32 v147, v147
  v_exp_f32 v148, v148
  v_mfma_f32_32x32x16_bf16 v[192:207], v[104:107], v[168:171], v[192:207]
  v_cvt_pk_bf16_f32 v172, v144, v145
  v_exp_f32 v149, v149
  v_exp_f32 v150, v150
  v_cvt_pk_bf16_f32 v173, v146, v147
  v_exp_f32 v151, v151
  s_mul_i32 s49, s71, 5376
  v_add_u32 v220, s49, v223
  v_exp_f32 v152, v152
  v_exp_f32 v153, v153
  v_cvt_pk_bf16_f32 v174, v148, v149
  v_exp_f32 v154, v154
  v_cvt_pk_bf16_f32 v175, v150, v151
  v_mfma_f32_32x32x16_bf16 v[136:151], v[48:51], v[212:215], 0
  v_exp_f32 v155, v155
  v_exp_f32 v156, v156
  v_cvt_pk_bf16_f32 v168, v152, v153
  v_exp_f32 v157, v157
  v_mfma_f32_32x32x16_bf16 v[192:207], v[108:111], v[172:175], v[192:207]
  v_exp_f32 v158, v158
  v_cvt_pk_bf16_f32 v169, v154, v155
  v_exp_f32 v159, v159
  v_exp_f32 v160, v160
  v_mfma_f32_32x32x8_bf16 v[136:151], v[68:69], v[218:219], v[136:151]
  v_cvt_pk_bf16_f32 v170, v156, v157
  v_exp_f32 v161, v161
  v_exp_f32 v162, v162
  v_cvt_pk_bf16_f32 v171, v158, v159
  v_exp_f32 v163, v163
  v_exp_f32 v164, v164
  v_mfma_f32_32x32x16_bf16 v[192:207], v[112:115], v[168:171], v[192:207]
  v_cvt_pk_bf16_f32 v172, v160, v161
  v_exp_f32 v165, v165
  v_exp_f32 v166, v166
  v_cvt_pk_bf16_f32 v173, v162, v163
  v_exp_f32 v167, v167
  v_exp_f32 v136, v136
  v_exp_f32 v137, v137
  v_cvt_pk_bf16_f32 v174, v164, v165
  v_exp_f32 v138, v138
  v_cvt_pk_bf16_f32 v175, v166, v167
  v_mfma_f32_32x32x16_bf16 v[152:167], v[52:55], v[212:215], 0
  v_exp_f32 v139, v139
  v_exp_f32 v140, v140
  v_cvt_pk_bf16_f32 v168, v136, v137
  v_exp_f32 v141, v141
  v_mfma_f32_32x32x16_bf16 v[192:207], v[116:119], v[172:175], v[192:207]
  v_exp_f32 v142, v142
  v_cvt_pk_bf16_f32 v169, v138, v139
  v_exp_f32 v143, v143
  v_exp_f32 v144, v144
  v_mfma_f32_32x32x8_bf16 v[152:167], v[70:71], v[218:219], v[152:167]
  v_cvt_pk_bf16_f32 v170, v140, v141
  v_exp_f32 v145, v145
  v_exp_f32 v146, v146
  v_cvt_pk_bf16_f32 v171, v142, v143
  v_exp_f32 v147, v147
  v_exp_f32 v148, v148
  v_mfma_f32_32x32x16_bf16 v[192:207], v[120:123], v[168:171], v[192:207]
  v_cvt_pk_bf16_f32 v172, v144, v145
  v_exp_f32 v149, v149
  v_exp_f32 v150, v150
  v_cvt_pk_bf16_f32 v173, v146, v147
  v_exp_f32 v151, v151
  s_waitcnt lgkmcnt(0)
  v_exp_f32 v152, v152
  v_exp_f32 v153, v153
  v_cvt_pk_bf16_f32 v174, v148, v149
  v_exp_f32 v154, v154
  v_cvt_pk_bf16_f32 v175, v150, v151
  v_mfma_f32_32x32x16_bf16 v[136:151], v[24:27], v[208:211], 0
  v_exp_f32 v155, v155
  v_exp_f32 v156, v156
  v_cvt_pk_bf16_f32 v168, v152, v153
  v_exp_f32 v157, v157
  v_mfma_f32_32x32x16_bf16 v[192:207], v[124:127], v[172:175], v[192:207]
  v_exp_f32 v158, v158
  v_cvt_pk_bf16_f32 v169, v154, v155
  v_exp_f32 v159, v159
  v_exp_f32 v160, v160
  v_mfma_f32_32x32x8_bf16 v[136:151], v[56:57], v[216:217], v[136:151]
  v_cvt_pk_bf16_f32 v170, v156, v157
  v_exp_f32 v161, v161
  v_exp_f32 v162, v162
  v_cvt_pk_bf16_f32 v171, v158, v159
  v_exp_f32 v163, v163
  v_exp_f32 v164, v164
  v_mfma_f32_32x32x16_bf16 v[192:207], v[128:131], v[168:171], v[192:207]
  v_cvt_pk_bf16_f32 v172, v160, v161
  v_exp_f32 v165, v165
  v_exp_f32 v166, v166
  v_cvt_pk_bf16_f32 v173, v162, v163
  v_exp_f32 v167, v167
  s_mov_b32 s71, s48
  s_cmp_lg_u32 s44, 3
  s_cbranch_scc1 gated_mix__grouped_kv_mqa__spectral_gfnet__prompt_kernel_c337
  v_lshlrev_b32 v3, 4, v1
  v_add_u32 v4, 76800, v3
  v_mov_b32 v5, s73
  v_add_co_u32 v4, vcc, s72, v4
  v_addc_co_u32 v5, vcc, 0, v5, vcc
  s_mov_b32 m0, 147744
  s_nop 0
  global_load_lds_dwordx4 v[4:5], off
  v_add_u32 v4, 77824, v3
  v_mov_b32 v5, s73
  v_add_co_u32 v4, vcc, s72, v4
  v_addc_co_u32 v5, vcc, 0, v5, vcc
  s_mov_b32 m0, 148768
  s_nop 0
  global_load_lds_dwordx4 v[4:5], off
  v_add_u32 v4, 78848, v3
  v_mov_b32 v5, s73
  v_add_co_u32 v4, vcc, s72, v4
  v_addc_co_u32 v5, vcc, 0, v5, vcc
  s_mov_b32 m0, 149792
  s_nop 0
  global_load_lds_dwordx4 v[4:5], off
  v_add_u32 v4, 79872, v3
  v_mov_b32 v5, s73
  v_add_co_u32 v4, vcc, s72, v4
  v_addc_co_u32 v5, vcc, 0, v5, vcc
  s_mov_b32 m0, 150816
  s_nop 0
  global_load_lds_dwordx4 v[4:5], off
  v_add_u32 v4, 80896, v3
  v_mov_b32 v5, s73
  v_add_co_u32 v4, vcc, s72, v4
  v_addc_co_u32 v5, vcc, 0, v5, vcc
  s_mov_b32 m0, 151840
  s_nop 0
  global_load_lds_dwordx4 v[4:5], off
  v_add_u32 v4, 81920, v3
  v_mov_b32 v5, s73
  v_add_co_u32 v4, vcc, s72, v4
  v_addc_co_u32 v5, vcc, 0, v5, vcc
  s_mov_b32 m0, 152864
  s_nop 0
  global_load_lds_dwordx4 v[4:5], off
  v_add_u32 v4, 82944, v3
  v_mov_b32 v5, s73
  v_add_co_u32 v4, vcc, s72, v4
  v_addc_co_u32 v5, vcc, 0, v5, vcc
  s_mov_b32 m0, 153888
  s_nop 0
  global_load_lds_dwordx4 v[4:5], off
  v_add_u32 v4, 83968, v3
  v_mov_b32 v5, s73
  v_add_co_u32 v4, vcc, s72, v4
  v_addc_co_u32 v5, vcc, 0, v5, vcc
  s_mov_b32 m0, 154912
  s_nop 0
  global_load_lds_dwordx4 v[4:5], off
  v_add_u32 v4, 84992, v3
  v_mov_b32 v5, s73
  v_add_co_u32 v4, vcc, s72, v4
  v_addc_co_u32 v5, vcc, 0, v5, vcc
  s_mov_b32 m0, 155936
  s_nop 0
  global_load_lds_dwordx4 v[4:5], off
  v_add_u32 v4, 86016, v3
  v_mov_b32 v5, s73
  v_add_co_u32 v4, vcc, s72, v4
  v_addc_co_u32 v5, vcc, 0, v5, vcc
  s_mov_b32 m0, 156960
  s_nop 0
  global_load_lds_dwordx4 v[4:5], off
  v_add_u32 v4, 87040, v3
  v_mov_b32 v5, s73
  v_add_co_u32 v4, vcc, s72, v4
  v_addc_co_u32 v5, vcc, 0, v5, vcc
  s_mov_b32 m0, 157984
  s_nop 0
  global_load_lds_dwordx4 v[4:5], off
  v_add_u32 v4, 37888, v3
  v_mov_b32 v5, s73
  v_add_co_u32 v4, vcc, s72, v4
  v_addc_co_u32 v5, vcc, 0, v5, vcc
  s_mov_b32 m0, 159008
  s_nop 0
  global_load_lds_dwordx4 v[4:5], off
  v_add_u32 v4, 39936, v3
  v_mov_b32 v5, s73
  v_add_co_u32 v4, vcc, s72, v4
  v_addc_co_u32 v5, vcc, 0, v5, vcc
  s_mov_b32 m0, 160032
  s_nop 0
  global_load_lds_dwordx4 v[4:5], off
  v_add_u32 v4, 40960, v3
  v_mov_b32 v5, s73
  v_add_co_u32 v4, vcc, s72, v4
  v_addc_co_u32 v5, vcc, 0, v5, vcc
  s_mov_b32 m0, 161056
  s_nop 0
  global_load_lds_dwordx4 v[4:5], off
  v_add_u32 v4, 43008, v3
  v_mov_b32 v5, s73
  v_add_co_u32 v4, vcc, s72, v4
  v_addc_co_u32 v5, vcc, 0, v5, vcc
  s_mov_b32 m0, 162080
  s_nop 0
  global_load_lds_dwordx4 v[4:5], off
  s_waitcnt vmcnt(0)
  v_mov_b32 v5, 10324
  v_mov_b32 v6, 1
  s_mov_b64 exec, 1
  ds_add_u32 v5, v6
  s_mov_b64 exec, -1
gated_mix__grouped_kv_mqa__spectral_gfnet__prompt_kernel_c337:
  s_mov_b32 s70, 1
gated_mix__grouped_kv_mqa__spectral_gfnet__prompt_kernel_al38:
  v_exp_f32 v136, v136
  v_exp_f32 v137, v137
  v_cvt_pk_bf16_f32 v174, v164, v165
  v_exp_f32 v138, v138
  v_cvt_pk_bf16_f32 v175, v166, v167
  v_mfma_f32_32x32x16_bf16 v[152:167], v[28:31], v[208:211], 0
  v_exp_f32 v139, v139
  v_exp_f32 v140, v140
  v_cvt_pk_bf16_f32 v168, v136, v137
  v_exp_f32 v141, v141
  v_mfma_f32_32x32x16_bf16 v[192:207], v[132:135], v[172:175], v[192:207]
  v_exp_f32 v142, v142
  v_cvt_pk_bf16_f32 v169, v138, v139
  v_exp_f32 v143, v143
  v_exp_f32 v144, v144
  v_mfma_f32_32x32x8_bf16 v[152:167], v[58:59], v[216:217], v[152:167]
  v_cvt_pk_bf16_f32 v170, v140, v141
  v_exp_f32 v145, v145
  v_exp_f32 v146, v146
  v_cvt_pk_bf16_f32 v171, v142, v143
  v_exp_f32 v147, v147
  v_exp_f32 v148, v148
  v_mfma_f32_32x32x16_bf16 v[176:191], v[72:75], v[168:171], 0
  v_cvt_pk_bf16_f32 v172, v144, v145
  v_exp_f32 v149, v149
  v_exp_f32 v150, v150
  v_cvt_pk_bf16_f32 v173, v146, v147
  v_exp_f32 v151, v151
  s_add_u32 s48, s71, 1
  s_and_b32 s48, s48, 7
  s_lshl_b32 s49, s48, 10
  v_add_u32 v3, s49, v221
  v_mad_u32_u24 v4, s48, v23, v222
  ds_read_b128 v[212:215], v3
  ds_read_b64 v[218:219], v4
  v_exp_f32 v152, v152
  v_exp_f32 v153, v153
  v_cvt_pk_bf16_f32 v174, v148, v149
  v_exp_f32 v154, v154
  v_cvt_pk_bf16_f32 v175, v150, v151
  v_mfma_f32_32x32x16_bf16 v[136:151], v[32:35], v[208:211], 0
  v_exp_f32 v155, v155
  v_exp_f32 v156, v156
  v_cvt_pk_bf16_f32 v168, v152, v153
  v_exp_f32 v157, v157
  v_mfma_f32_32x32x16_bf16 v[176:191], v[76:79], v[172:175], v[176:191]
  v_exp_f32 v158, v158
  v_cvt_pk_bf16_f32 v169, v154, v155
  v_exp_f32 v159, v159
  v_exp_f32 v160, v160
  v_mfma_f32_32x32x8_bf16 v[136:151], v[60:61], v[216:217], v[136:151]
  v_cvt_pk_bf16_f32 v170, v156, v157
  v_exp_f32 v161, v161
  v_exp_f32 v162, v162
  v_cvt_pk_bf16_f32 v171, v158, v159
  v_exp_f32 v163, v163
  v_exp_f32 v164, v164
  v_mfma_f32_32x32x16_bf16 v[176:191], v[80:83], v[168:171], v[176:191]
  v_cvt_pk_bf16_f32 v172, v160, v161
  v_exp_f32 v165, v165
  v_exp_f32 v166, v166
  v_cvt_pk_bf16_f32 v173, v162, v163
  v_exp_f32 v167, v167
  v_exp_f32 v136, v136
  v_exp_f32 v137, v137
  v_cvt_pk_bf16_f32 v174, v164, v165
  v_exp_f32 v138, v138
  v_cvt_pk_bf16_f32 v175, v166, v167
  v_mfma_f32_32x32x16_bf16 v[152:167], v[36:39], v[208:211], 0
  v_exp_f32 v139, v139
  v_exp_f32 v140, v140
  v_cvt_pk_bf16_f32 v168, v136, v137
  v_exp_f32 v141, v141
  v_mfma_f32_32x32x16_bf16 v[176:191], v[84:87], v[172:175], v[176:191]
  v_exp_f32 v142, v142
  v_cvt_pk_bf16_f32 v169, v138, v139
  v_exp_f32 v143, v143
  v_exp_f32 v144, v144
  v_mfma_f32_32x32x8_bf16 v[152:167], v[62:63], v[216:217], v[152:167]
  v_cvt_f64_f32 v[224:225], v192
  v_cvt_f64_f32 v[226:227], v193
  v_cvt_f64_f32 v[228:229], v194
  v_cvt_f64_f32 v[230:231], v195
  v_cvt_f64_f32 v[232:233], v196
  v_cvt_f64_f32 v[234:235], v197
  v_cvt_pk_bf16_f32 v170, v140, v141
  v_exp_f32 v145, v145
  v_exp_f32 v146, v146
  v_cvt_pk_bf16_f32 v171, v142, v143
  v_exp_f32 v147, v147
  v_exp_f32 v148, v148
  v_mfma_f32_32x32x16_bf16 v[176:191], v[88:91], v[168:171], v[176:191]
  ds_add_f64 v220, v[224:225] offset:0
  ds_add_f64 v220, v[226:227] offset:256
  ds_add_f64 v220, v[228:229] offset:512
  ds_add_f64 v220, v[230:231] offset:768
  ds_add_f64 v220, v[232:233] offset:2048
  ds_add_f64 v220, v[234:235] offset:2304
  v_cvt_pk_bf16_f32 v172, v144, v145
  v_exp_f32 v149, v149
  v_exp_f32 v150, v150
  v_cvt_pk_bf16_f32 v173, v146, v147
  v_exp_f32 v151, v151
  v_exp_f32 v152, v152
  v_exp_f32 v153, v153
  v_cvt_pk_bf16_f32 v174, v148, v149
  v_exp_f32 v154, v154
  v_cvt_pk_bf16_f32 v175, v150, v151
  v_mfma_f32_32x32x16_bf16 v[136:151], v[40:43], v[208:211], 0
  v_exp_f32 v155, v155
  v_exp_f32 v156, v156
  v_cvt_pk_bf16_f32 v168, v152, v153
  v_exp_f32 v157, v157
  v_mfma_f32_32x32x16_bf16 v[176:191], v[92:95], v[172:175], v[176:191]
  v_exp_f32 v158, v158
  v_cvt_pk_bf16_f32 v169, v154, v155
  v_exp_f32 v159, v159
  v_exp_f32 v160, v160
  v_mfma_f32_32x32x8_bf16 v[136:151], v[64:65], v[216:217], v[136:151]
  v_cvt_f64_f32 v[224:225], v198
  v_cvt_f64_f32 v[226:227], v199
  v_cvt_f64_f32 v[228:229], v200
  v_cvt_f64_f32 v[230:231], v201
  v_cvt_f64_f32 v[232:233], v202
  v_cvt_f64_f32 v[234:235], v203
  v_cvt_pk_bf16_f32 v170, v156, v157
  v_exp_f32 v161, v161
  v_exp_f32 v162, v162
  v_cvt_pk_bf16_f32 v171, v158, v159
  v_exp_f32 v163, v163
  v_exp_f32 v164, v164
  v_mfma_f32_32x32x16_bf16 v[176:191], v[96:99], v[168:171], v[176:191]
  ds_add_f64 v220, v[224:225] offset:2560
  ds_add_f64 v220, v[226:227] offset:2816
  ds_add_f64 v220, v[228:229] offset:4096
  s_mov_b32 exec_hi, 0
  ds_add_f64 v220, v[230:231] offset:4352
  ds_add_f64 v220, v[232:233] offset:4608
  ds_add_f64 v220, v[234:235] offset:4864
  s_mov_b64 exec, -1
  v_cvt_pk_bf16_f32 v172, v160, v161
  v_exp_f32 v165, v165
  v_exp_f32 v166, v166
  v_cvt_pk_bf16_f32 v173, v162, v163
  v_exp_f32 v167, v167
  v_exp_f32 v136, v136
  v_exp_f32 v137, v137
  v_cvt_pk_bf16_f32 v174, v164, v165
  v_exp_f32 v138, v138
  v_cvt_pk_bf16_f32 v175, v166, v167
  v_mfma_f32_32x32x16_bf16 v[152:167], v[44:47], v[208:211], 0
  v_exp_f32 v139, v139
  v_exp_f32 v140, v140
  v_cvt_pk_bf16_f32 v168, v136, v137
  v_exp_f32 v141, v141
  v_mfma_f32_32x32x16_bf16 v[176:191], v[100:103], v[172:175], v[176:191]
  v_exp_f32 v142, v142
  v_cvt_pk_bf16_f32 v169, v138, v139
  v_exp_f32 v143, v143
  v_exp_f32 v144, v144
  v_mfma_f32_32x32x8_bf16 v[152:167], v[66:67], v[216:217], v[152:167]
  v_cvt_pk_bf16_f32 v170, v140, v141
  v_exp_f32 v145, v145
  v_exp_f32 v146, v146
  v_cvt_pk_bf16_f32 v171, v142, v143
  v_exp_f32 v147, v147
  v_exp_f32 v148, v148
  v_mfma_f32_32x32x16_bf16 v[176:191], v[104:107], v[168:171], v[176:191]
  v_cvt_pk_bf16_f32 v172, v144, v145
  v_exp_f32 v149, v149
  v_exp_f32 v150, v150
  v_cvt_pk_bf16_f32 v173, v146, v147
  v_exp_f32 v151, v151
  s_mul_i32 s49, s71, 5376
  v_add_u32 v220, s49, v223
  v_exp_f32 v152, v152
  v_exp_f32 v153, v153
  v_cvt_pk_bf16_f32 v174, v148, v149
  v_exp_f32 v154, v154
  v_cvt_pk_bf16_f32 v175, v150, v151
  v_mfma_f32_32x32x16_bf16 v[136:151], v[48:51], v[208:211], 0
  v_exp_f32 v155, v155
  v_exp_f32 v156, v156
  v_cvt_pk_bf16_f32 v168, v152, v153
  v_exp_f32 v157, v157
  v_mfma_f32_32x32x16_bf16 v[176:191], v[108:111], v[172:175], v[176:191]
  v_exp_f32 v158, v158
  v_cvt_pk_bf16_f32 v169, v154, v155
  v_exp_f32 v159, v159
  v_exp_f32 v160, v160
  v_mfma_f32_32x32x8_bf16 v[136:151], v[68:69], v[216:217], v[136:151]
  v_cvt_pk_bf16_f32 v170, v156, v157
  v_exp_f32 v161, v161
  v_exp_f32 v162, v162
  v_cvt_pk_bf16_f32 v171, v158, v159
  v_exp_f32 v163, v163
  v_exp_f32 v164, v164
  v_mfma_f32_32x32x16_bf16 v[176:191], v[112:115], v[168:171], v[176:191]
  v_cvt_pk_bf16_f32 v172, v160, v161
  v_exp_f32 v165, v165
  v_exp_f32 v166, v166
  v_cvt_pk_bf16_f32 v173, v162, v163
  v_exp_f32 v167, v167
  v_exp_f32 v136, v136
  v_exp_f32 v137, v137
  v_cvt_pk_bf16_f32 v174, v164, v165
  v_exp_f32 v138, v138
  v_cvt_pk_bf16_f32 v175, v166, v167
  v_mfma_f32_32x32x16_bf16 v[152:167], v[52:55], v[208:211], 0
  v_exp_f32 v139, v139
  v_exp_f32 v140, v140
  v_cvt_pk_bf16_f32 v168, v136, v137
  v_exp_f32 v141, v141
  v_mfma_f32_32x32x16_bf16 v[176:191], v[116:119], v[172:175], v[176:191]
  v_exp_f32 v142, v142
  v_cvt_pk_bf16_f32 v169, v138, v139
  v_exp_f32 v143, v143
  v_exp_f32 v144, v144
  v_mfma_f32_32x32x8_bf16 v[152:167], v[70:71], v[216:217], v[152:167]
  v_cvt_pk_bf16_f32 v170, v140, v141
  v_exp_f32 v145, v145
  v_exp_f32 v146, v146
  v_cvt_pk_bf16_f32 v171, v142, v143
  v_exp_f32 v147, v147
  v_exp_f32 v148, v148
  v_mfma_f32_32x32x16_bf16 v[176:191], v[120:123], v[168:171], v[176:191]
  v_cvt_pk_bf16_f32 v172, v144, v145
  v_exp_f32 v149, v149
  v_exp_f32 v150, v150
  v_cvt_pk_bf16_f32 v173, v146, v147
  v_exp_f32 v151, v151
  s_waitcnt lgkmcnt(0)
  v_exp_f32 v152, v152
  v_exp_f32 v153, v153
  v_cvt_pk_bf16_f32 v174, v148, v149
  v_exp_f32 v154, v154
  v_cvt_pk_bf16_f32 v175, v150, v151
  v_mfma_f32_32x32x16_bf16 v[136:151], v[24:27], v[212:215], 0
  v_exp_f32 v155, v155
  v_exp_f32 v156, v156
  v_cvt_pk_bf16_f32 v168, v152, v153
  v_exp_f32 v157, v157
  v_mfma_f32_32x32x16_bf16 v[176:191], v[124:127], v[172:175], v[176:191]
  v_exp_f32 v158, v158
  v_cvt_pk_bf16_f32 v169, v154, v155
  v_exp_f32 v159, v159
  v_exp_f32 v160, v160
  v_mfma_f32_32x32x8_bf16 v[136:151], v[56:57], v[218:219], v[136:151]
  v_cvt_pk_bf16_f32 v170, v156, v157
  v_exp_f32 v161, v161
  v_exp_f32 v162, v162
  v_cvt_pk_bf16_f32 v171, v158, v159
  v_exp_f32 v163, v163
  v_exp_f32 v164, v164
  v_mfma_f32_32x32x16_bf16 v[176:191], v[128:131], v[168:171], v[176:191]
  v_cvt_pk_bf16_f32 v172, v160, v161
  v_exp_f32 v165, v165
  v_exp_f32 v166, v166
  v_cvt_pk_bf16_f32 v173, v162, v163
  v_exp_f32 v167, v167
  s_mov_b32 s71, s48
  v_exp_f32 v136, v136
  v_exp_f32 v137, v137
  v_cvt_pk_bf16_f32 v174, v164, v165
  v_exp_f32 v138, v138
  v_cvt_pk_bf16_f32 v175, v166, v167
  v_mfma_f32_32x32x16_bf16 v[152:167], v[28:31], v[212:215], 0
  v_exp_f32 v139, v139
  v_exp_f32 v140, v140
  v_cvt_pk_bf16_f32 v168, v136, v137
  v_exp_f32 v141, v141
  v_mfma_f32_32x32x16_bf16 v[176:191], v[132:135], v[172:175], v[176:191]
  v_exp_f32 v142, v142
  v_cvt_pk_bf16_f32 v169, v138, v139
  v_exp_f32 v143, v143
  v_exp_f32 v144, v144
  v_mfma_f32_32x32x8_bf16 v[152:167], v[58:59], v[218:219], v[152:167]
  v_cvt_pk_bf16_f32 v170, v140, v141
  v_exp_f32 v145, v145
  v_exp_f32 v146, v146
  v_cvt_pk_bf16_f32 v171, v142, v143
  v_exp_f32 v147, v147
  v_exp_f32 v148, v148
  v_mfma_f32_32x32x16_bf16 v[192:207], v[72:75], v[168:171], 0
  v_cvt_pk_bf16_f32 v172, v144, v145
  v_exp_f32 v149, v149
  v_exp_f32 v150, v150
  v_cvt_pk_bf16_f32 v173, v146, v147
  v_exp_f32 v151, v151
  s_add_u32 s48, s71, 1
  s_and_b32 s48, s48, 7
  s_lshl_b32 s49, s48, 10
  v_add_u32 v3, s49, v221
  v_mad_u32_u24 v4, s48, v23, v222
  ds_read_b128 v[208:211], v3
  ds_read_b64 v[216:217], v4
  v_exp_f32 v152, v152
  v_exp_f32 v153, v153
  v_cvt_pk_bf16_f32 v174, v148, v149
  v_exp_f32 v154, v154
  v_cvt_pk_bf16_f32 v175, v150, v151
  v_mfma_f32_32x32x16_bf16 v[136:151], v[32:35], v[212:215], 0
  v_exp_f32 v155, v155
  v_exp_f32 v156, v156
  v_cvt_pk_bf16_f32 v168, v152, v153
  v_exp_f32 v157, v157
  v_mfma_f32_32x32x16_bf16 v[192:207], v[76:79], v[172:175], v[192:207]
  v_exp_f32 v158, v158
  v_cvt_pk_bf16_f32 v169, v154, v155
  v_exp_f32 v159, v159
  v_exp_f32 v160, v160
  v_mfma_f32_32x32x8_bf16 v[136:151], v[60:61], v[218:219], v[136:151]
  v_cvt_pk_bf16_f32 v170, v156, v157
  v_exp_f32 v161, v161
  v_exp_f32 v162, v162
  v_cvt_pk_bf16_f32 v171, v158, v159
  v_exp_f32 v163, v163
  v_exp_f32 v164, v164
  v_mfma_f32_32x32x16_bf16 v[192:207], v[80:83], v[168:171], v[192:207]
  v_cvt_pk_bf16_f32 v172, v160, v161
  v_exp_f32 v165, v165
  v_exp_f32 v166, v166
  v_cvt_pk_bf16_f32 v173, v162, v163
  v_exp_f32 v167, v167
  v_exp_f32 v136, v136
  v_exp_f32 v137, v137
  v_cvt_pk_bf16_f32 v174, v164, v165
  v_exp_f32 v138, v138
  v_cvt_pk_bf16_f32 v175, v166, v167
  v_mfma_f32_32x32x16_bf16 v[152:167], v[36:39], v[212:215], 0
  v_exp_f32 v139, v139
  v_exp_f32 v140, v140
  v_cvt_pk_bf16_f32 v168, v136, v137
  v_exp_f32 v141, v141
  v_mfma_f32_32x32x16_bf16 v[192:207], v[84:87], v[172:175], v[192:207]
  v_exp_f32 v142, v142
  v_cvt_pk_bf16_f32 v169, v138, v139
  v_exp_f32 v143, v143
  v_exp_f32 v144, v144
  v_mfma_f32_32x32x8_bf16 v[152:167], v[62:63], v[218:219], v[152:167]
  v_cvt_f64_f32 v[224:225], v176
  v_cvt_f64_f32 v[226:227], v177
  v_cvt_f64_f32 v[228:229], v178
  v_cvt_f64_f32 v[230:231], v179
  v_cvt_f64_f32 v[232:233], v180
  v_cvt_f64_f32 v[234:235], v181
  v_cvt_pk_bf16_f32 v170, v140, v141
  v_exp_f32 v145, v145
  v_exp_f32 v146, v146
  v_cvt_pk_bf16_f32 v171, v142, v143
  v_exp_f32 v147, v147
  v_exp_f32 v148, v148
  v_mfma_f32_32x32x16_bf16 v[192:207], v[88:91], v[168:171], v[192:207]
  ds_add_f64 v220, v[224:225] offset:0
  ds_add_f64 v220, v[226:227] offset:256
  ds_add_f64 v220, v[228:229] offset:512
  ds_add_f64 v220, v[230:231] offset:768
  ds_add_f64 v220, v[232:233] offset:2048
  ds_add_f64 v220, v[234:235] offset:2304
  v_cvt_pk_bf16_f32 v172, v144, v145
  v_exp_f32 v149, v149
  v_exp_f32 v150, v150
  v_cvt_pk_bf16_f32 v173, v146, v147
  v_exp_f32 v151, v151
  v_exp_f32 v152, v152
  v_exp_f32 v153, v153
  v_cvt_pk_bf16_f32 v174, v148, v149
  v_exp_f32 v154, v154
  v_cvt_pk_bf16_f32 v175, v150, v151
  v_mfma_f32_32x32x16_bf16 v[136:151], v[40:43], v[212:215], 0
  v_exp_f32 v155, v155
  v_exp_f32 v156, v156
  v_cvt_pk_bf16_f32 v168, v152, v153
  v_exp_f32 v157, v157
  v_mfma_f32_32x32x16_bf16 v[192:207], v[92:95], v[172:175], v[192:207]
  v_exp_f32 v158, v158
  v_cvt_pk_bf16_f32 v169, v154, v155
  v_exp_f32 v159, v159
  v_exp_f32 v160, v160
  v_mfma_f32_32x32x8_bf16 v[136:151], v[64:65], v[218:219], v[136:151]
  v_cvt_f64_f32 v[224:225], v182
  v_cvt_f64_f32 v[226:227], v183
  v_cvt_f64_f32 v[228:229], v184
  v_cvt_f64_f32 v[230:231], v185
  v_cvt_f64_f32 v[232:233], v186
  v_cvt_f64_f32 v[234:235], v187
  v_cvt_pk_bf16_f32 v170, v156, v157
  v_exp_f32 v161, v161
  v_exp_f32 v162, v162
  v_cvt_pk_bf16_f32 v171, v158, v159
  v_exp_f32 v163, v163
  v_exp_f32 v164, v164
  v_mfma_f32_32x32x16_bf16 v[192:207], v[96:99], v[168:171], v[192:207]
  ds_add_f64 v220, v[224:225] offset:2560
  ds_add_f64 v220, v[226:227] offset:2816
  ds_add_f64 v220, v[228:229] offset:4096
  s_mov_b32 exec_hi, 0
  ds_add_f64 v220, v[230:231] offset:4352
  ds_add_f64 v220, v[232:233] offset:4608
  ds_add_f64 v220, v[234:235] offset:4864
  s_mov_b64 exec, -1
  v_cvt_pk_bf16_f32 v172, v160, v161
  v_exp_f32 v165, v165
  v_exp_f32 v166, v166
  v_cvt_pk_bf16_f32 v173, v162, v163
  v_exp_f32 v167, v167
  v_exp_f32 v136, v136
  v_exp_f32 v137, v137
  v_cvt_pk_bf16_f32 v174, v164, v165
  v_exp_f32 v138, v138
  v_cvt_pk_bf16_f32 v175, v166, v167
  v_mfma_f32_32x32x16_bf16 v[152:167], v[44:47], v[212:215], 0
  v_exp_f32 v139, v139
  v_exp_f32 v140, v140
  v_cvt_pk_bf16_f32 v168, v136, v137
  v_exp_f32 v141, v141
  v_mfma_f32_32x32x16_bf16 v[192:207], v[100:103], v[172:175], v[192:207]
  v_exp_f32 v142, v142
  v_cvt_pk_bf16_f32 v169, v138, v139
  v_exp_f32 v143, v143
  v_exp_f32 v144, v144
  v_mfma_f32_32x32x8_bf16 v[152:167], v[66:67], v[218:219], v[152:167]
  v_cvt_pk_bf16_f32 v170, v140, v141
  v_exp_f32 v145, v145
  v_exp_f32 v146, v146
  v_cvt_pk_bf16_f32 v171, v142, v143
  v_exp_f32 v147, v147
  v_exp_f32 v148, v148
  v_mfma_f32_32x32x16_bf16 v[192:207], v[104:107], v[168:171], v[192:207]
  v_cvt_pk_bf16_f32 v172, v144, v145
  v_exp_f32 v149, v149
  v_exp_f32 v150, v150
  v_cvt_pk_bf16_f32 v173, v146, v147
  v_exp_f32 v151, v151
  s_mul_i32 s49, s71, 5376
  v_add_u32 v220, s49, v223
  v_exp_f32 v152, v152
  v_exp_f32 v153, v153
  v_cvt_pk_bf16_f32 v174, v148, v149
  v_exp_f32 v154, v154
  v_cvt_pk_bf16_f32 v175, v150, v151
  v_mfma_f32_32x32x16_bf16 v[136:151], v[48:51], v[212:215], 0
  v_exp_f32 v155, v155
  v_exp_f32 v156, v156
  v_cvt_pk_bf16_f32 v168, v152, v153
  v_exp_f32 v157, v157
  v_mfma_f32_32x32x16_bf16 v[192:207], v[108:111], v[172:175], v[192:207]
  v_exp_f32 v158, v158
  v_cvt_pk_bf16_f32 v169, v154, v155
  v_exp_f32 v159, v159
  v_exp_f32 v160, v160
  v_mfma_f32_32x32x8_bf16 v[136:151], v[68:69], v[218:219], v[136:151]
  v_cvt_pk_bf16_f32 v170, v156, v157
  v_exp_f32 v161, v161
  v_exp_f32 v162, v162
  v_cvt_pk_bf16_f32 v171, v158, v159
  v_exp_f32 v163, v163
  v_exp_f32 v164, v164
  v_mfma_f32_32x32x16_bf16 v[192:207], v[112:115], v[168:171], v[192:207]
  v_cvt_pk_bf16_f32 v172, v160, v161
  v_exp_f32 v165, v165
  v_exp_f32 v166, v166
  v_cvt_pk_bf16_f32 v173, v162, v163
  v_exp_f32 v167, v167
  v_exp_f32 v136, v136
  v_exp_f32 v137, v137
  v_cvt_pk_bf16_f32 v174, v164, v165
  v_exp_f32 v138, v138
  v_cvt_pk_bf16_f32 v175, v166, v167
  v_mfma_f32_32x32x16_bf16 v[152:167], v[52:55], v[212:215], 0
  v_exp_f32 v139, v139
  v_exp_f32 v140, v140
  v_cvt_pk_bf16_f32 v168, v136, v137
  v_exp_f32 v141, v141
  v_mfma_f32_32x32x16_bf16 v[192:207], v[116:119], v[172:175], v[192:207]
  v_exp_f32 v142, v142
  v_cvt_pk_bf16_f32 v169, v138, v139
  v_exp_f32 v143, v143
  v_exp_f32 v144, v144
  v_mfma_f32_32x32x8_bf16 v[152:167], v[70:71], v[218:219], v[152:167]
  v_cvt_pk_bf16_f32 v170, v140, v141
  v_exp_f32 v145, v145
  v_exp_f32 v146, v146
  v_cvt_pk_bf16_f32 v171, v142, v143
  v_exp_f32 v147, v147
  v_exp_f32 v148, v148
  v_mfma_f32_32x32x16_bf16 v[192:207], v[120:123], v[168:171], v[192:207]
  v_cvt_pk_bf16_f32 v172, v144, v145
  v_exp_f32 v149, v149
  v_exp_f32 v150, v150
  v_cvt_pk_bf16_f32 v173, v146, v147
  v_exp_f32 v151, v151
  s_waitcnt lgkmcnt(0)
  v_exp_f32 v152, v152
  v_exp_f32 v153, v153
  v_cvt_pk_bf16_f32 v174, v148, v149
  v_exp_f32 v154, v154
  v_cvt_pk_bf16_f32 v175, v150, v151
  v_mfma_f32_32x32x16_bf16 v[136:151], v[24:27], v[208:211], 0
  v_exp_f32 v155, v155
  v_exp_f32 v156, v156
  v_cvt_pk_bf16_f32 v168, v152, v153
  v_exp_f32 v157, v157
  v_mfma_f32_32x32x16_bf16 v[192:207], v[124:127], v[172:175], v[192:207]
  v_exp_f32 v158, v158
  v_cvt_pk_bf16_f32 v169, v154, v155
  v_exp_f32 v159, v159
  v_exp_f32 v160, v160
  v_mfma_f32_32x32x8_bf16 v[136:151], v[56:57], v[216:217], v[136:151]
  v_cvt_pk_bf16_f32 v170, v156, v157
  v_exp_f32 v161, v161
  v_exp_f32 v162, v162
  v_cvt_pk_bf16_f32 v171, v158, v159
  v_exp_f32 v163, v163
  v_exp_f32 v164, v164
  v_mfma_f32_32x32x16_bf16 v[192:207], v[128:131], v[168:171], v[192:207]
  v_cvt_pk_bf16_f32 v172, v160, v161
  v_exp_f32 v165, v165
  v_exp_f32 v166, v166
  v_cvt_pk_bf16_f32 v173, v162, v163
  v_exp_f32 v167, v167
  s_mov_b32 s71, s48
  s_add_u32 s70, s70, 1
  s_cmp_lt_u32 s70, 4
  s_cbranch_scc1 gated_mix__grouped_kv_mqa__spectral_gfnet__prompt_kernel_al38
  s_nop 0
  v_cvt_pk_bf16_f32 v174, v164, v165
  v_cvt_pk_bf16_f32 v175, v166, v167
  s_nop 1
  v_mfma_f32_32x32x16_bf16 v[192:207], v[132:135], v[172:175], v[192:207]
  s_nop 15
  v_cvt_f64_f32 v[224:225], v192
  v_cvt_f64_f32 v[226:227], v193
  v_cvt_f64_f32 v[228:229], v194
  v_cvt_f64_f32 v[230:231], v195
  v_cvt_f64_f32 v[232:233], v196
  v_cvt_f64_f32 v[234:235], v197
  v_cvt_f64_f32 v[236:237], v198
  v_cvt_f64_f32 v[238:239], v199
  v_cvt_f64_f32 v[240:241], v200
  v_cvt_f64_f32 v[242:243], v201
  v_cvt_f64_f32 v[244:245], v202
  v_cvt_f64_f32 v[246:247], v203
  ds_add_f64 v220, v[224:225] offset:0
  ds_add_f64 v220, v[226:227] offset:256
  ds_add_f64 v220, v[228:229] offset:512
  ds_add_f64 v220, v[230:231] offset:768
  ds_add_f64 v220, v[232:233] offset:2048
  ds_add_f64 v220, v[234:235] offset:2304
  ds_add_f64 v220, v[236:237] offset:2560
  ds_add_f64 v220, v[238:239] offset:2816
  ds_add_f64 v220, v[240:241] offset:4096
  s_mov_b32 exec_hi, 0
  ds_add_f64 v220, v[242:243] offset:4352
  ds_add_f64 v220, v[244:245] offset:4608
  ds_add_f64 v220, v[246:247] offset:4864
  s_mov_b64 exec, -1
  s_branch gated_mix__grouped_kv_mqa__spectral_gfnet__prompt_kernel_adone36
gated_mix__grouped_kv_mqa__spectral_gfnet__prompt_kernel_res35:
  s_lshl_b32 s49, s71, 10
  v_add_u32 v3, s49, v221
  v_mad_u32_u24 v4, s71, v23, v222
  ds_read_b128 v[208:211], v3
  ds_read_b64 v[216:217], v4
  s_waitcnt lgkmcnt(0)
  v_mfma_f32_32x32x16_bf16 v[136:151], v[24:27], v[208:211], 0
  v_mfma_f32_32x32x8_bf16 v[136:151], v[56:57], v[216:217], v[136:151]
  s_nop 13
  v_exp_f32 v136, v136
  v_exp_f32 v137, v137
  v_exp_f32 v138, v138
  v_mfma_f32_32x32x16_bf16 v[152:167], v[28:31], v[208:211], 0
  v_exp_f32 v139, v139
  v_exp_f32 v140, v140
  v_cvt_pk_bf16_f32 v168, v136, v137
  v_exp_f32 v141, v141
  v_exp_f32 v142, v142
  v_cvt_pk_bf16_f32 v169, v138, v139
  v_exp_f32 v143, v143
  v_exp_f32 v144, v144
  v_mfma_f32_32x32x8_bf16 v[152:167], v[58:59], v[216:217], v[152:167]
  v_cvt_pk_bf16_f32 v170, v140, v141
  v_exp_f32 v145, v145
  v_exp_f32 v146, v146
  v_cvt_pk_bf16_f32 v171, v142, v143
  v_exp_f32 v147, v147
  v_exp_f32 v148, v148
  v_mfma_f32_32x32x16_bf16 v[176:191], v[72:75], v[168:171], 0
  v_cvt_pk_bf16_f32 v172, v144, v145
  v_exp_f32 v149, v149
  v_exp_f32 v150, v150
  v_cvt_pk_bf16_f32 v173, v146, v147
  v_exp_f32 v151, v151
  s_add_u32 s48, s71, 1
  s_and_b32 s48, s48, 7
  s_lshl_b32 s49, s48, 10
  v_add_u32 v3, s49, v221
  v_mad_u32_u24 v4, s48, v23, v222
  ds_read_b128 v[212:215], v3
  ds_read_b64 v[218:219], v4
  v_exp_f32 v152, v152
  v_exp_f32 v153, v153
  v_cvt_pk_bf16_f32 v174, v148, v149
  v_exp_f32 v154, v154
  v_cvt_pk_bf16_f32 v175, v150, v151
  v_mfma_f32_32x32x16_bf16 v[136:151], v[32:35], v[208:211], 0
  v_exp_f32 v155, v155
  v_exp_f32 v156, v156
  v_cvt_pk_bf16_f32 v168, v152, v153
  v_exp_f32 v157, v157
  v_mfma_f32_32x32x16_bf16 v[176:191], v[76:79], v[172:175], v[176:191]
  v_exp_f32 v158, v158
  v_cvt_pk_bf16_f32 v169, v154, v155
  v_exp_f32 v159, v159
  v_exp_f32 v160, v160
  v_mfma_f32_32x32x8_bf16 v[136:151], v[60:61], v[216:217], v[136:151]
  v_cvt_pk_bf16_f32 v170, v156, v157
  v_exp_f32 v161, v161
  v_exp_f32 v162, v162
  v_cvt_pk_bf16_f32 v171, v158, v159
  v_exp_f32 v163, v163
  v_exp_f32 v164, v164
  v_mfma_f32_32x32x16_bf16 v[176:191], v[80:83], v[168:171], v[176:191]
  v_cvt_pk_bf16_f32 v172, v160, v161
  v_exp_f32 v165, v165
  v_exp_f32 v166, v166
  v_cvt_pk_bf16_f32 v173, v162, v163
  v_exp_f32 v167, v167
  v_exp_f32 v136, v136
  v_exp_f32 v137, v137
  v_cvt_pk_bf16_f32 v174, v164, v165
  v_exp_f32 v138, v138
  v_cvt_pk_bf16_f32 v175, v166, v167
  v_mfma_f32_32x32x16_bf16 v[152:167], v[36:39], v[208:211], 0
  v_exp_f32 v139, v139
  v_exp_f32 v140, v140
  v_cvt_pk_bf16_f32 v168, v136, v137
  v_exp_f32 v141, v141
  v_mfma_f32_32x32x16_bf16 v[176:191], v[84:87], v[172:175], v[176:191]
  v_exp_f32 v142, v142
  v_cvt_pk_bf16_f32 v169, v138, v139
  v_exp_f32 v143, v143
  v_exp_f32 v144, v144
  v_mfma_f32_32x32x8_bf16 v[152:167], v[62:63], v[216:217], v[152:167]
  v_cvt_pk_bf16_f32 v170, v140, v141
  v_exp_f32 v145, v145
  v_exp_f32 v146, v146
  v_cvt_pk_bf16_f32 v171, v142, v143
  v_exp_f32 v147, v147
  v_exp_f32 v148, v148
  v_mfma_f32_32x32x16_bf16 v[176:191], v[88:91], v[168:171], v[176:191]
  v_cvt_pk_bf16_f32 v172, v144, v145
  v_exp_f32 v149, v149
  v_exp_f32 v150, v150
  v_cvt_pk_bf16_f32 v173, v146, v147
  v_exp_f32 v151, v151
  v_exp_f32 v152, v152
  v_exp_f32 v153, v153
  v_cvt_pk_bf16_f32 v174, v148, v149
  v_exp_f32 v154, v154
  v_cvt_pk_bf16_f32 v175, v150, v151
  v_mfma_f32_32x32x16_bf16 v[136:151], v[40:43], v[208:211], 0
  v_exp_f32 v155, v155
  v_exp_f32 v156, v156
  v_cvt_pk_bf16_f32 v168, v152, v153
  v_exp_f32 v157, v157
  v_mfma_f32_32x32x16_bf16 v[176:191], v[92:95], v[172:175], v[176:191]
  v_exp_f32 v158, v158
  v_cvt_pk_bf16_f32 v169, v154, v155
  v_exp_f32 v159, v159
  v_exp_f32 v160, v160
  v_mfma_f32_32x32x8_bf16 v[136:151], v[64:65], v[216:217], v[136:151]
  v_cvt_pk_bf16_f32 v170, v156, v157
  v_exp_f32 v161, v161
  v_exp_f32 v162, v162
  v_cvt_pk_bf16_f32 v171, v158, v159
  v_exp_f32 v163, v163
  v_exp_f32 v164, v164
  v_mfma_f32_32x32x16_bf16 v[176:191], v[96:99], v[168:171], v[176:191]
  v_cvt_pk_bf16_f32 v172, v160, v161
  v_exp_f32 v165, v165
  v_exp_f32 v166, v166
  v_cvt_pk_bf16_f32 v173, v162, v163
  v_exp_f32 v167, v167
  v_exp_f32 v136, v136
  v_exp_f32 v137, v137
  v_cvt_pk_bf16_f32 v174, v164, v165
  v_exp_f32 v138, v138
  v_cvt_pk_bf16_f32 v175, v166, v167
  v_mfma_f32_32x32x16_bf16 v[152:167], v[44:47], v[208:211], 0
  v_exp_f32 v139, v139
  v_exp_f32 v140, v140
  v_cvt_pk_bf16_f32 v168, v136, v137
  v_exp_f32 v141, v141
  v_mfma_f32_32x32x16_bf16 v[176:191], v[100:103], v[172:175], v[176:191]
  v_exp_f32 v142, v142
  v_cvt_pk_bf16_f32 v169, v138, v139
  v_exp_f32 v143, v143
  v_exp_f32 v144, v144
  v_mfma_f32_32x32x8_bf16 v[152:167], v[66:67], v[216:217], v[152:167]
  v_cvt_pk_bf16_f32 v170, v140, v141
  v_exp_f32 v145, v145
  v_exp_f32 v146, v146
  v_cvt_pk_bf16_f32 v171, v142, v143
  v_exp_f32 v147, v147
  v_exp_f32 v148, v148
  v_mfma_f32_32x32x16_bf16 v[176:191], v[104:107], v[168:171], v[176:191]
  v_cvt_pk_bf16_f32 v172, v144, v145
  v_exp_f32 v149, v149
  v_exp_f32 v150, v150
  v_cvt_pk_bf16_f32 v173, v146, v147
  v_exp_f32 v151, v151
  s_mul_i32 s49, s71, 5376
  v_add_u32 v220, s49, v223
  v_exp_f32 v152, v152
  v_exp_f32 v153, v153
  v_cvt_pk_bf16_f32 v174, v148, v149
  v_exp_f32 v154, v154
  v_cvt_pk_bf16_f32 v175, v150, v151
  v_mfma_f32_32x32x16_bf16 v[136:151], v[48:51], v[208:211], 0
  v_exp_f32 v155, v155
  v_exp_f32 v156, v156
  v_cvt_pk_bf16_f32 v168, v152, v153
  v_exp_f32 v157, v157
  v_mfma_f32_32x32x16_bf16 v[176:191], v[108:111], v[172:175], v[176:191]
  v_exp_f32 v158, v158
  v_cvt_pk_bf16_f32 v169, v154, v155
  v_exp_f32 v159, v159
  v_exp_f32 v160, v160
  v_mfma_f32_32x32x8_bf16 v[136:151], v[68:69], v[216:217], v[136:151]
  v_cvt_pk_bf16_f32 v170, v156, v157
  v_exp_f32 v161, v161
  v_exp_f32 v162, v162
  v_cvt_pk_bf16_f32 v171, v158, v159
  v_exp_f32 v163, v163
  v_exp_f32 v164, v164
  v_mfma_f32_32x32x16_bf16 v[176:191], v[112:115], v[168:171], v[176:191]
  v_cvt_pk_bf16_f32 v172, v160, v161
  v_exp_f32 v165, v165
  v_exp_f32 v166, v166
  v_cvt_pk_bf16_f32 v173, v162, v163
  v_exp_f32 v167, v167
  v_exp_f32 v136, v136
  v_exp_f32 v137, v137
  v_cvt_pk_bf16_f32 v174, v164, v165
  v_exp_f32 v138, v138
  v_cvt_pk_bf16_f32 v175, v166, v167
  v_mfma_f32_32x32x16_bf16 v[152:167], v[52:55], v[208:211], 0
  v_exp_f32 v139, v139
  v_exp_f32 v140, v140
  v_cvt_pk_bf16_f32 v168, v136, v137
  v_exp_f32 v141, v141
  v_mfma_f32_32x32x16_bf16 v[176:191], v[116:119], v[172:175], v[176:191]
  v_exp_f32 v142, v142
  v_cvt_pk_bf16_f32 v169, v138, v139
  v_exp_f32 v143, v143
  v_exp_f32 v144, v144
  v_mfma_f32_32x32x8_bf16 v[152:167], v[70:71], v[216:217], v[152:167]
  v_cvt_pk_bf16_f32 v170, v140, v141
  v_exp_f32 v145, v145
  v_exp_f32 v146, v146
  v_cvt_pk_bf16_f32 v171, v142, v143
  v_exp_f32 v147, v147
  v_exp_f32 v148, v148
  v_mfma_f32_32x32x16_bf16 v[176:191], v[120:123], v[168:171], v[176:191]
  v_cvt_pk_bf16_f32 v172, v144, v145
  v_exp_f32 v149, v149
  v_exp_f32 v150, v150
  v_cvt_pk_bf16_f32 v173, v146, v147
  v_exp_f32 v151, v151
  s_waitcnt lgkmcnt(0)
  v_exp_f32 v152, v152
  v_exp_f32 v153, v153
  v_cvt_pk_bf16_f32 v174, v148, v149
  v_exp_f32 v154, v154
  v_cvt_pk_bf16_f32 v175, v150, v151
  v_mfma_f32_32x32x16_bf16 v[136:151], v[24:27], v[212:215], 0
  v_exp_f32 v155, v155
  v_exp_f32 v156, v156
  v_cvt_pk_bf16_f32 v168, v152, v153
  v_exp_f32 v157, v157
  v_mfma_f32_32x32x16_bf16 v[176:191], v[124:127], v[172:175], v[176:191]
  v_exp_f32 v158, v158
  v_cvt_pk_bf16_f32 v169, v154, v155
  v_exp_f32 v159, v159
  v_exp_f32 v160, v160
  v_mfma_f32_32x32x8_bf16 v[136:151], v[56:57], v[218:219], v[136:151]
  v_cvt_pk_bf16_f32 v170, v156, v157
  v_exp_f32 v161, v161
  v_exp_f32 v162, v162
  v_cvt_pk_bf16_f32 v171, v158, v159
  v_exp_f32 v163, v163
  v_exp_f32 v164, v164
  v_mfma_f32_32x32x16_bf16 v[176:191], v[128:131], v[168:171], v[176:191]
  v_cvt_pk_bf16_f32 v172, v160, v161
  v_exp_f32 v165, v165
  v_exp_f32 v166, v166
  v_cvt_pk_bf16_f32 v173, v162, v163
  v_exp_f32 v167, v167
  s_mov_b32 s71, s48
  v_exp_f32 v136, v136
  v_exp_f32 v137, v137
  v_cvt_pk_bf16_f32 v174, v164, v165
  v_exp_f32 v138, v138
  v_cvt_pk_bf16_f32 v175, v166, v167
  v_mfma_f32_32x32x16_bf16 v[152:167], v[28:31], v[212:215], 0
  v_exp_f32 v139, v139
  v_exp_f32 v140, v140
  v_cvt_pk_bf16_f32 v168, v136, v137
  v_exp_f32 v141, v141
  v_mfma_f32_32x32x16_bf16 v[176:191], v[132:135], v[172:175], v[176:191]
  v_exp_f32 v142, v142
  v_cvt_pk_bf16_f32 v169, v138, v139
  v_exp_f32 v143, v143
  v_exp_f32 v144, v144
  v_mfma_f32_32x32x8_bf16 v[152:167], v[58:59], v[218:219], v[152:167]
  v_cvt_pk_bf16_f32 v170, v140, v141
  v_exp_f32 v145, v145
  v_exp_f32 v146, v146
  v_cvt_pk_bf16_f32 v171, v142, v143
  v_exp_f32 v147, v147
  v_exp_f32 v148, v148
  v_mfma_f32_32x32x16_bf16 v[192:207], v[72:75], v[168:171], 0
  v_cvt_pk_bf16_f32 v172, v144, v145
  v_exp_f32 v149, v149
  v_exp_f32 v150, v150
  v_cvt_pk_bf16_f32 v173, v146, v147
  v_exp_f32 v151, v151
  s_add_u32 s48, s71, 1
  s_and_b32 s48, s48, 7
  s_lshl_b32 s49, s48, 10
  v_add_u32 v3, s49, v221
  v_mad_u32_u24 v4, s48, v23, v222
  ds_read_b128 v[208:211], v3
  ds_read_b64 v[216:217], v4
  v_exp_f32 v152, v152
  v_exp_f32 v153, v153
  v_cvt_pk_bf16_f32 v174, v148, v149
  v_exp_f32 v154, v154
  v_cvt_pk_bf16_f32 v175, v150, v151
  v_mfma_f32_32x32x16_bf16 v[136:151], v[32:35], v[212:215], 0
  v_exp_f32 v155, v155
  v_exp_f32 v156, v156
  v_cvt_pk_bf16_f32 v168, v152, v153
  v_exp_f32 v157, v157
  v_mfma_f32_32x32x16_bf16 v[192:207], v[76:79], v[172:175], v[192:207]
  v_exp_f32 v158, v158
  v_cvt_pk_bf16_f32 v169, v154, v155
  v_exp_f32 v159, v159
  v_exp_f32 v160, v160
  v_mfma_f32_32x32x8_bf16 v[136:151], v[60:61], v[218:219], v[136:151]
  v_cvt_pk_bf16_f32 v170, v156, v157
  v_exp_f32 v161, v161
  v_exp_f32 v162, v162
  v_cvt_pk_bf16_f32 v171, v158, v159
  v_exp_f32 v163, v163
  v_exp_f32 v164, v164
  v_mfma_f32_32x32x16_bf16 v[192:207], v[80:83], v[168:171], v[192:207]
  v_cvt_pk_bf16_f32 v172, v160, v161
  v_exp_f32 v165, v165
  v_exp_f32 v166, v166
  v_cvt_pk_bf16_f32 v173, v162, v163
  v_exp_f32 v167, v167
  v_exp_f32 v136, v136
  v_exp_f32 v137, v137
  v_cvt_pk_bf16_f32 v174, v164, v165
  v_exp_f32 v138, v138
  v_cvt_pk_bf16_f32 v175, v166, v167
  v_mfma_f32_32x32x16_bf16 v[152:167], v[36:39], v[212:215], 0
  v_exp_f32 v139, v139
  v_exp_f32 v140, v140
  v_cvt_pk_bf16_f32 v168, v136, v137
  v_exp_f32 v141, v141
  v_mfma_f32_32x32x16_bf16 v[192:207], v[84:87], v[172:175], v[192:207]
  v_exp_f32 v142, v142
  v_cvt_pk_bf16_f32 v169, v138, v139
  v_exp_f32 v143, v143
  v_exp_f32 v144, v144
  v_mfma_f32_32x32x8_bf16 v[152:167], v[62:63], v[218:219], v[152:167]
  v_cvt_f64_f32 v[224:225], v176
  v_cvt_f64_f32 v[226:227], v177
  v_cvt_f64_f32 v[228:229], v178
  v_cvt_f64_f32 v[230:231], v179
  v_cvt_f64_f32 v[232:233], v180
  v_cvt_f64_f32 v[234:235], v181
  v_cvt_pk_bf16_f32 v170, v140, v141
  v_exp_f32 v145, v145
  v_exp_f32 v146, v146
  v_cvt_pk_bf16_f32 v171, v142, v143
  v_exp_f32 v147, v147
  v_exp_f32 v148, v148
  v_mfma_f32_32x32x16_bf16 v[192:207], v[88:91], v[168:171], v[192:207]
  ds_add_f64 v220, v[224:225] offset:0
  ds_add_f64 v220, v[226:227] offset:256
  ds_add_f64 v220, v[228:229] offset:512
  ds_add_f64 v220, v[230:231] offset:768
  ds_add_f64 v220, v[232:233] offset:2048
  ds_add_f64 v220, v[234:235] offset:2304
  v_cvt_pk_bf16_f32 v172, v144, v145
  v_exp_f32 v149, v149
  v_exp_f32 v150, v150
  v_cvt_pk_bf16_f32 v173, v146, v147
  v_exp_f32 v151, v151
  v_exp_f32 v152, v152
  v_exp_f32 v153, v153
  v_cvt_pk_bf16_f32 v174, v148, v149
  v_exp_f32 v154, v154
  v_cvt_pk_bf16_f32 v175, v150, v151
  v_mfma_f32_32x32x16_bf16 v[136:151], v[40:43], v[212:215], 0
  v_exp_f32 v155, v155
  v_exp_f32 v156, v156
  v_cvt_pk_bf16_f32 v168, v152, v153
  v_exp_f32 v157, v157
  v_mfma_f32_32x32x16_bf16 v[192:207], v[92:95], v[172:175], v[192:207]
  v_exp_f32 v158, v158
  v_cvt_pk_bf16_f32 v169, v154, v155
  v_exp_f32 v159, v159
  v_exp_f32 v160, v160
  v_mfma_f32_32x32x8_bf16 v[136:151], v[64:65], v[218:219], v[136:151]
  v_cvt_f64_f32 v[224:225], v182
  v_cvt_f64_f32 v[226:227], v183
  v_cvt_f64_f32 v[228:229], v184
  v_cvt_f64_f32 v[230:231], v185
  v_cvt_f64_f32 v[232:233], v186
  v_cvt_f64_f32 v[234:235], v187
  v_cvt_pk_bf16_f32 v170, v156, v157
  v_exp_f32 v161, v161
  v_exp_f32 v162, v162
  v_cvt_pk_bf16_f32 v171, v158, v159
  v_exp_f32 v163, v163
  v_exp_f32 v164, v164
  v_mfma_f32_32x32x16_bf16 v[192:207], v[96:99], v[168:171], v[192:207]
  ds_add_f64 v220, v[224:225] offset:2560
  ds_add_f64 v220, v[226:227] offset:2816
  ds_add_f64 v220, v[228:229] offset:4096
  s_mov_b32 exec_hi, 0
  ds_add_f64 v220, v[230:231] offset:4352
  ds_add_f64 v220, v[232:233] offset:4608
  ds_add_f64 v220, v[234:235] offset:4864
  s_mov_b64 exec, -1
  v_cvt_pk_bf16_f32 v172, v160, v161
  v_exp_f32 v165, v165
  v_exp_f32 v166, v166
  v_cvt_pk_bf16_f32 v173, v162, v163
  v_exp_f32 v167, v167
  v_exp_f32 v136, v136
  v_exp_f32 v137, v137
  v_cvt_pk_bf16_f32 v174, v164, v165
  v_exp_f32 v138, v138
  v_cvt_pk_bf16_f32 v175, v166, v167
  v_mfma_f32_32x32x16_bf16 v[152:167], v[44:47], v[212:215], 0
  v_exp_f32 v139, v139
  v_exp_f32 v140, v140
  v_cvt_pk_bf16_f32 v168, v136, v137
  v_exp_f32 v141, v141
  v_mfma_f32_32x32x16_bf16 v[192:207], v[100:103], v[172:175], v[192:207]
  v_exp_f32 v142, v142
  v_cvt_pk_bf16_f32 v169, v138, v139
  v_exp_f32 v143, v143
  v_exp_f32 v144, v144
  v_mfma_f32_32x32x8_bf16 v[152:167], v[66:67], v[218:219], v[152:167]
  v_cvt_pk_bf16_f32 v170, v140, v141
  v_exp_f32 v145, v145
  v_exp_f32 v146, v146
  v_cvt_pk_bf16_f32 v171, v142, v143
  v_exp_f32 v147, v147
  v_exp_f32 v148, v148
  v_mfma_f32_32x32x16_bf16 v[192:207], v[104:107], v[168:171], v[192:207]
  v_cvt_pk_bf16_f32 v172, v144, v145
  v_exp_f32 v149, v149
  v_exp_f32 v150, v150
  v_cvt_pk_bf16_f32 v173, v146, v147
  v_exp_f32 v151, v151
  s_mul_i32 s49, s71, 5376
  v_add_u32 v220, s49, v223
  v_exp_f32 v152, v152
  v_exp_f32 v153, v153
  v_cvt_pk_bf16_f32 v174, v148, v149
  v_exp_f32 v154, v154
  v_cvt_pk_bf16_f32 v175, v150, v151
  v_mfma_f32_32x32x16_bf16 v[136:151], v[48:51], v[212:215], 0
  v_exp_f32 v155, v155
  v_exp_f32 v156, v156
  v_cvt_pk_bf16_f32 v168, v152, v153
  v_exp_f32 v157, v157
  v_mfma_f32_32x32x16_bf16 v[192:207], v[108:111], v[172:175], v[192:207]
  v_exp_f32 v158, v158
  v_cvt_pk_bf16_f32 v169, v154, v155
  v_exp_f32 v159, v159
  v_exp_f32 v160, v160
  v_mfma_f32_32x32x8_bf16 v[136:151], v[68:69], v[218:219], v[136:151]
  v_cvt_pk_bf16_f32 v170, v156, v157
  v_exp_f32 v161, v161
  v_exp_f32 v162, v162
  v_cvt_pk_bf16_f32 v171, v158, v159
  v_exp_f32 v163, v163
  v_exp_f32 v164, v164
  v_mfma_f32_32x32x16_bf16 v[192:207], v[112:115], v[168:171], v[192:207]
  v_cvt_pk_bf16_f32 v172, v160, v161
  v_exp_f32 v165, v165
  v_exp_f32 v166, v166
  v_cvt_pk_bf16_f32 v173, v162, v163
  v_exp_f32 v167, v167
  v_exp_f32 v136, v136
  v_exp_f32 v137, v137
  v_cvt_pk_bf16_f32 v174, v164, v165
  v_exp_f32 v138, v138
  v_cvt_pk_bf16_f32 v175, v166, v167
  v_mfma_f32_32x32x16_bf16 v[152:167], v[52:55], v[212:215], 0
  v_exp_f32 v139, v139
  v_exp_f32 v140, v140
  v_cvt_pk_bf16_f32 v168, v136, v137
  v_exp_f32 v141, v141
  v_mfma_f32_32x32x16_bf16 v[192:207], v[116:119], v[172:175], v[192:207]
  v_exp_f32 v142, v142
  v_cvt_pk_bf16_f32 v169, v138, v139
  v_exp_f32 v143, v143
  v_exp_f32 v144, v144
  v_mfma_f32_32x32x8_bf16 v[152:167], v[70:71], v[218:219], v[152:167]
  v_cvt_pk_bf16_f32 v170, v140, v141
  v_exp_f32 v145, v145
  v_exp_f32 v146, v146
  v_cvt_pk_bf16_f32 v171, v142, v143
  v_exp_f32 v147, v147
  v_exp_f32 v148, v148
  v_mfma_f32_32x32x16_bf16 v[192:207], v[120:123], v[168:171], v[192:207]
  v_cvt_pk_bf16_f32 v172, v144, v145
  v_exp_f32 v149, v149
  v_exp_f32 v150, v150
  v_cvt_pk_bf16_f32 v173, v146, v147
  v_exp_f32 v151, v151
  s_waitcnt lgkmcnt(0)
  v_exp_f32 v152, v152
  v_exp_f32 v153, v153
  v_cvt_pk_bf16_f32 v174, v148, v149
  v_exp_f32 v154, v154
  v_cvt_pk_bf16_f32 v175, v150, v151
  v_mfma_f32_32x32x16_bf16 v[136:151], v[24:27], v[208:211], 0
  v_exp_f32 v155, v155
  v_exp_f32 v156, v156
  v_cvt_pk_bf16_f32 v168, v152, v153
  v_exp_f32 v157, v157
  v_mfma_f32_32x32x16_bf16 v[192:207], v[124:127], v[172:175], v[192:207]
  v_exp_f32 v158, v158
  v_cvt_pk_bf16_f32 v169, v154, v155
  v_exp_f32 v159, v159
  v_exp_f32 v160, v160
  v_mfma_f32_32x32x8_bf16 v[136:151], v[56:57], v[216:217], v[136:151]
  v_cvt_pk_bf16_f32 v170, v156, v157
  v_exp_f32 v161, v161
  v_exp_f32 v162, v162
  v_cvt_pk_bf16_f32 v171, v158, v159
  v_exp_f32 v163, v163
  v_exp_f32 v164, v164
  v_mfma_f32_32x32x16_bf16 v[192:207], v[128:131], v[168:171], v[192:207]
  v_cvt_pk_bf16_f32 v172, v160, v161
  v_exp_f32 v165, v165
  v_exp_f32 v166, v166
  v_cvt_pk_bf16_f32 v173, v162, v163
  v_exp_f32 v167, v167
  s_mov_b32 s71, s48
  s_mov_b32 s70, 1
gated_mix__grouped_kv_mqa__spectral_gfnet__prompt_kernel_attn39:
  v_exp_f32 v136, v136
  v_exp_f32 v137, v137
  v_cvt_pk_bf16_f32 v174, v164, v165
  v_exp_f32 v138, v138
  v_cvt_pk_bf16_f32 v175, v166, v167
  v_mfma_f32_32x32x16_bf16 v[152:167], v[28:31], v[208:211], 0
  v_exp_f32 v139, v139
  v_exp_f32 v140, v140
  v_cvt_pk_bf16_f32 v168, v136, v137
  v_exp_f32 v141, v141
  v_mfma_f32_32x32x16_bf16 v[192:207], v[132:135], v[172:175], v[192:207]
  v_exp_f32 v142, v142
  v_cvt_pk_bf16_f32 v169, v138, v139
  v_exp_f32 v143, v143
  v_exp_f32 v144, v144
  v_mfma_f32_32x32x8_bf16 v[152:167], v[58:59], v[216:217], v[152:167]
  v_cvt_pk_bf16_f32 v170, v140, v141
  v_exp_f32 v145, v145
  v_exp_f32 v146, v146
  v_cvt_pk_bf16_f32 v171, v142, v143
  v_exp_f32 v147, v147
  v_exp_f32 v148, v148
  v_mfma_f32_32x32x16_bf16 v[176:191], v[72:75], v[168:171], 0
  v_cvt_pk_bf16_f32 v172, v144, v145
  v_exp_f32 v149, v149
  v_exp_f32 v150, v150
  v_cvt_pk_bf16_f32 v173, v146, v147
  v_exp_f32 v151, v151
  s_add_u32 s48, s71, 1
  s_and_b32 s48, s48, 7
  s_lshl_b32 s49, s48, 10
  v_add_u32 v3, s49, v221
  v_mad_u32_u24 v4, s48, v23, v222
  ds_read_b128 v[212:215], v3
  ds_read_b64 v[218:219], v4
  v_exp_f32 v152, v152
  v_exp_f32 v153, v153
  v_cvt_pk_bf16_f32 v174, v148, v149
  v_exp_f32 v154, v154
  v_cvt_pk_bf16_f32 v175, v150, v151
  v_mfma_f32_32x32x16_bf16 v[136:151], v[32:35], v[208:211], 0
  v_exp_f32 v155, v155
  v_exp_f32 v156, v156
  v_cvt_pk_bf16_f32 v168, v152, v153
  v_exp_f32 v157, v157
  v_mfma_f32_32x32x16_bf16 v[176:191], v[76:79], v[172:175], v[176:191]
  v_exp_f32 v158, v158
  v_cvt_pk_bf16_f32 v169, v154, v155
  v_exp_f32 v159, v159
  v_exp_f32 v160, v160
  v_mfma_f32_32x32x8_bf16 v[136:151], v[60:61], v[216:217], v[136:151]
  v_cvt_pk_bf16_f32 v170, v156, v157
  v_exp_f32 v161, v161
  v_exp_f32 v162, v162
  v_cvt_pk_bf16_f32 v171, v158, v159
  v_exp_f32 v163, v163
  v_exp_f32 v164, v164
  v_mfma_f32_32x32x16_bf16 v[176:191], v[80:83], v[168:171], v[176:191]
  v_cvt_pk_bf16_f32 v172, v160, v161
  v_exp_f32 v165, v165
  v_exp_f32 v166, v166
  v_cvt_pk_bf16_f32 v173, v162, v163
  v_exp_f32 v167, v167
  v_exp_f32 v136, v136
  v_exp_f32 v137, v137
  v_cvt_pk_bf16_f32 v174, v164, v165
  v_exp_f32 v138, v138
  v_cvt_pk_bf16_f32 v175, v166, v167
  v_mfma_f32_32x32x16_bf16 v[152:167], v[36:39], v[208:211], 0
  v_exp_f32 v139, v139
  v_exp_f32 v140, v140
  v_cvt_pk_bf16_f32 v168, v136, v137
  v_exp_f32 v141, v141
  v_mfma_f32_32x32x16_bf16 v[176:191], v[84:87], v[172:175], v[176:191]
  v_exp_f32 v142, v142
  v_cvt_pk_bf16_f32 v169, v138, v139
  v_exp_f32 v143, v143
  v_exp_f32 v144, v144
  v_mfma_f32_32x32x8_bf16 v[152:167], v[62:63], v[216:217], v[152:167]
  v_cvt_f64_f32 v[224:225], v192
  v_cvt_f64_f32 v[226:227], v193
  v_cvt_f64_f32 v[228:229], v194
  v_cvt_f64_f32 v[230:231], v195
  v_cvt_f64_f32 v[232:233], v196
  v_cvt_f64_f32 v[234:235], v197
  v_cvt_pk_bf16_f32 v170, v140, v141
  v_exp_f32 v145, v145
  v_exp_f32 v146, v146
  v_cvt_pk_bf16_f32 v171, v142, v143
  v_exp_f32 v147, v147
  v_exp_f32 v148, v148
  v_mfma_f32_32x32x16_bf16 v[176:191], v[88:91], v[168:171], v[176:191]
  ds_add_f64 v220, v[224:225] offset:0
  ds_add_f64 v220, v[226:227] offset:256
  ds_add_f64 v220, v[228:229] offset:512
  ds_add_f64 v220, v[230:231] offset:768
  ds_add_f64 v220, v[232:233] offset:2048
  ds_add_f64 v220, v[234:235] offset:2304
  v_cvt_pk_bf16_f32 v172, v144, v145
  v_exp_f32 v149, v149
  v_exp_f32 v150, v150
  v_cvt_pk_bf16_f32 v173, v146, v147
  v_exp_f32 v151, v151
  v_exp_f32 v152, v152
  v_exp_f32 v153, v153
  v_cvt_pk_bf16_f32 v174, v148, v149
  v_exp_f32 v154, v154
  v_cvt_pk_bf16_f32 v175, v150, v151
  v_mfma_f32_32x32x16_bf16 v[136:151], v[40:43], v[208:211], 0
  v_exp_f32 v155, v155
  v_exp_f32 v156, v156
  v_cvt_pk_bf16_f32 v168, v152, v153
  v_exp_f32 v157, v157
  v_mfma_f32_32x32x16_bf16 v[176:191], v[92:95], v[172:175], v[176:191]
  v_exp_f32 v158, v158
  v_cvt_pk_bf16_f32 v169, v154, v155
  v_exp_f32 v159, v159
  v_exp_f32 v160, v160
  v_mfma_f32_32x32x8_bf16 v[136:151], v[64:65], v[216:217], v[136:151]
  v_cvt_f64_f32 v[224:225], v198
  v_cvt_f64_f32 v[226:227], v199
  v_cvt_f64_f32 v[228:229], v200
  v_cvt_f64_f32 v[230:231], v201
  v_cvt_f64_f32 v[232:233], v202
  v_cvt_f64_f32 v[234:235], v203
  v_cvt_pk_bf16_f32 v170, v156, v157
  v_exp_f32 v161, v161
  v_exp_f32 v162, v162
  v_cvt_pk_bf16_f32 v171, v158, v159
  v_exp_f32 v163, v163
  v_exp_f32 v164, v164
  v_mfma_f32_32x32x16_bf16 v[176:191], v[96:99], v[168:171], v[176:191]
  ds_add_f64 v220, v[224:225] offset:2560
  ds_add_f64 v220, v[226:227] offset:2816
  ds_add_f64 v220, v[228:229] offset:4096
  s_mov_b32 exec_hi, 0
  ds_add_f64 v220, v[230:231] offset:4352
  ds_add_f64 v220, v[232:233] offset:4608
  ds_add_f64 v220, v[234:235] offset:4864
  s_mov_b64 exec, -1
  v_cvt_pk_bf16_f32 v172, v160, v161
  v_exp_f32 v165, v165
  v_exp_f32 v166, v166
  v_cvt_pk_bf16_f32 v173, v162, v163
  v_exp_f32 v167, v167
  v_exp_f32 v136, v136
  v_exp_f32 v137, v137
  v_cvt_pk_bf16_f32 v174, v164, v165
  v_exp_f32 v138, v138
  v_cvt_pk_bf16_f32 v175, v166, v167
  v_mfma_f32_32x32x16_bf16 v[152:167], v[44:47], v[208:211], 0
  v_exp_f32 v139, v139
  v_exp_f32 v140, v140
  v_cvt_pk_bf16_f32 v168, v136, v137
  v_exp_f32 v141, v141
  v_mfma_f32_32x32x16_bf16 v[176:191], v[100:103], v[172:175], v[176:191]
  v_exp_f32 v142, v142
  v_cvt_pk_bf16_f32 v169, v138, v139
  v_exp_f32 v143, v143
  v_exp_f32 v144, v144
  v_mfma_f32_32x32x8_bf16 v[152:167], v[66:67], v[216:217], v[152:167]
  v_cvt_pk_bf16_f32 v170, v140, v141
  v_exp_f32 v145, v145
  v_exp_f32 v146, v146
  v_cvt_pk_bf16_f32 v171, v142, v143
  v_exp_f32 v147, v147
  v_exp_f32 v148, v148
  v_mfma_f32_32x32x16_bf16 v[176:191], v[104:107], v[168:171], v[176:191]
  v_cvt_pk_bf16_f32 v172, v144, v145
  v_exp_f32 v149, v149
  v_exp_f32 v150, v150
  v_cvt_pk_bf16_f32 v173, v146, v147
  v_exp_f32 v151, v151
  s_mul_i32 s49, s71, 5376
  v_add_u32 v220, s49, v223
  v_exp_f32 v152, v152
  v_exp_f32 v153, v153
  v_cvt_pk_bf16_f32 v174, v148, v149
  v_exp_f32 v154, v154
  v_cvt_pk_bf16_f32 v175, v150, v151
  v_mfma_f32_32x32x16_bf16 v[136:151], v[48:51], v[208:211], 0
  v_exp_f32 v155, v155
  v_exp_f32 v156, v156
  v_cvt_pk_bf16_f32 v168, v152, v153
  v_exp_f32 v157, v157
  v_mfma_f32_32x32x16_bf16 v[176:191], v[108:111], v[172:175], v[176:191]
  v_exp_f32 v158, v158
  v_cvt_pk_bf16_f32 v169, v154, v155
  v_exp_f32 v159, v159
  v_exp_f32 v160, v160
  v_mfma_f32_32x32x8_bf16 v[136:151], v[68:69], v[216:217], v[136:151]
  v_cvt_pk_bf16_f32 v170, v156, v157
  v_exp_f32 v161, v161
  v_exp_f32 v162, v162
  v_cvt_pk_bf16_f32 v171, v158, v159
  v_exp_f32 v163, v163
  v_exp_f32 v164, v164
  v_mfma_f32_32x32x16_bf16 v[176:191], v[112:115], v[168:171], v[176:191]
  v_cvt_pk_bf16_f32 v172, v160, v161
  v_exp_f32 v165, v165
  v_exp_f32 v166, v166
  v_cvt_pk_bf16_f32 v173, v162, v163
  v_exp_f32 v167, v167
  v_exp_f32 v136, v136
  v_exp_f32 v137, v137
  v_cvt_pk_bf16_f32 v174, v164, v165
  v_exp_f32 v138, v138
  v_cvt_pk_bf16_f32 v175, v166, v167
  v_mfma_f32_32x32x16_bf16 v[152:167], v[52:55], v[208:211], 0
  v_exp_f32 v139, v139
  v_exp_f32 v140, v140
  v_cvt_pk_bf16_f32 v168, v136, v137
  v_exp_f32 v141, v141
  v_mfma_f32_32x32x16_bf16 v[176:191], v[116:119], v[172:175], v[176:191]
  v_exp_f32 v142, v142
  v_cvt_pk_bf16_f32 v169, v138, v139
  v_exp_f32 v143, v143
  v_exp_f32 v144, v144
  v_mfma_f32_32x32x8_bf16 v[152:167], v[70:71], v[216:217], v[152:167]
  v_cvt_pk_bf16_f32 v170, v140, v141
  v_exp_f32 v145, v145
  v_exp_f32 v146, v146
  v_cvt_pk_bf16_f32 v171, v142, v143
  v_exp_f32 v147, v147
  v_exp_f32 v148, v148
  v_mfma_f32_32x32x16_bf16 v[176:191], v[120:123], v[168:171], v[176:191]
  v_cvt_pk_bf16_f32 v172, v144, v145
  v_exp_f32 v149, v149
  v_exp_f32 v150, v150
  v_cvt_pk_bf16_f32 v173, v146, v147
  v_exp_f32 v151, v151
  s_waitcnt lgkmcnt(0)
  v_exp_f32 v152, v152
  v_exp_f32 v153, v153
  v_cvt_pk_bf16_f32 v174, v148, v149
  v_exp_f32 v154, v154
  v_cvt_pk_bf16_f32 v175, v150, v151
  v_mfma_f32_32x32x16_bf16 v[136:151], v[24:27], v[212:215], 0
  v_exp_f32 v155, v155
  v_exp_f32 v156, v156
  v_cvt_pk_bf16_f32 v168, v152, v153
  v_exp_f32 v157, v157
  v_mfma_f32_32x32x16_bf16 v[176:191], v[124:127], v[172:175], v[176:191]
  v_exp_f32 v158, v158
  v_cvt_pk_bf16_f32 v169, v154, v155
  v_exp_f32 v159, v159
  v_exp_f32 v160, v160
  v_mfma_f32_32x32x8_bf16 v[136:151], v[56:57], v[218:219], v[136:151]
  v_cvt_pk_bf16_f32 v170, v156, v157
  v_exp_f32 v161, v161
  v_exp_f32 v162, v162
  v_cvt_pk_bf16_f32 v171, v158, v159
  v_exp_f32 v163, v163
  v_exp_f32 v164, v164
  v_mfma_f32_32x32x16_bf16 v[176:191], v[128:131], v[168:171], v[176:191]
  v_cvt_pk_bf16_f32 v172, v160, v161
  v_exp_f32 v165, v165
  v_exp_f32 v166, v166
  v_cvt_pk_bf16_f32 v173, v162, v163
  v_exp_f32 v167, v167
  s_mov_b32 s71, s48
  v_exp_f32 v136, v136
  v_exp_f32 v137, v137
  v_cvt_pk_bf16_f32 v174, v164, v165
  v_exp_f32 v138, v138
  v_cvt_pk_bf16_f32 v175, v166, v167
  v_mfma_f32_32x32x16_bf16 v[152:167], v[28:31], v[212:215], 0
  v_exp_f32 v139, v139
  v_exp_f32 v140, v140
  v_cvt_pk_bf16_f32 v168, v136, v137
  v_exp_f32 v141, v141
  v_mfma_f32_32x32x16_bf16 v[176:191], v[132:135], v[172:175], v[176:191]
  v_exp_f32 v142, v142
  v_cvt_pk_bf16_f32 v169, v138, v139
  v_exp_f32 v143, v143
  v_exp_f32 v144, v144
  v_mfma_f32_32x32x8_bf16 v[152:167], v[58:59], v[218:219], v[152:167]
  v_cvt_pk_bf16_f32 v170, v140, v141
  v_exp_f32 v145, v145
  v_exp_f32 v146, v146
  v_cvt_pk_bf16_f32 v171, v142, v143
  v_exp_f32 v147, v147
  v_exp_f32 v148, v148
  v_mfma_f32_32x32x16_bf16 v[192:207], v[72:75], v[168:171], 0
  v_cvt_pk_bf16_f32 v172, v144, v145
  v_exp_f32 v149, v149
  v_exp_f32 v150, v150
  v_cvt_pk_bf16_f32 v173, v146, v147
  v_exp_f32 v151, v151
  s_add_u32 s48, s71, 1
  s_and_b32 s48, s48, 7
  s_lshl_b32 s49, s48, 10
  v_add_u32 v3, s49, v221
  v_mad_u32_u24 v4, s48, v23, v222
  ds_read_b128 v[208:211], v3
  ds_read_b64 v[216:217], v4
  v_exp_f32 v152, v152
  v_exp_f32 v153, v153
  v_cvt_pk_bf16_f32 v174, v148, v149
  v_exp_f32 v154, v154
  v_cvt_pk_bf16_f32 v175, v150, v151
  v_mfma_f32_32x32x16_bf16 v[136:151], v[32:35], v[212:215], 0
  v_exp_f32 v155, v155
  v_exp_f32 v156, v156
  v_cvt_pk_bf16_f32 v168, v152, v153
  v_exp_f32 v157, v157
  v_mfma_f32_32x32x16_bf16 v[192:207], v[76:79], v[172:175], v[192:207]
  v_exp_f32 v158, v158
  v_cvt_pk_bf16_f32 v169, v154, v155
  v_exp_f32 v159, v159
  v_exp_f32 v160, v160
  v_mfma_f32_32x32x8_bf16 v[136:151], v[60:61], v[218:219], v[136:151]
  v_cvt_pk_bf16_f32 v170, v156, v157
  v_exp_f32 v161, v161
  v_exp_f32 v162, v162
  v_cvt_pk_bf16_f32 v171, v158, v159
  v_exp_f32 v163, v163
  v_exp_f32 v164, v164
  v_mfma_f32_32x32x16_bf16 v[192:207], v[80:83], v[168:171], v[192:207]
  v_cvt_pk_bf16_f32 v172, v160, v161
  v_exp_f32 v165, v165
  v_exp_f32 v166, v166
  v_cvt_pk_bf16_f32 v173, v162, v163
  v_exp_f32 v167, v167
  v_exp_f32 v136, v136
  v_exp_f32 v137, v137
  v_cvt_pk_bf16_f32 v174, v164, v165
  v_exp_f32 v138, v138
  v_cvt_pk_bf16_f32 v175, v166, v167
  v_mfma_f32_32x32x16_bf16 v[152:167], v[36:39], v[212:215], 0
  v_exp_f32 v139, v139
  v_exp_f32 v140, v140
  v_cvt_pk_bf16_f32 v168, v136, v137
  v_exp_f32 v141, v141
  v_mfma_f32_32x32x16_bf16 v[192:207], v[84:87], v[172:175], v[192:207]
  v_exp_f32 v142, v142
  v_cvt_pk_bf16_f32 v169, v138, v139
  v_exp_f32 v143, v143
  v_exp_f32 v144, v144
  v_mfma_f32_32x32x8_bf16 v[152:167], v[62:63], v[218:219], v[152:167]
  v_cvt_f64_f32 v[224:225], v176
  v_cvt_f64_f32 v[226:227], v177
  v_cvt_f64_f32 v[228:229], v178
  v_cvt_f64_f32 v[230:231], v179
  v_cvt_f64_f32 v[232:233], v180
  v_cvt_f64_f32 v[234:235], v181
  v_cvt_pk_bf16_f32 v170, v140, v141
  v_exp_f32 v145, v145
  v_exp_f32 v146, v146
  v_cvt_pk_bf16_f32 v171, v142, v143
  v_exp_f32 v147, v147
  v_exp_f32 v148, v148
  v_mfma_f32_32x32x16_bf16 v[192:207], v[88:91], v[168:171], v[192:207]
  ds_add_f64 v220, v[224:225] offset:0
  ds_add_f64 v220, v[226:227] offset:256
  ds_add_f64 v220, v[228:229] offset:512
  ds_add_f64 v220, v[230:231] offset:768
  ds_add_f64 v220, v[232:233] offset:2048
  ds_add_f64 v220, v[234:235] offset:2304
  v_cvt_pk_bf16_f32 v172, v144, v145
  v_exp_f32 v149, v149
  v_exp_f32 v150, v150
  v_cvt_pk_bf16_f32 v173, v146, v147
  v_exp_f32 v151, v151
  v_exp_f32 v152, v152
  v_exp_f32 v153, v153
  v_cvt_pk_bf16_f32 v174, v148, v149
  v_exp_f32 v154, v154
  v_cvt_pk_bf16_f32 v175, v150, v151
  v_mfma_f32_32x32x16_bf16 v[136:151], v[40:43], v[212:215], 0
  v_exp_f32 v155, v155
  v_exp_f32 v156, v156
  v_cvt_pk_bf16_f32 v168, v152, v153
  v_exp_f32 v157, v157
  v_mfma_f32_32x32x16_bf16 v[192:207], v[92:95], v[172:175], v[192:207]
  v_exp_f32 v158, v158
  v_cvt_pk_bf16_f32 v169, v154, v155
  v_exp_f32 v159, v159
  v_exp_f32 v160, v160
  v_mfma_f32_32x32x8_bf16 v[136:151], v[64:65], v[218:219], v[136:151]
  v_cvt_f64_f32 v[224:225], v182
  v_cvt_f64_f32 v[226:227], v183
  v_cvt_f64_f32 v[228:229], v184
  v_cvt_f64_f32 v[230:231], v185
  v_cvt_f64_f32 v[232:233], v186
  v_cvt_f64_f32 v[234:235], v187
  v_cvt_pk_bf16_f32 v170, v156, v157
  v_exp_f32 v161, v161
  v_exp_f32 v162, v162
  v_cvt_pk_bf16_f32 v171, v158, v159
  v_exp_f32 v163, v163
  v_exp_f32 v164, v164
  v_mfma_f32_32x32x16_bf16 v[192:207], v[96:99], v[168:171], v[192:207]
  ds_add_f64 v220, v[224:225] offset:2560
  ds_add_f64 v220, v[226:227] offset:2816
  ds_add_f64 v220, v[228:229] offset:4096
  s_mov_b32 exec_hi, 0
  ds_add_f64 v220, v[230:231] offset:4352
  ds_add_f64 v220, v[232:233] offset:4608
  ds_add_f64 v220, v[234:235] offset:4864
  s_mov_b64 exec, -1
  v_cvt_pk_bf16_f32 v172, v160, v161
  v_exp_f32 v165, v165
  v_exp_f32 v166, v166
  v_cvt_pk_bf16_f32 v173, v162, v163
  v_exp_f32 v167, v167
  v_exp_f32 v136, v136
  v_exp_f32 v137, v137
  v_cvt_pk_bf16_f32 v174, v164, v165
  v_exp_f32 v138, v138
  v_cvt_pk_bf16_f32 v175, v166, v167
  v_mfma_f32_32x32x16_bf16 v[152:167], v[44:47], v[212:215], 0
  v_exp_f32 v139, v139
  v_exp_f32 v140, v140
  v_cvt_pk_bf16_f32 v168, v136, v137
  v_exp_f32 v141, v141
  v_mfma_f32_32x32x16_bf16 v[192:207], v[100:103], v[172:175], v[192:207]
  v_exp_f32 v142, v142
  v_cvt_pk_bf16_f32 v169, v138, v139
  v_exp_f32 v143, v143
  v_exp_f32 v144, v144
  v_mfma_f32_32x32x8_bf16 v[152:167], v[66:67], v[218:219], v[152:167]
  v_cvt_pk_bf16_f32 v170, v140, v141
  v_exp_f32 v145, v145
  v_exp_f32 v146, v146
  v_cvt_pk_bf16_f32 v171, v142, v143
  v_exp_f32 v147, v147
  v_exp_f32 v148, v148
  v_mfma_f32_32x32x16_bf16 v[192:207], v[104:107], v[168:171], v[192:207]
  v_cvt_pk_bf16_f32 v172, v144, v145
  v_exp_f32 v149, v149
  v_exp_f32 v150, v150
  v_cvt_pk_bf16_f32 v173, v146, v147
  v_exp_f32 v151, v151
  s_mul_i32 s49, s71, 5376
  v_add_u32 v220, s49, v223
  v_exp_f32 v152, v152
  v_exp_f32 v153, v153
  v_cvt_pk_bf16_f32 v174, v148, v149
  v_exp_f32 v154, v154
  v_cvt_pk_bf16_f32 v175, v150, v151
  v_mfma_f32_32x32x16_bf16 v[136:151], v[48:51], v[212:215], 0
  v_exp_f32 v155, v155
  v_exp_f32 v156, v156
  v_cvt_pk_bf16_f32 v168, v152, v153
  v_exp_f32 v157, v157
  v_mfma_f32_32x32x16_bf16 v[192:207], v[108:111], v[172:175], v[192:207]
  v_exp_f32 v158, v158
  v_cvt_pk_bf16_f32 v169, v154, v155
  v_exp_f32 v159, v159
  v_exp_f32 v160, v160
  v_mfma_f32_32x32x8_bf16 v[136:151], v[68:69], v[218:219], v[136:151]
  v_cvt_pk_bf16_f32 v170, v156, v157
  v_exp_f32 v161, v161
  v_exp_f32 v162, v162
  v_cvt_pk_bf16_f32 v171, v158, v159
  v_exp_f32 v163, v163
  v_exp_f32 v164, v164
  v_mfma_f32_32x32x16_bf16 v[192:207], v[112:115], v[168:171], v[192:207]
  v_cvt_pk_bf16_f32 v172, v160, v161
  v_exp_f32 v165, v165
  v_exp_f32 v166, v166
  v_cvt_pk_bf16_f32 v173, v162, v163
  v_exp_f32 v167, v167
  v_exp_f32 v136, v136
  v_exp_f32 v137, v137
  v_cvt_pk_bf16_f32 v174, v164, v165
  v_exp_f32 v138, v138
  v_cvt_pk_bf16_f32 v175, v166, v167
  v_mfma_f32_32x32x16_bf16 v[152:167], v[52:55], v[212:215], 0
  v_exp_f32 v139, v139
  v_exp_f32 v140, v140
  v_cvt_pk_bf16_f32 v168, v136, v137
  v_exp_f32 v141, v141
  v_mfma_f32_32x32x16_bf16 v[192:207], v[116:119], v[172:175], v[192:207]
  v_exp_f32 v142, v142
  v_cvt_pk_bf16_f32 v169, v138, v139
  v_exp_f32 v143, v143
  v_exp_f32 v144, v144
  v_mfma_f32_32x32x8_bf16 v[152:167], v[70:71], v[218:219], v[152:167]
  v_cvt_pk_bf16_f32 v170, v140, v141
  v_exp_f32 v145, v145
  v_exp_f32 v146, v146
  v_cvt_pk_bf16_f32 v171, v142, v143
  v_exp_f32 v147, v147
  v_exp_f32 v148, v148
  v_mfma_f32_32x32x16_bf16 v[192:207], v[120:123], v[168:171], v[192:207]
  v_cvt_pk_bf16_f32 v172, v144, v145
  v_exp_f32 v149, v149
  v_exp_f32 v150, v150
  v_cvt_pk_bf16_f32 v173, v146, v147
  v_exp_f32 v151, v151
  s_waitcnt lgkmcnt(0)
  v_exp_f32 v152, v152
  v_exp_f32 v153, v153
  v_cvt_pk_bf16_f32 v174, v148, v149
  v_exp_f32 v154, v154
  v_cvt_pk_bf16_f32 v175, v150, v151
  v_mfma_f32_32x32x16_bf16 v[136:151], v[24:27], v[208:211], 0
  v_exp_f32 v155, v155
  v_exp_f32 v156, v156
  v_cvt_pk_bf16_f32 v168, v152, v153
  v_exp_f32 v157, v157
  v_mfma_f32_32x32x16_bf16 v[192:207], v[124:127], v[172:175], v[192:207]
  v_exp_f32 v158, v158
  v_cvt_pk_bf16_f32 v169, v154, v155
  v_exp_f32 v159, v159
  v_exp_f32 v160, v160
  v_mfma_f32_32x32x8_bf16 v[136:151], v[56:57], v[216:217], v[136:151]
  v_cvt_pk_bf16_f32 v170, v156, v157
  v_exp_f32 v161, v161
  v_exp_f32 v162, v162
  v_cvt_pk_bf16_f32 v171, v158, v159
  v_exp_f32 v163, v163
  v_exp_f32 v164, v164
  v_mfma_f32_32x32x16_bf16 v[192:207], v[128:131], v[168:171], v[192:207]
  v_cvt_pk_bf16_f32 v172, v160, v161
  v_exp_f32 v165, v165
  v_exp_f32 v166, v166
  v_cvt_pk_bf16_f32 v173, v162, v163
  v_exp_f32 v167, v167
  s_mov_b32 s71, s48
  s_add_u32 s70, s70, 1
  s_cmp_lt_u32 s70, 4
  s_cbranch_scc1 gated_mix__grouped_kv_mqa__spectral_gfnet__prompt_kernel_attn39
  s_nop 0
  v_cvt_pk_bf16_f32 v174, v164, v165
  v_cvt_pk_bf16_f32 v175, v166, v167
  s_nop 1
  v_mfma_f32_32x32x16_bf16 v[192:207], v[132:135], v[172:175], v[192:207]
  s_nop 15
  v_cvt_f64_f32 v[224:225], v192
  v_cvt_f64_f32 v[226:227], v193
  v_cvt_f64_f32 v[228:229], v194
  v_cvt_f64_f32 v[230:231], v195
  v_cvt_f64_f32 v[232:233], v196
  v_cvt_f64_f32 v[234:235], v197
  v_cvt_f64_f32 v[236:237], v198
  v_cvt_f64_f32 v[238:239], v199
  v_cvt_f64_f32 v[240:241], v200
  v_cvt_f64_f32 v[242:243], v201
  v_cvt_f64_f32 v[244:245], v202
  v_cvt_f64_f32 v[246:247], v203
  ds_add_f64 v220, v[224:225] offset:0
  ds_add_f64 v220, v[226:227] offset:256
  ds_add_f64 v220, v[228:229] offset:512
  ds_add_f64 v220, v[230:231] offset:768
  ds_add_f64 v220, v[232:233] offset:2048
  ds_add_f64 v220, v[234:235] offset:2304
  ds_add_f64 v220, v[236:237] offset:2560
  ds_add_f64 v220, v[238:239] offset:2816
  ds_add_f64 v220, v[240:241] offset:4096
  s_mov_b32 exec_hi, 0
  ds_add_f64 v220, v[242:243] offset:4352
  ds_add_f64 v220, v[244:245] offset:4608
  ds_add_f64 v220, v[246:247] offset:4864
  s_mov_b64 exec, -1
  s_branch gated_mix__grouped_kv_mqa__spectral_gfnet__prompt_kernel_adone36
gated_mix__grouped_kv_mqa__spectral_gfnet__prompt_kernel_slow33:
  s_cmp_eq_u32 s91, 0
  s_cbranch_scc1 gated_mix__grouped_kv_mqa__spectral_gfnet__prompt_kernel_sl140
  v_mov_b32 v104, 0
  v_mov_b32 v105, 0
  v_mov_b32 v106, 0
  v_mov_b32 v107, 0
  v_mov_b32 v108, 0
  v_mov_b32 v109, 0
  v_mov_b32 v110, 0
  v_mov_b32 v111, 0
  v_mov_b32 v64, 0
  v_mov_b32 v65, 0
  s_add_u32 s51, s90, 16384
  buffer_load_dwordx4 v[40:43], v248, s[40:43], s51 offen
  s_mov_b32 exec_hi, 0
  buffer_load_dwordx2 v[64:65], v249, s[40:43], s51 offen offset:3072
  s_mov_b32 exec_lo, 0x1fffff
  s_mov_b32 exec_hi, 0x1fffff
  buffer_load_dwordx4 v[104:107], v248, s[40:43], s51 offen offset:1024
  buffer_load_dwordx4 v[108:111], v248, s[40:43], s51 offen offset:2048
  s_mov_b64 exec, -1
  v_mov_b32 v112, 0
  v_mov_b32 v113, 0
  v_mov_b32 v114, 0
  v_mov_b32 v115, 0
  v_mov_b32 v116, 0
  v_mov_b32 v117, 0
  v_mov_b32 v118, 0
  v_mov_b32 v119, 0
  v_mov_b32 v66, 0
  v_mov_b32 v67, 0
  s_add_u32 s51, s90, 20480
  buffer_load_dwordx4 v[44:47], v248, s[40:43], s51 offen
  s_mov_b32 exec_hi, 0
  buffer_load_dwordx2 v[66:67], v249, s[40:43], s51 offen offset:3072
  s_mov_b32 exec_lo, 0x1fffff
  s_mov_b32 exec_hi, 0x1fffff
  buffer_load_dwordx4 v[112:115], v248, s[40:43], s51 offen offset:1024
  buffer_load_dwordx4 v[116:119], v248, s[40:43], s51 offen offset:2048
  s_mov_b64 exec, -1
  v_mov_b32 v120, 0
  v_mov_b32 v121, 0
  v_mov_b32 v122, 0
  v_mov_b32 v123, 0
  v_mov_b32 v124, 0
  v_mov_b32 v125, 0
  v_mov_b32 v126, 0
  v_mov_b32 v127, 0
  v_mov_b32 v68, 0
  v_mov_b32 v69, 0
  s_add_u32 s51, s90, 24576
  buffer_load_dwordx4 v[48:51], v248, s[40:43], s51 offen
  s_mov_b32 exec_hi, 0
  buffer_load_dwordx2 v[68:69], v249, s[40:43], s51 offen offset:3072
  s_mov_b32 exec_lo, 0x1fffff
  s_mov_b32 exec_hi, 0x1fffff
  buffer_load_dwordx4 v[120:123], v248, s[40:43], s51 offen offset:1024
  buffer_load_dwordx4 v[124:127], v248, s[40:43], s51 offen offset:2048
  s_mov_b64 exec, -1
  v_mov_b32 v128, 0
  v_mov_b32 v129, 0
  v_mov_b32 v130, 0
  v_mov_b32 v131, 0
  v_mov_b32 v132, 0
  v_mov_b32 v133, 0
  v_mov_b32 v134, 0
  v_mov_b32 v135, 0
  v_mov_b32 v70, 0
  v_mov_b32 v71, 0
  s_add_u32 s51, s90, 28672
  buffer_load_dwordx4 v[52:55], v248, s[40:43], s51 offen
  s_mov_b32 exec_hi, 0
  buffer_load_dwordx2 v[70:71], v249, s[40:43], s51 offen offset:3072
  s_mov_b32 exec_lo, 0x1fffff
  s_mov_b32 exec_hi, 0x1fffff
  buffer_load_dwordx4 v[128:131], v248, s[40:43], s51 offen offset:1024
  buffer_load_dwordx4 v[132:135], v248, s[40:43], s51 offen offset:2048
  s_mov_b64 exec, -1
gated_mix__grouped_kv_mqa__spectral_gfnet__prompt_kernel_sl140:
  s_cmp_lg_u32 s44, 3
  s_cbranch_scc1 gated_mix__grouped_kv_mqa__spectral_gfnet__prompt_kernel_sl341
  v_lshlrev_b32 v3, 4, v1
  v_add_u32 v4, 76800, v3
  v_mov_b32 v5, s73
  v_add_co_u32 v4, vcc, s72, v4
  v_addc_co_u32 v5, vcc, 0, v5, vcc
  s_mov_b32 m0, 147744
  s_nop 0
  global_load_lds_dwordx4 v[4:5], off
  v_add_u32 v4, 77824, v3
  v_mov_b32 v5, s73
  v_add_co_u32 v4, vcc, s72, v4
  v_addc_co_u32 v5, vcc, 0, v5, vcc
  s_mov_b32 m0, 148768
  s_nop 0
  global_load_lds_dwordx4 v[4:5], off
  v_add_u32 v4, 78848, v3
  v_mov_b32 v5, s73
  v_add_co_u32 v4, vcc, s72, v4
  v_addc_co_u32 v5, vcc, 0, v5, vcc
  s_mov_b32 m0, 149792
  s_nop 0
  global_load_lds_dwordx4 v[4:5], off
  v_add_u32 v4, 79872, v3
  v_mov_b32 v5, s73
  v_add_co_u32 v4, vcc, s72, v4
  v_addc_co_u32 v5, vcc, 0, v5, vcc
  s_mov_b32 m0, 150816
  s_nop 0
  global_load_lds_dwordx4 v[4:5], off
  v_add_u32 v4, 80896, v3
  v_mov_b32 v5, s73
  v_add_co_u32 v4, vcc, s72, v4
  v_addc_co_u32 v5, vcc, 0, v5, vcc
  s_mov_b32 m0, 151840
  s_nop 0
  global_load_lds_dwordx4 v[4:5], off
  v_add_u32 v4, 81920, v3
  v_mov_b32 v5, s73
  v_add_co_u32 v4, vcc, s72, v4
  v_addc_co_u32 v5, vcc, 0, v5, vcc
  s_mov_b32 m0, 152864
  s_nop 0
  global_load_lds_dwordx4 v[4:5], off
  v_add_u32 v4, 82944, v3
  v_mov_b32 v5, s73
  v_add_co_u32 v4, vcc, s72, v4
  v_addc_co_u32 v5, vcc, 0, v5, vcc
  s_mov_b32 m0, 153888
  s_nop 0
  global_load_lds_dwordx4 v[4:5], off
  v_add_u32 v4, 83968, v3
  v_mov_b32 v5, s73
  v_add_co_u32 v4, vcc, s72, v4
  v_addc_co_u32 v5, vcc, 0, v5, vcc
  s_mov_b32 m0, 154912
  s_nop 0
  global_load_lds_dwordx4 v[4:5], off
  v_add_u32 v4, 84992, v3
  v_mov_b32 v5, s73
  v_add_co_u32 v4, vcc, s72, v4
  v_addc_co_u32 v5, vcc, 0, v5, vcc
  s_mov_b32 m0, 155936
  s_nop 0
  global_load_lds_dwordx4 v[4:5], off
  v_add_u32 v4, 86016, v3
  v_mov_b32 v5, s73
  v_add_co_u32 v4, vcc, s72, v4
  v_addc_co_u32 v5, vcc, 0, v5, vcc
  s_mov_b32 m0, 156960
  s_nop 0
  global_load_lds_dwordx4 v[4:5], off
  v_add_u32 v4, 87040, v3
  v_mov_b32 v5, s73
  v_add_co_u32 v4, vcc, s72, v4
  v_addc_co_u32 v5, vcc, 0, v5, vcc
  s_mov_b32 m0, 157984
  s_nop 0
  global_load_lds_dwordx4 v[4:5], off
  v_add_u32 v4, 37888, v3
  v_mov_b32 v5, s73
  v_add_co_u32 v4, vcc, s72, v4
  v_addc_co_u32 v5, vcc, 0, v5, vcc
  s_mov_b32 m0, 159008
  s_nop 0
  global_load_lds_dwordx4 v[4:5], off
  v_add_u32 v4, 39936, v3
  v_mov_b32 v5, s73
  v_add_co_u32 v4, vcc, s72, v4
  v_addc_co_u32 v5, vcc, 0, v5, vcc
  s_mov_b32 m0, 160032
  s_nop 0
  global_load_lds_dwordx4 v[4:5], off
  v_add_u32 v4, 40960, v3
  v_mov_b32 v5, s73
  v_add_co_u32 v4, vcc, s72, v4
  v_addc_co_u32 v5, vcc, 0, v5, vcc
  s_mov_b32 m0, 161056
  s_nop 0
  global_load_lds_dwordx4 v[4:5], off
  v_add_u32 v4, 43008, v3
  v_mov_b32 v5, s73
  v_add_co_u32 v4, vcc, s72, v4
  v_addc_co_u32 v5, vcc, 0, v5, vcc
  s_mov_b32 m0, 162080
  s_nop 0
  global_load_lds_dwordx4 v[4:5], off
  s_waitcnt vmcnt(0)
  v_mov_b32 v5, 10324
  v_mov_b32 v6, 1
  s_mov_b64 exec, 1
  ds_add_u32 v5, v6
  s_mov_b64 exec, -1
gated_mix__grouped_kv_mqa__spectral_gfnet__prompt_kernel_sl341:
  s_waitcnt vmcnt(0)
  v_and_b32 v5, 31, v1
  v_lshlrev_b32 v5, 2, v5
  v_add_u32 v5, 54400, v5
  s_mov_b32 s70, 0
gated_mix__grouped_kv_mqa__spectral_gfnet__prompt_kernel_mx42:
  s_mov_b32 s71, s70
  s_lshl_b32 s49, s71, 10
  v_add_u32 v3, s49, v221
  v_mad_u32_u24 v4, s71, v23, v222
  ds_read_b128 v[208:211], v3
  ds_read_b64 v[216:217], v4
  v_mov_b32 v6, 0xff800000
  s_waitcnt lgkmcnt(0)
  v_mfma_f32_32x32x16_bf16 v[136:151], v[24:27], v[208:211], 0
  v_mfma_f32_32x32x8_bf16 v[136:151], v[56:57], v[216:217], v[136:151]
  s_nop 15
  v_max3_f32 v6, v6, v136, v137
  v_max3_f32 v6, v6, v138, v139
  v_max3_f32 v6, v6, v140, v141
  v_max3_f32 v6, v6, v142, v143
  v_max3_f32 v6, v6, v144, v145
  v_max3_f32 v6, v6, v146, v147
  v_max3_f32 v6, v6, v148, v149
  v_max3_f32 v6, v6, v150, v151
  v_mfma_f32_32x32x16_bf16 v[136:151], v[28:31], v[208:211], 0
  v_mfma_f32_32x32x8_bf16 v[136:151], v[58:59], v[216:217], v[136:151]
  s_nop 15
  v_max3_f32 v6, v6, v136, v137
  v_max3_f32 v6, v6, v138, v139
  v_max3_f32 v6, v6, v140, v141
  v_max3_f32 v6, v6, v142, v143
  v_max3_f32 v6, v6, v144, v145
  v_max3_f32 v6, v6, v146, v147
  v_max3_f32 v6, v6, v148, v149
  v_max3_f32 v6, v6, v150, v151
  v_mfma_f32_32x32x16_bf16 v[136:151], v[32:35], v[208:211], 0
  v_mfma_f32_32x32x8_bf16 v[136:151], v[60:61], v[216:217], v[136:151]
  s_nop 15
  v_max3_f32 v6, v6, v136, v137
  v_max3_f32 v6, v6, v138, v139
  v_max3_f32 v6, v6, v140, v141
  v_max3_f32 v6, v6, v142, v143
  v_max3_f32 v6, v6, v144, v145
  v_max3_f32 v6, v6, v146, v147
  v_max3_f32 v6, v6, v148, v149
  v_max3_f32 v6, v6, v150, v151
  v_mfma_f32_32x32x16_bf16 v[136:151], v[36:39], v[208:211], 0
  v_mfma_f32_32x32x8_bf16 v[136:151], v[62:63], v[216:217], v[136:151]
  s_nop 15
  v_max3_f32 v6, v6, v136, v137
  v_max3_f32 v6, v6, v138, v139
  v_max3_f32 v6, v6, v140, v141
  v_max3_f32 v6, v6, v142, v143
  v_max3_f32 v6, v6, v144, v145
  v_max3_f32 v6, v6, v146, v147
  v_max3_f32 v6, v6, v148, v149
  v_max3_f32 v6, v6, v150, v151
  v_mfma_f32_32x32x16_bf16 v[136:151], v[40:43], v[208:211], 0
  v_mfma_f32_32x32x8_bf16 v[136:151], v[64:65], v[216:217], v[136:151]
  s_nop 15
  v_max3_f32 v6, v6, v136, v137
  v_max3_f32 v6, v6, v138, v139
  v_max3_f32 v6, v6, v140, v141
  v_max3_f32 v6, v6, v142, v143
  v_max3_f32 v6, v6, v144, v145
  v_max3_f32 v6, v6, v146, v147
  v_max3_f32 v6, v6, v148, v149
  v_max3_f32 v6, v6, v150, v151
  v_mfma_f32_32x32x16_bf16 v[136:151], v[44:47], v[208:211], 0
  v_mfma_f32_32x32x8_bf16 v[136:151], v[66:67], v[216:217], v[136:151]
  s_nop 15
  v_max3_f32 v6, v6, v136, v137
  v_max3_f32 v6, v6, v138, v139
  v_max3_f32 v6, v6, v140, v141
  v_max3_f32 v6, v6, v142, v143
  v_max3_f32 v6, v6, v144, v145
  v_max3_f32 v6, v6, v146, v147
  v_max3_f32 v6, v6, v148, v149
  v_max3_f32 v6, v6, v150, v151
  v_mfma_f32_32x32x16_bf16 v[136:151], v[48:51], v[208:211], 0
  v_mfma_f32_32x32x8_bf16 v[136:151], v[68:69], v[216:217], v[136:151]
  s_nop 15
  v_max3_f32 v6, v6, v136, v137
  v_max3_f32 v6, v6, v138, v139
  v_max3_f32 v6, v6, v140, v141
  v_max3_f32 v6, v6, v142, v143
  v_max3_f32 v6, v6, v144, v145
  v_max3_f32 v6, v6, v146, v147
  v_max3_f32 v6, v6, v148, v149
  v_max3_f32 v6, v6, v150, v151
  v_mfma_f32_32x32x16_bf16 v[136:151], v[52:55], v[208:211], 0
  v_mfma_f32_32x32x8_bf16 v[136:151], v[70:71], v[216:217], v[136:151]
  s_nop 15
  v_max3_f32 v6, v6, v136, v137
  v_max3_f32 v6, v6, v138, v139
  v_max3_f32 v6, v6, v140, v141
  v_max3_f32 v6, v6, v142, v143
  v_max3_f32 v6, v6, v144, v145
  v_max3_f32 v6, v6, v146, v147
  v_max3_f32 v6, v6, v148, v149
  v_max3_f32 v6, v6, v150, v151
  s_lshl_b32 s49, s70, 7
  v_add_u32 v7, s49, v5
  ds_max_f32 v7, v6
  s_add_u32 s70, s70, 1
  s_cmp_lt_u32 s70, 8
  s_cbranch_scc1 gated_mix__grouped_kv_mqa__spectral_gfnet__prompt_kernel_mx42
  s_waitcnt lgkmcnt(0)
  s_barrier
  s_mov_b32 s71, s44
  s_lshl_b32 s49, s71, 10
  v_add_u32 v3, s49, v221
  v_mad_u32_u24 v4, s71, v23, v222
  ds_read_b128 v[208:211], v3
  ds_read_b64 v[216:217], v4
  s_lshl_b32 s49, s71, 7
  v_and_b32 v3, 31, v1
  v_lshlrev_b32 v3, 2, v3
  v_add_u32 v3, s49, v3
  ds_read_b32 v22, v3 offset:54400
  s_waitcnt lgkmcnt(0)
  v_sub_f32 v6, 0, v22
  v_sub_f32 v7, 0, v22
  v_sub_f32 v8, 0, v22
  v_sub_f32 v9, 0, v22
  v_sub_f32 v10, 0, v22
  v_sub_f32 v11, 0, v22
  v_sub_f32 v12, 0, v22
  v_sub_f32 v13, 0, v22
  v_sub_f32 v14, 0, v22
  v_sub_f32 v15, 0, v22
  v_sub_f32 v16, 0, v22
  v_sub_f32 v17, 0, v22
  v_sub_f32 v18, 0, v22
  v_sub_f32 v19, 0, v22
  v_sub_f32 v20, 0, v22
  v_sub_f32 v21, 0, v22
  s_nop 1
  v_mfma_f32_32x32x16_bf16 v[136:151], v[24:27], v[208:211], v[6:21]
  v_mfma_f32_32x32x8_bf16 v[136:151], v[56:57], v[216:217], v[136:151]
  s_nop 13
  v_exp_f32 v136, v136
  v_exp_f32 v137, v137
  v_exp_f32 v138, v138
  v_mfma_f32_32x32x16_bf16 v[152:167], v[28:31], v[208:211], v[6:21]
  v_exp_f32 v139, v139
  v_exp_f32 v140, v140
  v_cvt_pk_bf16_f32 v168, v136, v137
  v_exp_f32 v141, v141
  v_exp_f32 v142, v142
  v_cvt_pk_bf16_f32 v169, v138, v139
  v_exp_f32 v143, v143
  v_exp_f32 v144, v144
  v_mfma_f32_32x32x8_bf16 v[152:167], v[58:59], v[216:217], v[152:167]
  v_cvt_pk_bf16_f32 v170, v140, v141
  v_exp_f32 v145, v145
  v_exp_f32 v146, v146
  v_cvt_pk_bf16_f32 v171, v142, v143
  v_exp_f32 v147, v147
  v_exp_f32 v148, v148
  v_mfma_f32_32x32x16_bf16 v[176:191], v[72:75], v[168:171], 0
  v_cvt_pk_bf16_f32 v172, v144, v145
  v_exp_f32 v149, v149
  v_exp_f32 v150, v150
  v_cvt_pk_bf16_f32 v173, v146, v147
  v_exp_f32 v151, v151
  s_add_u32 s48, s71, 1
  s_and_b32 s48, s48, 7
  s_lshl_b32 s49, s48, 10
  v_add_u32 v3, s49, v221
  v_mad_u32_u24 v4, s48, v23, v222
  ds_read_b128 v[212:215], v3
  ds_read_b64 v[218:219], v4
  s_lshl_b32 s49, s48, 7
  v_and_b32 v3, 31, v1
  v_lshlrev_b32 v3, 2, v3
  v_add_u32 v3, s49, v3
  ds_read_b32 v22, v3 offset:54400
  v_exp_f32 v152, v152
  v_exp_f32 v153, v153
  v_cvt_pk_bf16_f32 v174, v148, v149
  v_exp_f32 v154, v154
  v_cvt_pk_bf16_f32 v175, v150, v151
  v_mfma_f32_32x32x16_bf16 v[136:151], v[32:35], v[208:211], v[6:21]
  v_exp_f32 v155, v155
  v_exp_f32 v156, v156
  v_cvt_pk_bf16_f32 v168, v152, v153
  v_exp_f32 v157, v157
  v_mfma_f32_32x32x16_bf16 v[176:191], v[76:79], v[172:175], v[176:191]
  v_exp_f32 v158, v158
  v_cvt_pk_bf16_f32 v169, v154, v155
  v_exp_f32 v159, v159
  v_exp_f32 v160, v160
  v_mfma_f32_32x32x8_bf16 v[136:151], v[60:61], v[216:217], v[136:151]
  v_cvt_pk_bf16_f32 v170, v156, v157
  v_exp_f32 v161, v161
  v_exp_f32 v162, v162
  v_cvt_pk_bf16_f32 v171, v158, v159
  v_exp_f32 v163, v163
  v_exp_f32 v164, v164
  v_mfma_f32_32x32x16_bf16 v[176:191], v[80:83], v[168:171], v[176:191]
  v_cvt_pk_bf16_f32 v172, v160, v161
  v_exp_f32 v165, v165
  v_exp_f32 v166, v166
  v_cvt_pk_bf16_f32 v173, v162, v163
  v_exp_f32 v167, v167
  v_exp_f32 v136, v136
  v_exp_f32 v137, v137
  v_cvt_pk_bf16_f32 v174, v164, v165
  v_exp_f32 v138, v138
  v_cvt_pk_bf16_f32 v175, v166, v167
  v_mfma_f32_32x32x16_bf16 v[152:167], v[36:39], v[208:211], v[6:21]
  v_exp_f32 v139, v139
  v_exp_f32 v140, v140
  v_cvt_pk_bf16_f32 v168, v136, v137
  v_exp_f32 v141, v141
  v_mfma_f32_32x32x16_bf16 v[176:191], v[84:87], v[172:175], v[176:191]
  v_exp_f32 v142, v142
  v_cvt_pk_bf16_f32 v169, v138, v139
  v_exp_f32 v143, v143
  v_exp_f32 v144, v144
  v_mfma_f32_32x32x8_bf16 v[152:167], v[62:63], v[216:217], v[152:167]
  v_cvt_pk_bf16_f32 v170, v140, v141
  v_exp_f32 v145, v145
  v_exp_f32 v146, v146
  v_cvt_pk_bf16_f32 v171, v142, v143
  v_exp_f32 v147, v147
  v_exp_f32 v148, v148
  v_mfma_f32_32x32x16_bf16 v[176:191], v[88:91], v[168:171], v[176:191]
  v_cvt_pk_bf16_f32 v172, v144, v145
  v_exp_f32 v149, v149
  v_exp_f32 v150, v150
  v_cvt_pk_bf16_f32 v173, v146, v147
  v_exp_f32 v151, v151
  v_exp_f32 v152, v152
  v_exp_f32 v153, v153
  v_cvt_pk_bf16_f32 v174, v148, v149
  v_exp_f32 v154, v154
  v_cvt_pk_bf16_f32 v175, v150, v151
  v_mfma_f32_32x32x16_bf16 v[136:151], v[40:43], v[208:211], v[6:21]
  v_exp_f32 v155, v155
  v_exp_f32 v156, v156
  v_cvt_pk_bf16_f32 v168, v152, v153
  v_exp_f32 v157, v157
  v_mfma_f32_32x32x16_bf16 v[176:191], v[92:95], v[172:175], v[176:191]
  v_exp_f32 v158, v158
  v_cvt_pk_bf16_f32 v169, v154, v155
  v_exp_f32 v159, v159
  v_exp_f32 v160, v160
  v_mfma_f32_32x32x8_bf16 v[136:151], v[64:65], v[216:217], v[136:151]
  v_cvt_pk_bf16_f32 v170, v156, v157
  v_exp_f32 v161, v161
  v_exp_f32 v162, v162
  v_cvt_pk_bf16_f32 v171, v158, v159
  v_exp_f32 v163, v163
  v_exp_f32 v164, v164
  v_mfma_f32_32x32x16_bf16 v[176:191], v[96:99], v[168:171], v[176:191]
  v_cvt_pk_bf16_f32 v172, v160, v161
  v_exp_f32 v165, v165
  v_exp_f32 v166, v166
  v_cvt_pk_bf16_f32 v173, v162, v163
  v_exp_f32 v167, v167
  v_exp_f32 v136, v136
  v_exp_f32 v137, v137
  v_cvt_pk_bf16_f32 v174, v164, v165
  v_exp_f32 v138, v138
  v_cvt_pk_bf16_f32 v175, v166, v167
  v_mfma_f32_32x32x16_bf16 v[152:167], v[44:47], v[208:211], v[6:21]
  v_exp_f32 v139, v139
  v_exp_f32 v140, v140
  v_cvt_pk_bf16_f32 v168, v136, v137
  v_exp_f32 v141, v141
  v_mfma_f32_32x32x16_bf16 v[176:191], v[100:103], v[172:175], v[176:191]
  v_exp_f32 v142, v142
  v_cvt_pk_bf16_f32 v169, v138, v139
  v_exp_f32 v143, v143
  v_exp_f32 v144, v144
  v_mfma_f32_32x32x8_bf16 v[152:167], v[66:67], v[216:217], v[152:167]
  v_cvt_pk_bf16_f32 v170, v140, v141
  v_exp_f32 v145, v145
  v_exp_f32 v146, v146
  v_cvt_pk_bf16_f32 v171, v142, v143
  v_exp_f32 v147, v147
  v_exp_f32 v148, v148
  v_mfma_f32_32x32x16_bf16 v[176:191], v[104:107], v[168:171], v[176:191]
  v_cvt_pk_bf16_f32 v172, v144, v145
  v_exp_f32 v149, v149
  v_exp_f32 v150, v150
  v_cvt_pk_bf16_f32 v173, v146, v147
  v_exp_f32 v151, v151
  s_mul_i32 s49, s71, 5376
  v_add_u32 v220, s49, v223
  v_exp_f32 v152, v152
  v_exp_f32 v153, v153
  v_cvt_pk_bf16_f32 v174, v148, v149
  v_exp_f32 v154, v154
  v_cvt_pk_bf16_f32 v175, v150, v151
  v_mfma_f32_32x32x16_bf16 v[136:151], v[48:51], v[208:211], v[6:21]
  v_exp_f32 v155, v155
  v_exp_f32 v156, v156
  v_cvt_pk_bf16_f32 v168, v152, v153
  v_exp_f32 v157, v157
  v_mfma_f32_32x32x16_bf16 v[176:191], v[108:111], v[172:175], v[176:191]
  v_exp_f32 v158, v158
  v_cvt_pk_bf16_f32 v169, v154, v155
  v_exp_f32 v159, v159
  v_exp_f32 v160, v160
  v_mfma_f32_32x32x8_bf16 v[136:151], v[68:69], v[216:217], v[136:151]
  v_cvt_pk_bf16_f32 v170, v156, v157
  v_exp_f32 v161, v161
  v_exp_f32 v162, v162
  v_cvt_pk_bf16_f32 v171, v158, v159
  v_exp_f32 v163, v163
  v_exp_f32 v164, v164
  v_mfma_f32_32x32x16_bf16 v[176:191], v[112:115], v[168:171], v[176:191]
  v_cvt_pk_bf16_f32 v172, v160, v161
  v_exp_f32 v165, v165
  v_exp_f32 v166, v166
  v_cvt_pk_bf16_f32 v173, v162, v163
  v_exp_f32 v167, v167
  v_exp_f32 v136, v136
  v_exp_f32 v137, v137
  v_cvt_pk_bf16_f32 v174, v164, v165
  v_exp_f32 v138, v138
  v_cvt_pk_bf16_f32 v175, v166, v167
  v_mfma_f32_32x32x16_bf16 v[152:167], v[52:55], v[208:211], v[6:21]
  v_exp_f32 v139, v139
  v_exp_f32 v140, v140
  v_cvt_pk_bf16_f32 v168, v136, v137
  v_exp_f32 v141, v141
  v_mfma_f32_32x32x16_bf16 v[176:191], v[116:119], v[172:175], v[176:191]
  v_exp_f32 v142, v142
  v_cvt_pk_bf16_f32 v169, v138, v139
  v_exp_f32 v143, v143
  v_exp_f32 v144, v144
  v_mfma_f32_32x32x8_bf16 v[152:167], v[70:71], v[216:217], v[152:167]
  v_cvt_pk_bf16_f32 v170, v140, v141
  v_exp_f32 v145, v145
  v_exp_f32 v146, v146
  v_cvt_pk_bf16_f32 v171, v142, v143
  v_exp_f32 v147, v147
  v_exp_f32 v148, v148
  v_mfma_f32_32x32x16_bf16 v[176:191], v[120:123], v[168:171], v[176:191]
  v_cvt_pk_bf16_f32 v172, v144, v145
  v_exp_f32 v149, v149
  v_exp_f32 v150, v150
  v_cvt_pk_bf16_f32 v173, v146, v147
  v_exp_f32 v151, v151
  s_waitcnt lgkmcnt(0)
  v_sub_f32 v6, 0, v22
  v_sub_f32 v7, 0, v22
  v_sub_f32 v8, 0, v22
  v_sub_f32 v9, 0, v22
  v_sub_f32 v10, 0, v22
  v_sub_f32 v11, 0, v22
  v_sub_f32 v12, 0, v22
  v_sub_f32 v13, 0, v22
  v_sub_f32 v14, 0, v22
  v_sub_f32 v15, 0, v22
  v_sub_f32 v16, 0, v22
  v_sub_f32 v17, 0, v22
  v_sub_f32 v18, 0, v22
  v_sub_f32 v19, 0, v22
  v_sub_f32 v20, 0, v22
  v_sub_f32 v21, 0, v22
  v_exp_f32 v152, v152
  v_exp_f32 v153, v153
  v_cvt_pk_bf16_f32 v174, v148, v149
  v_exp_f32 v154, v154
  v_cvt_pk_bf16_f32 v175, v150, v151
  v_mfma_f32_32x32x16_bf16 v[136:151], v[24:27], v[212:215], v[6:21]
  v_exp_f32 v155, v155
  v_exp_f32 v156, v156
  v_cvt_pk_bf16_f32 v168, v152, v153
  v_exp_f32 v157, v157
  v_mfma_f32_32x32x16_bf16 v[176:191], v[124:127], v[172:175], v[176:191]
  v_exp_f32 v158, v158
  v_cvt_pk_bf16_f32 v169, v154, v155
  v_exp_f32 v159, v159
  v_exp_f32 v160, v160
  v_mfma_f32_32x32x8_bf16 v[136:151], v[56:57], v[218:219], v[136:151]
  v_cvt_pk_bf16_f32 v170, v156, v157
  v_exp_f32 v161, v161
  v_exp_f32 v162, v162
  v_cvt_pk_bf16_f32 v171, v158, v159
  v_exp_f32 v163, v163
  v_exp_f32 v164, v164
  v_mfma_f32_32x32x16_bf16 v[176:191], v[128:131], v[168:171], v[176:191]
  v_cvt_pk_bf16_f32 v172, v160, v161
  v_exp_f32 v165, v165
  v_exp_f32 v166, v166
  v_cvt_pk_bf16_f32 v173, v162, v163
  v_exp_f32 v167, v167
  s_mov_b32 s71, s48
  v_exp_f32 v136, v136
  v_exp_f32 v137, v137
  v_cvt_pk_bf16_f32 v174, v164, v165
  v_exp_f32 v138, v138
  v_cvt_pk_bf16_f32 v175, v166, v167
  v_mfma_f32_32x32x16_bf16 v[152:167], v[28:31], v[212:215], v[6:21]
  v_exp_f32 v139, v139
  v_exp_f32 v140, v140
  v_cvt_pk_bf16_f32 v168, v136, v137
  v_exp_f32 v141, v141
  v_mfma_f32_32x32x16_bf16 v[176:191], v[132:135], v[172:175], v[176:191]
  v_exp_f32 v142, v142
  v_cvt_pk_bf16_f32 v169, v138, v139
  v_exp_f32 v143, v143
  v_exp_f32 v144, v144
  v_mfma_f32_32x32x8_bf16 v[152:167], v[58:59], v[218:219], v[152:167]
  v_cvt_pk_bf16_f32 v170, v140, v141
  v_exp_f32 v145, v145
  v_exp_f32 v146, v146
  v_cvt_pk_bf16_f32 v171, v142, v143
  v_exp_f32 v147, v147
  v_exp_f32 v148, v148
  v_mfma_f32_32x32x16_bf16 v[192:207], v[72:75], v[168:171], 0
  v_cvt_pk_bf16_f32 v172, v144, v145
  v_exp_f32 v149, v149
  v_exp_f32 v150, v150
  v_cvt_pk_bf16_f32 v173, v146, v147
  v_exp_f32 v151, v151
  s_add_u32 s48, s71, 1
  s_and_b32 s48, s48, 7
  s_lshl_b32 s49, s48, 10
  v_add_u32 v3, s49, v221
  v_mad_u32_u24 v4, s48, v23, v222
  ds_read_b128 v[208:211], v3
  ds_read_b64 v[216:217], v4
  s_lshl_b32 s49, s48, 7
  v_and_b32 v3, 31, v1
  v_lshlrev_b32 v3, 2, v3
  v_add_u32 v3, s49, v3
  ds_read_b32 v22, v3 offset:54400
  v_exp_f32 v152, v152
  v_exp_f32 v153, v153
  v_cvt_pk_bf16_f32 v174, v148, v149
  v_exp_f32 v154, v154
  v_cvt_pk_bf16_f32 v175, v150, v151
  v_mfma_f32_32x32x16_bf16 v[136:151], v[32:35], v[212:215], v[6:21]
  v_exp_f32 v155, v155
  v_exp_f32 v156, v156
  v_cvt_pk_bf16_f32 v168, v152, v153
  v_exp_f32 v157, v157
  v_mfma_f32_32x32x16_bf16 v[192:207], v[76:79], v[172:175], v[192:207]
  v_exp_f32 v158, v158
  v_cvt_pk_bf16_f32 v169, v154, v155
  v_exp_f32 v159, v159
  v_exp_f32 v160, v160
  v_mfma_f32_32x32x8_bf16 v[136:151], v[60:61], v[218:219], v[136:151]
  v_cvt_pk_bf16_f32 v170, v156, v157
  v_exp_f32 v161, v161
  v_exp_f32 v162, v162
  v_cvt_pk_bf16_f32 v171, v158, v159
  v_exp_f32 v163, v163
  v_exp_f32 v164, v164
  v_mfma_f32_32x32x16_bf16 v[192:207], v[80:83], v[168:171], v[192:207]
  v_cvt_pk_bf16_f32 v172, v160, v161
  v_exp_f32 v165, v165
  v_exp_f32 v166, v166
  v_cvt_pk_bf16_f32 v173, v162, v163
  v_exp_f32 v167, v167
  v_exp_f32 v136, v136
  v_exp_f32 v137, v137
  v_cvt_pk_bf16_f32 v174, v164, v165
  v_exp_f32 v138, v138
  v_cvt_pk_bf16_f32 v175, v166, v167
  v_mfma_f32_32x32x16_bf16 v[152:167], v[36:39], v[212:215], v[6:21]
  v_exp_f32 v139, v139
  v_exp_f32 v140, v140
  v_cvt_pk_bf16_f32 v168, v136, v137
  v_exp_f32 v141, v141
  v_mfma_f32_32x32x16_bf16 v[192:207], v[84:87], v[172:175], v[192:207]
  v_exp_f32 v142, v142
  v_cvt_pk_bf16_f32 v169, v138, v139
  v_exp_f32 v143, v143
  v_exp_f32 v144, v144
  v_mfma_f32_32x32x8_bf16 v[152:167], v[62:63], v[218:219], v[152:167]
  v_cvt_f64_f32 v[224:225], v176
  v_cvt_f64_f32 v[226:227], v177
  v_cvt_f64_f32 v[228:229], v178
  v_cvt_f64_f32 v[230:231], v179
  v_cvt_f64_f32 v[232:233], v180
  v_cvt_f64_f32 v[234:235], v181
  v_cvt_pk_bf16_f32 v170, v140, v141
  v_exp_f32 v145, v145
  v_exp_f32 v146, v146
  v_cvt_pk_bf16_f32 v171, v142, v143
  v_exp_f32 v147, v147
  v_exp_f32 v148, v148
  v_mfma_f32_32x32x16_bf16 v[192:207], v[88:91], v[168:171], v[192:207]
  ds_add_f64 v220, v[224:225] offset:0
  ds_add_f64 v220, v[226:227] offset:256
  ds_add_f64 v220, v[228:229] offset:512
  ds_add_f64 v220, v[230:231] offset:768
  ds_add_f64 v220, v[232:233] offset:2048
  ds_add_f64 v220, v[234:235] offset:2304
  v_cvt_pk_bf16_f32 v172, v144, v145
  v_exp_f32 v149, v149
  v_exp_f32 v150, v150
  v_cvt_pk_bf16_f32 v173, v146, v147
  v_exp_f32 v151, v151
  v_exp_f32 v152, v152
  v_exp_f32 v153, v153
  v_cvt_pk_bf16_f32 v174, v148, v149
  v_exp_f32 v154, v154
  v_cvt_pk_bf16_f32 v175, v150, v151
  v_mfma_f32_32x32x16_bf16 v[136:151], v[40:43], v[212:215], v[6:21]
  v_exp_f32 v155, v155
  v_exp_f32 v156, v156
  v_cvt_pk_bf16_f32 v168, v152, v153
  v_exp_f32 v157, v157
  v_mfma_f32_32x32x16_bf16 v[192:207], v[92:95], v[172:175], v[192:207]
  v_exp_f32 v158, v158
  v_cvt_pk_bf16_f32 v169, v154, v155
  v_exp_f32 v159, v159
  v_exp_f32 v160, v160
  v_mfma_f32_32x32x8_bf16 v[136:151], v[64:65], v[218:219], v[136:151]
  v_cvt_f64_f32 v[224:225], v182
  v_cvt_f64_f32 v[226:227], v183
  v_cvt_f64_f32 v[228:229], v184
  v_cvt_f64_f32 v[230:231], v185
  v_cvt_f64_f32 v[232:233], v186
  v_cvt_f64_f32 v[234:235], v187
  v_cvt_pk_bf16_f32 v170, v156, v157
  v_exp_f32 v161, v161
  v_exp_f32 v162, v162
  v_cvt_pk_bf16_f32 v171, v158, v159
  v_exp_f32 v163, v163
  v_exp_f32 v164, v164
  v_mfma_f32_32x32x16_bf16 v[192:207], v[96:99], v[168:171], v[192:207]
  ds_add_f64 v220, v[224:225] offset:2560
  ds_add_f64 v220, v[226:227] offset:2816
  ds_add_f64 v220, v[228:229] offset:4096
  s_mov_b32 exec_hi, 0
  ds_add_f64 v220, v[230:231] offset:4352
  ds_add_f64 v220, v[232:233] offset:4608
  ds_add_f64 v220, v[234:235] offset:4864
  s_mov_b64 exec, -1
  v_cvt_pk_bf16_f32 v172, v160, v161
  v_exp_f32 v165, v165
  v_exp_f32 v166, v166
  v_cvt_pk_bf16_f32 v173, v162, v163
  v_exp_f32 v167, v167
  v_exp_f32 v136, v136
  v_exp_f32 v137, v137
  v_cvt_pk_bf16_f32 v174, v164, v165
  v_exp_f32 v138, v138
  v_cvt_pk_bf16_f32 v175, v166, v167
  v_mfma_f32_32x32x16_bf16 v[152:167], v[44:47], v[212:215], v[6:21]
  v_exp_f32 v139, v139
  v_exp_f32 v140, v140
  v_cvt_pk_bf16_f32 v168, v136, v137
  v_exp_f32 v141, v141
  v_mfma_f32_32x32x16_bf16 v[192:207], v[100:103], v[172:175], v[192:207]
  v_exp_f32 v142, v142
  v_cvt_pk_bf16_f32 v169, v138, v139
  v_exp_f32 v143, v143
  v_exp_f32 v144, v144
  v_mfma_f32_32x32x8_bf16 v[152:167], v[66:67], v[218:219], v[152:167]
  v_cvt_pk_bf16_f32 v170, v140, v141
  v_exp_f32 v145, v145
  v_exp_f32 v146, v146
  v_cvt_pk_bf16_f32 v171, v142, v143
  v_exp_f32 v147, v147
  v_exp_f32 v148, v148
  v_mfma_f32_32x32x16_bf16 v[192:207], v[104:107], v[168:171], v[192:207]
  v_cvt_pk_bf16_f32 v172, v144, v145
  v_exp_f32 v149, v149
  v_exp_f32 v150, v150
  v_cvt_pk_bf16_f32 v173, v146, v147
  v_exp_f32 v151, v151
  s_mul_i32 s49, s71, 5376
  v_add_u32 v220, s49, v223
  v_exp_f32 v152, v152
  v_exp_f32 v153, v153
  v_cvt_pk_bf16_f32 v174, v148, v149
  v_exp_f32 v154, v154
  v_cvt_pk_bf16_f32 v175, v150, v151
  v_mfma_f32_32x32x16_bf16 v[136:151], v[48:51], v[212:215], v[6:21]
  v_exp_f32 v155, v155
  v_exp_f32 v156, v156
  v_cvt_pk_bf16_f32 v168, v152, v153
  v_exp_f32 v157, v157
  v_mfma_f32_32x32x16_bf16 v[192:207], v[108:111], v[172:175], v[192:207]
  v_exp_f32 v158, v158
  v_cvt_pk_bf16_f32 v169, v154, v155
  v_exp_f32 v159, v159
  v_exp_f32 v160, v160
  v_mfma_f32_32x32x8_bf16 v[136:151], v[68:69], v[218:219], v[136:151]
  v_cvt_pk_bf16_f32 v170, v156, v157
  v_exp_f32 v161, v161
  v_exp_f32 v162, v162
  v_cvt_pk_bf16_f32 v171, v158, v159
  v_exp_f32 v163, v163
  v_exp_f32 v164, v164
  v_mfma_f32_32x32x16_bf16 v[192:207], v[112:115], v[168:171], v[192:207]
  v_cvt_pk_bf16_f32 v172, v160, v161
  v_exp_f32 v165, v165
  v_exp_f32 v166, v166
  v_cvt_pk_bf16_f32 v173, v162, v163
  v_exp_f32 v167, v167
  v_exp_f32 v136, v136
  v_exp_f32 v137, v137
  v_cvt_pk_bf16_f32 v174, v164, v165
  v_exp_f32 v138, v138
  v_cvt_pk_bf16_f32 v175, v166, v167
  v_mfma_f32_32x32x16_bf16 v[152:167], v[52:55], v[212:215], v[6:21]
  v_exp_f32 v139, v139
  v_exp_f32 v140, v140
  v_cvt_pk_bf16_f32 v168, v136, v137
  v_exp_f32 v141, v141
  v_mfma_f32_32x32x16_bf16 v[192:207], v[116:119], v[172:175], v[192:207]
  v_exp_f32 v142, v142
  v_cvt_pk_bf16_f32 v169, v138, v139
  v_exp_f32 v143, v143
  v_exp_f32 v144, v144
  v_mfma_f32_32x32x8_bf16 v[152:167], v[70:71], v[218:219], v[152:167]
  v_cvt_pk_bf16_f32 v170, v140, v141
  v_exp_f32 v145, v145
  v_exp_f32 v146, v146
  v_cvt_pk_bf16_f32 v171, v142, v143
  v_exp_f32 v147, v147
  v_exp_f32 v148, v148
  v_mfma_f32_32x32x16_bf16 v[192:207], v[120:123], v[168:171], v[192:207]
  v_cvt_pk_bf16_f32 v172, v144, v145
  v_exp_f32 v149, v149
  v_exp_f32 v150, v150
  v_cvt_pk_bf16_f32 v173, v146, v147
  v_exp_f32 v151, v151
  s_waitcnt lgkmcnt(0)
  v_sub_f32 v6, 0, v22
  v_sub_f32 v7, 0, v22
  v_sub_f32 v8, 0, v22
  v_sub_f32 v9, 0, v22
  v_sub_f32 v10, 0, v22
  v_sub_f32 v11, 0, v22
  v_sub_f32 v12, 0, v22
  v_sub_f32 v13, 0, v22
  v_sub_f32 v14, 0, v22
  v_sub_f32 v15, 0, v22
  v_sub_f32 v16, 0, v22
  v_sub_f32 v17, 0, v22
  v_sub_f32 v18, 0, v22
  v_sub_f32 v19, 0, v22
  v_sub_f32 v20, 0, v22
  v_sub_f32 v21, 0, v22
  v_exp_f32 v152, v152
  v_exp_f32 v153, v153
  v_cvt_pk_bf16_f32 v174, v148, v149
  v_exp_f32 v154, v154
  v_cvt_pk_bf16_f32 v175, v150, v151
  v_mfma_f32_32x32x16_bf16 v[136:151], v[24:27], v[208:211], v[6:21]
  v_exp_f32 v155, v155
  v_exp_f32 v156, v156
  v_cvt_pk_bf16_f32 v168, v152, v153
  v_exp_f32 v157, v157
  v_mfma_f32_32x32x16_bf16 v[192:207], v[124:127], v[172:175], v[192:207]
  v_exp_f32 v158, v158
  v_cvt_pk_bf16_f32 v169, v154, v155
  v_exp_f32 v159, v159
  v_exp_f32 v160, v160
  v_mfma_f32_32x32x8_bf16 v[136:151], v[56:57], v[216:217], v[136:151]
  v_cvt_pk_bf16_f32 v170, v156, v157
  v_exp_f32 v161, v161
  v_exp_f32 v162, v162
  v_cvt_pk_bf16_f32 v171, v158, v159
  v_exp_f32 v163, v163
  v_exp_f32 v164, v164
  v_mfma_f32_32x32x16_bf16 v[192:207], v[128:131], v[168:171], v[192:207]
  v_cvt_pk_bf16_f32 v172, v160, v161
  v_exp_f32 v165, v165
  v_exp_f32 v166, v166
  v_cvt_pk_bf16_f32 v173, v162, v163
  v_exp_f32 v167, v167
  s_mov_b32 s71, s48
  s_mov_b32 s70, 1
gated_mix__grouped_kv_mqa__spectral_gfnet__prompt_kernel_attn43:
  v_exp_f32 v136, v136
  v_exp_f32 v137, v137
  v_cvt_pk_bf16_f32 v174, v164, v165
  v_exp_f32 v138, v138
  v_cvt_pk_bf16_f32 v175, v166, v167
  v_mfma_f32_32x32x16_bf16 v[152:167], v[28:31], v[208:211], v[6:21]
  v_exp_f32 v139, v139
  v_exp_f32 v140, v140
  v_cvt_pk_bf16_f32 v168, v136, v137
  v_exp_f32 v141, v141
  v_mfma_f32_32x32x16_bf16 v[192:207], v[132:135], v[172:175], v[192:207]
  v_exp_f32 v142, v142
  v_cvt_pk_bf16_f32 v169, v138, v139
  v_exp_f32 v143, v143
  v_exp_f32 v144, v144
  v_mfma_f32_32x32x8_bf16 v[152:167], v[58:59], v[216:217], v[152:167]
  v_cvt_pk_bf16_f32 v170, v140, v141
  v_exp_f32 v145, v145
  v_exp_f32 v146, v146
  v_cvt_pk_bf16_f32 v171, v142, v143
  v_exp_f32 v147, v147
  v_exp_f32 v148, v148
  v_mfma_f32_32x32x16_bf16 v[176:191], v[72:75], v[168:171], 0
  v_cvt_pk_bf16_f32 v172, v144, v145
  v_exp_f32 v149, v149
  v_exp_f32 v150, v150
  v_cvt_pk_bf16_f32 v173, v146, v147
  v_exp_f32 v151, v151
  s_add_u32 s48, s71, 1
  s_and_b32 s48, s48, 7
  s_lshl_b32 s49, s48, 10
  v_add_u32 v3, s49, v221
  v_mad_u32_u24 v4, s48, v23, v222
  ds_read_b128 v[212:215], v3
  ds_read_b64 v[218:219], v4
  s_lshl_b32 s49, s48, 7
  v_and_b32 v3, 31, v1
  v_lshlrev_b32 v3, 2, v3
  v_add_u32 v3, s49, v3
  ds_read_b32 v22, v3 offset:54400
  v_exp_f32 v152, v152
  v_exp_f32 v153, v153
  v_cvt_pk_bf16_f32 v174, v148, v149
  v_exp_f32 v154, v154
  v_cvt_pk_bf16_f32 v175, v150, v151
  v_mfma_f32_32x32x16_bf16 v[136:151], v[32:35], v[208:211], v[6:21]
  v_exp_f32 v155, v155
  v_exp_f32 v156, v156
  v_cvt_pk_bf16_f32 v168, v152, v153
  v_exp_f32 v157, v157
  v_mfma_f32_32x32x16_bf16 v[176:191], v[76:79], v[172:175], v[176:191]
  v_exp_f32 v158, v158
  v_cvt_pk_bf16_f32 v169, v154, v155
  v_exp_f32 v159, v159
  v_exp_f32 v160, v160
  v_mfma_f32_32x32x8_bf16 v[136:151], v[60:61], v[216:217], v[136:151]
  v_cvt_pk_bf16_f32 v170, v156, v157
  v_exp_f32 v161, v161
  v_exp_f32 v162, v162
  v_cvt_pk_bf16_f32 v171, v158, v159
  v_exp_f32 v163, v163
  v_exp_f32 v164, v164
  v_mfma_f32_32x32x16_bf16 v[176:191], v[80:83], v[168:171], v[176:191]
  v_cvt_pk_bf16_f32 v172, v160, v161
  v_exp_f32 v165, v165
  v_exp_f32 v166, v166
  v_cvt_pk_bf16_f32 v173, v162, v163
  v_exp_f32 v167, v167
  v_exp_f32 v136, v136
  v_exp_f32 v137, v137
  v_cvt_pk_bf16_f32 v174, v164, v165
  v_exp_f32 v138, v138
  v_cvt_pk_bf16_f32 v175, v166, v167
  v_mfma_f32_32x32x16_bf16 v[152:167], v[36:39], v[208:211], v[6:21]
  v_exp_f32 v139, v139
  v_exp_f32 v140, v140
  v_cvt_pk_bf16_f32 v168, v136, v137
  v_exp_f32 v141, v141
  v_mfma_f32_32x32x16_bf16 v[176:191], v[84:87], v[172:175], v[176:191]
  v_exp_f32 v142, v142
  v_cvt_pk_bf16_f32 v169, v138, v139
  v_exp_f32 v143, v143
  v_exp_f32 v144, v144
  v_mfma_f32_32x32x8_bf16 v[152:167], v[62:63], v[216:217], v[152:167]
  v_cvt_f64_f32 v[224:225], v192
  v_cvt_f64_f32 v[226:227], v193
  v_cvt_f64_f32 v[228:229], v194
  v_cvt_f64_f32 v[230:231], v195
  v_cvt_f64_f32 v[232:233], v196
  v_cvt_f64_f32 v[234:235], v197
  v_cvt_pk_bf16_f32 v170, v140, v141
  v_exp_f32 v145, v145
  v_exp_f32 v146, v146
  v_cvt_pk_bf16_f32 v171, v142, v143
  v_exp_f32 v147, v147
  v_exp_f32 v148, v148
  v_mfma_f32_32x32x16_bf16 v[176:191], v[88:91], v[168:171], v[176:191]
  ds_add_f64 v220, v[224:225] offset:0
  ds_add_f64 v220, v[226:227] offset:256
  ds_add_f64 v220, v[228:229] offset:512
  ds_add_f64 v220, v[230:231] offset:768
  ds_add_f64 v220, v[232:233] offset:2048
  ds_add_f64 v220, v[234:235] offset:2304
  v_cvt_pk_bf16_f32 v172, v144, v145
  v_exp_f32 v149, v149
  v_exp_f32 v150, v150
  v_cvt_pk_bf16_f32 v173, v146, v147
  v_exp_f32 v151, v151
  v_exp_f32 v152, v152
  v_exp_f32 v153, v153
  v_cvt_pk_bf16_f32 v174, v148, v149
  v_exp_f32 v154, v154
  v_cvt_pk_bf16_f32 v175, v150, v151
  v_mfma_f32_32x32x16_bf16 v[136:151], v[40:43], v[208:211], v[6:21]
  v_exp_f32 v155, v155
  v_exp_f32 v156, v156
  v_cvt_pk_bf16_f32 v168, v152, v153
  v_exp_f32 v157, v157
  v_mfma_f32_32x32x16_bf16 v[176:191], v[92:95], v[172:175], v[176:191]
  v_exp_f32 v158, v158
  v_cvt_pk_bf16_f32 v169, v154, v155
  v_exp_f32 v159, v159
  v_exp_f32 v160, v160
  v_mfma_f32_32x32x8_bf16 v[136:151], v[64:65], v[216:217], v[136:151]
  v_cvt_f64_f32 v[224:225], v198
  v_cvt_f64_f32 v[226:227], v199
  v_cvt_f64_f32 v[228:229], v200
  v_cvt_f64_f32 v[230:231], v201
  v_cvt_f64_f32 v[232:233], v202
  v_cvt_f64_f32 v[234:235], v203
  v_cvt_pk_bf16_f32 v170, v156, v157
  v_exp_f32 v161, v161
  v_exp_f32 v162, v162
  v_cvt_pk_bf16_f32 v171, v158, v159
  v_exp_f32 v163, v163
  v_exp_f32 v164, v164
  v_mfma_f32_32x32x16_bf16 v[176:191], v[96:99], v[168:171], v[176:191]
  ds_add_f64 v220, v[224:225] offset:2560
  ds_add_f64 v220, v[226:227] offset:2816
  ds_add_f64 v220, v[228:229] offset:4096
  s_mov_b32 exec_hi, 0
  ds_add_f64 v220, v[230:231] offset:4352
  ds_add_f64 v220, v[232:233] offset:4608
  ds_add_f64 v220, v[234:235] offset:4864
  s_mov_b64 exec, -1
  v_cvt_pk_bf16_f32 v172, v160, v161
  v_exp_f32 v165, v165
  v_exp_f32 v166, v166
  v_cvt_pk_bf16_f32 v173, v162, v163
  v_exp_f32 v167, v167
  v_exp_f32 v136, v136
  v_exp_f32 v137, v137
  v_cvt_pk_bf16_f32 v174, v164, v165
  v_exp_f32 v138, v138
  v_cvt_pk_bf16_f32 v175, v166, v167
  v_mfma_f32_32x32x16_bf16 v[152:167], v[44:47], v[208:211], v[6:21]
  v_exp_f32 v139, v139
  v_exp_f32 v140, v140
  v_cvt_pk_bf16_f32 v168, v136, v137
  v_exp_f32 v141, v141
  v_mfma_f32_32x32x16_bf16 v[176:191], v[100:103], v[172:175], v[176:191]
  v_exp_f32 v142, v142
  v_cvt_pk_bf16_f32 v169, v138, v139
  v_exp_f32 v143, v143
  v_exp_f32 v144, v144
  v_mfma_f32_32x32x8_bf16 v[152:167], v[66:67], v[216:217], v[152:167]
  v_cvt_pk_bf16_f32 v170, v140, v141
  v_exp_f32 v145, v145
  v_exp_f32 v146, v146
  v_cvt_pk_bf16_f32 v171, v142, v143
  v_exp_f32 v147, v147
  v_exp_f32 v148, v148
  v_mfma_f32_32x32x16_bf16 v[176:191], v[104:107], v[168:171], v[176:191]
  v_cvt_pk_bf16_f32 v172, v144, v145
  v_exp_f32 v149, v149
  v_exp_f32 v150, v150
  v_cvt_pk_bf16_f32 v173, v146, v147
  v_exp_f32 v151, v151
  s_mul_i32 s49, s71, 5376
  v_add_u32 v220, s49, v223
  v_exp_f32 v152, v152
  v_exp_f32 v153, v153
  v_cvt_pk_bf16_f32 v174, v148, v149
  v_exp_f32 v154, v154
  v_cvt_pk_bf16_f32 v175, v150, v151
  v_mfma_f32_32x32x16_bf16 v[136:151], v[48:51], v[208:211], v[6:21]
  v_exp_f32 v155, v155
  v_exp_f32 v156, v156
  v_cvt_pk_bf16_f32 v168, v152, v153
  v_exp_f32 v157, v157
  v_mfma_f32_32x32x16_bf16 v[176:191], v[108:111], v[172:175], v[176:191]
  v_exp_f32 v158, v158
  v_cvt_pk_bf16_f32 v169, v154, v155
  v_exp_f32 v159, v159
  v_exp_f32 v160, v160
  v_mfma_f32_32x32x8_bf16 v[136:151], v[68:69], v[216:217], v[136:151]
  v_cvt_pk_bf16_f32 v170, v156, v157
  v_exp_f32 v161, v161
  v_exp_f32 v162, v162
  v_cvt_pk_bf16_f32 v171, v158, v159
  v_exp_f32 v163, v163
  v_exp_f32 v164, v164
  v_mfma_f32_32x32x16_bf16 v[176:191], v[112:115], v[168:171], v[176:191]
  v_cvt_pk_bf16_f32 v172, v160, v161
  v_exp_f32 v165, v165
  v_exp_f32 v166, v166
  v_cvt_pk_bf16_f32 v173, v162, v163
  v_exp_f32 v167, v167
  v_exp_f32 v136, v136
  v_exp_f32 v137, v137
  v_cvt_pk_bf16_f32 v174, v164, v165
  v_exp_f32 v138, v138
  v_cvt_pk_bf16_f32 v175, v166, v167
  v_mfma_f32_32x32x16_bf16 v[152:167], v[52:55], v[208:211], v[6:21]
  v_exp_f32 v139, v139
  v_exp_f32 v140, v140
  v_cvt_pk_bf16_f32 v168, v136, v137
  v_exp_f32 v141, v141
  v_mfma_f32_32x32x16_bf16 v[176:191], v[116:119], v[172:175], v[176:191]
  v_exp_f32 v142, v142
  v_cvt_pk_bf16_f32 v169, v138, v139
  v_exp_f32 v143, v143
  v_exp_f32 v144, v144
  v_mfma_f32_32x32x8_bf16 v[152:167], v[70:71], v[216:217], v[152:167]
  v_cvt_pk_bf16_f32 v170, v140, v141
  v_exp_f32 v145, v145
  v_exp_f32 v146, v146
  v_cvt_pk_bf16_f32 v171, v142, v143
  v_exp_f32 v147, v147
  v_exp_f32 v148, v148
  v_mfma_f32_32x32x16_bf16 v[176:191], v[120:123], v[168:171], v[176:191]
  v_cvt_pk_bf16_f32 v172, v144, v145
  v_exp_f32 v149, v149
  v_exp_f32 v150, v150
  v_cvt_pk_bf16_f32 v173, v146, v147
  v_exp_f32 v151, v151
  s_waitcnt lgkmcnt(0)
  v_sub_f32 v6, 0, v22
  v_sub_f32 v7, 0, v22
  v_sub_f32 v8, 0, v22
  v_sub_f32 v9, 0, v22
  v_sub_f32 v10, 0, v22
  v_sub_f32 v11, 0, v22
  v_sub_f32 v12, 0, v22
  v_sub_f32 v13, 0, v22
  v_sub_f32 v14, 0, v22
  v_sub_f32 v15, 0, v22
  v_sub_f32 v16, 0, v22
  v_sub_f32 v17, 0, v22
  v_sub_f32 v18, 0, v22
  v_sub_f32 v19, 0, v22
  v_sub_f32 v20, 0, v22
  v_sub_f32 v21, 0, v22
  v_exp_f32 v152, v152
  v_exp_f32 v153, v153
  v_cvt_pk_bf16_f32 v174, v148, v149
  v_exp_f32 v154, v154
  v_cvt_pk_bf16_f32 v175, v150, v151
  v_mfma_f32_32x32x16_bf16 v[136:151], v[24:27], v[212:215], v[6:21]
  v_exp_f32 v155, v155
  v_exp_f32 v156, v156
  v_cvt_pk_bf16_f32 v168, v152, v153
  v_exp_f32 v157, v157
  v_mfma_f32_32x32x16_bf16 v[176:191], v[124:127], v[172:175], v[176:191]
  v_exp_f32 v158, v158
  v_cvt_pk_bf16_f32 v169, v154, v155
  v_exp_f32 v159, v159
  v_exp_f32 v160, v160
  v_mfma_f32_32x32x8_bf16 v[136:151], v[56:57], v[218:219], v[136:151]
  v_cvt_pk_bf16_f32 v170, v156, v157
  v_exp_f32 v161, v161
  v_exp_f32 v162, v162
  v_cvt_pk_bf16_f32 v171, v158, v159
  v_exp_f32 v163, v163
  v_exp_f32 v164, v164
  v_mfma_f32_32x32x16_bf16 v[176:191], v[128:131], v[168:171], v[176:191]
  v_cvt_pk_bf16_f32 v172, v160, v161
  v_exp_f32 v165, v165
  v_exp_f32 v166, v166
  v_cvt_pk_bf16_f32 v173, v162, v163
  v_exp_f32 v167, v167
  s_mov_b32 s71, s48
  v_exp_f32 v136, v136
  v_exp_f32 v137, v137
  v_cvt_pk_bf16_f32 v174, v164, v165
  v_exp_f32 v138, v138
  v_cvt_pk_bf16_f32 v175, v166, v167
  v_mfma_f32_32x32x16_bf16 v[152:167], v[28:31], v[212:215], v[6:21]
  v_exp_f32 v139, v139
  v_exp_f32 v140, v140
  v_cvt_pk_bf16_f32 v168, v136, v137
  v_exp_f32 v141, v141
  v_mfma_f32_32x32x16_bf16 v[176:191], v[132:135], v[172:175], v[176:191]
  v_exp_f32 v142, v142
  v_cvt_pk_bf16_f32 v169, v138, v139
  v_exp_f32 v143, v143
  v_exp_f32 v144, v144
  v_mfma_f32_32x32x8_bf16 v[152:167], v[58:59], v[218:219], v[152:167]
  v_cvt_pk_bf16_f32 v170, v140, v141
  v_exp_f32 v145, v145
  v_exp_f32 v146, v146
  v_cvt_pk_bf16_f32 v171, v142, v143
  v_exp_f32 v147, v147
  v_exp_f32 v148, v148
  v_mfma_f32_32x32x16_bf16 v[192:207], v[72:75], v[168:171], 0
  v_cvt_pk_bf16_f32 v172, v144, v145
  v_exp_f32 v149, v149
  v_exp_f32 v150, v150
  v_cvt_pk_bf16_f32 v173, v146, v147
  v_exp_f32 v151, v151
  s_add_u32 s48, s71, 1
  s_and_b32 s48, s48, 7
  s_lshl_b32 s49, s48, 10
  v_add_u32 v3, s49, v221
  v_mad_u32_u24 v4, s48, v23, v222
  ds_read_b128 v[208:211], v3
  ds_read_b64 v[216:217], v4
  s_lshl_b32 s49, s48, 7
  v_and_b32 v3, 31, v1
  v_lshlrev_b32 v3, 2, v3
  v_add_u32 v3, s49, v3
  ds_read_b32 v22, v3 offset:54400
  v_exp_f32 v152, v152
  v_exp_f32 v153, v153
  v_cvt_pk_bf16_f32 v174, v148, v149
  v_exp_f32 v154, v154
  v_cvt_pk_bf16_f32 v175, v150, v151
  v_mfma_f32_32x32x16_bf16 v[136:151], v[32:35], v[212:215], v[6:21]
  v_exp_f32 v155, v155
  v_exp_f32 v156, v156
  v_cvt_pk_bf16_f32 v168, v152, v153
  v_exp_f32 v157, v157
  v_mfma_f32_32x32x16_bf16 v[192:207], v[76:79], v[172:175], v[192:207]
  v_exp_f32 v158, v158
  v_cvt_pk_bf16_f32 v169, v154, v155
  v_exp_f32 v159, v159
  v_exp_f32 v160, v160
  v_mfma_f32_32x32x8_bf16 v[136:151], v[60:61], v[218:219], v[136:151]
  v_cvt_pk_bf16_f32 v170, v156, v157
  v_exp_f32 v161, v161
  v_exp_f32 v162, v162
  v_cvt_pk_bf16_f32 v171, v158, v159
  v_exp_f32 v163, v163
  v_exp_f32 v164, v164
  v_mfma_f32_32x32x16_bf16 v[192:207], v[80:83], v[168:171], v[192:207]
  v_cvt_pk_bf16_f32 v172, v160, v161
  v_exp_f32 v165, v165
  v_exp_f32 v166, v166
  v_cvt_pk_bf16_f32 v173, v162, v163
  v_exp_f32 v167, v167
  v_exp_f32 v136, v136
  v_exp_f32 v137, v137
  v_cvt_pk_bf16_f32 v174, v164, v165
  v_exp_f32 v138, v138
  v_cvt_pk_bf16_f32 v175, v166, v167
  v_mfma_f32_32x32x16_bf16 v[152:167], v[36:39], v[212:215], v[6:21]
  v_exp_f32 v139, v139
  v_exp_f32 v140, v140
  v_cvt_pk_bf16_f32 v168, v136, v137
  v_exp_f32 v141, v141
  v_mfma_f32_32x32x16_bf16 v[192:207], v[84:87], v[172:175], v[192:207]
  v_exp_f32 v142, v142
  v_cvt_pk_bf16_f32 v169, v138, v139
  v_exp_f32 v143, v143
  v_exp_f32 v144, v144
  v_mfma_f32_32x32x8_bf16 v[152:167], v[62:63], v[218:219], v[152:167]
  v_cvt_f64_f32 v[224:225], v176
  v_cvt_f64_f32 v[226:227], v177
  v_cvt_f64_f32 v[228:229], v178
  v_cvt_f64_f32 v[230:231], v179
  v_cvt_f64_f32 v[232:233], v180
  v_cvt_f64_f32 v[234:235], v181
  v_cvt_pk_bf16_f32 v170, v140, v141
  v_exp_f32 v145, v145
  v_exp_f32 v146, v146
  v_cvt_pk_bf16_f32 v171, v142, v143
  v_exp_f32 v147, v147
  v_exp_f32 v148, v148
  v_mfma_f32_32x32x16_bf16 v[192:207], v[88:91], v[168:171], v[192:207]
  ds_add_f64 v220, v[224:225] offset:0
  ds_add_f64 v220, v[226:227] offset:256
  ds_add_f64 v220, v[228:229] offset:512
  ds_add_f64 v220, v[230:231] offset:768
  ds_add_f64 v220, v[232:233] offset:2048
  ds_add_f64 v220, v[234:235] offset:2304
  v_cvt_pk_bf16_f32 v172, v144, v145
  v_exp_f32 v149, v149
  v_exp_f32 v150, v150
  v_cvt_pk_bf16_f32 v173, v146, v147
  v_exp_f32 v151, v151
  v_exp_f32 v152, v152
  v_exp_f32 v153, v153
  v_cvt_pk_bf16_f32 v174, v148, v149
  v_exp_f32 v154, v154
  v_cvt_pk_bf16_f32 v175, v150, v151
  v_mfma_f32_32x32x16_bf16 v[136:151], v[40:43], v[212:215], v[6:21]
  v_exp_f32 v155, v155
  v_exp_f32 v156, v156
  v_cvt_pk_bf16_f32 v168, v152, v153
  v_exp_f32 v157, v157
  v_mfma_f32_32x32x16_bf16 v[192:207], v[92:95], v[172:175], v[192:207]
  v_exp_f32 v158, v158
  v_cvt_pk_bf16_f32 v169, v154, v155
  v_exp_f32 v159, v159
  v_exp_f32 v160, v160
  v_mfma_f32_32x32x8_bf16 v[136:151], v[64:65], v[218:219], v[136:151]
  v_cvt_f64_f32 v[224:225], v182
  v_cvt_f64_f32 v[226:227], v183
  v_cvt_f64_f32 v[228:229], v184
  v_cvt_f64_f32 v[230:231], v185
  v_cvt_f64_f32 v[232:233], v186
  v_cvt_f64_f32 v[234:235], v187
  v_cvt_pk_bf16_f32 v170, v156, v157
  v_exp_f32 v161, v161
  v_exp_f32 v162, v162
  v_cvt_pk_bf16_f32 v171, v158, v159
  v_exp_f32 v163, v163
  v_exp_f32 v164, v164
  v_mfma_f32_32x32x16_bf16 v[192:207], v[96:99], v[168:171], v[192:207]
  ds_add_f64 v220, v[224:225] offset:2560
  ds_add_f64 v220, v[226:227] offset:2816
  ds_add_f64 v220, v[228:229] offset:4096
  s_mov_b32 exec_hi, 0
  ds_add_f64 v220, v[230:231] offset:4352
  ds_add_f64 v220, v[232:233] offset:4608
  ds_add_f64 v220, v[234:235] offset:4864
  s_mov_b64 exec, -1
  v_cvt_pk_bf16_f32 v172, v160, v161
  v_exp_f32 v165, v165
  v_exp_f32 v166, v166
  v_cvt_pk_bf16_f32 v173, v162, v163
  v_exp_f32 v167, v167
  v_exp_f32 v136, v136
  v_exp_f32 v137, v137
  v_cvt_pk_bf16_f32 v174, v164, v165
  v_exp_f32 v138, v138
  v_cvt_pk_bf16_f32 v175, v166, v167
  v_mfma_f32_32x32x16_bf16 v[152:167], v[44:47], v[212:215], v[6:21]
  v_exp_f32 v139, v139
  v_exp_f32 v140, v140
  v_cvt_pk_bf16_f32 v168, v136, v137
  v_exp_f32 v141, v141
  v_mfma_f32_32x32x16_bf16 v[192:207], v[100:103], v[172:175], v[192:207]
  v_exp_f32 v142, v142
  v_cvt_pk_bf16_f32 v169, v138, v139
  v_exp_f32 v143, v143
  v_exp_f32 v144, v144
  v_mfma_f32_32x32x8_bf16 v[152:167], v[66:67], v[218:219], v[152:167]
  v_cvt_pk_bf16_f32 v170, v140, v141
  v_exp_f32 v145, v145
  v_exp_f32 v146, v146
  v_cvt_pk_bf16_f32 v171, v142, v143
  v_exp_f32 v147, v147
  v_exp_f32 v148, v148
  v_mfma_f32_32x32x16_bf16 v[192:207], v[104:107], v[168:171], v[192:207]
  v_cvt_pk_bf16_f32 v172, v144, v145
  v_exp_f32 v149, v149
  v_exp_f32 v150, v150
  v_cvt_pk_bf16_f32 v173, v146, v147
  v_exp_f32 v151, v151
  s_mul_i32 s49, s71, 5376
  v_add_u32 v220, s49, v223
  v_exp_f32 v152, v152
  v_exp_f32 v153, v153
  v_cvt_pk_bf16_f32 v174, v148, v149
  v_exp_f32 v154, v154
  v_cvt_pk_bf16_f32 v175, v150, v151
  v_mfma_f32_32x32x16_bf16 v[136:151], v[48:51], v[212:215], v[6:21]
  v_exp_f32 v155, v155
  v_exp_f32 v156, v156
  v_cvt_pk_bf16_f32 v168, v152, v153
  v_exp_f32 v157, v157
  v_mfma_f32_32x32x16_bf16 v[192:207], v[108:111], v[172:175], v[192:207]
  v_exp_f32 v158, v158
  v_cvt_pk_bf16_f32 v169, v154, v155
  v_exp_f32 v159, v159
  v_exp_f32 v160, v160
  v_mfma_f32_32x32x8_bf16 v[136:151], v[68:69], v[218:219], v[136:151]
  v_cvt_pk_bf16_f32 v170, v156, v157
  v_exp_f32 v161, v161
  v_exp_f32 v162, v162
  v_cvt_pk_bf16_f32 v171, v158, v159
  v_exp_f32 v163, v163
  v_exp_f32 v164, v164
  v_mfma_f32_32x32x16_bf16 v[192:207], v[112:115], v[168:171], v[192:207]
  v_cvt_pk_bf16_f32 v172, v160, v161
  v_exp_f32 v165, v165
  v_exp_f32 v166, v166
  v_cvt_pk_bf16_f32 v173, v162, v163
  v_exp_f32 v167, v167
  v_exp_f32 v136, v136
  v_exp_f32 v137, v137
  v_cvt_pk_bf16_f32 v174, v164, v165
  v_exp_f32 v138, v138
  v_cvt_pk_bf16_f32 v175, v166, v167
  v_mfma_f32_32x32x16_bf16 v[152:167], v[52:55], v[212:215], v[6:21]
  v_exp_f32 v139, v139
  v_exp_f32 v140, v140
  v_cvt_pk_bf16_f32 v168, v136, v137
  v_exp_f32 v141, v141
  v_mfma_f32_32x32x16_bf16 v[192:207], v[116:119], v[172:175], v[192:207]
  v_exp_f32 v142, v142
  v_cvt_pk_bf16_f32 v169, v138, v139
  v_exp_f32 v143, v143
  v_exp_f32 v144, v144
  v_mfma_f32_32x32x8_bf16 v[152:167], v[70:71], v[218:219], v[152:167]
  v_cvt_pk_bf16_f32 v170, v140, v141
  v_exp_f32 v145, v145
  v_exp_f32 v146, v146
  v_cvt_pk_bf16_f32 v171, v142, v143
  v_exp_f32 v147, v147
  v_exp_f32 v148, v148
  v_mfma_f32_32x32x16_bf16 v[192:207], v[120:123], v[168:171], v[192:207]
  v_cvt_pk_bf16_f32 v172, v144, v145
  v_exp_f32 v149, v149
  v_exp_f32 v150, v150
  v_cvt_pk_bf16_f32 v173, v146, v147
  v_exp_f32 v151, v151
  s_waitcnt lgkmcnt(0)
  v_sub_f32 v6, 0, v22
  v_sub_f32 v7, 0, v22
  v_sub_f32 v8, 0, v22
  v_sub_f32 v9, 0, v22
  v_sub_f32 v10, 0, v22
  v_sub_f32 v11, 0, v22
  v_sub_f32 v12, 0, v22
  v_sub_f32 v13, 0, v22
  v_sub_f32 v14, 0, v22
  v_sub_f32 v15, 0, v22
  v_sub_f32 v16, 0, v22
  v_sub_f32 v17, 0, v22
  v_sub_f32 v18, 0, v22
  v_sub_f32 v19, 0, v22
  v_sub_f32 v20, 0, v22
  v_sub_f32 v21, 0, v22
  v_exp_f32 v152, v152
  v_exp_f32 v153, v153
  v_cvt_pk_bf16_f32 v174, v148, v149
  v_exp_f32 v154, v154
  v_cvt_pk_bf16_f32 v175, v150, v151
  v_mfma_f32_32x32x16_bf16 v[136:151], v[24:27], v[208:211], v[6:21]
  v_exp_f32 v155, v155
  v_exp_f32 v156, v156
  v_cvt_pk_bf16_f32 v168, v152, v153
  v_exp_f32 v157, v157
  v_mfma_f32_32x32x16_bf16 v[192:207], v[124:127], v[172:175], v[192:207]
  v_exp_f32 v158, v158
  v_cvt_pk_bf16_f32 v169, v154, v155
  v_exp_f32 v159, v159
  v_exp_f32 v160, v160
  v_mfma_f32_32x32x8_bf16 v[136:151], v[56:57], v[216:217], v[136:151]
  v_cvt_pk_bf16_f32 v170, v156, v157
  v_exp_f32 v161, v161
  v_exp_f32 v162, v162
  v_cvt_pk_bf16_f32 v171, v158, v159
  v_exp_f32 v163, v163
  v_exp_f32 v164, v164
  v_mfma_f32_32x32x16_bf16 v[192:207], v[128:131], v[168:171], v[192:207]
  v_cvt_pk_bf16_f32 v172, v160, v161
  v_exp_f32 v165, v165
  v_exp_f32 v166, v166
  v_cvt_pk_bf16_f32 v173, v162, v163
  v_exp_f32 v167, v167
  s_mov_b32 s71, s48
  s_add_u32 s70, s70, 1
  s_cmp_lt_u32 s70, 4
  s_cbranch_scc1 gated_mix__grouped_kv_mqa__spectral_gfnet__prompt_kernel_attn43
  s_nop 0
  v_cvt_pk_bf16_f32 v174, v164, v165
  v_cvt_pk_bf16_f32 v175, v166, v167
  s_nop 1
  v_mfma_f32_32x32x16_bf16 v[192:207], v[132:135], v[172:175], v[192:207]
  s_nop 15
  v_cvt_f64_f32 v[224:225], v192
  v_cvt_f64_f32 v[226:227], v193
  v_cvt_f64_f32 v[228:229], v194
  v_cvt_f64_f32 v[230:231], v195
  v_cvt_f64_f32 v[232:233], v196
  v_cvt_f64_f32 v[234:235], v197
  v_cvt_f64_f32 v[236:237], v198
  v_cvt_f64_f32 v[238:239], v199
  v_cvt_f64_f32 v[240:241], v200
  v_cvt_f64_f32 v[242:243], v201
  v_cvt_f64_f32 v[244:245], v202
  v_cvt_f64_f32 v[246:247], v203
  ds_add_f64 v220, v[224:225] offset:0
  ds_add_f64 v220, v[226:227] offset:256
  ds_add_f64 v220, v[228:229] offset:512
  ds_add_f64 v220, v[230:231] offset:768
  ds_add_f64 v220, v[232:233] offset:2048
  ds_add_f64 v220, v[234:235] offset:2304
  ds_add_f64 v220, v[236:237] offset:2560
  ds_add_f64 v220, v[238:239] offset:2816
  ds_add_f64 v220, v[240:241] offset:4096
  s_mov_b32 exec_hi, 0
  ds_add_f64 v220, v[242:243] offset:4352
  ds_add_f64 v220, v[244:245] offset:4608
  ds_add_f64 v220, v[246:247] offset:4864
  s_mov_b64 exec, -1
  s_waitcnt lgkmcnt(0)
  s_barrier
gated_mix__grouped_kv_mqa__spectral_gfnet__prompt_kernel_adone36:
  s_setprio 0
  s_cmp_eq_u32 s44, 3
  s_cbranch_scc1 gated_mix__grouped_kv_mqa__spectral_gfnet__prompt_kernel_w344
  s_cmp_eq_u32 s44, 2
  s_cbranch_scc1 gated_mix__grouped_kv_mqa__spectral_gfnet__prompt_kernel_w245
  s_branch gated_mix__grouped_kv_mqa__spectral_gfnet__prompt_kernel_aend34
gated_mix__grouped_kv_mqa__spectral_gfnet__prompt_kernel_w344:
  v_mov_b32 v5, 10308
gated_mix__grouped_kv_mqa__spectral_gfnet__prompt_kernel_lw46:
  ds_read_b32 v6, v5
  s_waitcnt lgkmcnt(0)
  v_readfirstlane_b32 s48, v6
  s_cmp_lt_u32 s48, 2
  s_cbranch_scc0 gated_mix__grouped_kv_mqa__spectral_gfnet__prompt_kernel_lq47
  s_sleep 2
  s_branch gated_mix__grouped_kv_mqa__spectral_gfnet__prompt_kernel_lw46
gated_mix__grouped_kv_mqa__spectral_gfnet__prompt_kernel_lq47:
  s_mov_b32 s62, s44
  s_mov_b32 s44, 0
  s_mov_b32 s48, 0xCCCCCCCD
  s_mul_i32 s49, s46, 160
  s_add_u32 s50, s44, 0
  s_mul_i32 s51, s50, 41
  s_lshr_b32 s51, s51, 10
  s_mul_i32 s52, s51, 25
  s_sub_u32 s52, s50, s52
  s_lshl_b32 s53, s52, 6
  v_add_u32 v3, s53, v1
  v_mul_hi_u32 v4, v3, s48
  v_lshrrev_b32 v4, 3, v4
  v_mul_u32_u24 v5, 10, v4
  v_sub_u32 v5, v3, v5
  v_mul_u32_u24 v4, 5120, v4
  v_lshlrev_b32 v5, 4, v5
  s_mul_i32 s53, s51, 1280
  s_add_u32 s53, s53, s49
  v_add3_u32 v4, v4, v5, s53
  s_mul_i32 s53, s51, 25600
  s_and_b32 s54, s51, 1
  s_lshl_b32 s54, s54, 5
  s_add_u32 s53, s53, s54
  s_lshr_b32 s54, s51, 1
  s_lshl_b32 s54, s54, 7
  s_add_u32 s53, s53, s54
  s_lshl_b32 s52, s52, 10
  s_add_u32 s53, s53, s52
  s_add_u32 m0, s53, 60544
  s_nop 0
  buffer_load_dwordx4 v4, s[20:23], 0 offen lds
  s_add_u32 s50, s44, 1
  s_mul_i32 s51, s50, 41
  s_lshr_b32 s51, s51, 10
  s_mul_i32 s52, s51, 25
  s_sub_u32 s52, s50, s52
  s_lshl_b32 s53, s52, 6
  v_add_u32 v3, s53, v1
  v_mul_hi_u32 v4, v3, s48
  v_lshrrev_b32 v4, 3, v4
  v_mul_u32_u24 v5, 10, v4
  v_sub_u32 v5, v3, v5
  v_mul_u32_u24 v4, 5120, v4
  v_lshlrev_b32 v5, 4, v5
  s_mul_i32 s53, s51, 1280
  s_add_u32 s53, s53, s49
  v_add3_u32 v4, v4, v5, s53
  s_mul_i32 s53, s51, 25600
  s_and_b32 s54, s51, 1
  s_lshl_b32 s54, s54, 5
  s_add_u32 s53, s53, s54
  s_lshr_b32 s54, s51, 1
  s_lshl_b32 s54, s54, 7
  s_add_u32 s53, s53, s54
  s_lshl_b32 s52, s52, 10
  s_add_u32 s53, s53, s52
  s_add_u32 m0, s53, 60544
  s_nop 0
  buffer_load_dwordx4 v4, s[20:23], 0 offen lds
  s_add_u32 s50, s44, 2
  s_mul_i32 s51, s50, 41
  s_lshr_b32 s51, s51, 10
  s_mul_i32 s52, s51, 25
  s_sub_u32 s52, s50, s52
  s_lshl_b32 s53, s52, 6
  v_add_u32 v3, s53, v1
  v_mul_hi_u32 v4, v3, s48
  v_lshrrev_b32 v4, 3, v4
  v_mul_u32_u24 v5, 10, v4
  v_sub_u32 v5, v3, v5
  v_mul_u32_u24 v4, 5120, v4
  v_lshlrev_b32 v5, 4, v5
  s_mul_i32 s53, s51, 1280
  s_add_u32 s53, s53, s49
  v_add3_u32 v4, v4, v5, s53
  s_mul_i32 s53, s51, 25600
  s_and_b32 s54, s51, 1
  s_lshl_b32 s54, s54, 5
  s_add_u32 s53, s53, s54
  s_lshr_b32 s54, s51, 1
  s_lshl_b32 s54, s54, 7
  s_add_u32 s53, s53, s54
  s_lshl_b32 s52, s52, 10
  s_add_u32 s53, s53, s52
  s_add_u32 m0, s53, 60544
  s_nop 0
  buffer_load_dwordx4 v4, s[20:23], 0 offen lds
  s_add_u32 s50, s44, 3
  s_mul_i32 s51, s50, 41
  s_lshr_b32 s51, s51, 10
  s_mul_i32 s52, s51, 25
  s_sub_u32 s52, s50, s52
  s_lshl_b32 s53, s52, 6
  v_add_u32 v3, s53, v1
  v_mul_hi_u32 v4, v3, s48
  v_lshrrev_b32 v4, 3, v4
  v_mul_u32_u24 v5, 10, v4
  v_sub_u32 v5, v3, v5
  v_mul_u32_u24 v4, 5120, v4
  v_lshlrev_b32 v5, 4, v5
  s_mul_i32 s53, s51, 1280
  s_add_u32 s53, s53, s49
  v_add3_u32 v4, v4, v5, s53
  s_mul_i32 s53, s51, 25600
  s_and_b32 s54, s51, 1
  s_lshl_b32 s54, s54, 5
  s_add_u32 s53, s53, s54
  s_lshr_b32 s54, s51, 1
  s_lshl_b32 s54, s54, 7
  s_add_u32 s53, s53, s54
  s_lshl_b32 s52, s52, 10
  s_add_u32 s53, s53, s52
  s_add_u32 m0, s53, 60544
  s_nop 0
  buffer_load_dwordx4 v4, s[20:23], 0 offen lds
  s_add_u32 s50, s44, 4
  s_mul_i32 s51, s50, 41
  s_lshr_b32 s51, s51, 10
  s_mul_i32 s52, s51, 25
  s_sub_u32 s52, s50, s52
  s_lshl_b32 s53, s52, 6
  v_add_u32 v3, s53, v1
  v_mul_hi_u32 v4, v3, s48
  v_lshrrev_b32 v4, 3, v4
  v_mul_u32_u24 v5, 10, v4
  v_sub_u32 v5, v3, v5
  v_mul_u32_u24 v4, 5120, v4
  v_lshlrev_b32 v5, 4, v5
  s_mul_i32 s53, s51, 1280
  s_add_u32 s53, s53, s49
  v_add3_u32 v4, v4, v5, s53
  s_mul_i32 s53, s51, 25600
  s_and_b32 s54, s51, 1
  s_lshl_b32 s54, s54, 5
  s_add_u32 s53, s53, s54
  s_lshr_b32 s54, s51, 1
  s_lshl_b32 s54, s54, 7
  s_add_u32 s53, s53, s54
  s_lshl_b32 s52, s52, 10
  s_add_u32 s53, s53, s52
  s_add_u32 m0, s53, 60544
  s_nop 0
  buffer_load_dwordx4 v4, s[20:23], 0 offen lds
  s_add_u32 s50, s44, 5
  s_mul_i32 s51, s50, 41
  s_lshr_b32 s51, s51, 10
  s_mul_i32 s52, s51, 25
  s_sub_u32 s52, s50, s52
  s_lshl_b32 s53, s52, 6
  v_add_u32 v3, s53, v1
  v_mul_hi_u32 v4, v3, s48
  v_lshrrev_b32 v4, 3, v4
  v_mul_u32_u24 v5, 10, v4
  v_sub_u32 v5, v3, v5
  v_mul_u32_u24 v4, 5120, v4
  v_lshlrev_b32 v5, 4, v5
  s_mul_i32 s53, s51, 1280
  s_add_u32 s53, s53, s49
  v_add3_u32 v4, v4, v5, s53
  s_mul_i32 s53, s51, 25600
  s_and_b32 s54, s51, 1
  s_lshl_b32 s54, s54, 5
  s_add_u32 s53, s53, s54
  s_lshr_b32 s54, s51, 1
  s_lshl_b32 s54, s54, 7
  s_add_u32 s53, s53, s54
  s_lshl_b32 s52, s52, 10
  s_add_u32 s53, s53, s52
  s_add_u32 m0, s53, 60544
  s_nop 0
  buffer_load_dwordx4 v4, s[20:23], 0 offen lds
  s_add_u32 s50, s44, 6
  s_mul_i32 s51, s50, 41
  s_lshr_b32 s51, s51, 10
  s_mul_i32 s52, s51, 25
  s_sub_u32 s52, s50, s52
  s_lshl_b32 s53, s52, 6
  v_add_u32 v3, s53, v1
  v_mul_hi_u32 v4, v3, s48
  v_lshrrev_b32 v4, 3, v4
  v_mul_u32_u24 v5, 10, v4
  v_sub_u32 v5, v3, v5
  v_mul_u32_u24 v4, 5120, v4
  v_lshlrev_b32 v5, 4, v5
  s_mul_i32 s53, s51, 1280
  s_add_u32 s53, s53, s49
  v_add3_u32 v4, v4, v5, s53
  s_mul_i32 s53, s51, 25600
  s_and_b32 s54, s51, 1
  s_lshl_b32 s54, s54, 5
  s_add_u32 s53, s53, s54
  s_lshr_b32 s54, s51, 1
  s_lshl_b32 s54, s54, 7
  s_add_u32 s53, s53, s54
  s_lshl_b32 s52, s52, 10
  s_add_u32 s53, s53, s52
  s_add_u32 m0, s53, 60544
  s_nop 0
  buffer_load_dwordx4 v4, s[20:23], 0 offen lds
  s_add_u32 s50, s44, 7
  s_mul_i32 s51, s50, 41
  s_lshr_b32 s51, s51, 10
  s_mul_i32 s52, s51, 25
  s_sub_u32 s52, s50, s52
  s_lshl_b32 s53, s52, 6
  v_add_u32 v3, s53, v1
  v_mul_hi_u32 v4, v3, s48
  v_lshrrev_b32 v4, 3, v4
  v_mul_u32_u24 v5, 10, v4
  v_sub_u32 v5, v3, v5
  v_mul_u32_u24 v4, 5120, v4
  v_lshlrev_b32 v5, 4, v5
  s_mul_i32 s53, s51, 1280
  s_add_u32 s53, s53, s49
  v_add3_u32 v4, v4, v5, s53
  s_mul_i32 s53, s51, 25600
  s_and_b32 s54, s51, 1
  s_lshl_b32 s54, s54, 5
  s_add_u32 s53, s53, s54
  s_lshr_b32 s54, s51, 1
  s_lshl_b32 s54, s54, 7
  s_add_u32 s53, s53, s54
  s_lshl_b32 s52, s52, 10
  s_add_u32 s53, s53, s52
  s_add_u32 m0, s53, 60544
  s_nop 0
  buffer_load_dwordx4 v4, s[20:23], 0 offen lds
  s_add_u32 s50, s44, 8
  s_mul_i32 s51, s50, 41
  s_lshr_b32 s51, s51, 10
  s_mul_i32 s52, s51, 25
  s_sub_u32 s52, s50, s52
  s_lshl_b32 s53, s52, 6
  v_add_u32 v3, s53, v1
  v_mul_hi_u32 v4, v3, s48
  v_lshrrev_b32 v4, 3, v4
  v_mul_u32_u24 v5, 10, v4
  v_sub_u32 v5, v3, v5
  v_mul_u32_u24 v4, 5120, v4
  v_lshlrev_b32 v5, 4, v5
  s_mul_i32 s53, s51, 1280
  s_add_u32 s53, s53, s49
  v_add3_u32 v4, v4, v5, s53
  s_mul_i32 s53, s51, 25600
  s_and_b32 s54, s51, 1
  s_lshl_b32 s54, s54, 5
  s_add_u32 s53, s53, s54
  s_lshr_b32 s54, s51, 1
  s_lshl_b32 s54, s54, 7
  s_add_u32 s53, s53, s54
  s_lshl_b32 s52, s52, 10
  s_add_u32 s53, s53, s52
  s_add_u32 m0, s53, 60544
  s_nop 0
  buffer_load_dwordx4 v4, s[20:23], 0 offen lds
  s_add_u32 s50, s44, 9
  s_mul_i32 s51, s50, 41
  s_lshr_b32 s51, s51, 10
  s_mul_i32 s52, s51, 25
  s_sub_u32 s52, s50, s52
  s_lshl_b32 s53, s52, 6
  v_add_u32 v3, s53, v1
  v_mul_hi_u32 v4, v3, s48
  v_lshrrev_b32 v4, 3, v4
  v_mul_u32_u24 v5, 10, v4
  v_sub_u32 v5, v3, v5
  v_mul_u32_u24 v4, 5120, v4
  v_lshlrev_b32 v5, 4, v5
  s_mul_i32 s53, s51, 1280
  s_add_u32 s53, s53, s49
  v_add3_u32 v4, v4, v5, s53
  s_mul_i32 s53, s51, 25600
  s_and_b32 s54, s51, 1
  s_lshl_b32 s54, s54, 5
  s_add_u32 s53, s53, s54
  s_lshr_b32 s54, s51, 1
  s_lshl_b32 s54, s54, 7
  s_add_u32 s53, s53, s54
  s_lshl_b32 s52, s52, 10
  s_add_u32 s53, s53, s52
  s_add_u32 m0, s53, 60544
  s_nop 0
  buffer_load_dwordx4 v4, s[20:23], 0 offen lds
  s_add_u32 s50, s44, 10
  s_mul_i32 s51, s50, 41
  s_lshr_b32 s51, s51, 10
  s_mul_i32 s52, s51, 25
  s_sub_u32 s52, s50, s52
  s_lshl_b32 s53, s52, 6
  v_add_u32 v3, s53, v1
  v_mul_hi_u32 v4, v3, s48
  v_lshrrev_b32 v4, 3, v4
  v_mul_u32_u24 v5, 10, v4
  v_sub_u32 v5, v3, v5
  v_mul_u32_u24 v4, 5120, v4
  v_lshlrev_b32 v5, 4, v5
  s_mul_i32 s53, s51, 1280
  s_add_u32 s53, s53, s49
  v_add3_u32 v4, v4, v5, s53
  s_mul_i32 s53, s51, 25600
  s_and_b32 s54, s51, 1
  s_lshl_b32 s54, s54, 5
  s_add_u32 s53, s53, s54
  s_lshr_b32 s54, s51, 1
  s_lshl_b32 s54, s54, 7
  s_add_u32 s53, s53, s54
  s_lshl_b32 s52, s52, 10
  s_add_u32 s53, s53, s52
  s_add_u32 m0, s53, 60544
  s_nop 0
  buffer_load_dwordx4 v4, s[20:23], 0 offen lds
  s_add_u32 s50, s44, 11
  s_mul_i32 s51, s50, 41
  s_lshr_b32 s51, s51, 10
  s_mul_i32 s52, s51, 25
  s_sub_u32 s52, s50, s52
  s_lshl_b32 s53, s52, 6
  v_add_u32 v3, s53, v1
  v_mul_hi_u32 v4, v3, s48
  v_lshrrev_b32 v4, 3, v4
  v_mul_u32_u24 v5, 10, v4
  v_sub_u32 v5, v3, v5
  v_mul_u32_u24 v4, 5120, v4
  v_lshlrev_b32 v5, 4, v5
  s_mul_i32 s53, s51, 1280
  s_add_u32 s53, s53, s49
  v_add3_u32 v4, v4, v5, s53
  s_mul_i32 s53, s51, 25600
  s_and_b32 s54, s51, 1
  s_lshl_b32 s54, s54, 5
  s_add_u32 s53, s53, s54
  s_lshr_b32 s54, s51, 1
  s_lshl_b32 s54, s54, 7
  s_add_u32 s53, s53, s54
  s_lshl_b32 s52, s52, 10
  s_add_u32 s53, s53, s52
  s_add_u32 m0, s53, 60544
  s_nop 0
  buffer_load_dwordx4 v4, s[20:23], 0 offen lds
  s_add_u32 s50, s44, 12
  s_mul_i32 s51, s50, 41
  s_lshr_b32 s51, s51, 10
  s_mul_i32 s52, s51, 25
  s_sub_u32 s52, s50, s52
  s_lshl_b32 s53, s52, 6
  v_add_u32 v3, s53, v1
  v_mul_hi_u32 v4, v3, s48
  v_lshrrev_b32 v4, 3, v4
  v_mul_u32_u24 v5, 10, v4
  v_sub_u32 v5, v3, v5
  v_mul_u32_u24 v4, 5120, v4
  v_lshlrev_b32 v5, 4, v5
  s_mul_i32 s53, s51, 1280
  s_add_u32 s53, s53, s49
  v_add3_u32 v4, v4, v5, s53
  s_mul_i32 s53, s51, 25600
  s_and_b32 s54, s51, 1
  s_lshl_b32 s54, s54, 5
  s_add_u32 s53, s53, s54
  s_lshr_b32 s54, s51, 1
  s_lshl_b32 s54, s54, 7
  s_add_u32 s53, s53, s54
  s_lshl_b32 s52, s52, 10
  s_add_u32 s53, s53, s52
  s_add_u32 m0, s53, 60544
  s_nop 0
  buffer_load_dwordx4 v4, s[20:23], 0 offen lds
  s_add_u32 s50, s44, 13
  s_mul_i32 s51, s50, 41
  s_lshr_b32 s51, s51, 10
  s_mul_i32 s52, s51, 25
  s_sub_u32 s52, s50, s52
  s_lshl_b32 s53, s52, 6
  v_add_u32 v3, s53, v1
  v_mul_hi_u32 v4, v3, s48
  v_lshrrev_b32 v4, 3, v4
  v_mul_u32_u24 v5, 10, v4
  v_sub_u32 v5, v3, v5
  v_mul_u32_u24 v4, 5120, v4
  v_lshlrev_b32 v5, 4, v5
  s_mul_i32 s53, s51, 1280
  s_add_u32 s53, s53, s49
  v_add3_u32 v4, v4, v5, s53
  s_mul_i32 s53, s51, 25600
  s_and_b32 s54, s51, 1
  s_lshl_b32 s54, s54, 5
  s_add_u32 s53, s53, s54
  s_lshr_b32 s54, s51, 1
  s_lshl_b32 s54, s54, 7
  s_add_u32 s53, s53, s54
  s_lshl_b32 s52, s52, 10
  s_add_u32 s53, s53, s52
  s_add_u32 m0, s53, 60544
  s_nop 0
  buffer_load_dwordx4 v4, s[20:23], 0 offen lds
  s_add_u32 s50, s44, 14
  s_mul_i32 s51, s50, 41
  s_lshr_b32 s51, s51, 10
  s_mul_i32 s52, s51, 25
  s_sub_u32 s52, s50, s52
  s_lshl_b32 s53, s52, 6
  v_add_u32 v3, s53, v1
  v_mul_hi_u32 v4, v3, s48
  v_lshrrev_b32 v4, 3, v4
  v_mul_u32_u24 v5, 10, v4
  v_sub_u32 v5, v3, v5
  v_mul_u32_u24 v4, 5120, v4
  v_lshlrev_b32 v5, 4, v5
  s_mul_i32 s53, s51, 1280
  s_add_u32 s53, s53, s49
  v_add3_u32 v4, v4, v5, s53
  s_mul_i32 s53, s51, 25600
  s_and_b32 s54, s51, 1
  s_lshl_b32 s54, s54, 5
  s_add_u32 s53, s53, s54
  s_lshr_b32 s54, s51, 1
  s_lshl_b32 s54, s54, 7
  s_add_u32 s53, s53, s54
  s_lshl_b32 s52, s52, 10
  s_add_u32 s53, s53, s52
  s_add_u32 m0, s53, 60544
  s_nop 0
  buffer_load_dwordx4 v4, s[20:23], 0 offen lds
  s_add_u32 s50, s44, 15
  s_mul_i32 s51, s50, 41
  s_lshr_b32 s51, s51, 10
  s_mul_i32 s52, s51, 25
  s_sub_u32 s52, s50, s52
  s_lshl_b32 s53, s52, 6
  v_add_u32 v3, s53, v1
  v_mul_hi_u32 v4, v3, s48
  v_lshrrev_b32 v4, 3, v4
  v_mul_u32_u24 v5, 10, v4
  v_sub_u32 v5, v3, v5
  v_mul_u32_u24 v4, 5120, v4
  v_lshlrev_b32 v5, 4, v5
  s_mul_i32 s53, s51, 1280
  s_add_u32 s53, s53, s49
  v_add3_u32 v4, v4, v5, s53
  s_mul_i32 s53, s51, 25600
  s_and_b32 s54, s51, 1
  s_lshl_b32 s54, s54, 5
  s_add_u32 s53, s53, s54
  s_lshr_b32 s54, s51, 1
  s_lshl_b32 s54, s54, 7
  s_add_u32 s53, s53, s54
  s_lshl_b32 s52, s52, 10
  s_add_u32 s53, s53, s52
  s_add_u32 m0, s53, 60544
  s_nop 0
  buffer_load_dwordx4 v4, s[20:23], 0 offen lds
  s_add_u32 s50, s44, 16
  s_mul_i32 s51, s50, 41
  s_lshr_b32 s51, s51, 10
  s_mul_i32 s52, s51, 25
  s_sub_u32 s52, s50, s52
  s_lshl_b32 s53, s52, 6
  v_add_u32 v3, s53, v1
  v_mul_hi_u32 v4, v3, s48
  v_lshrrev_b32 v4, 3, v4
  v_mul_u32_u24 v5, 10, v4
  v_sub_u32 v5, v3, v5
  v_mul_u32_u24 v4, 5120, v4
  v_lshlrev_b32 v5, 4, v5
  s_mul_i32 s53, s51, 1280
  s_add_u32 s53, s53, s49
  v_add3_u32 v4, v4, v5, s53
  s_mul_i32 s53, s51, 25600
  s_and_b32 s54, s51, 1
  s_lshl_b32 s54, s54, 5
  s_add_u32 s53, s53, s54
  s_lshr_b32 s54, s51, 1
  s_lshl_b32 s54, s54, 7
  s_add_u32 s53, s53, s54
  s_lshl_b32 s52, s52, 10
  s_add_u32 s53, s53, s52
  s_add_u32 m0, s53, 60544
  s_nop 0
  buffer_load_dwordx4 v4, s[20:23], 0 offen lds
  s_add_u32 s50, s44, 17
  s_mul_i32 s51, s50, 41
  s_lshr_b32 s51, s51, 10
  s_mul_i32 s52, s51, 25
  s_sub_u32 s52, s50, s52
  s_lshl_b32 s53, s52, 6
  v_add_u32 v3, s53, v1
  v_mul_hi_u32 v4, v3, s48
  v_lshrrev_b32 v4, 3, v4
  v_mul_u32_u24 v5, 10, v4
  v_sub_u32 v5, v3, v5
  v_mul_u32_u24 v4, 5120, v4
  v_lshlrev_b32 v5, 4, v5
  s_mul_i32 s53, s51, 1280
  s_add_u32 s53, s53, s49
  v_add3_u32 v4, v4, v5, s53
  s_mul_i32 s53, s51, 25600
  s_and_b32 s54, s51, 1
  s_lshl_b32 s54, s54, 5
  s_add_u32 s53, s53, s54
  s_lshr_b32 s54, s51, 1
  s_lshl_b32 s54, s54, 7
  s_add_u32 s53, s53, s54
  s_lshl_b32 s52, s52, 10
  s_add_u32 s53, s53, s52
  s_add_u32 m0, s53, 60544
  s_nop 0
  buffer_load_dwordx4 v4, s[20:23], 0 offen lds
  s_add_u32 s50, s44, 18
  s_mul_i32 s51, s50, 41
  s_lshr_b32 s51, s51, 10
  s_mul_i32 s52, s51, 25
  s_sub_u32 s52, s50, s52
  s_lshl_b32 s53, s52, 6
  v_add_u32 v3, s53, v1
  v_mul_hi_u32 v4, v3, s48
  v_lshrrev_b32 v4, 3, v4
  v_mul_u32_u24 v5, 10, v4
  v_sub_u32 v5, v3, v5
  v_mul_u32_u24 v4, 5120, v4
  v_lshlrev_b32 v5, 4, v5
  s_mul_i32 s53, s51, 1280
  s_add_u32 s53, s53, s49
  v_add3_u32 v4, v4, v5, s53
  s_mul_i32 s53, s51, 25600
  s_and_b32 s54, s51, 1
  s_lshl_b32 s54, s54, 5
  s_add_u32 s53, s53, s54
  s_lshr_b32 s54, s51, 1
  s_lshl_b32 s54, s54, 7
  s_add_u32 s53, s53, s54
  s_lshl_b32 s52, s52, 10
  s_add_u32 s53, s53, s52
  s_add_u32 m0, s53, 60544
  s_nop 0
  buffer_load_dwordx4 v4, s[20:23], 0 offen lds
  s_add_u32 s50, s44, 19
  s_mul_i32 s51, s50, 41
  s_lshr_b32 s51, s51, 10
  s_mul_i32 s52, s51, 25
  s_sub_u32 s52, s50, s52
  s_lshl_b32 s53, s52, 6
  v_add_u32 v3, s53, v1
  v_mul_hi_u32 v4, v3, s48
  v_lshrrev_b32 v4, 3, v4
  v_mul_u32_u24 v5, 10, v4
  v_sub_u32 v5, v3, v5
  v_mul_u32_u24 v4, 5120, v4
  v_lshlrev_b32 v5, 4, v5
  s_mul_i32 s53, s51, 1280
  s_add_u32 s53, s53, s49
  v_add3_u32 v4, v4, v5, s53
  s_mul_i32 s53, s51, 25600
  s_and_b32 s54, s51, 1
  s_lshl_b32 s54, s54, 5
  s_add_u32 s53, s53, s54
  s_lshr_b32 s54, s51, 1
  s_lshl_b32 s54, s54, 7
  s_add_u32 s53, s53, s54
  s_lshl_b32 s52, s52, 10
  s_add_u32 s53, s53, s52
  s_add_u32 m0, s53, 60544
  s_nop 0
  buffer_load_dwordx4 v4, s[20:23], 0 offen lds
  s_add_u32 s50, s44, 20
  s_mul_i32 s51, s50, 41
  s_lshr_b32 s51, s51, 10
  s_mul_i32 s52, s51, 25
  s_sub_u32 s52, s50, s52
  s_lshl_b32 s53, s52, 6
  v_add_u32 v3, s53, v1
  v_mul_hi_u32 v4, v3, s48
  v_lshrrev_b32 v4, 3, v4
  v_mul_u32_u24 v5, 10, v4
  v_sub_u32 v5, v3, v5
  v_mul_u32_u24 v4, 5120, v4
  v_lshlrev_b32 v5, 4, v5
  s_mul_i32 s53, s51, 1280
  s_add_u32 s53, s53, s49
  v_add3_u32 v4, v4, v5, s53
  s_mul_i32 s53, s51, 25600
  s_and_b32 s54, s51, 1
  s_lshl_b32 s54, s54, 5
  s_add_u32 s53, s53, s54
  s_lshr_b32 s54, s51, 1
  s_lshl_b32 s54, s54, 7
  s_add_u32 s53, s53, s54
  s_lshl_b32 s52, s52, 10
  s_add_u32 s53, s53, s52
  s_add_u32 m0, s53, 60544
  s_nop 0
  buffer_load_dwordx4 v4, s[20:23], 0 offen lds
  s_add_u32 s50, s44, 21
  s_mul_i32 s51, s50, 41
  s_lshr_b32 s51, s51, 10
  s_mul_i32 s52, s51, 25
  s_sub_u32 s52, s50, s52
  s_lshl_b32 s53, s52, 6
  v_add_u32 v3, s53, v1
  v_mul_hi_u32 v4, v3, s48
  v_lshrrev_b32 v4, 3, v4
  v_mul_u32_u24 v5, 10, v4
  v_sub_u32 v5, v3, v5
  v_mul_u32_u24 v4, 5120, v4
  v_lshlrev_b32 v5, 4, v5
  s_mul_i32 s53, s51, 1280
  s_add_u32 s53, s53, s49
  v_add3_u32 v4, v4, v5, s53
  s_mul_i32 s53, s51, 25600
  s_and_b32 s54, s51, 1
  s_lshl_b32 s54, s54, 5
  s_add_u32 s53, s53, s54
  s_lshr_b32 s54, s51, 1
  s_lshl_b32 s54, s54, 7
  s_add_u32 s53, s53, s54
  s_lshl_b32 s52, s52, 10
  s_add_u32 s53, s53, s52
  s_add_u32 m0, s53, 60544
  s_nop 0
  buffer_load_dwordx4 v4, s[20:23], 0 offen lds
  s_add_u32 s50, s44, 22
  s_mul_i32 s51, s50, 41
  s_lshr_b32 s51, s51, 10
  s_mul_i32 s52, s51, 25
  s_sub_u32 s52, s50, s52
  s_lshl_b32 s53, s52, 6
  v_add_u32 v3, s53, v1
  v_mul_hi_u32 v4, v3, s48
  v_lshrrev_b32 v4, 3, v4
  v_mul_u32_u24 v5, 10, v4
  v_sub_u32 v5, v3, v5
  v_mul_u32_u24 v4, 5120, v4
  v_lshlrev_b32 v5, 4, v5
  s_mul_i32 s53, s51, 1280
  s_add_u32 s53, s53, s49
  v_add3_u32 v4, v4, v5, s53
  s_mul_i32 s53, s51, 25600
  s_and_b32 s54, s51, 1
  s_lshl_b32 s54, s54, 5
  s_add_u32 s53, s53, s54
  s_lshr_b32 s54, s51, 1
  s_lshl_b32 s54, s54, 7
  s_add_u32 s53, s53, s54
  s_lshl_b32 s52, s52, 10
  s_add_u32 s53, s53, s52
  s_add_u32 m0, s53, 60544
  s_nop 0
  buffer_load_dwordx4 v4, s[20:23], 0 offen lds
  s_add_u32 s50, s44, 23
  s_mul_i32 s51, s50, 41
  s_lshr_b32 s51, s51, 10
  s_mul_i32 s52, s51, 25
  s_sub_u32 s52, s50, s52
  s_lshl_b32 s53, s52, 6
  v_add_u32 v3, s53, v1
  v_mul_hi_u32 v4, v3, s48
  v_lshrrev_b32 v4, 3, v4
  v_mul_u32_u24 v5, 10, v4
  v_sub_u32 v5, v3, v5
  v_mul_u32_u24 v4, 5120, v4
  v_lshlrev_b32 v5, 4, v5
  s_mul_i32 s53, s51, 1280
  s_add_u32 s53, s53, s49
  v_add3_u32 v4, v4, v5, s53
  s_mul_i32 s53, s51, 25600
  s_and_b32 s54, s51, 1
  s_lshl_b32 s54, s54, 5
  s_add_u32 s53, s53, s54
  s_lshr_b32 s54, s51, 1
  s_lshl_b32 s54, s54, 7
  s_add_u32 s53, s53, s54
  s_lshl_b32 s52, s52, 10
  s_add_u32 s53, s53, s52
  s_add_u32 m0, s53, 60544
  s_nop 0
  buffer_load_dwordx4 v4, s[20:23], 0 offen lds
  s_add_u32 s50, s44, 24
  s_mul_i32 s51, s50, 41
  s_lshr_b32 s51, s51, 10
  s_mul_i32 s52, s51, 25
  s_sub_u32 s52, s50, s52
  s_lshl_b32 s53, s52, 6
  v_add_u32 v3, s53, v1
  v_mul_hi_u32 v4, v3, s48
  v_lshrrev_b32 v4, 3, v4
  v_mul_u32_u24 v5, 10, v4
  v_sub_u32 v5, v3, v5
  v_mul_u32_u24 v4, 5120, v4
  v_lshlrev_b32 v5, 4, v5
  s_mul_i32 s53, s51, 1280
  s_add_u32 s53, s53, s49
  v_add3_u32 v4, v4, v5, s53
  s_mul_i32 s53, s51, 25600
  s_and_b32 s54, s51, 1
  s_lshl_b32 s54, s54, 5
  s_add_u32 s53, s53, s54
  s_lshr_b32 s54, s51, 1
  s_lshl_b32 s54, s54, 7
  s_add_u32 s53, s53, s54
  s_lshl_b32 s52, s52, 10
  s_add_u32 s53, s53, s52
  s_add_u32 m0, s53, 60544
  s_nop 0
  buffer_load_dwordx4 v4, s[20:23], 0 offen lds
  s_add_u32 s50, s44, 25
  s_mul_i32 s51, s50, 41
  s_lshr_b32 s51, s51, 10
  s_mul_i32 s52, s51, 25
  s_sub_u32 s52, s50, s52
  s_lshl_b32 s53, s52, 6
  v_add_u32 v3, s53, v1
  v_mul_hi_u32 v4, v3, s48
  v_lshrrev_b32 v4, 3, v4
  v_mul_u32_u24 v5, 10, v4
  v_sub_u32 v5, v3, v5
  v_mul_u32_u24 v4, 5120, v4
  v_lshlrev_b32 v5, 4, v5
  s_mul_i32 s53, s51, 1280
  s_add_u32 s53, s53, s49
  v_add3_u32 v4, v4, v5, s53
  s_mul_i32 s53, s51, 25600
  s_and_b32 s54, s51, 1
  s_lshl_b32 s54, s54, 5
  s_add_u32 s53, s53, s54
  s_lshr_b32 s54, s51, 1
  s_lshl_b32 s54, s54, 7
  s_add_u32 s53, s53, s54
  s_lshl_b32 s52, s52, 10
  s_add_u32 s53, s53, s52
  s_add_u32 m0, s53, 60544
  s_nop 0
  buffer_load_dwordx4 v4, s[20:23], 0 offen lds
  s_add_u32 s50, s44, 26
  s_mul_i32 s51, s50, 41
  s_lshr_b32 s51, s51, 10
  s_mul_i32 s52, s51, 25
  s_sub_u32 s52, s50, s52
  s_lshl_b32 s53, s52, 6
  v_add_u32 v3, s53, v1
  v_mul_hi_u32 v4, v3, s48
  v_lshrrev_b32 v4, 3, v4
  v_mul_u32_u24 v5, 10, v4
  v_sub_u32 v5, v3, v5
  v_mul_u32_u24 v4, 5120, v4
  v_lshlrev_b32 v5, 4, v5
  s_mul_i32 s53, s51, 1280
  s_add_u32 s53, s53, s49
  v_add3_u32 v4, v4, v5, s53
  s_mul_i32 s53, s51, 25600
  s_and_b32 s54, s51, 1
  s_lshl_b32 s54, s54, 5
  s_add_u32 s53, s53, s54
  s_lshr_b32 s54, s51, 1
  s_lshl_b32 s54, s54, 7
  s_add_u32 s53, s53, s54
  s_lshl_b32 s52, s52, 10
  s_add_u32 s53, s53, s52
  s_add_u32 m0, s53, 60544
  s_nop 0
  buffer_load_dwordx4 v4, s[20:23], 0 offen lds
  s_add_u32 s50, s44, 27
  s_mul_i32 s51, s50, 41
  s_lshr_b32 s51, s51, 10
  s_mul_i32 s52, s51, 25
  s_sub_u32 s52, s50, s52
  s_lshl_b32 s53, s52, 6
  v_add_u32 v3, s53, v1
  v_mul_hi_u32 v4, v3, s48
  v_lshrrev_b32 v4, 3, v4
  v_mul_u32_u24 v5, 10, v4
  v_sub_u32 v5, v3, v5
  v_mul_u32_u24 v4, 5120, v4
  v_lshlrev_b32 v5, 4, v5
  s_mul_i32 s53, s51, 1280
  s_add_u32 s53, s53, s49
  v_add3_u32 v4, v4, v5, s53
  s_mul_i32 s53, s51, 25600
  s_and_b32 s54, s51, 1
  s_lshl_b32 s54, s54, 5
  s_add_u32 s53, s53, s54
  s_lshr_b32 s54, s51, 1
  s_lshl_b32 s54, s54, 7
  s_add_u32 s53, s53, s54
  s_lshl_b32 s52, s52, 10
  s_add_u32 s53, s53, s52
  s_add_u32 m0, s53, 60544
  s_nop 0
  buffer_load_dwordx4 v4, s[20:23], 0 offen lds
  s_add_u32 s50, s44, 28
  s_mul_i32 s51, s50, 41
  s_lshr_b32 s51, s51, 10
  s_mul_i32 s52, s51, 25
  s_sub_u32 s52, s50, s52
  s_lshl_b32 s53, s52, 6
  v_add_u32 v3, s53, v1
  v_mul_hi_u32 v4, v3, s48
  v_lshrrev_b32 v4, 3, v4
  v_mul_u32_u24 v5, 10, v4
  v_sub_u32 v5, v3, v5
  v_mul_u32_u24 v4, 5120, v4
  v_lshlrev_b32 v5, 4, v5
  s_mul_i32 s53, s51, 1280
  s_add_u32 s53, s53, s49
  v_add3_u32 v4, v4, v5, s53
  s_mul_i32 s53, s51, 25600
  s_and_b32 s54, s51, 1
  s_lshl_b32 s54, s54, 5
  s_add_u32 s53, s53, s54
  s_lshr_b32 s54, s51, 1
  s_lshl_b32 s54, s54, 7
  s_add_u32 s53, s53, s54
  s_lshl_b32 s52, s52, 10
  s_add_u32 s53, s53, s52
  s_add_u32 m0, s53, 60544
  s_nop 0
  buffer_load_dwordx4 v4, s[20:23], 0 offen lds
  s_add_u32 s50, s44, 29
  s_mul_i32 s51, s50, 41
  s_lshr_b32 s51, s51, 10
  s_mul_i32 s52, s51, 25
  s_sub_u32 s52, s50, s52
  s_lshl_b32 s53, s52, 6
  v_add_u32 v3, s53, v1
  v_mul_hi_u32 v4, v3, s48
  v_lshrrev_b32 v4, 3, v4
  v_mul_u32_u24 v5, 10, v4
  v_sub_u32 v5, v3, v5
  v_mul_u32_u24 v4, 5120, v4
  v_lshlrev_b32 v5, 4, v5
  s_mul_i32 s53, s51, 1280
  s_add_u32 s53, s53, s49
  v_add3_u32 v4, v4, v5, s53
  s_mul_i32 s53, s51, 25600
  s_and_b32 s54, s51, 1
  s_lshl_b32 s54, s54, 5
  s_add_u32 s53, s53, s54
  s_lshr_b32 s54, s51, 1
  s_lshl_b32 s54, s54, 7
  s_add_u32 s53, s53, s54
  s_lshl_b32 s52, s52, 10
  s_add_u32 s53, s53, s52
  s_add_u32 m0, s53, 60544
  s_nop 0
  buffer_load_dwordx4 v4, s[20:23], 0 offen lds
  s_add_u32 s50, s44, 30
  s_mul_i32 s51, s50, 41
  s_lshr_b32 s51, s51, 10
  s_mul_i32 s52, s51, 25
  s_sub_u32 s52, s50, s52
  s_lshl_b32 s53, s52, 6
  v_add_u32 v3, s53, v1
  v_mul_hi_u32 v4, v3, s48
  v_lshrrev_b32 v4, 3, v4
  v_mul_u32_u24 v5, 10, v4
  v_sub_u32 v5, v3, v5
  v_mul_u32_u24 v4, 5120, v4
  v_lshlrev_b32 v5, 4, v5
  s_mul_i32 s53, s51, 1280
  s_add_u32 s53, s53, s49
  v_add3_u32 v4, v4, v5, s53
  s_mul_i32 s53, s51, 25600
  s_and_b32 s54, s51, 1
  s_lshl_b32 s54, s54, 5
  s_add_u32 s53, s53, s54
  s_lshr_b32 s54, s51, 1
  s_lshl_b32 s54, s54, 7
  s_add_u32 s53, s53, s54
  s_lshl_b32 s52, s52, 10
  s_add_u32 s53, s53, s52
  s_add_u32 m0, s53, 60544
  s_nop 0
  buffer_load_dwordx4 v4, s[20:23], 0 offen lds
  s_add_u32 s50, s44, 31
  s_mul_i32 s51, s50, 41
  s_lshr_b32 s51, s51, 10
  s_mul_i32 s52, s51, 25
  s_sub_u32 s52, s50, s52
  s_lshl_b32 s53, s52, 6
  v_add_u32 v3, s53, v1
  v_mul_hi_u32 v4, v3, s48
  v_lshrrev_b32 v4, 3, v4
  v_mul_u32_u24 v5, 10, v4
  v_sub_u32 v5, v3, v5
  v_mul_u32_u24 v4, 5120, v4
  v_lshlrev_b32 v5, 4, v5
  s_mul_i32 s53, s51, 1280
  s_add_u32 s53, s53, s49
  v_add3_u32 v4, v4, v5, s53
  s_mul_i32 s53, s51, 25600
  s_and_b32 s54, s51, 1
  s_lshl_b32 s54, s54, 5
  s_add_u32 s53, s53, s54
  s_lshr_b32 s54, s51, 1
  s_lshl_b32 s54, s54, 7
  s_add_u32 s53, s53, s54
  s_lshl_b32 s52, s52, 10
  s_add_u32 s53, s53, s52
  s_add_u32 m0, s53, 60544
  s_nop 0
  buffer_load_dwordx4 v4, s[20:23], 0 offen lds
  s_add_u32 s50, s44, 32
  s_mul_i32 s51, s50, 41
  s_lshr_b32 s51, s51, 10
  s_mul_i32 s52, s51, 25
  s_sub_u32 s52, s50, s52
  s_lshl_b32 s53, s52, 6
  v_add_u32 v3, s53, v1
  v_mul_hi_u32 v4, v3, s48
  v_lshrrev_b32 v4, 3, v4
  v_mul_u32_u24 v5, 10, v4
  v_sub_u32 v5, v3, v5
  v_mul_u32_u24 v4, 5120, v4
  v_lshlrev_b32 v5, 4, v5
  s_mul_i32 s53, s51, 1280
  s_add_u32 s53, s53, s49
  v_add3_u32 v4, v4, v5, s53
  s_mul_i32 s53, s51, 25600
  s_and_b32 s54, s51, 1
  s_lshl_b32 s54, s54, 5
  s_add_u32 s53, s53, s54
  s_lshr_b32 s54, s51, 1
  s_lshl_b32 s54, s54, 7
  s_add_u32 s53, s53, s54
  s_lshl_b32 s52, s52, 10
  s_add_u32 s53, s53, s52
  s_add_u32 m0, s53, 60544
  s_nop 0
  buffer_load_dwordx4 v4, s[20:23], 0 offen lds
  s_add_u32 s50, s44, 33
  s_mul_i32 s51, s50, 41
  s_lshr_b32 s51, s51, 10
  s_mul_i32 s52, s51, 25
  s_sub_u32 s52, s50, s52
  s_lshl_b32 s53, s52, 6
  v_add_u32 v3, s53, v1
  v_mul_hi_u32 v4, v3, s48
  v_lshrrev_b32 v4, 3, v4
  v_mul_u32_u24 v5, 10, v4
  v_sub_u32 v5, v3, v5
  v_mul_u32_u24 v4, 5120, v4
  v_lshlrev_b32 v5, 4, v5
  s_mul_i32 s53, s51, 1280
  s_add_u32 s53, s53, s49
  v_add3_u32 v4, v4, v5, s53
  s_mul_i32 s53, s51, 25600
  s_and_b32 s54, s51, 1
  s_lshl_b32 s54, s54, 5
  s_add_u32 s53, s53, s54
  s_lshr_b32 s54, s51, 1
  s_lshl_b32 s54, s54, 7
  s_add_u32 s53, s53, s54
  s_lshl_b32 s52, s52, 10
  s_add_u32 s53, s53, s52
  s_add_u32 m0, s53, 60544
  s_nop 0
  buffer_load_dwordx4 v4, s[20:23], 0 offen lds
  s_add_u32 s50, s44, 34
  s_mul_i32 s51, s50, 41
  s_lshr_b32 s51, s51, 10
  s_mul_i32 s52, s51, 25
  s_sub_u32 s52, s50, s52
  s_lshl_b32 s53, s52, 6
  v_add_u32 v3, s53, v1
  v_mul_hi_u32 v4, v3, s48
  v_lshrrev_b32 v4, 3, v4
  v_mul_u32_u24 v5, 10, v4
  v_sub_u32 v5, v3, v5
  v_mul_u32_u24 v4, 5120, v4
  v_lshlrev_b32 v5, 4, v5
  s_mul_i32 s53, s51, 1280
  s_add_u32 s53, s53, s49
  v_add3_u32 v4, v4, v5, s53
  s_mul_i32 s53, s51, 25600
  s_and_b32 s54, s51, 1
  s_lshl_b32 s54, s54, 5
  s_add_u32 s53, s53, s54
  s_lshr_b32 s54, s51, 1
  s_lshl_b32 s54, s54, 7
  s_add_u32 s53, s53, s54
  s_lshl_b32 s52, s52, 10
  s_add_u32 s53, s53, s52
  s_add_u32 m0, s53, 60544
  s_nop 0
  buffer_load_dwordx4 v4, s[20:23], 0 offen lds
  s_add_u32 s50, s44, 35
  s_mul_i32 s51, s50, 41
  s_lshr_b32 s51, s51, 10
  s_mul_i32 s52, s51, 25
  s_sub_u32 s52, s50, s52
  s_lshl_b32 s53, s52, 6
  v_add_u32 v3, s53, v1
  v_mul_hi_u32 v4, v3, s48
  v_lshrrev_b32 v4, 3, v4
  v_mul_u32_u24 v5, 10, v4
  v_sub_u32 v5, v3, v5
  v_mul_u32_u24 v4, 5120, v4
  v_lshlrev_b32 v5, 4, v5
  s_mul_i32 s53, s51, 1280
  s_add_u32 s53, s53, s49
  v_add3_u32 v4, v4, v5, s53
  s_mul_i32 s53, s51, 25600
  s_and_b32 s54, s51, 1
  s_lshl_b32 s54, s54, 5
  s_add_u32 s53, s53, s54
  s_lshr_b32 s54, s51, 1
  s_lshl_b32 s54, s54, 7
  s_add_u32 s53, s53, s54
  s_lshl_b32 s52, s52, 10
  s_add_u32 s53, s53, s52
  s_add_u32 m0, s53, 60544
  s_nop 0
  buffer_load_dwordx4 v4, s[20:23], 0 offen lds
  s_add_u32 s50, s44, 36
  s_mul_i32 s51, s50, 41
  s_lshr_b32 s51, s51, 10
  s_mul_i32 s52, s51, 25
  s_sub_u32 s52, s50, s52
  s_lshl_b32 s53, s52, 6
  v_add_u32 v3, s53, v1
  v_mul_hi_u32 v4, v3, s48
  v_lshrrev_b32 v4, 3, v4
  v_mul_u32_u24 v5, 10, v4
  v_sub_u32 v5, v3, v5
  v_mul_u32_u24 v4, 5120, v4
  v_lshlrev_b32 v5, 4, v5
  s_mul_i32 s53, s51, 1280
  s_add_u32 s53, s53, s49
  v_add3_u32 v4, v4, v5, s53
  s_mul_i32 s53, s51, 25600
  s_and_b32 s54, s51, 1
  s_lshl_b32 s54, s54, 5
  s_add_u32 s53, s53, s54
  s_lshr_b32 s54, s51, 1
  s_lshl_b32 s54, s54, 7
  s_add_u32 s53, s53, s54
  s_lshl_b32 s52, s52, 10
  s_add_u32 s53, s53, s52
  s_add_u32 m0, s53, 60544
  s_nop 0
  buffer_load_dwordx4 v4, s[20:23], 0 offen lds
  s_add_u32 s50, s44, 37
  s_mul_i32 s51, s50, 41
  s_lshr_b32 s51, s51, 10
  s_mul_i32 s52, s51, 25
  s_sub_u32 s52, s50, s52
  s_lshl_b32 s53, s52, 6
  v_add_u32 v3, s53, v1
  v_mul_hi_u32 v4, v3, s48
  v_lshrrev_b32 v4, 3, v4
  v_mul_u32_u24 v5, 10, v4
  v_sub_u32 v5, v3, v5
  v_mul_u32_u24 v4, 5120, v4
  v_lshlrev_b32 v5, 4, v5
  s_mul_i32 s53, s51, 1280
  s_add_u32 s53, s53, s49
  v_add3_u32 v4, v4, v5, s53
  s_mul_i32 s53, s51, 25600
  s_and_b32 s54, s51, 1
  s_lshl_b32 s54, s54, 5
  s_add_u32 s53, s53, s54
  s_lshr_b32 s54, s51, 1
  s_lshl_b32 s54, s54, 7
  s_add_u32 s53, s53, s54
  s_lshl_b32 s52, s52, 10
  s_add_u32 s53, s53, s52
  s_add_u32 m0, s53, 60544
  s_nop 0
  buffer_load_dwordx4 v4, s[20:23], 0 offen lds
  s_add_u32 s50, s44, 38
  s_mul_i32 s51, s50, 41
  s_lshr_b32 s51, s51, 10
  s_mul_i32 s52, s51, 25
  s_sub_u32 s52, s50, s52
  s_lshl_b32 s53, s52, 6
  v_add_u32 v3, s53, v1
  v_mul_hi_u32 v4, v3, s48
  v_lshrrev_b32 v4, 3, v4
  v_mul_u32_u24 v5, 10, v4
  v_sub_u32 v5, v3, v5
  v_mul_u32_u24 v4, 5120, v4
  v_lshlrev_b32 v5, 4, v5
  s_mul_i32 s53, s51, 1280
  s_add_u32 s53, s53, s49
  v_add3_u32 v4, v4, v5, s53
  s_mul_i32 s53, s51, 25600
  s_and_b32 s54, s51, 1
  s_lshl_b32 s54, s54, 5
  s_add_u32 s53, s53, s54
  s_lshr_b32 s54, s51, 1
  s_lshl_b32 s54, s54, 7
  s_add_u32 s53, s53, s54
  s_lshl_b32 s52, s52, 10
  s_add_u32 s53, s53, s52
  s_add_u32 m0, s53, 60544
  s_nop 0
  buffer_load_dwordx4 v4, s[20:23], 0 offen lds
  s_add_u32 s50, s44, 39
  s_mul_i32 s51, s50, 41
  s_lshr_b32 s51, s51, 10
  s_mul_i32 s52, s51, 25
  s_sub_u32 s52, s50, s52
  s_lshl_b32 s53, s52, 6
  v_add_u32 v3, s53, v1
  v_mul_hi_u32 v4, v3, s48
  v_lshrrev_b32 v4, 3, v4
  v_mul_u32_u24 v5, 10, v4
  v_sub_u32 v5, v3, v5
  v_mul_u32_u24 v4, 5120, v4
  v_lshlrev_b32 v5, 4, v5
  s_mul_i32 s53, s51, 1280
  s_add_u32 s53, s53, s49
  v_add3_u32 v4, v4, v5, s53
  s_mul_i32 s53, s51, 25600
  s_and_b32 s54, s51, 1
  s_lshl_b32 s54, s54, 5
  s_add_u32 s53, s53, s54
  s_lshr_b32 s54, s51, 1
  s_lshl_b32 s54, s54, 7
  s_add_u32 s53, s53, s54
  s_lshl_b32 s52, s52, 10
  s_add_u32 s53, s53, s52
  s_add_u32 m0, s53, 60544
  s_nop 0
  buffer_load_dwordx4 v4, s[20:23], 0 offen lds
  s_add_u32 s50, s44, 40
  s_mul_i32 s51, s50, 41
  s_lshr_b32 s51, s51, 10
  s_mul_i32 s52, s51, 25
  s_sub_u32 s52, s50, s52
  s_lshl_b32 s53, s52, 6
  v_add_u32 v3, s53, v1
  v_mul_hi_u32 v4, v3, s48
  v_lshrrev_b32 v4, 3, v4
  v_mul_u32_u24 v5, 10, v4
  v_sub_u32 v5, v3, v5
  v_mul_u32_u24 v4, 5120, v4
  v_lshlrev_b32 v5, 4, v5
  s_mul_i32 s53, s51, 1280
  s_add_u32 s53, s53, s49
  v_add3_u32 v4, v4, v5, s53
  s_mul_i32 s53, s51, 25600
  s_and_b32 s54, s51, 1
  s_lshl_b32 s54, s54, 5
  s_add_u32 s53, s53, s54
  s_lshr_b32 s54, s51, 1
  s_lshl_b32 s54, s54, 7
  s_add_u32 s53, s53, s54
  s_lshl_b32 s52, s52, 10
  s_add_u32 s53, s53, s52
  s_add_u32 m0, s53, 60544
  s_nop 0
  buffer_load_dwordx4 v4, s[20:23], 0 offen lds
  s_add_u32 s50, s44, 41
  s_mul_i32 s51, s50, 41
  s_lshr_b32 s51, s51, 10
  s_mul_i32 s52, s51, 25
  s_sub_u32 s52, s50, s52
  s_lshl_b32 s53, s52, 6
  v_add_u32 v3, s53, v1
  v_mul_hi_u32 v4, v3, s48
  v_lshrrev_b32 v4, 3, v4
  v_mul_u32_u24 v5, 10, v4
  v_sub_u32 v5, v3, v5
  v_mul_u32_u24 v4, 5120, v4
  v_lshlrev_b32 v5, 4, v5
  s_mul_i32 s53, s51, 1280
  s_add_u32 s53, s53, s49
  v_add3_u32 v4, v4, v5, s53
  s_mul_i32 s53, s51, 25600
  s_and_b32 s54, s51, 1
  s_lshl_b32 s54, s54, 5
  s_add_u32 s53, s53, s54
  s_lshr_b32 s54, s51, 1
  s_lshl_b32 s54, s54, 7
  s_add_u32 s53, s53, s54
  s_lshl_b32 s52, s52, 10
  s_add_u32 s53, s53, s52
  s_add_u32 m0, s53, 60544
  s_nop 0
  buffer_load_dwordx4 v4, s[20:23], 0 offen lds
  s_add_u32 s50, s44, 42
  s_mul_i32 s51, s50, 41
  s_lshr_b32 s51, s51, 10
  s_mul_i32 s52, s51, 25
  s_sub_u32 s52, s50, s52
  s_lshl_b32 s53, s52, 6
  v_add_u32 v3, s53, v1
  v_mul_hi_u32 v4, v3, s48
  v_lshrrev_b32 v4, 3, v4
  v_mul_u32_u24 v5, 10, v4
  v_sub_u32 v5, v3, v5
  v_mul_u32_u24 v4, 5120, v4
  v_lshlrev_b32 v5, 4, v5
  s_mul_i32 s53, s51, 1280
  s_add_u32 s53, s53, s49
  v_add3_u32 v4, v4, v5, s53
  s_mul_i32 s53, s51, 25600
  s_and_b32 s54, s51, 1
  s_lshl_b32 s54, s54, 5
  s_add_u32 s53, s53, s54
  s_lshr_b32 s54, s51, 1
  s_lshl_b32 s54, s54, 7
  s_add_u32 s53, s53, s54
  s_lshl_b32 s52, s52, 10
  s_add_u32 s53, s53, s52
  s_add_u32 m0, s53, 60544
  s_nop 0
  buffer_load_dwordx4 v4, s[20:23], 0 offen lds
  s_add_u32 s50, s44, 43
  s_mul_i32 s51, s50, 41
  s_lshr_b32 s51, s51, 10
  s_mul_i32 s52, s51, 25
  s_sub_u32 s52, s50, s52
  s_lshl_b32 s53, s52, 6
  v_add_u32 v3, s53, v1
  v_mul_hi_u32 v4, v3, s48
  v_lshrrev_b32 v4, 3, v4
  v_mul_u32_u24 v5, 10, v4
  v_sub_u32 v5, v3, v5
  v_mul_u32_u24 v4, 5120, v4
  v_lshlrev_b32 v5, 4, v5
  s_mul_i32 s53, s51, 1280
  s_add_u32 s53, s53, s49
  v_add3_u32 v4, v4, v5, s53
  s_mul_i32 s53, s51, 25600
  s_and_b32 s54, s51, 1
  s_lshl_b32 s54, s54, 5
  s_add_u32 s53, s53, s54
  s_lshr_b32 s54, s51, 1
  s_lshl_b32 s54, s54, 7
  s_add_u32 s53, s53, s54
  s_lshl_b32 s52, s52, 10
  s_add_u32 s53, s53, s52
  s_add_u32 m0, s53, 60544
  s_nop 0
  buffer_load_dwordx4 v4, s[20:23], 0 offen lds
  s_add_u32 s50, s44, 44
  s_mul_i32 s51, s50, 41
  s_lshr_b32 s51, s51, 10
  s_mul_i32 s52, s51, 25
  s_sub_u32 s52, s50, s52
  s_lshl_b32 s53, s52, 6
  v_add_u32 v3, s53, v1
  v_mul_hi_u32 v4, v3, s48
  v_lshrrev_b32 v4, 3, v4
  v_mul_u32_u24 v5, 10, v4
  v_sub_u32 v5, v3, v5
  v_mul_u32_u24 v4, 5120, v4
  v_lshlrev_b32 v5, 4, v5
  s_mul_i32 s53, s51, 1280
  s_add_u32 s53, s53, s49
  v_add3_u32 v4, v4, v5, s53
  s_mul_i32 s53, s51, 25600
  s_and_b32 s54, s51, 1
  s_lshl_b32 s54, s54, 5
  s_add_u32 s53, s53, s54
  s_lshr_b32 s54, s51, 1
  s_lshl_b32 s54, s54, 7
  s_add_u32 s53, s53, s54
  s_lshl_b32 s52, s52, 10
  s_add_u32 s53, s53, s52
  s_add_u32 m0, s53, 60544
  s_nop 0
  buffer_load_dwordx4 v4, s[20:23], 0 offen lds
  s_add_u32 s50, s44, 45
  s_mul_i32 s51, s50, 41
  s_lshr_b32 s51, s51, 10
  s_mul_i32 s52, s51, 25
  s_sub_u32 s52, s50, s52
  s_lshl_b32 s53, s52, 6
  v_add_u32 v3, s53, v1
  v_mul_hi_u32 v4, v3, s48
  v_lshrrev_b32 v4, 3, v4
  v_mul_u32_u24 v5, 10, v4
  v_sub_u32 v5, v3, v5
  v_mul_u32_u24 v4, 5120, v4
  v_lshlrev_b32 v5, 4, v5
  s_mul_i32 s53, s51, 1280
  s_add_u32 s53, s53, s49
  v_add3_u32 v4, v4, v5, s53
  s_mul_i32 s53, s51, 25600
  s_and_b32 s54, s51, 1
  s_lshl_b32 s54, s54, 5
  s_add_u32 s53, s53, s54
  s_lshr_b32 s54, s51, 1
  s_lshl_b32 s54, s54, 7
  s_add_u32 s53, s53, s54
  s_lshl_b32 s52, s52, 10
  s_add_u32 s53, s53, s52
  s_add_u32 m0, s53, 60544
  s_nop 0
  buffer_load_dwordx4 v4, s[20:23], 0 offen lds
  s_add_u32 s50, s44, 46
  s_mul_i32 s51, s50, 41
  s_lshr_b32 s51, s51, 10
  s_mul_i32 s52, s51, 25
  s_sub_u32 s52, s50, s52
  s_lshl_b32 s53, s52, 6
  v_add_u32 v3, s53, v1
  v_mul_hi_u32 v4, v3, s48
  v_lshrrev_b32 v4, 3, v4
  v_mul_u32_u24 v5, 10, v4
  v_sub_u32 v5, v3, v5
  v_mul_u32_u24 v4, 5120, v4
  v_lshlrev_b32 v5, 4, v5
  s_mul_i32 s53, s51, 1280
  s_add_u32 s53, s53, s49
  v_add3_u32 v4, v4, v5, s53
  s_mul_i32 s53, s51, 25600
  s_and_b32 s54, s51, 1
  s_lshl_b32 s54, s54, 5
  s_add_u32 s53, s53, s54
  s_lshr_b32 s54, s51, 1
  s_lshl_b32 s54, s54, 7
  s_add_u32 s53, s53, s54
  s_lshl_b32 s52, s52, 10
  s_add_u32 s53, s53, s52
  s_add_u32 m0, s53, 60544
  s_nop 0
  buffer_load_dwordx4 v4, s[20:23], 0 offen lds
  s_add_u32 s50, s44, 47
  s_mul_i32 s51, s50, 41
  s_lshr_b32 s51, s51, 10
  s_mul_i32 s52, s51, 25
  s_sub_u32 s52, s50, s52
  s_lshl_b32 s53, s52, 6
  v_add_u32 v3, s53, v1
  v_mul_hi_u32 v4, v3, s48
  v_lshrrev_b32 v4, 3, v4
  v_mul_u32_u24 v5, 10, v4
  v_sub_u32 v5, v3, v5
  v_mul_u32_u24 v4, 5120, v4
  v_lshlrev_b32 v5, 4, v5
  s_mul_i32 s53, s51, 1280
  s_add_u32 s53, s53, s49
  v_add3_u32 v4, v4, v5, s53
  s_mul_i32 s53, s51, 25600
  s_and_b32 s54, s51, 1
  s_lshl_b32 s54, s54, 5
  s_add_u32 s53, s53, s54
  s_lshr_b32 s54, s51, 1
  s_lshl_b32 s54, s54, 7
  s_add_u32 s53, s53, s54
  s_lshl_b32 s52, s52, 10
  s_add_u32 s53, s53, s52
  s_add_u32 m0, s53, 60544
  s_nop 0
  buffer_load_dwordx4 v4, s[20:23], 0 offen lds
  s_add_u32 s50, s44, 48
  s_mul_i32 s51, s50, 41
  s_lshr_b32 s51, s51, 10
  s_mul_i32 s52, s51, 25
  s_sub_u32 s52, s50, s52
  s_lshl_b32 s53, s52, 6
  v_add_u32 v3, s53, v1
  v_mul_hi_u32 v4, v3, s48
  v_lshrrev_b32 v4, 3, v4
  v_mul_u32_u24 v5, 10, v4
  v_sub_u32 v5, v3, v5
  v_mul_u32_u24 v4, 5120, v4
  v_lshlrev_b32 v5, 4, v5
  s_mul_i32 s53, s51, 1280
  s_add_u32 s53, s53, s49
  v_add3_u32 v4, v4, v5, s53
  s_mul_i32 s53, s51, 25600
  s_and_b32 s54, s51, 1
  s_lshl_b32 s54, s54, 5
  s_add_u32 s53, s53, s54
  s_lshr_b32 s54, s51, 1
  s_lshl_b32 s54, s54, 7
  s_add_u32 s53, s53, s54
  s_lshl_b32 s52, s52, 10
  s_add_u32 s53, s53, s52
  s_add_u32 m0, s53, 60544
  s_nop 0
  buffer_load_dwordx4 v4, s[20:23], 0 offen lds
  s_add_u32 s50, s44, 49
  s_mul_i32 s51, s50, 41
  s_lshr_b32 s51, s51, 10
  s_mul_i32 s52, s51, 25
  s_sub_u32 s52, s50, s52
  s_lshl_b32 s53, s52, 6
  v_add_u32 v3, s53, v1
  v_mul_hi_u32 v4, v3, s48
  v_lshrrev_b32 v4, 3, v4
  v_mul_u32_u24 v5, 10, v4
  v_sub_u32 v5, v3, v5
  v_mul_u32_u24 v4, 5120, v4
  v_lshlrev_b32 v5, 4, v5
  s_mul_i32 s53, s51, 1280
  s_add_u32 s53, s53, s49
  v_add3_u32 v4, v4, v5, s53
  s_mul_i32 s53, s51, 25600
  s_and_b32 s54, s51, 1
  s_lshl_b32 s54, s54, 5
  s_add_u32 s53, s53, s54
  s_lshr_b32 s54, s51, 1
  s_lshl_b32 s54, s54, 7
  s_add_u32 s53, s53, s54
  s_lshl_b32 s52, s52, 10
  s_add_u32 s53, s53, s52
  s_add_u32 m0, s53, 60544
  s_nop 0
  buffer_load_dwordx4 v4, s[20:23], 0 offen lds
  s_add_u32 s50, s44, 50
  s_mul_i32 s51, s50, 41
  s_lshr_b32 s51, s51, 10
  s_mul_i32 s52, s51, 25
  s_sub_u32 s52, s50, s52
  s_lshl_b32 s53, s52, 6
  v_add_u32 v3, s53, v1
  v_mul_hi_u32 v4, v3, s48
  v_lshrrev_b32 v4, 3, v4
  v_mul_u32_u24 v5, 10, v4
  v_sub_u32 v5, v3, v5
  v_mul_u32_u24 v4, 5120, v4
  v_lshlrev_b32 v5, 4, v5
  s_mul_i32 s53, s51, 1280
  s_add_u32 s53, s53, s49
  v_add3_u32 v4, v4, v5, s53
  s_mul_i32 s53, s51, 25600
  s_and_b32 s54, s51, 1
  s_lshl_b32 s54, s54, 5
  s_add_u32 s53, s53, s54
  s_lshr_b32 s54, s51, 1
  s_lshl_b32 s54, s54, 7
  s_add_u32 s53, s53, s54
  s_lshl_b32 s52, s52, 10
  s_add_u32 s53, s53, s52
  s_add_u32 m0, s53, 60544
  s_nop 0
  buffer_load_dwordx4 v4, s[20:23], 0 offen lds
  s_add_u32 s50, s44, 51
  s_mul_i32 s51, s50, 41
  s_lshr_b32 s51, s51, 10
  s_mul_i32 s52, s51, 25
  s_sub_u32 s52, s50, s52
  s_lshl_b32 s53, s52, 6
  v_add_u32 v3, s53, v1
  v_mul_hi_u32 v4, v3, s48
  v_lshrrev_b32 v4, 3, v4
  v_mul_u32_u24 v5, 10, v4
  v_sub_u32 v5, v3, v5
  v_mul_u32_u24 v4, 5120, v4
  v_lshlrev_b32 v5, 4, v5
  s_mul_i32 s53, s51, 1280
  s_add_u32 s53, s53, s49
  v_add3_u32 v4, v4, v5, s53
  s_mul_i32 s53, s51, 25600
  s_and_b32 s54, s51, 1
  s_lshl_b32 s54, s54, 5
  s_add_u32 s53, s53, s54
  s_lshr_b32 s54, s51, 1
  s_lshl_b32 s54, s54, 7
  s_add_u32 s53, s53, s54
  s_lshl_b32 s52, s52, 10
  s_add_u32 s53, s53, s52
  s_add_u32 m0, s53, 60544
  s_nop 0
  buffer_load_dwordx4 v4, s[20:23], 0 offen lds
  s_add_u32 s50, s44, 52
  s_mul_i32 s51, s50, 41
  s_lshr_b32 s51, s51, 10
  s_mul_i32 s52, s51, 25
  s_sub_u32 s52, s50, s52
  s_lshl_b32 s53, s52, 6
  v_add_u32 v3, s53, v1
  v_mul_hi_u32 v4, v3, s48
  v_lshrrev_b32 v4, 3, v4
  v_mul_u32_u24 v5, 10, v4
  v_sub_u32 v5, v3, v5
  v_mul_u32_u24 v4, 5120, v4
  v_lshlrev_b32 v5, 4, v5
  s_mul_i32 s53, s51, 1280
  s_add_u32 s53, s53, s49
  v_add3_u32 v4, v4, v5, s53
  s_mul_i32 s53, s51, 25600
  s_and_b32 s54, s51, 1
  s_lshl_b32 s54, s54, 5
  s_add_u32 s53, s53, s54
  s_lshr_b32 s54, s51, 1
  s_lshl_b32 s54, s54, 7
  s_add_u32 s53, s53, s54
  s_lshl_b32 s52, s52, 10
  s_add_u32 s53, s53, s52
  s_add_u32 m0, s53, 60544
  s_nop 0
  buffer_load_dwordx4 v4, s[20:23], 0 offen lds
  s_add_u32 s50, s44, 53
  s_mul_i32 s51, s50, 41
  s_lshr_b32 s51, s51, 10
  s_mul_i32 s52, s51, 25
  s_sub_u32 s52, s50, s52
  s_lshl_b32 s53, s52, 6
  v_add_u32 v3, s53, v1
  v_mul_hi_u32 v4, v3, s48
  v_lshrrev_b32 v4, 3, v4
  v_mul_u32_u24 v5, 10, v4
  v_sub_u32 v5, v3, v5
  v_mul_u32_u24 v4, 5120, v4
  v_lshlrev_b32 v5, 4, v5
  s_mul_i32 s53, s51, 1280
  s_add_u32 s53, s53, s49
  v_add3_u32 v4, v4, v5, s53
  s_mul_i32 s53, s51, 25600
  s_and_b32 s54, s51, 1
  s_lshl_b32 s54, s54, 5
  s_add_u32 s53, s53, s54
  s_lshr_b32 s54, s51, 1
  s_lshl_b32 s54, s54, 7
  s_add_u32 s53, s53, s54
  s_lshl_b32 s52, s52, 10
  s_add_u32 s53, s53, s52
  s_add_u32 m0, s53, 60544
  s_nop 0
  buffer_load_dwordx4 v4, s[20:23], 0 offen lds
  s_add_u32 s50, s44, 54
  s_mul_i32 s51, s50, 41
  s_lshr_b32 s51, s51, 10
  s_mul_i32 s52, s51, 25
  s_sub_u32 s52, s50, s52
  s_lshl_b32 s53, s52, 6
  v_add_u32 v3, s53, v1
  v_mul_hi_u32 v4, v3, s48
  v_lshrrev_b32 v4, 3, v4
  v_mul_u32_u24 v5, 10, v4
  v_sub_u32 v5, v3, v5
  v_mul_u32_u24 v4, 5120, v4
  v_lshlrev_b32 v5, 4, v5
  s_mul_i32 s53, s51, 1280
  s_add_u32 s53, s53, s49
  v_add3_u32 v4, v4, v5, s53
  s_mul_i32 s53, s51, 25600
  s_and_b32 s54, s51, 1
  s_lshl_b32 s54, s54, 5
  s_add_u32 s53, s53, s54
  s_lshr_b32 s54, s51, 1
  s_lshl_b32 s54, s54, 7
  s_add_u32 s53, s53, s54
  s_lshl_b32 s52, s52, 10
  s_add_u32 s53, s53, s52
  s_add_u32 m0, s53, 60544
  s_nop 0
  buffer_load_dwordx4 v4, s[20:23], 0 offen lds
  s_add_u32 s50, s44, 55
  s_mul_i32 s51, s50, 41
  s_lshr_b32 s51, s51, 10
  s_mul_i32 s52, s51, 25
  s_sub_u32 s52, s50, s52
  s_lshl_b32 s53, s52, 6
  v_add_u32 v3, s53, v1
  v_mul_hi_u32 v4, v3, s48
  v_lshrrev_b32 v4, 3, v4
  v_mul_u32_u24 v5, 10, v4
  v_sub_u32 v5, v3, v5
  v_mul_u32_u24 v4, 5120, v4
  v_lshlrev_b32 v5, 4, v5
  s_mul_i32 s53, s51, 1280
  s_add_u32 s53, s53, s49
  v_add3_u32 v4, v4, v5, s53
  s_mul_i32 s53, s51, 25600
  s_and_b32 s54, s51, 1
  s_lshl_b32 s54, s54, 5
  s_add_u32 s53, s53, s54
  s_lshr_b32 s54, s51, 1
  s_lshl_b32 s54, s54, 7
  s_add_u32 s53, s53, s54
  s_lshl_b32 s52, s52, 10
  s_add_u32 s53, s53, s52
  s_add_u32 m0, s53, 60544
  s_nop 0
  buffer_load_dwordx4 v4, s[20:23], 0 offen lds
  s_add_u32 s50, s44, 56
  s_mul_i32 s51, s50, 41
  s_lshr_b32 s51, s51, 10
  s_mul_i32 s52, s51, 25
  s_sub_u32 s52, s50, s52
  s_lshl_b32 s53, s52, 6
  v_add_u32 v3, s53, v1
  v_mul_hi_u32 v4, v3, s48
  v_lshrrev_b32 v4, 3, v4
  v_mul_u32_u24 v5, 10, v4
  v_sub_u32 v5, v3, v5
  v_mul_u32_u24 v4, 5120, v4
  v_lshlrev_b32 v5, 4, v5
  s_mul_i32 s53, s51, 1280
  s_add_u32 s53, s53, s49
  v_add3_u32 v4, v4, v5, s53
  s_mul_i32 s53, s51, 25600
  s_and_b32 s54, s51, 1
  s_lshl_b32 s54, s54, 5
  s_add_u32 s53, s53, s54
  s_lshr_b32 s54, s51, 1
  s_lshl_b32 s54, s54, 7
  s_add_u32 s53, s53, s54
  s_lshl_b32 s52, s52, 10
  s_add_u32 s53, s53, s52
  s_add_u32 m0, s53, 60544
  s_nop 0
  buffer_load_dwordx4 v4, s[20:23], 0 offen lds
  s_add_u32 s50, s44, 57
  s_mul_i32 s51, s50, 41
  s_lshr_b32 s51, s51, 10
  s_mul_i32 s52, s51, 25
  s_sub_u32 s52, s50, s52
  s_lshl_b32 s53, s52, 6
  v_add_u32 v3, s53, v1
  v_mul_hi_u32 v4, v3, s48
  v_lshrrev_b32 v4, 3, v4
  v_mul_u32_u24 v5, 10, v4
  v_sub_u32 v5, v3, v5
  v_mul_u32_u24 v4, 5120, v4
  v_lshlrev_b32 v5, 4, v5
  s_mul_i32 s53, s51, 1280
  s_add_u32 s53, s53, s49
  v_add3_u32 v4, v4, v5, s53
  s_mul_i32 s53, s51, 25600
  s_and_b32 s54, s51, 1
  s_lshl_b32 s54, s54, 5
  s_add_u32 s53, s53, s54
  s_lshr_b32 s54, s51, 1
  s_lshl_b32 s54, s54, 7
  s_add_u32 s53, s53, s54
  s_lshl_b32 s52, s52, 10
  s_add_u32 s53, s53, s52
  s_add_u32 m0, s53, 60544
  s_nop 0
  buffer_load_dwordx4 v4, s[20:23], 0 offen lds
  s_add_u32 s50, s44, 58
  s_mul_i32 s51, s50, 41
  s_lshr_b32 s51, s51, 10
  s_mul_i32 s52, s51, 25
  s_sub_u32 s52, s50, s52
  s_lshl_b32 s53, s52, 6
  v_add_u32 v3, s53, v1
  v_mul_hi_u32 v4, v3, s48
  v_lshrrev_b32 v4, 3, v4
  v_mul_u32_u24 v5, 10, v4
  v_sub_u32 v5, v3, v5
  v_mul_u32_u24 v4, 5120, v4
  v_lshlrev_b32 v5, 4, v5
  s_mul_i32 s53, s51, 1280
  s_add_u32 s53, s53, s49
  v_add3_u32 v4, v4, v5, s53
  s_mul_i32 s53, s51, 25600
  s_and_b32 s54, s51, 1
  s_lshl_b32 s54, s54, 5
  s_add_u32 s53, s53, s54
  s_lshr_b32 s54, s51, 1
  s_lshl_b32 s54, s54, 7
  s_add_u32 s53, s53, s54
  s_lshl_b32 s52, s52, 10
  s_add_u32 s53, s53, s52
  s_add_u32 m0, s53, 60544
  s_nop 0
  buffer_load_dwordx4 v4, s[20:23], 0 offen lds
  s_add_u32 s50, s44, 59
  s_mul_i32 s51, s50, 41
  s_lshr_b32 s51, s51, 10
  s_mul_i32 s52, s51, 25
  s_sub_u32 s52, s50, s52
  s_lshl_b32 s53, s52, 6
  v_add_u32 v3, s53, v1
  v_mul_hi_u32 v4, v3, s48
  v_lshrrev_b32 v4, 3, v4
  v_mul_u32_u24 v5, 10, v4
  v_sub_u32 v5, v3, v5
  v_mul_u32_u24 v4, 5120, v4
  v_lshlrev_b32 v5, 4, v5
  s_mul_i32 s53, s51, 1280
  s_add_u32 s53, s53, s49
  v_add3_u32 v4, v4, v5, s53
  s_mul_i32 s53, s51, 25600
  s_and_b32 s54, s51, 1
  s_lshl_b32 s54, s54, 5
  s_add_u32 s53, s53, s54
  s_lshr_b32 s54, s51, 1
  s_lshl_b32 s54, s54, 7
  s_add_u32 s53, s53, s54
  s_lshl_b32 s52, s52, 10
  s_add_u32 s53, s53, s52
  s_add_u32 m0, s53, 60544
  s_nop 0
  buffer_load_dwordx4 v4, s[20:23], 0 offen lds
  s_add_u32 s50, s44, 60
  s_mul_i32 s51, s50, 41
  s_lshr_b32 s51, s51, 10
  s_mul_i32 s52, s51, 25
  s_sub_u32 s52, s50, s52
  s_lshl_b32 s53, s52, 6
  v_add_u32 v3, s53, v1
  v_mul_hi_u32 v4, v3, s48
  v_lshrrev_b32 v4, 3, v4
  v_mul_u32_u24 v5, 10, v4
  v_sub_u32 v5, v3, v5
  v_mul_u32_u24 v4, 5120, v4
  v_lshlrev_b32 v5, 4, v5
  s_mul_i32 s53, s51, 1280
  s_add_u32 s53, s53, s49
  v_add3_u32 v4, v4, v5, s53
  s_mul_i32 s53, s51, 25600
  s_and_b32 s54, s51, 1
  s_lshl_b32 s54, s54, 5
  s_add_u32 s53, s53, s54
  s_lshr_b32 s54, s51, 1
  s_lshl_b32 s54, s54, 7
  s_add_u32 s53, s53, s54
  s_lshl_b32 s52, s52, 10
  s_add_u32 s53, s53, s52
  s_add_u32 m0, s53, 60544
  s_nop 0
  buffer_load_dwordx4 v4, s[20:23], 0 offen lds
  s_add_u32 s50, s44, 61
  s_mul_i32 s51, s50, 41
  s_lshr_b32 s51, s51, 10
  s_mul_i32 s52, s51, 25
  s_sub_u32 s52, s50, s52
  s_lshl_b32 s53, s52, 6
  v_add_u32 v3, s53, v1
  v_mul_hi_u32 v4, v3, s48
  v_lshrrev_b32 v4, 3, v4
  v_mul_u32_u24 v5, 10, v4
  v_sub_u32 v5, v3, v5
  v_mul_u32_u24 v4, 5120, v4
  v_lshlrev_b32 v5, 4, v5
  s_mul_i32 s53, s51, 1280
  s_add_u32 s53, s53, s49
  v_add3_u32 v4, v4, v5, s53
  s_mul_i32 s53, s51, 25600
  s_and_b32 s54, s51, 1
  s_lshl_b32 s54, s54, 5
  s_add_u32 s53, s53, s54
  s_lshr_b32 s54, s51, 1
  s_lshl_b32 s54, s54, 7
  s_add_u32 s53, s53, s54
  s_lshl_b32 s52, s52, 10
  s_add_u32 s53, s53, s52
  s_add_u32 m0, s53, 60544
  s_nop 0
  buffer_load_dwordx4 v4, s[20:23], 0 offen lds
  s_add_u32 s50, s44, 62
  s_mul_i32 s51, s50, 41
  s_lshr_b32 s51, s51, 10
  s_mul_i32 s52, s51, 25
  s_sub_u32 s52, s50, s52
  s_lshl_b32 s53, s52, 6
  v_add_u32 v3, s53, v1
  v_mul_hi_u32 v4, v3, s48
  v_lshrrev_b32 v4, 3, v4
  v_mul_u32_u24 v5, 10, v4
  v_sub_u32 v5, v3, v5
  v_mul_u32_u24 v4, 5120, v4
  v_lshlrev_b32 v5, 4, v5
  s_mul_i32 s53, s51, 1280
  s_add_u32 s53, s53, s49
  v_add3_u32 v4, v4, v5, s53
  s_mul_i32 s53, s51, 25600
  s_and_b32 s54, s51, 1
  s_lshl_b32 s54, s54, 5
  s_add_u32 s53, s53, s54
  s_lshr_b32 s54, s51, 1
  s_lshl_b32 s54, s54, 7
  s_add_u32 s53, s53, s54
  s_lshl_b32 s52, s52, 10
  s_add_u32 s53, s53, s52
  s_add_u32 m0, s53, 60544
  s_nop 0
  buffer_load_dwordx4 v4, s[20:23], 0 offen lds
  s_add_u32 s50, s44, 63
  s_mul_i32 s51, s50, 41
  s_lshr_b32 s51, s51, 10
  s_mul_i32 s52, s51, 25
  s_sub_u32 s52, s50, s52
  s_lshl_b32 s53, s52, 6
  v_add_u32 v3, s53, v1
  v_mul_hi_u32 v4, v3, s48
  v_lshrrev_b32 v4, 3, v4
  v_mul_u32_u24 v5, 10, v4
  v_sub_u32 v5, v3, v5
  v_mul_u32_u24 v4, 5120, v4
  v_lshlrev_b32 v5, 4, v5
  s_mul_i32 s53, s51, 1280
  s_add_u32 s53, s53, s49
  v_add3_u32 v4, v4, v5, s53
  s_mul_i32 s53, s51, 25600
  s_and_b32 s54, s51, 1
  s_lshl_b32 s54, s54, 5
  s_add_u32 s53, s53, s54
  s_lshr_b32 s54, s51, 1
  s_lshl_b32 s54, s54, 7
  s_add_u32 s53, s53, s54
  s_lshl_b32 s52, s52, 10
  s_add_u32 s53, s53, s52
  s_add_u32 m0, s53, 60544
  s_nop 0
  buffer_load_dwordx4 v4, s[20:23], 0 offen lds
  s_add_u32 s50, s44, 64
  s_mul_i32 s51, s50, 41
  s_lshr_b32 s51, s51, 10
  s_mul_i32 s52, s51, 25
  s_sub_u32 s52, s50, s52
  s_lshl_b32 s53, s52, 6
  v_add_u32 v3, s53, v1
  v_mul_hi_u32 v4, v3, s48
  v_lshrrev_b32 v4, 3, v4
  v_mul_u32_u24 v5, 10, v4
  v_sub_u32 v5, v3, v5
  v_mul_u32_u24 v4, 5120, v4
  v_lshlrev_b32 v5, 4, v5
  s_mul_i32 s53, s51, 1280
  s_add_u32 s53, s53, s49
  v_add3_u32 v4, v4, v5, s53
  s_mul_i32 s53, s51, 25600
  s_and_b32 s54, s51, 1
  s_lshl_b32 s54, s54, 5
  s_add_u32 s53, s53, s54
  s_lshr_b32 s54, s51, 1
  s_lshl_b32 s54, s54, 7
  s_add_u32 s53, s53, s54
  s_lshl_b32 s52, s52, 10
  s_add_u32 s53, s53, s52
  s_add_u32 m0, s53, 60544
  s_nop 0
  buffer_load_dwordx4 v4, s[20:23], 0 offen lds
  s_add_u32 s50, s44, 65
  s_mul_i32 s51, s50, 41
  s_lshr_b32 s51, s51, 10
  s_mul_i32 s52, s51, 25
  s_sub_u32 s52, s50, s52
  s_lshl_b32 s53, s52, 6
  v_add_u32 v3, s53, v1
  v_mul_hi_u32 v4, v3, s48
  v_lshrrev_b32 v4, 3, v4
  v_mul_u32_u24 v5, 10, v4
  v_sub_u32 v5, v3, v5
  v_mul_u32_u24 v4, 5120, v4
  v_lshlrev_b32 v5, 4, v5
  s_mul_i32 s53, s51, 1280
  s_add_u32 s53, s53, s49
  v_add3_u32 v4, v4, v5, s53
  s_mul_i32 s53, s51, 25600
  s_and_b32 s54, s51, 1
  s_lshl_b32 s54, s54, 5
  s_add_u32 s53, s53, s54
  s_lshr_b32 s54, s51, 1
  s_lshl_b32 s54, s54, 7
  s_add_u32 s53, s53, s54
  s_lshl_b32 s52, s52, 10
  s_add_u32 s53, s53, s52
  s_add_u32 m0, s53, 60544
  s_nop 0
  buffer_load_dwordx4 v4, s[20:23], 0 offen lds
  s_add_u32 s50, s44, 66
  s_mul_i32 s51, s50, 41
  s_lshr_b32 s51, s51, 10
  s_mul_i32 s52, s51, 25
  s_sub_u32 s52, s50, s52
  s_lshl_b32 s53, s52, 6
  v_add_u32 v3, s53, v1
  v_mul_hi_u32 v4, v3, s48
  v_lshrrev_b32 v4, 3, v4
  v_mul_u32_u24 v5, 10, v4
  v_sub_u32 v5, v3, v5
  v_mul_u32_u24 v4, 5120, v4
  v_lshlrev_b32 v5, 4, v5
  s_mul_i32 s53, s51, 1280
  s_add_u32 s53, s53, s49
  v_add3_u32 v4, v4, v5, s53
  s_mul_i32 s53, s51, 25600
  s_and_b32 s54, s51, 1
  s_lshl_b32 s54, s54, 5
  s_add_u32 s53, s53, s54
  s_lshr_b32 s54, s51, 1
  s_lshl_b32 s54, s54, 7
  s_add_u32 s53, s53, s54
  s_lshl_b32 s52, s52, 10
  s_add_u32 s53, s53, s52
  s_add_u32 m0, s53, 60544
  s_nop 0
  buffer_load_dwordx4 v4, s[20:23], 0 offen lds
  s_add_u32 s50, s44, 67
  s_mul_i32 s51, s50, 41
  s_lshr_b32 s51, s51, 10
  s_mul_i32 s52, s51, 25
  s_sub_u32 s52, s50, s52
  s_lshl_b32 s53, s52, 6
  v_add_u32 v3, s53, v1
  v_mul_hi_u32 v4, v3, s48
  v_lshrrev_b32 v4, 3, v4
  v_mul_u32_u24 v5, 10, v4
  v_sub_u32 v5, v3, v5
  v_mul_u32_u24 v4, 5120, v4
  v_lshlrev_b32 v5, 4, v5
  s_mul_i32 s53, s51, 1280
  s_add_u32 s53, s53, s49
  v_add3_u32 v4, v4, v5, s53
  s_mul_i32 s53, s51, 25600
  s_and_b32 s54, s51, 1
  s_lshl_b32 s54, s54, 5
  s_add_u32 s53, s53, s54
  s_lshr_b32 s54, s51, 1
  s_lshl_b32 s54, s54, 7
  s_add_u32 s53, s53, s54
  s_lshl_b32 s52, s52, 10
  s_add_u32 s53, s53, s52
  s_add_u32 m0, s53, 60544
  s_nop 0
  buffer_load_dwordx4 v4, s[20:23], 0 offen lds
  s_add_u32 s50, s44, 68
  s_mul_i32 s51, s50, 41
  s_lshr_b32 s51, s51, 10
  s_mul_i32 s52, s51, 25
  s_sub_u32 s52, s50, s52
  s_lshl_b32 s53, s52, 6
  v_add_u32 v3, s53, v1
  v_mul_hi_u32 v4, v3, s48
  v_lshrrev_b32 v4, 3, v4
  v_mul_u32_u24 v5, 10, v4
  v_sub_u32 v5, v3, v5
  v_mul_u32_u24 v4, 5120, v4
  v_lshlrev_b32 v5, 4, v5
  s_mul_i32 s53, s51, 1280
  s_add_u32 s53, s53, s49
  v_add3_u32 v4, v4, v5, s53
  s_mul_i32 s53, s51, 25600
  s_and_b32 s54, s51, 1
  s_lshl_b32 s54, s54, 5
  s_add_u32 s53, s53, s54
  s_lshr_b32 s54, s51, 1
  s_lshl_b32 s54, s54, 7
  s_add_u32 s53, s53, s54
  s_lshl_b32 s52, s52, 10
  s_add_u32 s53, s53, s52
  s_add_u32 m0, s53, 60544
  s_nop 0
  buffer_load_dwordx4 v4, s[20:23], 0 offen lds
  s_add_u32 s50, s44, 69
  s_mul_i32 s51, s50, 41
  s_lshr_b32 s51, s51, 10
  s_mul_i32 s52, s51, 25
  s_sub_u32 s52, s50, s52
  s_lshl_b32 s53, s52, 6
  v_add_u32 v3, s53, v1
  v_mul_hi_u32 v4, v3, s48
  v_lshrrev_b32 v4, 3, v4
  v_mul_u32_u24 v5, 10, v4
  v_sub_u32 v5, v3, v5
  v_mul_u32_u24 v4, 5120, v4
  v_lshlrev_b32 v5, 4, v5
  s_mul_i32 s53, s51, 1280
  s_add_u32 s53, s53, s49
  v_add3_u32 v4, v4, v5, s53
  s_mul_i32 s53, s51, 25600
  s_and_b32 s54, s51, 1
  s_lshl_b32 s54, s54, 5
  s_add_u32 s53, s53, s54
  s_lshr_b32 s54, s51, 1
  s_lshl_b32 s54, s54, 7
  s_add_u32 s53, s53, s54
  s_lshl_b32 s52, s52, 10
  s_add_u32 s53, s53, s52
  s_add_u32 m0, s53, 60544
  s_nop 0
  buffer_load_dwordx4 v4, s[20:23], 0 offen lds
  s_add_u32 s50, s44, 70
  s_mul_i32 s51, s50, 41
  s_lshr_b32 s51, s51, 10
  s_mul_i32 s52, s51, 25
  s_sub_u32 s52, s50, s52
  s_lshl_b32 s53, s52, 6
  v_add_u32 v3, s53, v1
  v_mul_hi_u32 v4, v3, s48
  v_lshrrev_b32 v4, 3, v4
  v_mul_u32_u24 v5, 10, v4
  v_sub_u32 v5, v3, v5
  v_mul_u32_u24 v4, 5120, v4
  v_lshlrev_b32 v5, 4, v5
  s_mul_i32 s53, s51, 1280
  s_add_u32 s53, s53, s49
  v_add3_u32 v4, v4, v5, s53
  s_mul_i32 s53, s51, 25600
  s_and_b32 s54, s51, 1
  s_lshl_b32 s54, s54, 5
  s_add_u32 s53, s53, s54
  s_lshr_b32 s54, s51, 1
  s_lshl_b32 s54, s54, 7
  s_add_u32 s53, s53, s54
  s_lshl_b32 s52, s52, 10
  s_add_u32 s53, s53, s52
  s_add_u32 m0, s53, 60544
  s_nop 0
  buffer_load_dwordx4 v4, s[20:23], 0 offen lds
  s_add_u32 s50, s44, 71
  s_mul_i32 s51, s50, 41
  s_lshr_b32 s51, s51, 10
  s_mul_i32 s52, s51, 25
  s_sub_u32 s52, s50, s52
  s_lshl_b32 s53, s52, 6
  v_add_u32 v3, s53, v1
  v_mul_hi_u32 v4, v3, s48
  v_lshrrev_b32 v4, 3, v4
  v_mul_u32_u24 v5, 10, v4
  v_sub_u32 v5, v3, v5
  v_mul_u32_u24 v4, 5120, v4
  v_lshlrev_b32 v5, 4, v5
  s_mul_i32 s53, s51, 1280
  s_add_u32 s53, s53, s49
  v_add3_u32 v4, v4, v5, s53
  s_mul_i32 s53, s51, 25600
  s_and_b32 s54, s51, 1
  s_lshl_b32 s54, s54, 5
  s_add_u32 s53, s53, s54
  s_lshr_b32 s54, s51, 1
  s_lshl_b32 s54, s54, 7
  s_add_u32 s53, s53, s54
  s_lshl_b32 s52, s52, 10
  s_add_u32 s53, s53, s52
  s_add_u32 m0, s53, 60544
  s_nop 0
  buffer_load_dwordx4 v4, s[20:23], 0 offen lds
  s_add_u32 s50, s44, 72
  s_mul_i32 s51, s50, 41
  s_lshr_b32 s51, s51, 10
  s_mul_i32 s52, s51, 25
  s_sub_u32 s52, s50, s52
  s_lshl_b32 s53, s52, 6
  v_add_u32 v3, s53, v1
  v_mul_hi_u32 v4, v3, s48
  v_lshrrev_b32 v4, 3, v4
  v_mul_u32_u24 v5, 10, v4
  v_sub_u32 v5, v3, v5
  v_mul_u32_u24 v4, 5120, v4
  v_lshlrev_b32 v5, 4, v5
  s_mul_i32 s53, s51, 1280
  s_add_u32 s53, s53, s49
  v_add3_u32 v4, v4, v5, s53
  s_mul_i32 s53, s51, 25600
  s_and_b32 s54, s51, 1
  s_lshl_b32 s54, s54, 5
  s_add_u32 s53, s53, s54
  s_lshr_b32 s54, s51, 1
  s_lshl_b32 s54, s54, 7
  s_add_u32 s53, s53, s54
  s_lshl_b32 s52, s52, 10
  s_add_u32 s53, s53, s52
  s_add_u32 m0, s53, 60544
  s_nop 0
  buffer_load_dwordx4 v4, s[20:23], 0 offen lds
  s_add_u32 s50, s44, 73
  s_mul_i32 s51, s50, 41
  s_lshr_b32 s51, s51, 10
  s_mul_i32 s52, s51, 25
  s_sub_u32 s52, s50, s52
  s_lshl_b32 s53, s52, 6
  v_add_u32 v3, s53, v1
  v_mul_hi_u32 v4, v3, s48
  v_lshrrev_b32 v4, 3, v4
  v_mul_u32_u24 v5, 10, v4
  v_sub_u32 v5, v3, v5
  v_mul_u32_u24 v4, 5120, v4
  v_lshlrev_b32 v5, 4, v5
  s_mul_i32 s53, s51, 1280
  s_add_u32 s53, s53, s49
  v_add3_u32 v4, v4, v5, s53
  s_mul_i32 s53, s51, 25600
  s_and_b32 s54, s51, 1
  s_lshl_b32 s54, s54, 5
  s_add_u32 s53, s53, s54
  s_lshr_b32 s54, s51, 1
  s_lshl_b32 s54, s54, 7
  s_add_u32 s53, s53, s54
  s_lshl_b32 s52, s52, 10
  s_add_u32 s53, s53, s52
  s_add_u32 m0, s53, 60544
  s_nop 0
  buffer_load_dwordx4 v4, s[20:23], 0 offen lds
  s_add_u32 s50, s44, 74
  s_mul_i32 s51, s50, 41
  s_lshr_b32 s51, s51, 10
  s_mul_i32 s52, s51, 25
  s_sub_u32 s52, s50, s52
  s_lshl_b32 s53, s52, 6
  v_add_u32 v3, s53, v1
  v_mul_hi_u32 v4, v3, s48
  v_lshrrev_b32 v4, 3, v4
  v_mul_u32_u24 v5, 10, v4
  v_sub_u32 v5, v3, v5
  v_mul_u32_u24 v4, 5120, v4
  v_lshlrev_b32 v5, 4, v5
  s_mul_i32 s53, s51, 1280
  s_add_u32 s53, s53, s49
  v_add3_u32 v4, v4, v5, s53
  s_mul_i32 s53, s51, 25600
  s_and_b32 s54, s51, 1
  s_lshl_b32 s54, s54, 5
  s_add_u32 s53, s53, s54
  s_lshr_b32 s54, s51, 1
  s_lshl_b32 s54, s54, 7
  s_add_u32 s53, s53, s54
  s_lshl_b32 s52, s52, 10
  s_add_u32 s53, s53, s52
  s_add_u32 m0, s53, 60544
  s_nop 0
  buffer_load_dwordx4 v4, s[20:23], 0 offen lds
  s_add_u32 s50, s44, 75
  s_mul_i32 s51, s50, 41
  s_lshr_b32 s51, s51, 10
  s_mul_i32 s52, s51, 25
  s_sub_u32 s52, s50, s52
  s_lshl_b32 s53, s52, 6
  v_add_u32 v3, s53, v1
  v_mul_hi_u32 v4, v3, s48
  v_lshrrev_b32 v4, 3, v4
  v_mul_u32_u24 v5, 10, v4
  v_sub_u32 v5, v3, v5
  v_mul_u32_u24 v4, 5120, v4
  v_lshlrev_b32 v5, 4, v5
  s_mul_i32 s53, s51, 1280
  s_add_u32 s53, s53, s49
  v_add3_u32 v4, v4, v5, s53
  s_mul_i32 s53, s51, 25600
  s_and_b32 s54, s51, 1
  s_lshl_b32 s54, s54, 5
  s_add_u32 s53, s53, s54
  s_lshr_b32 s54, s51, 1
  s_lshl_b32 s54, s54, 7
  s_add_u32 s53, s53, s54
  s_lshl_b32 s52, s52, 10
  s_add_u32 s53, s53, s52
  s_add_u32 m0, s53, 60544
  s_nop 0
  buffer_load_dwordx4 v4, s[20:23], 0 offen lds
  s_add_u32 s50, s44, 76
  s_mul_i32 s51, s50, 41
  s_lshr_b32 s51, s51, 10
  s_mul_i32 s52, s51, 25
  s_sub_u32 s52, s50, s52
  s_lshl_b32 s53, s52, 6
  v_add_u32 v3, s53, v1
  v_mul_hi_u32 v4, v3, s48
  v_lshrrev_b32 v4, 3, v4
  v_mul_u32_u24 v5, 10, v4
  v_sub_u32 v5, v3, v5
  v_mul_u32_u24 v4, 5120, v4
  v_lshlrev_b32 v5, 4, v5
  s_mul_i32 s53, s51, 1280
  s_add_u32 s53, s53, s49
  v_add3_u32 v4, v4, v5, s53
  s_mul_i32 s53, s51, 25600
  s_and_b32 s54, s51, 1
  s_lshl_b32 s54, s54, 5
  s_add_u32 s53, s53, s54
  s_lshr_b32 s54, s51, 1
  s_lshl_b32 s54, s54, 7
  s_add_u32 s53, s53, s54
  s_lshl_b32 s52, s52, 10
  s_add_u32 s53, s53, s52
  s_add_u32 m0, s53, 60544
  s_nop 0
  buffer_load_dwordx4 v4, s[20:23], 0 offen lds
  s_add_u32 s50, s44, 77
  s_mul_i32 s51, s50, 41
  s_lshr_b32 s51, s51, 10
  s_mul_i32 s52, s51, 25
  s_sub_u32 s52, s50, s52
  s_lshl_b32 s53, s52, 6
  v_add_u32 v3, s53, v1
  v_mul_hi_u32 v4, v3, s48
  v_lshrrev_b32 v4, 3, v4
  v_mul_u32_u24 v5, 10, v4
  v_sub_u32 v5, v3, v5
  v_mul_u32_u24 v4, 5120, v4
  v_lshlrev_b32 v5, 4, v5
  s_mul_i32 s53, s51, 1280
  s_add_u32 s53, s53, s49
  v_add3_u32 v4, v4, v5, s53
  s_mul_i32 s53, s51, 25600
  s_and_b32 s54, s51, 1
  s_lshl_b32 s54, s54, 5
  s_add_u32 s53, s53, s54
  s_lshr_b32 s54, s51, 1
  s_lshl_b32 s54, s54, 7
  s_add_u32 s53, s53, s54
  s_lshl_b32 s52, s52, 10
  s_add_u32 s53, s53, s52
  s_add_u32 m0, s53, 60544
  s_nop 0
  buffer_load_dwordx4 v4, s[20:23], 0 offen lds
  s_add_u32 s50, s44, 78
  s_mul_i32 s51, s50, 41
  s_lshr_b32 s51, s51, 10
  s_mul_i32 s52, s51, 25
  s_sub_u32 s52, s50, s52
  s_lshl_b32 s53, s52, 6
  v_add_u32 v3, s53, v1
  v_mul_hi_u32 v4, v3, s48
  v_lshrrev_b32 v4, 3, v4
  v_mul_u32_u24 v5, 10, v4
  v_sub_u32 v5, v3, v5
  v_mul_u32_u24 v4, 5120, v4
  v_lshlrev_b32 v5, 4, v5
  s_mul_i32 s53, s51, 1280
  s_add_u32 s53, s53, s49
  v_add3_u32 v4, v4, v5, s53
  s_mul_i32 s53, s51, 25600
  s_and_b32 s54, s51, 1
  s_lshl_b32 s54, s54, 5
  s_add_u32 s53, s53, s54
  s_lshr_b32 s54, s51, 1
  s_lshl_b32 s54, s54, 7
  s_add_u32 s53, s53, s54
  s_lshl_b32 s52, s52, 10
  s_add_u32 s53, s53, s52
  s_add_u32 m0, s53, 60544
  s_nop 0
  buffer_load_dwordx4 v4, s[20:23], 0 offen lds
  s_add_u32 s50, s44, 79
  s_mul_i32 s51, s50, 41
  s_lshr_b32 s51, s51, 10
  s_mul_i32 s52, s51, 25
  s_sub_u32 s52, s50, s52
  s_lshl_b32 s53, s52, 6
  v_add_u32 v3, s53, v1
  v_mul_hi_u32 v4, v3, s48
  v_lshrrev_b32 v4, 3, v4
  v_mul_u32_u24 v5, 10, v4
  v_sub_u32 v5, v3, v5
  v_mul_u32_u24 v4, 5120, v4
  v_lshlrev_b32 v5, 4, v5
  s_mul_i32 s53, s51, 1280
  s_add_u32 s53, s53, s49
  v_add3_u32 v4, v4, v5, s53
  s_mul_i32 s53, s51, 25600
  s_and_b32 s54, s51, 1
  s_lshl_b32 s54, s54, 5
  s_add_u32 s53, s53, s54
  s_lshr_b32 s54, s51, 1
  s_lshl_b32 s54, s54, 7
  s_add_u32 s53, s53, s54
  s_lshl_b32 s52, s52, 10
  s_add_u32 s53, s53, s52
  s_add_u32 m0, s53, 60544
  s_nop 0
  buffer_load_dwordx4 v4, s[20:23], 0 offen lds
  s_add_u32 s50, s44, 80
  s_mul_i32 s51, s50, 41
  s_lshr_b32 s51, s51, 10
  s_mul_i32 s52, s51, 25
  s_sub_u32 s52, s50, s52
  s_lshl_b32 s53, s52, 6
  v_add_u32 v3, s53, v1
  v_mul_hi_u32 v4, v3, s48
  v_lshrrev_b32 v4, 3, v4
  v_mul_u32_u24 v5, 10, v4
  v_sub_u32 v5, v3, v5
  v_mul_u32_u24 v4, 5120, v4
  v_lshlrev_b32 v5, 4, v5
  s_mul_i32 s53, s51, 1280
  s_add_u32 s53, s53, s49
  v_add3_u32 v4, v4, v5, s53
  s_mul_i32 s53, s51, 25600
  s_and_b32 s54, s51, 1
  s_lshl_b32 s54, s54, 5
  s_add_u32 s53, s53, s54
  s_lshr_b32 s54, s51, 1
  s_lshl_b32 s54, s54, 7
  s_add_u32 s53, s53, s54
  s_lshl_b32 s52, s52, 10
  s_add_u32 s53, s53, s52
  s_add_u32 m0, s53, 60544
  s_nop 0
  buffer_load_dwordx4 v4, s[20:23], 0 offen lds
  s_add_u32 s50, s44, 81
  s_mul_i32 s51, s50, 41
  s_lshr_b32 s51, s51, 10
  s_mul_i32 s52, s51, 25
  s_sub_u32 s52, s50, s52
  s_lshl_b32 s53, s52, 6
  v_add_u32 v3, s53, v1
  v_mul_hi_u32 v4, v3, s48
  v_lshrrev_b32 v4, 3, v4
  v_mul_u32_u24 v5, 10, v4
  v_sub_u32 v5, v3, v5
  v_mul_u32_u24 v4, 5120, v4
  v_lshlrev_b32 v5, 4, v5
  s_mul_i32 s53, s51, 1280
  s_add_u32 s53, s53, s49
  v_add3_u32 v4, v4, v5, s53
  s_mul_i32 s53, s51, 25600
  s_and_b32 s54, s51, 1
  s_lshl_b32 s54, s54, 5
  s_add_u32 s53, s53, s54
  s_lshr_b32 s54, s51, 1
  s_lshl_b32 s54, s54, 7
  s_add_u32 s53, s53, s54
  s_lshl_b32 s52, s52, 10
  s_add_u32 s53, s53, s52
  s_add_u32 m0, s53, 60544
  s_nop 0
  buffer_load_dwordx4 v4, s[20:23], 0 offen lds
  s_add_u32 s50, s44, 82
  s_mul_i32 s51, s50, 41
  s_lshr_b32 s51, s51, 10
  s_mul_i32 s52, s51, 25
  s_sub_u32 s52, s50, s52
  s_lshl_b32 s53, s52, 6
  v_add_u32 v3, s53, v1
  v_mul_hi_u32 v4, v3, s48
  v_lshrrev_b32 v4, 3, v4
  v_mul_u32_u24 v5, 10, v4
  v_sub_u32 v5, v3, v5
  v_mul_u32_u24 v4, 5120, v4
  v_lshlrev_b32 v5, 4, v5
  s_mul_i32 s53, s51, 1280
  s_add_u32 s53, s53, s49
  v_add3_u32 v4, v4, v5, s53
  s_mul_i32 s53, s51, 25600
  s_and_b32 s54, s51, 1
  s_lshl_b32 s54, s54, 5
  s_add_u32 s53, s53, s54
  s_lshr_b32 s54, s51, 1
  s_lshl_b32 s54, s54, 7
  s_add_u32 s53, s53, s54
  s_lshl_b32 s52, s52, 10
  s_add_u32 s53, s53, s52
  s_add_u32 m0, s53, 60544
  s_nop 0
  buffer_load_dwordx4 v4, s[20:23], 0 offen lds
  s_add_u32 s50, s44, 83
  s_mul_i32 s51, s50, 41
  s_lshr_b32 s51, s51, 10
  s_mul_i32 s52, s51, 25
  s_sub_u32 s52, s50, s52
  s_lshl_b32 s53, s52, 6
  v_add_u32 v3, s53, v1
  v_mul_hi_u32 v4, v3, s48
  v_lshrrev_b32 v4, 3, v4
  v_mul_u32_u24 v5, 10, v4
  v_sub_u32 v5, v3, v5
  v_mul_u32_u24 v4, 5120, v4
  v_lshlrev_b32 v5, 4, v5
  s_mul_i32 s53, s51, 1280
  s_add_u32 s53, s53, s49
  v_add3_u32 v4, v4, v5, s53
  s_mul_i32 s53, s51, 25600
  s_and_b32 s54, s51, 1
  s_lshl_b32 s54, s54, 5
  s_add_u32 s53, s53, s54
  s_lshr_b32 s54, s51, 1
  s_lshl_b32 s54, s54, 7
  s_add_u32 s53, s53, s54
  s_lshl_b32 s52, s52, 10
  s_add_u32 s53, s53, s52
  s_add_u32 m0, s53, 60544
  s_nop 0
  buffer_load_dwordx4 v4, s[20:23], 0 offen lds
  s_add_u32 s50, s44, 84
  s_mul_i32 s51, s50, 41
  s_lshr_b32 s51, s51, 10
  s_mul_i32 s52, s51, 25
  s_sub_u32 s52, s50, s52
  s_lshl_b32 s53, s52, 6
  v_add_u32 v3, s53, v1
  v_mul_hi_u32 v4, v3, s48
  v_lshrrev_b32 v4, 3, v4
  v_mul_u32_u24 v5, 10, v4
  v_sub_u32 v5, v3, v5
  v_mul_u32_u24 v4, 5120, v4
  v_lshlrev_b32 v5, 4, v5
  s_mul_i32 s53, s51, 1280
  s_add_u32 s53, s53, s49
  v_add3_u32 v4, v4, v5, s53
  s_mul_i32 s53, s51, 25600
  s_and_b32 s54, s51, 1
  s_lshl_b32 s54, s54, 5
  s_add_u32 s53, s53, s54
  s_lshr_b32 s54, s51, 1
  s_lshl_b32 s54, s54, 7
  s_add_u32 s53, s53, s54
  s_lshl_b32 s52, s52, 10
  s_add_u32 s53, s53, s52
  s_add_u32 m0, s53, 60544
  s_nop 0
  buffer_load_dwordx4 v4, s[20:23], 0 offen lds
  s_mov_b32 s44, s62
  s_branch gated_mix__grouped_kv_mqa__spectral_gfnet__prompt_kernel_aend34
gated_mix__grouped_kv_mqa__spectral_gfnet__prompt_kernel_w245:
  v_lshlrev_b32 v4, 4, v1
  s_mov_b32 s53, 12288
gated_mix__grouped_kv_mqa__spectral_gfnet__prompt_kernel_pyy133:
  buffer_load_dwordx4 v[6:9], v4, s[40:43], s53 offen sc1
  buffer_load_dwordx4 v[10:13], v4, s[40:43], s53 offen offset:1024 sc1
  s_waitcnt vmcnt(0)
  v_xor_b32 v6, s47, v6
  v_xor_b32 v7, s47, v7
  v_xor_b32 v8, s47, v8
  v_xor_b32 v9, s47, v9
  v_xor_b32 v10, s47, v10
  v_xor_b32 v11, s47, v11
  v_xor_b32 v12, s47, v12
  v_xor_b32 v13, s47, v13
  v_or_b32 v6, v6, v7
  v_or_b32 v6, v6, v8
  v_or_b32 v6, v6, v9
  v_or_b32 v6, v6, v10
  v_or_b32 v6, v6, v11
  v_or_b32 v6, v6, v12
  v_or_b32 v6, v6, v13
  v_cmp_ne_u32 vcc, 0, v6
  s_cbranch_vccz gated_mix__grouped_kv_mqa__spectral_gfnet__prompt_kernel_pyd134
  s_sleep 10
  s_branch gated_mix__grouped_kv_mqa__spectral_gfnet__prompt_kernel_pyy133
gated_mix__grouped_kv_mqa__spectral_gfnet__prompt_kernel_pyd134:
  v_mov_b32 v5, 10324
gated_mix__grouped_kv_mqa__spectral_gfnet__prompt_kernel_lw135:
  ds_read_b32 v6, v5
  s_waitcnt lgkmcnt(0)
  v_readfirstlane_b32 s48, v6
  s_cmp_lt_u32 s48, 1
  s_cbranch_scc0 gated_mix__grouped_kv_mqa__spectral_gfnet__prompt_kernel_lq136
  s_sleep 2
  s_branch gated_mix__grouped_kv_mqa__spectral_gfnet__prompt_kernel_lw135
gated_mix__grouped_kv_mqa__spectral_gfnet__prompt_kernel_lq136:
  v_and_b32 v3, 31, v1
  v_lshrrev_b32 v4, 5, v1
  s_lshr_b32 s48, s2, 6
  s_and_b32 s49, s2, 63
  s_lshl_b32 s50, s49, 7
  s_lshl_b32 s51, s48, 5
  s_add_u32 s50, s50, s51
  s_add_u32 s50, s50, 10485760
  v_add_u32 v8, 0, v1
  v_lshlrev_b32 v8, 13, v8
  buffer_load_dwordx4 v[16:19], v8, s[40:43], s50 offen sc1
  buffer_load_dwordx4 v[20:23], v8, s[40:43], s50 offen offset:16 sc1
  v_add_u32 v8, 64, v1
  v_lshlrev_b32 v8, 13, v8
  buffer_load_dwordx4 v[24:27], v8, s[40:43], s50 offen sc1
  buffer_load_dwordx4 v[28:31], v8, s[40:43], s50 offen offset:16 sc1
  v_add_u32 v8, 128, v1
  v_lshlrev_b32 v8, 13, v8
  buffer_load_dwordx4 v[32:35], v8, s[40:43], s50 offen sc1
  buffer_load_dwordx4 v[36:39], v8, s[40:43], s50 offen offset:16 sc1
  v_add_u32 v8, 192, v1
  v_lshlrev_b32 v8, 13, v8
  buffer_load_dwordx4 v[40:43], v8, s[40:43], s50 offen sc1
  buffer_load_dwordx4 v[44:47], v8, s[40:43], s50 offen offset:16 sc1
  v_add_u32 v8, 256, v1
  v_lshlrev_b32 v8, 13, v8
  buffer_load_dwordx4 v[48:51], v8, s[40:43], s50 offen sc1
  buffer_load_dwordx4 v[52:55], v8, s[40:43], s50 offen offset:16 sc1
  v_add_u32 v8, 320, v1
  v_lshlrev_b32 v8, 13, v8
  s_mov_b64 exec, 1
  buffer_load_dwordx4 v[56:59], v8, s[40:43], s50 offen sc1
  buffer_load_dwordx4 v[60:63], v8, s[40:43], s50 offen offset:16 sc1
  s_mov_b64 exec, -1
  v_lshlrev_b32 v10, 4, v1
  v_add_u32 v10, 147744, v10
  ds_read_b128 v[64:67], v10 offset:0
  ds_read_b128 v[68:71], v10 offset:1024
  ds_read_b128 v[72:75], v10 offset:2048
  ds_read_b128 v[76:79], v10 offset:3072
  ds_read_b128 v[92:95], v10 offset:4096
  ds_read_b128 v[80:83], v10 offset:5120
  ds_read_b128 v[96:99], v10 offset:6144
  ds_read_b128 v[84:87], v10 offset:7168
  ds_read_b128 v[100:103], v10 offset:8192
  ds_read_b128 v[88:91], v10 offset:9216
  ds_read_b128 v[104:107], v10 offset:10240
  ds_read_b128 v[108:111], v10 offset:11264
  ds_read_b128 v[116:119], v10 offset:12288
  ds_read_b128 v[112:115], v10 offset:13312
  ds_read_b128 v[120:123], v10 offset:14336
  v_mul_u32_u24 v8, 48, v3
  v_lshl_add_u32 v8, v4, 2, v8
  v_add_u32 v8, 54400, v8
  v_mul_u32_u24 v9, 48, v3
  v_add_u32 v9, 54400, v9
  v_lshl_add_u32 v12, v4, 3, v9
  v_lshl_add_u32 v9, v4, 4, v9
  v_cmp_eq_u32 s[62:63], 0, v4
  v_cmp_eq_u32 s[58:59], 0, v3
  s_or_b64 s[58:59], s[58:59], s[62:63]
  s_lshr_b32 s50, s48, 1
  s_and_b32 s51, s48, 1
  s_lshl_b32 s50, s50, 4
  s_lshl_b32 s51, s51, 2
  s_add_u32 s50, s50, s51
  v_mul_u32_u24 v13, 40, v3
  v_lshl_add_u32 v13, v4, 3, v13
  v_add_u32 v13, 54400, v13
  v_lshlrev_b32 v15, 4, v1
  v_add_u32 v14, 54400, v15
  s_waitcnt vmcnt(0) lgkmcnt(0)
  ds_write_b32 v8, v16 offset:0
  ds_write_b32 v8, v17 offset:1536
  ds_write_b32 v8, v18 offset:3072
  ds_write_b32 v8, v19 offset:4608
  ds_write_b32 v8, v24 offset:8
  ds_write_b32 v8, v25 offset:1544
  ds_write_b32 v8, v26 offset:3080
  ds_write_b32 v8, v27 offset:4616
  ds_write_b32 v8, v32 offset:16
  ds_write_b32 v8, v33 offset:1552
  ds_write_b32 v8, v34 offset:3088
  ds_write_b32 v8, v35 offset:4624
  ds_write_b32 v8, v40 offset:24
  ds_write_b32 v8, v41 offset:1560
  ds_write_b32 v8, v42 offset:3096
  ds_write_b32 v8, v43 offset:4632
  ds_write_b32 v8, v48 offset:32
  ds_write_b32 v8, v49 offset:1568
  ds_write_b32 v8, v50 offset:3104
  ds_write_b32 v8, v51 offset:4640
  s_mov_b64 exec, 1
  ds_write_b32 v8, v56 offset:40
  ds_write_b32 v8, v57 offset:1576
  ds_write_b32 v8, v58 offset:3112
  ds_write_b32 v8, v59 offset:4648
  s_mov_b64 exec, -1
  s_waitcnt lgkmcnt(0)
  ds_read_b128 v[124:127], v9 offset:0
  ds_read_b64 v[128:129], v12 offset:32
  ds_read_b128 v[130:133], v9 offset:1536
  ds_read_b64 v[134:135], v12 offset:1568
  s_waitcnt lgkmcnt(2)
  v_cndmask_b32 v128, 0, v128, s[58:59]
  v_cndmask_b32 v129, 0, v129, s[62:63]
  v_mfma_f32_32x32x16_bf16 v[136:151], v[124:127], v[64:67], 0
  v_mfma_f32_32x32x16_bf16 v[152:167], v[124:127], v[68:71], 0
  v_mfma_f32_32x32x8_bf16 v[136:151], v[128:129], v[72:73], v[136:151]
  v_mfma_f32_32x32x8_bf16 v[152:167], v[128:129], v[74:75], v[152:167]
  s_nop 15
  v_pk_mul_f32 v[168:169], v[136:137], v[76:77]
  v_pk_mul_f32 v[184:185], v[152:153], v[76:77]
  v_pk_fma_f32 v[168:169], v[152:153], v[92:93], v[168:169] neg_lo:[1,0,0] neg_hi:[1,0,0]
  v_pk_fma_f32 v[184:185], v[136:137], v[92:93], v[184:185]
  v_pk_mul_f32 v[170:171], v[138:139], v[78:79]
  v_pk_mul_f32 v[186:187], v[154:155], v[78:79]
  v_pk_fma_f32 v[170:171], v[154:155], v[94:95], v[170:171] neg_lo:[1,0,0] neg_hi:[1,0,0]
  v_pk_fma_f32 v[186:187], v[138:139], v[94:95], v[186:187]
  v_pk_mul_f32 v[172:173], v[140:141], v[80:81]
  v_pk_mul_f32 v[188:189], v[156:157], v[80:81]
  v_pk_fma_f32 v[172:173], v[156:157], v[96:97], v[172:173] neg_lo:[1,0,0] neg_hi:[1,0,0]
  v_pk_fma_f32 v[188:189], v[140:141], v[96:97], v[188:189]
  v_pk_mul_f32 v[174:175], v[142:143], v[82:83]
  v_pk_mul_f32 v[190:191], v[158:159], v[82:83]
  v_pk_fma_f32 v[174:175], v[158:159], v[98:99], v[174:175] neg_lo:[1,0,0] neg_hi:[1,0,0]
  v_pk_fma_f32 v[190:191], v[142:143], v[98:99], v[190:191]
  v_pk_mul_f32 v[176:177], v[144:145], v[84:85]
  v_pk_mul_f32 v[192:193], v[160:161], v[84:85]
  v_pk_fma_f32 v[176:177], v[160:161], v[100:101], v[176:177] neg_lo:[1,0,0] neg_hi:[1,0,0]
  v_pk_fma_f32 v[192:193], v[144:145], v[100:101], v[192:193]
  v_pk_mul_f32 v[178:179], v[146:147], v[86:87]
  v_pk_mul_f32 v[194:195], v[162:163], v[86:87]
  v_pk_fma_f32 v[178:179], v[162:163], v[102:103], v[178:179] neg_lo:[1,0,0] neg_hi:[1,0,0]
  v_pk_fma_f32 v[194:195], v[146:147], v[102:103], v[194:195]
  v_pk_mul_f32 v[180:181], v[148:149], v[88:89]
  v_pk_mul_f32 v[196:197], v[164:165], v[88:89]
  v_pk_fma_f32 v[180:181], v[164:165], v[104:105], v[180:181] neg_lo:[1,0,0] neg_hi:[1,0,0]
  v_pk_fma_f32 v[196:197], v[148:149], v[104:105], v[196:197]
  v_pk_mul_f32 v[182:183], v[150:151], v[90:91]
  v_pk_mul_f32 v[198:199], v[166:167], v[90:91]
  v_pk_fma_f32 v[182:183], v[166:167], v[106:107], v[182:183] neg_lo:[1,0,0] neg_hi:[1,0,0]
  v_pk_fma_f32 v[198:199], v[150:151], v[106:107], v[198:199]
  s_waitcnt lgkmcnt(0)
  v_cndmask_b32 v134, 0, v134, s[58:59]
  v_cndmask_b32 v135, 0, v135, s[62:63]
  v_mfma_f32_32x32x16_bf16 v[136:151], v[130:133], v[64:67], 0
  v_mfma_f32_32x32x16_bf16 v[152:167], v[130:133], v[68:71], 0
  v_mfma_f32_32x32x8_bf16 v[136:151], v[134:135], v[72:73], v[136:151]
  v_mfma_f32_32x32x8_bf16 v[152:167], v[134:135], v[74:75], v[152:167]
  ds_read_b128 v[124:127], v9 offset:3072
  ds_read_b64 v[128:129], v12 offset:3104
  v_cvt_pk_bf16_f32 v200, v168, v169
  v_cvt_pk_bf16_f32 v208, v184, v185
  v_cvt_pk_bf16_f32 v201, v170, v171
  v_cvt_pk_bf16_f32 v209, v186, v187
  v_cvt_pk_bf16_f32 v202, v172, v173
  v_cvt_pk_bf16_f32 v210, v188, v189
  v_cvt_pk_bf16_f32 v203, v174, v175
  v_cvt_pk_bf16_f32 v211, v190, v191
  v_cvt_pk_bf16_f32 v204, v176, v177
  v_cvt_pk_bf16_f32 v212, v192, v193
  v_cvt_pk_bf16_f32 v205, v178, v179
  v_cvt_pk_bf16_f32 v213, v194, v195
  v_cvt_pk_bf16_f32 v206, v180, v181
  v_cvt_pk_bf16_f32 v214, v196, v197
  v_cvt_pk_bf16_f32 v207, v182, v183
  v_cvt_pk_bf16_f32 v215, v198, v199
  s_nop 1
  v_mfma_f32_32x32x16_bf16 v[216:231], v[200:203], v[108:111], 0
  v_mfma_f32_32x32x16_bf16 v[216:231], v[208:211], v[116:119], v[216:231]
  v_mfma_f32_32x32x16_bf16 v[216:231], v[204:207], v[112:115], v[216:231]
  v_mfma_f32_32x32x16_bf16 v[216:231], v[212:215], v[120:123], v[216:231]
  v_pk_mul_f32 v[168:169], v[136:137], v[76:77]
  v_pk_mul_f32 v[184:185], v[152:153], v[76:77]
  v_pk_fma_f32 v[168:169], v[152:153], v[92:93], v[168:169] neg_lo:[1,0,0] neg_hi:[1,0,0]
  v_pk_fma_f32 v[184:185], v[136:137], v[92:93], v[184:185]
  v_pk_mul_f32 v[170:171], v[138:139], v[78:79]
  v_pk_mul_f32 v[186:187], v[154:155], v[78:79]
  v_pk_fma_f32 v[170:171], v[154:155], v[94:95], v[170:171] neg_lo:[1,0,0] neg_hi:[1,0,0]
  v_pk_fma_f32 v[186:187], v[138:139], v[94:95], v[186:187]
  v_pk_mul_f32 v[172:173], v[140:141], v[80:81]
  v_pk_mul_f32 v[188:189], v[156:157], v[80:81]
  v_pk_fma_f32 v[172:173], v[156:157], v[96:97], v[172:173] neg_lo:[1,0,0] neg_hi:[1,0,0]
  v_pk_fma_f32 v[188:189], v[140:141], v[96:97], v[188:189]
  v_pk_mul_f32 v[174:175], v[142:143], v[82:83]
  v_pk_mul_f32 v[190:191], v[158:159], v[82:83]
  v_pk_fma_f32 v[174:175], v[158:159], v[98:99], v[174:175] neg_lo:[1,0,0] neg_hi:[1,0,0]
  v_pk_fma_f32 v[190:191], v[142:143], v[98:99], v[190:191]
  v_pk_mul_f32 v[176:177], v[144:145], v[84:85]
  v_pk_mul_f32 v[192:193], v[160:161], v[84:85]
  v_pk_fma_f32 v[176:177], v[160:161], v[100:101], v[176:177] neg_lo:[1,0,0] neg_hi:[1,0,0]
  v_pk_fma_f32 v[192:193], v[144:145], v[100:101], v[192:193]
  v_pk_mul_f32 v[178:179], v[146:147], v[86:87]
  v_pk_mul_f32 v[194:195], v[162:163], v[86:87]
  v_pk_fma_f32 v[178:179], v[162:163], v[102:103], v[178:179] neg_lo:[1,0,0] neg_hi:[1,0,0]
  v_pk_fma_f32 v[194:195], v[146:147], v[102:103], v[194:195]
  v_pk_mul_f32 v[180:181], v[148:149], v[88:89]
  v_pk_mul_f32 v[196:197], v[164:165], v[88:89]
  v_pk_fma_f32 v[180:181], v[164:165], v[104:105], v[180:181] neg_lo:[1,0,0] neg_hi:[1,0,0]
  v_pk_fma_f32 v[196:197], v[148:149], v[104:105], v[196:197]
  v_pk_mul_f32 v[182:183], v[150:151], v[90:91]
  v_pk_mul_f32 v[198:199], v[166:167], v[90:91]
  v_pk_fma_f32 v[182:183], v[166:167], v[106:107], v[182:183] neg_lo:[1,0,0] neg_hi:[1,0,0]
  v_pk_fma_f32 v[198:199], v[150:151], v[106:107], v[198:199]
  s_waitcnt lgkmcnt(0)
  v_cndmask_b32 v128, 0, v128, s[58:59]
  v_cndmask_b32 v129, 0, v129, s[62:63]
  v_mfma_f32_32x32x16_bf16 v[136:151], v[124:127], v[64:67], 0
  v_mfma_f32_32x32x16_bf16 v[152:167], v[124:127], v[68:71], 0
  v_mfma_f32_32x32x8_bf16 v[136:151], v[128:129], v[72:73], v[136:151]
  v_mfma_f32_32x32x8_bf16 v[152:167], v[128:129], v[74:75], v[152:167]
  ds_read_b128 v[130:133], v9 offset:4608
  ds_read_b64 v[134:135], v12 offset:4640
  v_cvt_pk_bf16_f32 v232, v216, v217
  v_cvt_pk_bf16_f32 v233, v218, v219
  v_cvt_pk_bf16_f32 v234, v220, v221
  v_cvt_pk_bf16_f32 v235, v222, v223
  v_cvt_pk_bf16_f32 v236, v224, v225
  v_cvt_pk_bf16_f32 v237, v226, v227
  ds_write_b64 v13, v[232:233] offset:0
  ds_write_b64 v13, v[234:235] offset:16
  s_mov_b32 exec_hi, 0
  ds_write_b64 v13, v[236:237] offset:32
  s_mov_b64 exec, -1
  v_cvt_pk_bf16_f32 v200, v168, v169
  v_cvt_pk_bf16_f32 v208, v184, v185
  v_cvt_pk_bf16_f32 v201, v170, v171
  v_cvt_pk_bf16_f32 v209, v186, v187
  v_cvt_pk_bf16_f32 v202, v172, v173
  v_cvt_pk_bf16_f32 v210, v188, v189
  v_cvt_pk_bf16_f32 v203, v174, v175
  v_cvt_pk_bf16_f32 v211, v190, v191
  v_cvt_pk_bf16_f32 v204, v176, v177
  v_cvt_pk_bf16_f32 v212, v192, v193
  v_cvt_pk_bf16_f32 v205, v178, v179
  v_cvt_pk_bf16_f32 v213, v194, v195
  v_cvt_pk_bf16_f32 v206, v180, v181
  v_cvt_pk_bf16_f32 v214, v196, v197
  v_cvt_pk_bf16_f32 v207, v182, v183
  v_cvt_pk_bf16_f32 v215, v198, v199
  s_nop 1
  v_mfma_f32_32x32x16_bf16 v[216:231], v[200:203], v[108:111], 0
  v_mfma_f32_32x32x16_bf16 v[216:231], v[208:211], v[116:119], v[216:231]
  v_mfma_f32_32x32x16_bf16 v[216:231], v[204:207], v[112:115], v[216:231]
  v_mfma_f32_32x32x16_bf16 v[216:231], v[212:215], v[120:123], v[216:231]
  s_waitcnt lgkmcnt(0)
  ds_read_b128 v[238:241], v14 offset:0
  ds_read_b128 v[242:245], v14 offset:1024
  s_add_u32 s51, s50, 0
  s_lshl_b32 s51, s51, 6
  s_add_u32 s51, s51, s49
  s_mul_i32 s51, s51, 1280
  s_add_u32 s51, s51, 13631488
  s_waitcnt lgkmcnt(0)
  buffer_store_dwordx4 v[238:241], v15, s[40:43], s51 offen sc1
  s_mov_b64 exec, 0xffff
  buffer_store_dwordx4 v[242:245], v15, s[40:43], s51 offen offset:1024 sc1
  s_mov_b64 exec, -1
  v_pk_mul_f32 v[168:169], v[136:137], v[76:77]
  v_pk_mul_f32 v[184:185], v[152:153], v[76:77]
  v_pk_fma_f32 v[168:169], v[152:153], v[92:93], v[168:169] neg_lo:[1,0,0] neg_hi:[1,0,0]
  v_pk_fma_f32 v[184:185], v[136:137], v[92:93], v[184:185]
  v_pk_mul_f32 v[170:171], v[138:139], v[78:79]
  v_pk_mul_f32 v[186:187], v[154:155], v[78:79]
  v_pk_fma_f32 v[170:171], v[154:155], v[94:95], v[170:171] neg_lo:[1,0,0] neg_hi:[1,0,0]
  v_pk_fma_f32 v[186:187], v[138:139], v[94:95], v[186:187]
  v_pk_mul_f32 v[172:173], v[140:141], v[80:81]
  v_pk_mul_f32 v[188:189], v[156:157], v[80:81]
  v_pk_fma_f32 v[172:173], v[156:157], v[96:97], v[172:173] neg_lo:[1,0,0] neg_hi:[1,0,0]
  v_pk_fma_f32 v[188:189], v[140:141], v[96:97], v[188:189]
  v_pk_mul_f32 v[174:175], v[142:143], v[82:83]
  v_pk_mul_f32 v[190:191], v[158:159], v[82:83]
  v_pk_fma_f32 v[174:175], v[158:159], v[98:99], v[174:175] neg_lo:[1,0,0] neg_hi:[1,0,0]
  v_pk_fma_f32 v[190:191], v[142:143], v[98:99], v[190:191]
  v_pk_mul_f32 v[176:177], v[144:145], v[84:85]
  v_pk_mul_f32 v[192:193], v[160:161], v[84:85]
  v_pk_fma_f32 v[176:177], v[160:161], v[100:101], v[176:177] neg_lo:[1,0,0] neg_hi:[1,0,0]
  v_pk_fma_f32 v[192:193], v[144:145], v[100:101], v[192:193]
  v_pk_mul_f32 v[178:179], v[146:147], v[86:87]
  v_pk_mul_f32 v[194:195], v[162:163], v[86:87]
  v_pk_fma_f32 v[178:179], v[162:163], v[102:103], v[178:179] neg_lo:[1,0,0] neg_hi:[1,0,0]
  v_pk_fma_f32 v[194:195], v[146:147], v[102:103], v[194:195]
  v_pk_mul_f32 v[180:181], v[148:149], v[88:89]
  v_pk_mul_f32 v[196:197], v[164:165], v[88:89]
  v_pk_fma_f32 v[180:181], v[164:165], v[104:105], v[180:181] neg_lo:[1,0,0] neg_hi:[1,0,0]
  v_pk_fma_f32 v[196:197], v[148:149], v[104:105], v[196:197]
  v_pk_mul_f32 v[182:183], v[150:151], v[90:91]
  v_pk_mul_f32 v[198:199], v[166:167], v[90:91]
  v_pk_fma_f32 v[182:183], v[166:167], v[106:107], v[182:183] neg_lo:[1,0,0] neg_hi:[1,0,0]
  v_pk_fma_f32 v[198:199], v[150:151], v[106:107], v[198:199]
  s_waitcnt lgkmcnt(0)
  v_cndmask_b32 v134, 0, v134, s[58:59]
  v_cndmask_b32 v135, 0, v135, s[62:63]
  v_mfma_f32_32x32x16_bf16 v[136:151], v[130:133], v[64:67], 0
  v_mfma_f32_32x32x16_bf16 v[152:167], v[130:133], v[68:71], 0
  v_mfma_f32_32x32x8_bf16 v[136:151], v[134:135], v[72:73], v[136:151]
  v_mfma_f32_32x32x8_bf16 v[152:167], v[134:135], v[74:75], v[152:167]
  v_cvt_pk_bf16_f32 v232, v216, v217
  v_cvt_pk_bf16_f32 v233, v218, v219
  v_cvt_pk_bf16_f32 v234, v220, v221
  v_cvt_pk_bf16_f32 v235, v222, v223
  v_cvt_pk_bf16_f32 v236, v224, v225
  v_cvt_pk_bf16_f32 v237, v226, v227
  ds_write_b64 v13, v[232:233] offset:1536
  ds_write_b64 v13, v[234:235] offset:1552
  s_mov_b32 exec_hi, 0
  ds_write_b64 v13, v[236:237] offset:1568
  s_mov_b64 exec, -1
  v_cvt_pk_bf16_f32 v200, v168, v169
  v_cvt_pk_bf16_f32 v208, v184, v185
  v_cvt_pk_bf16_f32 v201, v170, v171
  v_cvt_pk_bf16_f32 v209, v186, v187
  v_cvt_pk_bf16_f32 v202, v172, v173
  v_cvt_pk_bf16_f32 v210, v188, v189
  v_cvt_pk_bf16_f32 v203, v174, v175
  v_cvt_pk_bf16_f32 v211, v190, v191
  v_cvt_pk_bf16_f32 v204, v176, v177
  v_cvt_pk_bf16_f32 v212, v192, v193
  v_cvt_pk_bf16_f32 v205, v178, v179
  v_cvt_pk_bf16_f32 v213, v194, v195
  v_cvt_pk_bf16_f32 v206, v180, v181
  v_cvt_pk_bf16_f32 v214, v196, v197
  v_cvt_pk_bf16_f32 v207, v182, v183
  v_cvt_pk_bf16_f32 v215, v198, v199
  s_nop 1
  v_mfma_f32_32x32x16_bf16 v[216:231], v[200:203], v[108:111], 0
  v_mfma_f32_32x32x16_bf16 v[216:231], v[208:211], v[116:119], v[216:231]
  v_mfma_f32_32x32x16_bf16 v[216:231], v[204:207], v[112:115], v[216:231]
  v_mfma_f32_32x32x16_bf16 v[216:231], v[212:215], v[120:123], v[216:231]
  s_waitcnt lgkmcnt(0)
  ds_read_b128 v[246:249], v14 offset:1536
  ds_read_b128 v[250:253], v14 offset:2560
  s_add_u32 s51, s50, 1
  s_lshl_b32 s51, s51, 6
  s_add_u32 s51, s51, s49
  s_mul_i32 s51, s51, 1280
  s_add_u32 s51, s51, 13631488
  s_waitcnt lgkmcnt(0)
  buffer_store_dwordx4 v[246:249], v15, s[40:43], s51 offen sc1
  s_mov_b64 exec, 0xffff
  buffer_store_dwordx4 v[250:253], v15, s[40:43], s51 offen offset:1024 sc1
  s_mov_b64 exec, -1
  v_pk_mul_f32 v[168:169], v[136:137], v[76:77]
  v_pk_mul_f32 v[184:185], v[152:153], v[76:77]
  v_pk_fma_f32 v[168:169], v[152:153], v[92:93], v[168:169] neg_lo:[1,0,0] neg_hi:[1,0,0]
  v_pk_fma_f32 v[184:185], v[136:137], v[92:93], v[184:185]
  v_pk_mul_f32 v[170:171], v[138:139], v[78:79]
  v_pk_mul_f32 v[186:187], v[154:155], v[78:79]
  v_pk_fma_f32 v[170:171], v[154:155], v[94:95], v[170:171] neg_lo:[1,0,0] neg_hi:[1,0,0]
  v_pk_fma_f32 v[186:187], v[138:139], v[94:95], v[186:187]
  v_pk_mul_f32 v[172:173], v[140:141], v[80:81]
  v_pk_mul_f32 v[188:189], v[156:157], v[80:81]
  v_pk_fma_f32 v[172:173], v[156:157], v[96:97], v[172:173] neg_lo:[1,0,0] neg_hi:[1,0,0]
  v_pk_fma_f32 v[188:189], v[140:141], v[96:97], v[188:189]
  v_pk_mul_f32 v[174:175], v[142:143], v[82:83]
  v_pk_mul_f32 v[190:191], v[158:159], v[82:83]
  v_pk_fma_f32 v[174:175], v[158:159], v[98:99], v[174:175] neg_lo:[1,0,0] neg_hi:[1,0,0]
  v_pk_fma_f32 v[190:191], v[142:143], v[98:99], v[190:191]
  v_pk_mul_f32 v[176:177], v[144:145], v[84:85]
  v_pk_mul_f32 v[192:193], v[160:161], v[84:85]
  v_pk_fma_f32 v[176:177], v[160:161], v[100:101], v[176:177] neg_lo:[1,0,0] neg_hi:[1,0,0]
  v_pk_fma_f32 v[192:193], v[144:145], v[100:101], v[192:193]
  v_pk_mul_f32 v[178:179], v[146:147], v[86:87]
  v_pk_mul_f32 v[194:195], v[162:163], v[86:87]
  v_pk_fma_f32 v[178:179], v[162:163], v[102:103], v[178:179] neg_lo:[1,0,0] neg_hi:[1,0,0]
  v_pk_fma_f32 v[194:195], v[146:147], v[102:103], v[194:195]
  v_pk_mul_f32 v[180:181], v[148:149], v[88:89]
  v_pk_mul_f32 v[196:197], v[164:165], v[88:89]
  v_pk_fma_f32 v[180:181], v[164:165], v[104:105], v[180:181] neg_lo:[1,0,0] neg_hi:[1,0,0]
  v_pk_fma_f32 v[196:197], v[148:149], v[104:105], v[196:197]
  v_pk_mul_f32 v[182:183], v[150:151], v[90:91]
  v_pk_mul_f32 v[198:199], v[166:167], v[90:91]
  v_pk_fma_f32 v[182:183], v[166:167], v[106:107], v[182:183] neg_lo:[1,0,0] neg_hi:[1,0,0]
  v_pk_fma_f32 v[198:199], v[150:151], v[106:107], v[198:199]
  v_cvt_pk_bf16_f32 v232, v216, v217
  v_cvt_pk_bf16_f32 v233, v218, v219
  v_cvt_pk_bf16_f32 v234, v220, v221
  v_cvt_pk_bf16_f32 v235, v222, v223
  v_cvt_pk_bf16_f32 v236, v224, v225
  v_cvt_pk_bf16_f32 v237, v226, v227
  ds_write_b64 v13, v[232:233] offset:3072
  ds_write_b64 v13, v[234:235] offset:3088
  s_mov_b32 exec_hi, 0
  ds_write_b64 v13, v[236:237] offset:3104
  s_mov_b64 exec, -1
  v_cvt_pk_bf16_f32 v200, v168, v169
  v_cvt_pk_bf16_f32 v208, v184, v185
  v_cvt_pk_bf16_f32 v201, v170, v171
  v_cvt_pk_bf16_f32 v209, v186, v187
  v_cvt_pk_bf16_f32 v202, v172, v173
  v_cvt_pk_bf16_f32 v210, v188, v189
  v_cvt_pk_bf16_f32 v203, v174, v175
  v_cvt_pk_bf16_f32 v211, v190, v191
  v_cvt_pk_bf16_f32 v204, v176, v177
  v_cvt_pk_bf16_f32 v212, v192, v193
  v_cvt_pk_bf16_f32 v205, v178, v179
  v_cvt_pk_bf16_f32 v213, v194, v195
  v_cvt_pk_bf16_f32 v206, v180, v181
  v_cvt_pk_bf16_f32 v214, v196, v197
  v_cvt_pk_bf16_f32 v207, v182, v183
  v_cvt_pk_bf16_f32 v215, v198, v199
  s_nop 1
  v_mfma_f32_32x32x16_bf16 v[216:231], v[200:203], v[108:111], 0
  v_mfma_f32_32x32x16_bf16 v[216:231], v[208:211], v[116:119], v[216:231]
  v_mfma_f32_32x32x16_bf16 v[216:231], v[204:207], v[112:115], v[216:231]
  v_mfma_f32_32x32x16_bf16 v[216:231], v[212:215], v[120:123], v[216:231]
  s_waitcnt lgkmcnt(0)
  ds_read_b128 v[238:241], v14 offset:3072
  ds_read_b128 v[242:245], v14 offset:4096
  s_add_u32 s51, s50, 2
  s_lshl_b32 s51, s51, 6
  s_add_u32 s51, s51, s49
  s_mul_i32 s51, s51, 1280
  s_add_u32 s51, s51, 13631488
  s_waitcnt lgkmcnt(0)
  buffer_store_dwordx4 v[238:241], v15, s[40:43], s51 offen sc1
  s_mov_b64 exec, 0xffff
  buffer_store_dwordx4 v[242:245], v15, s[40:43], s51 offen offset:1024 sc1
  s_mov_b64 exec, -1
  s_nop 15
  v_cvt_pk_bf16_f32 v232, v216, v217
  v_cvt_pk_bf16_f32 v233, v218, v219
  v_cvt_pk_bf16_f32 v234, v220, v221
  v_cvt_pk_bf16_f32 v235, v222, v223
  v_cvt_pk_bf16_f32 v236, v224, v225
  v_cvt_pk_bf16_f32 v237, v226, v227
  ds_write_b64 v13, v[232:233] offset:4608
  ds_write_b64 v13, v[234:235] offset:4624
  s_mov_b32 exec_hi, 0
  ds_write_b64 v13, v[236:237] offset:4640
  s_mov_b64 exec, -1
  s_waitcnt lgkmcnt(0)
  ds_read_b128 v[246:249], v14 offset:4608
  ds_read_b128 v[250:253], v14 offset:5632
  s_add_u32 s51, s50, 3
  s_lshl_b32 s51, s51, 6
  s_add_u32 s51, s51, s49
  s_mul_i32 s51, s51, 1280
  s_add_u32 s51, s51, 13631488
  s_waitcnt lgkmcnt(0)
  buffer_store_dwordx4 v[246:249], v15, s[40:43], s51 offen sc1
  s_mov_b64 exec, 0xffff
  buffer_store_dwordx4 v[250:253], v15, s[40:43], s51 offen offset:1024 sc1
  s_mov_b64 exec, -1
  ds_write_b32 v8, v20 offset:0
  ds_write_b32 v8, v21 offset:1536
  ds_write_b32 v8, v22 offset:3072
  ds_write_b32 v8, v23 offset:4608
  ds_write_b32 v8, v28 offset:8
  ds_write_b32 v8, v29 offset:1544
  ds_write_b32 v8, v30 offset:3080
  ds_write_b32 v8, v31 offset:4616
  ds_write_b32 v8, v36 offset:16
  ds_write_b32 v8, v37 offset:1552
  ds_write_b32 v8, v38 offset:3088
  ds_write_b32 v8, v39 offset:4624
  ds_write_b32 v8, v44 offset:24
  ds_write_b32 v8, v45 offset:1560
  ds_write_b32 v8, v46 offset:3096
  ds_write_b32 v8, v47 offset:4632
  ds_write_b32 v8, v52 offset:32
  ds_write_b32 v8, v53 offset:1568
  ds_write_b32 v8, v54 offset:3104
  ds_write_b32 v8, v55 offset:4640
  s_mov_b64 exec, 1
  ds_write_b32 v8, v60 offset:40
  ds_write_b32 v8, v61 offset:1576
  ds_write_b32 v8, v62 offset:3112
  ds_write_b32 v8, v63 offset:4648
  s_mov_b64 exec, -1
  s_waitcnt lgkmcnt(0)
  ds_read_b128 v[124:127], v9 offset:0
  ds_read_b64 v[128:129], v12 offset:32
  ds_read_b128 v[130:133], v9 offset:1536
  ds_read_b64 v[134:135], v12 offset:1568
  s_waitcnt lgkmcnt(2)
  v_cndmask_b32 v128, 0, v128, s[58:59]
  v_cndmask_b32 v129, 0, v129, s[62:63]
  v_mfma_f32_32x32x16_bf16 v[136:151], v[124:127], v[64:67], 0
  v_mfma_f32_32x32x16_bf16 v[152:167], v[124:127], v[68:71], 0
  v_mfma_f32_32x32x8_bf16 v[136:151], v[128:129], v[72:73], v[136:151]
  v_mfma_f32_32x32x8_bf16 v[152:167], v[128:129], v[74:75], v[152:167]
  s_nop 15
  v_pk_mul_f32 v[168:169], v[136:137], v[76:77]
  v_pk_mul_f32 v[184:185], v[152:153], v[76:77]
  v_pk_fma_f32 v[168:169], v[152:153], v[92:93], v[168:169] neg_lo:[1,0,0] neg_hi:[1,0,0]
  v_pk_fma_f32 v[184:185], v[136:137], v[92:93], v[184:185]
  v_pk_mul_f32 v[170:171], v[138:139], v[78:79]
  v_pk_mul_f32 v[186:187], v[154:155], v[78:79]
  v_pk_fma_f32 v[170:171], v[154:155], v[94:95], v[170:171] neg_lo:[1,0,0] neg_hi:[1,0,0]
  v_pk_fma_f32 v[186:187], v[138:139], v[94:95], v[186:187]
  v_pk_mul_f32 v[172:173], v[140:141], v[80:81]
  v_pk_mul_f32 v[188:189], v[156:157], v[80:81]
  v_pk_fma_f32 v[172:173], v[156:157], v[96:97], v[172:173] neg_lo:[1,0,0] neg_hi:[1,0,0]
  v_pk_fma_f32 v[188:189], v[140:141], v[96:97], v[188:189]
  v_pk_mul_f32 v[174:175], v[142:143], v[82:83]
  v_pk_mul_f32 v[190:191], v[158:159], v[82:83]
  v_pk_fma_f32 v[174:175], v[158:159], v[98:99], v[174:175] neg_lo:[1,0,0] neg_hi:[1,0,0]
  v_pk_fma_f32 v[190:191], v[142:143], v[98:99], v[190:191]
  v_pk_mul_f32 v[176:177], v[144:145], v[84:85]
  v_pk_mul_f32 v[192:193], v[160:161], v[84:85]
  v_pk_fma_f32 v[176:177], v[160:161], v[100:101], v[176:177] neg_lo:[1,0,0] neg_hi:[1,0,0]
  v_pk_fma_f32 v[192:193], v[144:145], v[100:101], v[192:193]
  v_pk_mul_f32 v[178:179], v[146:147], v[86:87]
  v_pk_mul_f32 v[194:195], v[162:163], v[86:87]
  v_pk_fma_f32 v[178:179], v[162:163], v[102:103], v[178:179] neg_lo:[1,0,0] neg_hi:[1,0,0]
  v_pk_fma_f32 v[194:195], v[146:147], v[102:103], v[194:195]
  v_pk_mul_f32 v[180:181], v[148:149], v[88:89]
  v_pk_mul_f32 v[196:197], v[164:165], v[88:89]
  v_pk_fma_f32 v[180:181], v[164:165], v[104:105], v[180:181] neg_lo:[1,0,0] neg_hi:[1,0,0]
  v_pk_fma_f32 v[196:197], v[148:149], v[104:105], v[196:197]
  v_pk_mul_f32 v[182:183], v[150:151], v[90:91]
  v_pk_mul_f32 v[198:199], v[166:167], v[90:91]
  v_pk_fma_f32 v[182:183], v[166:167], v[106:107], v[182:183] neg_lo:[1,0,0] neg_hi:[1,0,0]
  v_pk_fma_f32 v[198:199], v[150:151], v[106:107], v[198:199]
  s_waitcnt lgkmcnt(0)
  v_cndmask_b32 v134, 0, v134, s[58:59]
  v_cndmask_b32 v135, 0, v135, s[62:63]
  v_mfma_f32_32x32x16_bf16 v[136:151], v[130:133], v[64:67], 0
  v_mfma_f32_32x32x16_bf16 v[152:167], v[130:133], v[68:71], 0
  v_mfma_f32_32x32x8_bf16 v[136:151], v[134:135], v[72:73], v[136:151]
  v_mfma_f32_32x32x8_bf16 v[152:167], v[134:135], v[74:75], v[152:167]
  ds_read_b128 v[124:127], v9 offset:3072
  ds_read_b64 v[128:129], v12 offset:3104
  v_cvt_pk_bf16_f32 v200, v168, v169
  v_cvt_pk_bf16_f32 v208, v184, v185
  v_cvt_pk_bf16_f32 v201, v170, v171
  v_cvt_pk_bf16_f32 v209, v186, v187
  v_cvt_pk_bf16_f32 v202, v172, v173
  v_cvt_pk_bf16_f32 v210, v188, v189
  v_cvt_pk_bf16_f32 v203, v174, v175
  v_cvt_pk_bf16_f32 v211, v190, v191
  v_cvt_pk_bf16_f32 v204, v176, v177
  v_cvt_pk_bf16_f32 v212, v192, v193
  v_cvt_pk_bf16_f32 v205, v178, v179
  v_cvt_pk_bf16_f32 v213, v194, v195
  v_cvt_pk_bf16_f32 v206, v180, v181
  v_cvt_pk_bf16_f32 v214, v196, v197
  v_cvt_pk_bf16_f32 v207, v182, v183
  v_cvt_pk_bf16_f32 v215, v198, v199
  s_nop 1
  v_mfma_f32_32x32x16_bf16 v[216:231], v[200:203], v[108:111], 0
  v_mfma_f32_32x32x16_bf16 v[216:231], v[208:211], v[116:119], v[216:231]
  v_mfma_f32_32x32x16_bf16 v[216:231], v[204:207], v[112:115], v[216:231]
  v_mfma_f32_32x32x16_bf16 v[216:231], v[212:215], v[120:123], v[216:231]
  v_pk_mul_f32 v[168:169], v[136:137], v[76:77]
  v_pk_mul_f32 v[184:185], v[152:153], v[76:77]
  v_pk_fma_f32 v[168:169], v[152:153], v[92:93], v[168:169] neg_lo:[1,0,0] neg_hi:[1,0,0]
  v_pk_fma_f32 v[184:185], v[136:137], v[92:93], v[184:185]
  v_pk_mul_f32 v[170:171], v[138:139], v[78:79]
  v_pk_mul_f32 v[186:187], v[154:155], v[78:79]
  v_pk_fma_f32 v[170:171], v[154:155], v[94:95], v[170:171] neg_lo:[1,0,0] neg_hi:[1,0,0]
  v_pk_fma_f32 v[186:187], v[138:139], v[94:95], v[186:187]
  v_pk_mul_f32 v[172:173], v[140:141], v[80:81]
  v_pk_mul_f32 v[188:189], v[156:157], v[80:81]
  v_pk_fma_f32 v[172:173], v[156:157], v[96:97], v[172:173] neg_lo:[1,0,0] neg_hi:[1,0,0]
  v_pk_fma_f32 v[188:189], v[140:141], v[96:97], v[188:189]
  v_pk_mul_f32 v[174:175], v[142:143], v[82:83]
  v_pk_mul_f32 v[190:191], v[158:159], v[82:83]
  v_pk_fma_f32 v[174:175], v[158:159], v[98:99], v[174:175] neg_lo:[1,0,0] neg_hi:[1,0,0]
  v_pk_fma_f32 v[190:191], v[142:143], v[98:99], v[190:191]
  v_pk_mul_f32 v[176:177], v[144:145], v[84:85]
  v_pk_mul_f32 v[192:193], v[160:161], v[84:85]
  v_pk_fma_f32 v[176:177], v[160:161], v[100:101], v[176:177] neg_lo:[1,0,0] neg_hi:[1,0,0]
  v_pk_fma_f32 v[192:193], v[144:145], v[100:101], v[192:193]
  v_pk_mul_f32 v[178:179], v[146:147], v[86:87]
  v_pk_mul_f32 v[194:195], v[162:163], v[86:87]
  v_pk_fma_f32 v[178:179], v[162:163], v[102:103], v[178:179] neg_lo:[1,0,0] neg_hi:[1,0,0]
  v_pk_fma_f32 v[194:195], v[146:147], v[102:103], v[194:195]
  v_pk_mul_f32 v[180:181], v[148:149], v[88:89]
  v_pk_mul_f32 v[196:197], v[164:165], v[88:89]
  v_pk_fma_f32 v[180:181], v[164:165], v[104:105], v[180:181] neg_lo:[1,0,0] neg_hi:[1,0,0]
  v_pk_fma_f32 v[196:197], v[148:149], v[104:105], v[196:197]
  v_pk_mul_f32 v[182:183], v[150:151], v[90:91]
  v_pk_mul_f32 v[198:199], v[166:167], v[90:91]
  v_pk_fma_f32 v[182:183], v[166:167], v[106:107], v[182:183] neg_lo:[1,0,0] neg_hi:[1,0,0]
  v_pk_fma_f32 v[198:199], v[150:151], v[106:107], v[198:199]
  s_waitcnt lgkmcnt(0)
  v_cndmask_b32 v128, 0, v128, s[58:59]
  v_cndmask_b32 v129, 0, v129, s[62:63]
  v_mfma_f32_32x32x16_bf16 v[136:151], v[124:127], v[64:67], 0
  v_mfma_f32_32x32x16_bf16 v[152:167], v[124:127], v[68:71], 0
  v_mfma_f32_32x32x8_bf16 v[136:151], v[128:129], v[72:73], v[136:151]
  v_mfma_f32_32x32x8_bf16 v[152:167], v[128:129], v[74:75], v[152:167]
  ds_read_b128 v[130:133], v9 offset:4608
  ds_read_b64 v[134:135], v12 offset:4640
  v_cvt_pk_bf16_f32 v232, v216, v217
  v_cvt_pk_bf16_f32 v233, v218, v219
  v_cvt_pk_bf16_f32 v234, v220, v221
  v_cvt_pk_bf16_f32 v235, v222, v223
  v_cvt_pk_bf16_f32 v236, v224, v225
  v_cvt_pk_bf16_f32 v237, v226, v227
  ds_write_b64 v13, v[232:233] offset:0
  ds_write_b64 v13, v[234:235] offset:16
  s_mov_b32 exec_hi, 0
  ds_write_b64 v13, v[236:237] offset:32
  s_mov_b64 exec, -1
  v_cvt_pk_bf16_f32 v200, v168, v169
  v_cvt_pk_bf16_f32 v208, v184, v185
  v_cvt_pk_bf16_f32 v201, v170, v171
  v_cvt_pk_bf16_f32 v209, v186, v187
  v_cvt_pk_bf16_f32 v202, v172, v173
  v_cvt_pk_bf16_f32 v210, v188, v189
  v_cvt_pk_bf16_f32 v203, v174, v175
  v_cvt_pk_bf16_f32 v211, v190, v191
  v_cvt_pk_bf16_f32 v204, v176, v177
  v_cvt_pk_bf16_f32 v212, v192, v193
  v_cvt_pk_bf16_f32 v205, v178, v179
  v_cvt_pk_bf16_f32 v213, v194, v195
  v_cvt_pk_bf16_f32 v206, v180, v181
  v_cvt_pk_bf16_f32 v214, v196, v197
  v_cvt_pk_bf16_f32 v207, v182, v183
  v_cvt_pk_bf16_f32 v215, v198, v199
  s_nop 1
  v_mfma_f32_32x32x16_bf16 v[216:231], v[200:203], v[108:111], 0
  v_mfma_f32_32x32x16_bf16 v[216:231], v[208:211], v[116:119], v[216:231]
  v_mfma_f32_32x32x16_bf16 v[216:231], v[204:207], v[112:115], v[216:231]
  v_mfma_f32_32x32x16_bf16 v[216:231], v[212:215], v[120:123], v[216:231]
  s_waitcnt lgkmcnt(0)
  ds_read_b128 v[238:241], v14 offset:0
  ds_read_b128 v[242:245], v14 offset:1024
  s_add_u32 s51, s50, 8
  s_lshl_b32 s51, s51, 6
  s_add_u32 s51, s51, s49
  s_mul_i32 s51, s51, 1280
  s_add_u32 s51, s51, 13631488
  s_waitcnt lgkmcnt(0)
  buffer_store_dwordx4 v[238:241], v15, s[40:43], s51 offen sc1
  s_mov_b64 exec, 0xffff
  buffer_store_dwordx4 v[242:245], v15, s[40:43], s51 offen offset:1024 sc1
  s_mov_b64 exec, -1
  v_pk_mul_f32 v[168:169], v[136:137], v[76:77]
  v_pk_mul_f32 v[184:185], v[152:153], v[76:77]
  v_pk_fma_f32 v[168:169], v[152:153], v[92:93], v[168:169] neg_lo:[1,0,0] neg_hi:[1,0,0]
  v_pk_fma_f32 v[184:185], v[136:137], v[92:93], v[184:185]
  v_pk_mul_f32 v[170:171], v[138:139], v[78:79]
  v_pk_mul_f32 v[186:187], v[154:155], v[78:79]
  v_pk_fma_f32 v[170:171], v[154:155], v[94:95], v[170:171] neg_lo:[1,0,0] neg_hi:[1,0,0]
  v_pk_fma_f32 v[186:187], v[138:139], v[94:95], v[186:187]
  v_pk_mul_f32 v[172:173], v[140:141], v[80:81]
  v_pk_mul_f32 v[188:189], v[156:157], v[80:81]
  v_pk_fma_f32 v[172:173], v[156:157], v[96:97], v[172:173] neg_lo:[1,0,0] neg_hi:[1,0,0]
  v_pk_fma_f32 v[188:189], v[140:141], v[96:97], v[188:189]
  v_pk_mul_f32 v[174:175], v[142:143], v[82:83]
  v_pk_mul_f32 v[190:191], v[158:159], v[82:83]
  v_pk_fma_f32 v[174:175], v[158:159], v[98:99], v[174:175] neg_lo:[1,0,0] neg_hi:[1,0,0]
  v_pk_fma_f32 v[190:191], v[142:143], v[98:99], v[190:191]
  v_pk_mul_f32 v[176:177], v[144:145], v[84:85]
  v_pk_mul_f32 v[192:193], v[160:161], v[84:85]
  v_pk_fma_f32 v[176:177], v[160:161], v[100:101], v[176:177] neg_lo:[1,0,0] neg_hi:[1,0,0]
  v_pk_fma_f32 v[192:193], v[144:145], v[100:101], v[192:193]
  v_pk_mul_f32 v[178:179], v[146:147], v[86:87]
  v_pk_mul_f32 v[194:195], v[162:163], v[86:87]
  v_pk_fma_f32 v[178:179], v[162:163], v[102:103], v[178:179] neg_lo:[1,0,0] neg_hi:[1,0,0]
  v_pk_fma_f32 v[194:195], v[146:147], v[102:103], v[194:195]
  v_pk_mul_f32 v[180:181], v[148:149], v[88:89]
  v_pk_mul_f32 v[196:197], v[164:165], v[88:89]
  v_pk_fma_f32 v[180:181], v[164:165], v[104:105], v[180:181] neg_lo:[1,0,0] neg_hi:[1,0,0]
  v_pk_fma_f32 v[196:197], v[148:149], v[104:105], v[196:197]
  v_pk_mul_f32 v[182:183], v[150:151], v[90:91]
  v_pk_mul_f32 v[198:199], v[166:167], v[90:91]
  v_pk_fma_f32 v[182:183], v[166:167], v[106:107], v[182:183] neg_lo:[1,0,0] neg_hi:[1,0,0]
  v_pk_fma_f32 v[198:199], v[150:151], v[106:107], v[198:199]
  s_waitcnt lgkmcnt(0)
  v_cndmask_b32 v134, 0, v134, s[58:59]
  v_cndmask_b32 v135, 0, v135, s[62:63]
  v_mfma_f32_32x32x16_bf16 v[136:151], v[130:133], v[64:67], 0
  v_mfma_f32_32x32x16_bf16 v[152:167], v[130:133], v[68:71], 0
  v_mfma_f32_32x32x8_bf16 v[136:151], v[134:135], v[72:73], v[136:151]
  v_mfma_f32_32x32x8_bf16 v[152:167], v[134:135], v[74:75], v[152:167]
  v_cvt_pk_bf16_f32 v232, v216, v217
  v_cvt_pk_bf16_f32 v233, v218, v219
  v_cvt_pk_bf16_f32 v234, v220, v221
  v_cvt_pk_bf16_f32 v235, v222, v223
  v_cvt_pk_bf16_f32 v236, v224, v225
  v_cvt_pk_bf16_f32 v237, v226, v227
  ds_write_b64 v13, v[232:233] offset:1536
  ds_write_b64 v13, v[234:235] offset:1552
  s_mov_b32 exec_hi, 0
  ds_write_b64 v13, v[236:237] offset:1568
  s_mov_b64 exec, -1
  v_cvt_pk_bf16_f32 v200, v168, v169
  v_cvt_pk_bf16_f32 v208, v184, v185
  v_cvt_pk_bf16_f32 v201, v170, v171
  v_cvt_pk_bf16_f32 v209, v186, v187
  v_cvt_pk_bf16_f32 v202, v172, v173
  v_cvt_pk_bf16_f32 v210, v188, v189
  v_cvt_pk_bf16_f32 v203, v174, v175
  v_cvt_pk_bf16_f32 v211, v190, v191
  v_cvt_pk_bf16_f32 v204, v176, v177
  v_cvt_pk_bf16_f32 v212, v192, v193
  v_cvt_pk_bf16_f32 v205, v178, v179
  v_cvt_pk_bf16_f32 v213, v194, v195
  v_cvt_pk_bf16_f32 v206, v180, v181
  v_cvt_pk_bf16_f32 v214, v196, v197
  v_cvt_pk_bf16_f32 v207, v182, v183
  v_cvt_pk_bf16_f32 v215, v198, v199
  s_nop 1
  v_mfma_f32_32x32x16_bf16 v[216:231], v[200:203], v[108:111], 0
  v_mfma_f32_32x32x16_bf16 v[216:231], v[208:211], v[116:119], v[216:231]
  v_mfma_f32_32x32x16_bf16 v[216:231], v[204:207], v[112:115], v[216:231]
  v_mfma_f32_32x32x16_bf16 v[216:231], v[212:215], v[120:123], v[216:231]
  s_waitcnt lgkmcnt(0)
  ds_read_b128 v[246:249], v14 offset:1536
  ds_read_b128 v[250:253], v14 offset:2560
  s_add_u32 s51, s50, 9
  s_lshl_b32 s51, s51, 6
  s_add_u32 s51, s51, s49
  s_mul_i32 s51, s51, 1280
  s_add_u32 s51, s51, 13631488
  s_waitcnt lgkmcnt(0)
  buffer_store_dwordx4 v[246:249], v15, s[40:43], s51 offen sc1
  s_mov_b64 exec, 0xffff
  buffer_store_dwordx4 v[250:253], v15, s[40:43], s51 offen offset:1024 sc1
  s_mov_b64 exec, -1
  v_pk_mul_f32 v[168:169], v[136:137], v[76:77]
  v_pk_mul_f32 v[184:185], v[152:153], v[76:77]
  v_pk_fma_f32 v[168:169], v[152:153], v[92:93], v[168:169] neg_lo:[1,0,0] neg_hi:[1,0,0]
  v_pk_fma_f32 v[184:185], v[136:137], v[92:93], v[184:185]
  v_pk_mul_f32 v[170:171], v[138:139], v[78:79]
  v_pk_mul_f32 v[186:187], v[154:155], v[78:79]
  v_pk_fma_f32 v[170:171], v[154:155], v[94:95], v[170:171] neg_lo:[1,0,0] neg_hi:[1,0,0]
  v_pk_fma_f32 v[186:187], v[138:139], v[94:95], v[186:187]
  v_pk_mul_f32 v[172:173], v[140:141], v[80:81]
  v_pk_mul_f32 v[188:189], v[156:157], v[80:81]
  v_pk_fma_f32 v[172:173], v[156:157], v[96:97], v[172:173] neg_lo:[1,0,0] neg_hi:[1,0,0]
  v_pk_fma_f32 v[188:189], v[140:141], v[96:97], v[188:189]
  v_pk_mul_f32 v[174:175], v[142:143], v[82:83]
  v_pk_mul_f32 v[190:191], v[158:159], v[82:83]
  v_pk_fma_f32 v[174:175], v[158:159], v[98:99], v[174:175] neg_lo:[1,0,0] neg_hi:[1,0,0]
  v_pk_fma_f32 v[190:191], v[142:143], v[98:99], v[190:191]
  v_pk_mul_f32 v[176:177], v[144:145], v[84:85]
  v_pk_mul_f32 v[192:193], v[160:161], v[84:85]
  v_pk_fma_f32 v[176:177], v[160:161], v[100:101], v[176:177] neg_lo:[1,0,0] neg_hi:[1,0,0]
  v_pk_fma_f32 v[192:193], v[144:145], v[100:101], v[192:193]
  v_pk_mul_f32 v[178:179], v[146:147], v[86:87]
  v_pk_mul_f32 v[194:195], v[162:163], v[86:87]
  v_pk_fma_f32 v[178:179], v[162:163], v[102:103], v[178:179] neg_lo:[1,0,0] neg_hi:[1,0,0]
  v_pk_fma_f32 v[194:195], v[146:147], v[102:103], v[194:195]
  v_pk_mul_f32 v[180:181], v[148:149], v[88:89]
  v_pk_mul_f32 v[196:197], v[164:165], v[88:89]
  v_pk_fma_f32 v[180:181], v[164:165], v[104:105], v[180:181] neg_lo:[1,0,0] neg_hi:[1,0,0]
  v_pk_fma_f32 v[196:197], v[148:149], v[104:105], v[196:197]
  v_pk_mul_f32 v[182:183], v[150:151], v[90:91]
  v_pk_mul_f32 v[198:199], v[166:167], v[90:91]
  v_pk_fma_f32 v[182:183], v[166:167], v[106:107], v[182:183] neg_lo:[1,0,0] neg_hi:[1,0,0]
  v_pk_fma_f32 v[198:199], v[150:151], v[106:107], v[198:199]
  v_cvt_pk_bf16_f32 v232, v216, v217
  v_cvt_pk_bf16_f32 v233, v218, v219
  v_cvt_pk_bf16_f32 v234, v220, v221
  v_cvt_pk_bf16_f32 v235, v222, v223
  v_cvt_pk_bf16_f32 v236, v224, v225
  v_cvt_pk_bf16_f32 v237, v226, v227
  ds_write_b64 v13, v[232:233] offset:3072
  ds_write_b64 v13, v[234:235] offset:3088
  s_mov_b32 exec_hi, 0
  ds_write_b64 v13, v[236:237] offset:3104
  s_mov_b64 exec, -1
  v_cvt_pk_bf16_f32 v200, v168, v169
  v_cvt_pk_bf16_f32 v208, v184, v185
  v_cvt_pk_bf16_f32 v201, v170, v171
  v_cvt_pk_bf16_f32 v209, v186, v187
  v_cvt_pk_bf16_f32 v202, v172, v173
  v_cvt_pk_bf16_f32 v210, v188, v189
  v_cvt_pk_bf16_f32 v203, v174, v175
  v_cvt_pk_bf16_f32 v211, v190, v191
  v_cvt_pk_bf16_f32 v204, v176, v177
  v_cvt_pk_bf16_f32 v212, v192, v193
  v_cvt_pk_bf16_f32 v205, v178, v179
  v_cvt_pk_bf16_f32 v213, v194, v195
  v_cvt_pk_bf16_f32 v206, v180, v181
  v_cvt_pk_bf16_f32 v214, v196, v197
  v_cvt_pk_bf16_f32 v207, v182, v183
  v_cvt_pk_bf16_f32 v215, v198, v199
  s_nop 1
  v_mfma_f32_32x32x16_bf16 v[216:231], v[200:203], v[108:111], 0
  v_mfma_f32_32x32x16_bf16 v[216:231], v[208:211], v[116:119], v[216:231]
  v_mfma_f32_32x32x16_bf16 v[216:231], v[204:207], v[112:115], v[216:231]
  v_mfma_f32_32x32x16_bf16 v[216:231], v[212:215], v[120:123], v[216:231]
  s_waitcnt lgkmcnt(0)
  ds_read_b128 v[238:241], v14 offset:3072
  ds_read_b128 v[242:245], v14 offset:4096
  s_add_u32 s51, s50, 10
  s_lshl_b32 s51, s51, 6
  s_add_u32 s51, s51, s49
  s_mul_i32 s51, s51, 1280
  s_add_u32 s51, s51, 13631488
  s_waitcnt lgkmcnt(0)
  buffer_store_dwordx4 v[238:241], v15, s[40:43], s51 offen sc1
  s_mov_b64 exec, 0xffff
  buffer_store_dwordx4 v[242:245], v15, s[40:43], s51 offen offset:1024 sc1
  s_mov_b64 exec, -1
  s_nop 15
  v_cvt_pk_bf16_f32 v232, v216, v217
  v_cvt_pk_bf16_f32 v233, v218, v219
  v_cvt_pk_bf16_f32 v234, v220, v221
  v_cvt_pk_bf16_f32 v235, v222, v223
  v_cvt_pk_bf16_f32 v236, v224, v225
  v_cvt_pk_bf16_f32 v237, v226, v227
  ds_write_b64 v13, v[232:233] offset:4608
  ds_write_b64 v13, v[234:235] offset:4624
  s_mov_b32 exec_hi, 0
  ds_write_b64 v13, v[236:237] offset:4640
  s_mov_b64 exec, -1
  s_waitcnt lgkmcnt(0)
  ds_read_b128 v[246:249], v14 offset:4608
  ds_read_b128 v[250:253], v14 offset:5632
  s_add_u32 s51, s50, 11
  s_lshl_b32 s51, s51, 6
  s_add_u32 s51, s51, s49
  s_mul_i32 s51, s51, 1280
  s_add_u32 s51, s51, 13631488
  s_waitcnt lgkmcnt(0)
  buffer_store_dwordx4 v[246:249], v15, s[40:43], s51 offen sc1
  s_mov_b64 exec, 0xffff
  buffer_store_dwordx4 v[250:253], v15, s[40:43], s51 offen offset:1024 sc1
  s_mov_b64 exec, -1
  s_waitcnt vmcnt(0)
  s_mov_b32 s60, s2
  s_lshl_b32 s54, s60, 2
  s_add_u32 s54, s54, 16384
  v_mov_b32 v5, s47
  v_mov_b32 v6, 0
  s_mov_b64 s[56:57], exec
  s_mov_b64 exec, 1
  buffer_store_dword v5, v6, s[40:43], s54 offen sc1
  s_mov_b64 exec, s[56:57]
  s_mov_b32 s62, s44
  s_mov_b32 s44, 0
  s_mov_b32 s48, 0xCCCCCCCD
  s_mul_i32 s49, s46, 160
  s_add_u32 s50, s44, 85
  s_mul_i32 s51, s50, 41
  s_lshr_b32 s51, s51, 10
  s_mul_i32 s52, s51, 25
  s_sub_u32 s52, s50, s52
  s_lshl_b32 s53, s52, 6
  v_add_u32 v3, s53, v1
  v_mul_hi_u32 v4, v3, s48
  v_lshrrev_b32 v4, 3, v4
  v_mul_u32_u24 v5, 10, v4
  v_sub_u32 v5, v3, v5
  v_mul_u32_u24 v4, 5120, v4
  v_lshlrev_b32 v5, 4, v5
  s_mul_i32 s53, s51, 1280
  s_add_u32 s53, s53, s49
  v_add3_u32 v4, v4, v5, s53
  s_mul_i32 s53, s51, 25600
  s_and_b32 s54, s51, 1
  s_lshl_b32 s54, s54, 5
  s_add_u32 s53, s53, s54
  s_lshr_b32 s54, s51, 1
  s_lshl_b32 s54, s54, 7
  s_add_u32 s53, s53, s54
  s_lshl_b32 s52, s52, 10
  s_add_u32 s53, s53, s52
  s_add_u32 m0, s53, 60544
  s_nop 0
  buffer_load_dwordx4 v4, s[20:23], 0 offen lds
  s_add_u32 s50, s44, 86
  s_mul_i32 s51, s50, 41
  s_lshr_b32 s51, s51, 10
  s_mul_i32 s52, s51, 25
  s_sub_u32 s52, s50, s52
  s_lshl_b32 s53, s52, 6
  v_add_u32 v3, s53, v1
  v_mul_hi_u32 v4, v3, s48
  v_lshrrev_b32 v4, 3, v4
  v_mul_u32_u24 v5, 10, v4
  v_sub_u32 v5, v3, v5
  v_mul_u32_u24 v4, 5120, v4
  v_lshlrev_b32 v5, 4, v5
  s_mul_i32 s53, s51, 1280
  s_add_u32 s53, s53, s49
  v_add3_u32 v4, v4, v5, s53
  s_mul_i32 s53, s51, 25600
  s_and_b32 s54, s51, 1
  s_lshl_b32 s54, s54, 5
  s_add_u32 s53, s53, s54
  s_lshr_b32 s54, s51, 1
  s_lshl_b32 s54, s54, 7
  s_add_u32 s53, s53, s54
  s_lshl_b32 s52, s52, 10
  s_add_u32 s53, s53, s52
  s_add_u32 m0, s53, 60544
  s_nop 0
  buffer_load_dwordx4 v4, s[20:23], 0 offen lds
  s_add_u32 s50, s44, 87
  s_mul_i32 s51, s50, 41
  s_lshr_b32 s51, s51, 10
  s_mul_i32 s52, s51, 25
  s_sub_u32 s52, s50, s52
  s_lshl_b32 s53, s52, 6
  v_add_u32 v3, s53, v1
  v_mul_hi_u32 v4, v3, s48
  v_lshrrev_b32 v4, 3, v4
  v_mul_u32_u24 v5, 10, v4
  v_sub_u32 v5, v3, v5
  v_mul_u32_u24 v4, 5120, v4
  v_lshlrev_b32 v5, 4, v5
  s_mul_i32 s53, s51, 1280
  s_add_u32 s53, s53, s49
  v_add3_u32 v4, v4, v5, s53
  s_mul_i32 s53, s51, 25600
  s_and_b32 s54, s51, 1
  s_lshl_b32 s54, s54, 5
  s_add_u32 s53, s53, s54
  s_lshr_b32 s54, s51, 1
  s_lshl_b32 s54, s54, 7
  s_add_u32 s53, s53, s54
  s_lshl_b32 s52, s52, 10
  s_add_u32 s53, s53, s52
  s_add_u32 m0, s53, 60544
  s_nop 0
  buffer_load_dwordx4 v4, s[20:23], 0 offen lds
  s_add_u32 s50, s44, 88
  s_mul_i32 s51, s50, 41
  s_lshr_b32 s51, s51, 10
  s_mul_i32 s52, s51, 25
  s_sub_u32 s52, s50, s52
  s_lshl_b32 s53, s52, 6
  v_add_u32 v3, s53, v1
  v_mul_hi_u32 v4, v3, s48
  v_lshrrev_b32 v4, 3, v4
  v_mul_u32_u24 v5, 10, v4
  v_sub_u32 v5, v3, v5
  v_mul_u32_u24 v4, 5120, v4
  v_lshlrev_b32 v5, 4, v5
  s_mul_i32 s53, s51, 1280
  s_add_u32 s53, s53, s49
  v_add3_u32 v4, v4, v5, s53
  s_mul_i32 s53, s51, 25600
  s_and_b32 s54, s51, 1
  s_lshl_b32 s54, s54, 5
  s_add_u32 s53, s53, s54
  s_lshr_b32 s54, s51, 1
  s_lshl_b32 s54, s54, 7
  s_add_u32 s53, s53, s54
  s_lshl_b32 s52, s52, 10
  s_add_u32 s53, s53, s52
  s_add_u32 m0, s53, 60544
  s_nop 0
  buffer_load_dwordx4 v4, s[20:23], 0 offen lds
  s_add_u32 s50, s44, 89
  s_mul_i32 s51, s50, 41
  s_lshr_b32 s51, s51, 10
  s_mul_i32 s52, s51, 25
  s_sub_u32 s52, s50, s52
  s_lshl_b32 s53, s52, 6
  v_add_u32 v3, s53, v1
  v_mul_hi_u32 v4, v3, s48
  v_lshrrev_b32 v4, 3, v4
  v_mul_u32_u24 v5, 10, v4
  v_sub_u32 v5, v3, v5
  v_mul_u32_u24 v4, 5120, v4
  v_lshlrev_b32 v5, 4, v5
  s_mul_i32 s53, s51, 1280
  s_add_u32 s53, s53, s49
  v_add3_u32 v4, v4, v5, s53
  s_mul_i32 s53, s51, 25600
  s_and_b32 s54, s51, 1
  s_lshl_b32 s54, s54, 5
  s_add_u32 s53, s53, s54
  s_lshr_b32 s54, s51, 1
  s_lshl_b32 s54, s54, 7
  s_add_u32 s53, s53, s54
  s_lshl_b32 s52, s52, 10
  s_add_u32 s53, s53, s52
  s_add_u32 m0, s53, 60544
  s_nop 0
  buffer_load_dwordx4 v4, s[20:23], 0 offen lds
  s_add_u32 s50, s44, 90
  s_mul_i32 s51, s50, 41
  s_lshr_b32 s51, s51, 10
  s_mul_i32 s52, s51, 25
  s_sub_u32 s52, s50, s52
  s_lshl_b32 s53, s52, 6
  v_add_u32 v3, s53, v1
  v_mul_hi_u32 v4, v3, s48
  v_lshrrev_b32 v4, 3, v4
  v_mul_u32_u24 v5, 10, v4
  v_sub_u32 v5, v3, v5
  v_mul_u32_u24 v4, 5120, v4
  v_lshlrev_b32 v5, 4, v5
  s_mul_i32 s53, s51, 1280
  s_add_u32 s53, s53, s49
  v_add3_u32 v4, v4, v5, s53
  s_mul_i32 s53, s51, 25600
  s_and_b32 s54, s51, 1
  s_lshl_b32 s54, s54, 5
  s_add_u32 s53, s53, s54
  s_lshr_b32 s54, s51, 1
  s_lshl_b32 s54, s54, 7
  s_add_u32 s53, s53, s54
  s_lshl_b32 s52, s52, 10
  s_add_u32 s53, s53, s52
  s_add_u32 m0, s53, 60544
  s_nop 0
  buffer_load_dwordx4 v4, s[20:23], 0 offen lds
  s_add_u32 s50, s44, 91
  s_mul_i32 s51, s50, 41
  s_lshr_b32 s51, s51, 10
  s_mul_i32 s52, s51, 25
  s_sub_u32 s52, s50, s52
  s_lshl_b32 s53, s52, 6
  v_add_u32 v3, s53, v1
  v_mul_hi_u32 v4, v3, s48
  v_lshrrev_b32 v4, 3, v4
  v_mul_u32_u24 v5, 10, v4
  v_sub_u32 v5, v3, v5
  v_mul_u32_u24 v4, 5120, v4
  v_lshlrev_b32 v5, 4, v5
  s_mul_i32 s53, s51, 1280
  s_add_u32 s53, s53, s49
  v_add3_u32 v4, v4, v5, s53
  s_mul_i32 s53, s51, 25600
  s_and_b32 s54, s51, 1
  s_lshl_b32 s54, s54, 5
  s_add_u32 s53, s53, s54
  s_lshr_b32 s54, s51, 1
  s_lshl_b32 s54, s54, 7
  s_add_u32 s53, s53, s54
  s_lshl_b32 s52, s52, 10
  s_add_u32 s53, s53, s52
  s_add_u32 m0, s53, 60544
  s_nop 0
  buffer_load_dwordx4 v4, s[20:23], 0 offen lds
  s_add_u32 s50, s44, 92
  s_mul_i32 s51, s50, 41
  s_lshr_b32 s51, s51, 10
  s_mul_i32 s52, s51, 25
  s_sub_u32 s52, s50, s52
  s_lshl_b32 s53, s52, 6
  v_add_u32 v3, s53, v1
  v_mul_hi_u32 v4, v3, s48
  v_lshrrev_b32 v4, 3, v4
  v_mul_u32_u24 v5, 10, v4
  v_sub_u32 v5, v3, v5
  v_mul_u32_u24 v4, 5120, v4
  v_lshlrev_b32 v5, 4, v5
  s_mul_i32 s53, s51, 1280
  s_add_u32 s53, s53, s49
  v_add3_u32 v4, v4, v5, s53
  s_mul_i32 s53, s51, 25600
  s_and_b32 s54, s51, 1
  s_lshl_b32 s54, s54, 5
  s_add_u32 s53, s53, s54
  s_lshr_b32 s54, s51, 1
  s_lshl_b32 s54, s54, 7
  s_add_u32 s53, s53, s54
  s_lshl_b32 s52, s52, 10
  s_add_u32 s53, s53, s52
  s_add_u32 m0, s53, 60544
  s_nop 0
  buffer_load_dwordx4 v4, s[20:23], 0 offen lds
  s_add_u32 s50, s44, 93
  s_mul_i32 s51, s50, 41
  s_lshr_b32 s51, s51, 10
  s_mul_i32 s52, s51, 25
  s_sub_u32 s52, s50, s52
  s_lshl_b32 s53, s52, 6
  v_add_u32 v3, s53, v1
  v_mul_hi_u32 v4, v3, s48
  v_lshrrev_b32 v4, 3, v4
  v_mul_u32_u24 v5, 10, v4
  v_sub_u32 v5, v3, v5
  v_mul_u32_u24 v4, 5120, v4
  v_lshlrev_b32 v5, 4, v5
  s_mul_i32 s53, s51, 1280
  s_add_u32 s53, s53, s49
  v_add3_u32 v4, v4, v5, s53
  s_mul_i32 s53, s51, 25600
  s_and_b32 s54, s51, 1
  s_lshl_b32 s54, s54, 5
  s_add_u32 s53, s53, s54
  s_lshr_b32 s54, s51, 1
  s_lshl_b32 s54, s54, 7
  s_add_u32 s53, s53, s54
  s_lshl_b32 s52, s52, 10
  s_add_u32 s53, s53, s52
  s_add_u32 m0, s53, 60544
  s_nop 0
  buffer_load_dwordx4 v4, s[20:23], 0 offen lds
  s_add_u32 s50, s44, 94
  s_mul_i32 s51, s50, 41
  s_lshr_b32 s51, s51, 10
  s_mul_i32 s52, s51, 25
  s_sub_u32 s52, s50, s52
  s_lshl_b32 s53, s52, 6
  v_add_u32 v3, s53, v1
  v_mul_hi_u32 v4, v3, s48
  v_lshrrev_b32 v4, 3, v4
  v_mul_u32_u24 v5, 10, v4
  v_sub_u32 v5, v3, v5
  v_mul_u32_u24 v4, 5120, v4
  v_lshlrev_b32 v5, 4, v5
  s_mul_i32 s53, s51, 1280
  s_add_u32 s53, s53, s49
  v_add3_u32 v4, v4, v5, s53
  s_mul_i32 s53, s51, 25600
  s_and_b32 s54, s51, 1
  s_lshl_b32 s54, s54, 5
  s_add_u32 s53, s53, s54
  s_lshr_b32 s54, s51, 1
  s_lshl_b32 s54, s54, 7
  s_add_u32 s53, s53, s54
  s_lshl_b32 s52, s52, 10
  s_add_u32 s53, s53, s52
  s_add_u32 m0, s53, 60544
  s_nop 0
  buffer_load_dwordx4 v4, s[20:23], 0 offen lds
  s_add_u32 s50, s44, 95
  s_mul_i32 s51, s50, 41
  s_lshr_b32 s51, s51, 10
  s_mul_i32 s52, s51, 25
  s_sub_u32 s52, s50, s52
  s_lshl_b32 s53, s52, 6
  v_add_u32 v3, s53, v1
  v_mul_hi_u32 v4, v3, s48
  v_lshrrev_b32 v4, 3, v4
  v_mul_u32_u24 v5, 10, v4
  v_sub_u32 v5, v3, v5
  v_mul_u32_u24 v4, 5120, v4
  v_lshlrev_b32 v5, 4, v5
  s_mul_i32 s53, s51, 1280
  s_add_u32 s53, s53, s49
  v_add3_u32 v4, v4, v5, s53
  s_mul_i32 s53, s51, 25600
  s_and_b32 s54, s51, 1
  s_lshl_b32 s54, s54, 5
  s_add_u32 s53, s53, s54
  s_lshr_b32 s54, s51, 1
  s_lshl_b32 s54, s54, 7
  s_add_u32 s53, s53, s54
  s_lshl_b32 s52, s52, 10
  s_add_u32 s53, s53, s52
  s_add_u32 m0, s53, 60544
  s_nop 0
  buffer_load_dwordx4 v4, s[20:23], 0 offen lds
  s_add_u32 s50, s44, 96
  s_mul_i32 s51, s50, 41
  s_lshr_b32 s51, s51, 10
  s_mul_i32 s52, s51, 25
  s_sub_u32 s52, s50, s52
  s_lshl_b32 s53, s52, 6
  v_add_u32 v3, s53, v1
  v_mul_hi_u32 v4, v3, s48
  v_lshrrev_b32 v4, 3, v4
  v_mul_u32_u24 v5, 10, v4
  v_sub_u32 v5, v3, v5
  v_mul_u32_u24 v4, 5120, v4
  v_lshlrev_b32 v5, 4, v5
  s_mul_i32 s53, s51, 1280
  s_add_u32 s53, s53, s49
  v_add3_u32 v4, v4, v5, s53
  s_mul_i32 s53, s51, 25600
  s_and_b32 s54, s51, 1
  s_lshl_b32 s54, s54, 5
  s_add_u32 s53, s53, s54
  s_lshr_b32 s54, s51, 1
  s_lshl_b32 s54, s54, 7
  s_add_u32 s53, s53, s54
  s_lshl_b32 s52, s52, 10
  s_add_u32 s53, s53, s52
  s_add_u32 m0, s53, 60544
  s_nop 0
  buffer_load_dwordx4 v4, s[20:23], 0 offen lds
  s_add_u32 s50, s44, 97
  s_mul_i32 s51, s50, 41
  s_lshr_b32 s51, s51, 10
  s_mul_i32 s52, s51, 25
  s_sub_u32 s52, s50, s52
  s_lshl_b32 s53, s52, 6
  v_add_u32 v3, s53, v1
  v_mul_hi_u32 v4, v3, s48
  v_lshrrev_b32 v4, 3, v4
  v_mul_u32_u24 v5, 10, v4
  v_sub_u32 v5, v3, v5
  v_mul_u32_u24 v4, 5120, v4
  v_lshlrev_b32 v5, 4, v5
  s_mul_i32 s53, s51, 1280
  s_add_u32 s53, s53, s49
  v_add3_u32 v4, v4, v5, s53
  s_mul_i32 s53, s51, 25600
  s_and_b32 s54, s51, 1
  s_lshl_b32 s54, s54, 5
  s_add_u32 s53, s53, s54
  s_lshr_b32 s54, s51, 1
  s_lshl_b32 s54, s54, 7
  s_add_u32 s53, s53, s54
  s_lshl_b32 s52, s52, 10
  s_add_u32 s53, s53, s52
  s_add_u32 m0, s53, 60544
  s_nop 0
  buffer_load_dwordx4 v4, s[20:23], 0 offen lds
  s_add_u32 s50, s44, 98
  s_mul_i32 s51, s50, 41
  s_lshr_b32 s51, s51, 10
  s_mul_i32 s52, s51, 25
  s_sub_u32 s52, s50, s52
  s_lshl_b32 s53, s52, 6
  v_add_u32 v3, s53, v1
  v_mul_hi_u32 v4, v3, s48
  v_lshrrev_b32 v4, 3, v4
  v_mul_u32_u24 v5, 10, v4
  v_sub_u32 v5, v3, v5
  v_mul_u32_u24 v4, 5120, v4
  v_lshlrev_b32 v5, 4, v5
  s_mul_i32 s53, s51, 1280
  s_add_u32 s53, s53, s49
  v_add3_u32 v4, v4, v5, s53
  s_mul_i32 s53, s51, 25600
  s_and_b32 s54, s51, 1
  s_lshl_b32 s54, s54, 5
  s_add_u32 s53, s53, s54
  s_lshr_b32 s54, s51, 1
  s_lshl_b32 s54, s54, 7
  s_add_u32 s53, s53, s54
  s_lshl_b32 s52, s52, 10
  s_add_u32 s53, s53, s52
  s_add_u32 m0, s53, 60544
  s_nop 0
  buffer_load_dwordx4 v4, s[20:23], 0 offen lds
  s_add_u32 s50, s44, 99
  s_mul_i32 s51, s50, 41
  s_lshr_b32 s51, s51, 10
  s_mul_i32 s52, s51, 25
  s_sub_u32 s52, s50, s52
  s_lshl_b32 s53, s52, 6
  v_add_u32 v3, s53, v1
  v_mul_hi_u32 v4, v3, s48
  v_lshrrev_b32 v4, 3, v4
  v_mul_u32_u24 v5, 10, v4
  v_sub_u32 v5, v3, v5
  v_mul_u32_u24 v4, 5120, v4
  v_lshlrev_b32 v5, 4, v5
  s_mul_i32 s53, s51, 1280
  s_add_u32 s53, s53, s49
  v_add3_u32 v4, v4, v5, s53
  s_mul_i32 s53, s51, 25600
  s_and_b32 s54, s51, 1
  s_lshl_b32 s54, s54, 5
  s_add_u32 s53, s53, s54
  s_lshr_b32 s54, s51, 1
  s_lshl_b32 s54, s54, 7
  s_add_u32 s53, s53, s54
  s_lshl_b32 s52, s52, 10
  s_add_u32 s53, s53, s52
  s_add_u32 m0, s53, 60544
  s_nop 0
  buffer_load_dwordx4 v4, s[20:23], 0 offen lds
  s_mov_b32 s44, s62
gated_mix__grouped_kv_mqa__spectral_gfnet__prompt_kernel_aend34:
  s_waitcnt vmcnt(0) lgkmcnt(0)
  s_barrier
  s_mov_b32 s60, s44
  v_lshrrev_b32 v3, 5, v1
  v_mul_u32_u24 v3, 5376, v3
  v_and_b32 v4, 31, v1
  v_lshl_add_u32 v3, v4, 3, v3
  v_add_u32 v3, 11392, v3
  s_lshl_b32 s50, s60, 1
  s_add_u32 s50, s50, 0
  s_mul_i32 s51, s50, 52
  s_lshr_b32 s51, s51, 8
  s_mul_i32 s52, s51, 5
  s_sub_u32 s52, s50, s52
  s_mul_i32 s51, s51, 10752
  v_add_u32 v4, s51, v3
  ds_read_b64 v[32:33], v4 offset:5120
  s_lshl_b32 s52, s52, 10
  v_add_u32 v4, s52, v4
  ds_read_b64 v[40:41], v4 offset:0
  ds_read_b64 v[42:43], v4 offset:256
  ds_read_b64 v[44:45], v4 offset:512
  ds_read_b64 v[46:47], v4 offset:768
  s_lshl_b32 s50, s60, 1
  s_add_u32 s50, s50, 1
  s_mul_i32 s51, s50, 52
  s_lshr_b32 s51, s51, 8
  s_mul_i32 s52, s51, 5
  s_sub_u32 s52, s50, s52
  s_mul_i32 s51, s51, 10752
  v_add_u32 v4, s51, v3
  ds_read_b64 v[34:35], v4 offset:5120
  s_lshl_b32 s52, s52, 10
  v_add_u32 v4, s52, v4
  ds_read_b64 v[48:49], v4 offset:0
  ds_read_b64 v[50:51], v4 offset:256
  ds_read_b64 v[52:53], v4 offset:512
  ds_read_b64 v[54:55], v4 offset:768
  s_waitcnt lgkmcnt(0)
  v_cvt_f32_f64 v28, v[32:33]
  v_cvt_f32_f64 v56, v[40:41]
  v_cvt_f32_f64 v57, v[42:43]
  v_cvt_f32_f64 v58, v[44:45]
  v_cvt_f32_f64 v59, v[46:47]
  v_cvt_f32_f64 v29, v[34:35]
  v_cvt_f32_f64 v60, v[48:49]
  v_cvt_f32_f64 v61, v[50:51]
  v_cvt_f32_f64 v62, v[52:53]
  v_cvt_f32_f64 v63, v[54:55]
  v_rcp_f32 v28, v28
  v_rcp_f32 v29, v29
  s_nop 0
  v_mul_f32 v56, v56, v28
  v_mul_f32 v57, v57, v28
  v_mul_f32 v58, v58, v28
  v_mul_f32 v59, v59, v28
  v_mul_f32 v60, v60, v29
  v_mul_f32 v61, v61, v29
  v_mul_f32 v62, v62, v29
  v_mul_f32 v63, v63, v29
  v_cvt_pk_bf16_f32 v64, v56, v57
  v_cvt_pk_bf16_f32 v65, v58, v59
  v_cvt_pk_bf16_f32 v66, v60, v61
  v_cvt_pk_bf16_f32 v67, v62, v63
  s_mul_i32 s50, s46, 10
  s_add_u32 s50, s50, s60
  s_lshr_b32 s51, s50, 2
  s_and_b32 s52, s50, 3
  s_lshl_b32 s51, s51, 10
  s_lshl_b32 s52, s52, 8
  s_add_u32 s51, s51, s52
  s_mul_i32 s52, s45, 81920
  s_add_u32 s51, s51, s52
  s_add_u32 s51, s51, 1048576
  v_lshrrev_b32 v5, 4, v1
  v_mul_u32_u24 v5, 20480, v5
  v_and_b32 v6, 15, v1
  v_lshl_add_u32 v5, v6, 4, v5
  buffer_store_dwordx4 v[64:67], v5, s[40:43], s51 offen sc1
  s_cmp_ge_u32 s44, 2
  s_cbranch_scc1 gated_mix__grouped_kv_mqa__spectral_gfnet__prompt_kernel_n2152
  s_add_u32 s60, s44, 8
  v_lshrrev_b32 v3, 5, v1
  v_mul_u32_u24 v3, 5376, v3
  v_and_b32 v4, 31, v1
  v_lshl_add_u32 v3, v4, 3, v3
  v_add_u32 v3, 11392, v3
  s_lshl_b32 s50, s60, 1
  s_add_u32 s50, s50, 0
  s_mul_i32 s51, s50, 52
  s_lshr_b32 s51, s51, 8
  s_mul_i32 s52, s51, 5
  s_sub_u32 s52, s50, s52
  s_mul_i32 s51, s51, 10752
  v_add_u32 v4, s51, v3
  ds_read_b64 v[32:33], v4 offset:5120
  s_lshl_b32 s52, s52, 10
  v_add_u32 v4, s52, v4
  ds_read_b64 v[40:41], v4 offset:0
  ds_read_b64 v[42:43], v4 offset:256
  ds_read_b64 v[44:45], v4 offset:512
  ds_read_b64 v[46:47], v4 offset:768
  s_lshl_b32 s50, s60, 1
  s_add_u32 s50, s50, 1
  s_mul_i32 s51, s50, 52
  s_lshr_b32 s51, s51, 8
  s_mul_i32 s52, s51, 5
  s_sub_u32 s52, s50, s52
  s_mul_i32 s51, s51, 10752
  v_add_u32 v4, s51, v3
  ds_read_b64 v[34:35], v4 offset:5120
  s_lshl_b32 s52, s52, 10
  v_add_u32 v4, s52, v4
  ds_read_b64 v[48:49], v4 offset:0
  ds_read_b64 v[50:51], v4 offset:256
  ds_read_b64 v[52:53], v4 offset:512
  ds_read_b64 v[54:55], v4 offset:768
  s_waitcnt lgkmcnt(0)
  v_cvt_f32_f64 v28, v[32:33]
  v_cvt_f32_f64 v56, v[40:41]
  v_cvt_f32_f64 v57, v[42:43]
  v_cvt_f32_f64 v58, v[44:45]
  v_cvt_f32_f64 v59, v[46:47]
  v_cvt_f32_f64 v29, v[34:35]
  v_cvt_f32_f64 v60, v[48:49]
  v_cvt_f32_f64 v61, v[50:51]
  v_cvt_f32_f64 v62, v[52:53]
  v_cvt_f32_f64 v63, v[54:55]
  v_rcp_f32 v28, v28
  v_rcp_f32 v29, v29
  s_nop 0
  v_mul_f32 v56, v56, v28
  v_mul_f32 v57, v57, v28
  v_mul_f32 v58, v58, v28
  v_mul_f32 v59, v59, v28
  v_mul_f32 v60, v60, v29
  v_mul_f32 v61, v61, v29
  v_mul_f32 v62, v62, v29
  v_mul_f32 v63, v63, v29
  v_cvt_pk_bf16_f32 v64, v56, v57
  v_cvt_pk_bf16_f32 v65, v58, v59
  v_cvt_pk_bf16_f32 v66, v60, v61
  v_cvt_pk_bf16_f32 v67, v62, v63
  s_mul_i32 s50, s46, 10
  s_add_u32 s50, s50, s60
  s_lshr_b32 s51, s50, 2
  s_and_b32 s52, s50, 3
  s_lshl_b32 s51, s51, 10
  s_lshl_b32 s52, s52, 8
  s_add_u32 s51, s51, s52
  s_mul_i32 s52, s45, 81920
  s_add_u32 s51, s51, s52
  s_add_u32 s51, s51, 1048576
  v_lshrrev_b32 v5, 4, v1
  v_mul_u32_u24 v5, 20480, v5
  v_and_b32 v6, 15, v1
  v_lshl_add_u32 v5, v6, 4, v5
  buffer_store_dwordx4 v[64:67], v5, s[40:43], s51 offen sc1
gated_mix__grouped_kv_mqa__spectral_gfnet__prompt_kernel_n2152:
  s_waitcnt vmcnt(0)
  v_mov_b32 v5, 10312
  v_mov_b32 v6, 1
  s_mov_b64 s[58:59], exec
  s_mov_b64 exec, 1
  ds_add_rtn_u32 v7, v5, v6
  s_waitcnt lgkmcnt(0)
  s_mov_b64 exec, s[58:59]
  v_readfirstlane_b32 s55, v7
  s_cmp_lg_u32 s55, 7
  s_cbranch_scc1 gated_mix__grouped_kv_mqa__spectral_gfnet__prompt_kernel_cl153
  s_lshl_b32 s60, s45, 5
  s_add_u32 s60, s60, s46
  s_lshl_b32 s54, s60, 2
  s_add_u32 s54, s54, 20480
  v_mov_b32 v5, s47
  v_mov_b32 v6, 0
  s_mov_b64 s[56:57], exec
  s_mov_b64 exec, 1
  buffer_store_dword v5, v6, s[40:43], s54 offen sc1
  s_mov_b64 exec, s[56:57]
gated_mix__grouped_kv_mqa__spectral_gfnet__prompt_kernel_cl153:
  s_cmp_lg_u32 s2, 0
  s_cbranch_scc1 gated_mix__grouped_kv_mqa__spectral_gfnet__prompt_kernel_ep154
  s_cmp_lg_u32 s44, 7
  s_cbranch_scc1 gated_mix__grouped_kv_mqa__spectral_gfnet__prompt_kernel_ep154
  s_mov_b32 s53, 8192
  s_mov_b64 s[56:57], exec
  v_lshlrev_b32 v4, 4, v1
gated_mix__grouped_kv_mqa__spectral_gfnet__prompt_kernel_poll155:
  buffer_load_dwordx4 v[6:9], v4, s[40:43], s53 offen sc1
  s_waitcnt vmcnt(0)
  v_xor_b32 v6, s47, v6
  v_xor_b32 v7, s47, v7
  v_xor_b32 v8, s47, v8
  v_xor_b32 v9, s47, v9
  v_or_b32 v6, v6, v7
  v_or_b32 v8, v8, v9
  v_or_b32 v6, v6, v8
  v_cmp_ne_u32 vcc, 0, v6
  s_cbranch_vccz gated_mix__grouped_kv_mqa__spectral_gfnet__prompt_kernel_polld156
  s_sleep 2
  s_branch gated_mix__grouped_kv_mqa__spectral_gfnet__prompt_kernel_poll155
gated_mix__grouped_kv_mqa__spectral_gfnet__prompt_kernel_polld156:
  s_mov_b64 exec, s[56:57]
  s_mov_b32 s60, 0
  s_lshl_b32 s54, s60, 2
  s_add_u32 s54, s54, 0
  v_mov_b32 v5, s47
  v_mov_b32 v6, 0
  s_mov_b64 s[56:57], exec
  s_mov_b64 exec, 1
  buffer_store_dword v5, v6, s[40:43], s54 offen sc1
  s_mov_b64 exec, s[56:57]
gated_mix__grouped_kv_mqa__spectral_gfnet__prompt_kernel_ep154:
  s_and_b32 s48, s44, 3
  s_lshr_b32 s49, s44, 2
  s_lshl_b32 s50, s45, 2
  s_add_u32 s50, s50, s48
  s_mul_i32 s50, s50, 20
  s_mul_i32 s51, s49, 10
  s_add_u32 s50, s50, s51
  s_lshl_b32 s50, s50, 10
  s_add_u32 s88, s50, 1048576
  v_and_b32 v8, 15, v1
  s_lshl_b32 s52, s48, 6
  v_lshl_add_u32 v8, v8, 2, s52
  v_add_u32 v8, 10368, v8
  ds_read_b32 v10, v8 offset:0
  ds_read_b32 v11, v8 offset:256
  ds_read_b32 v12, v8 offset:512
  ds_read_b32 v13, v8 offset:768
  v_and_b32 v7, 15, v1
  v_lshrrev_b32 v6, 2, v7
  v_mul_u32_u24 v9, 25600, v6
  v_and_b32 v14, 1, v6
  v_lshl_add_u32 v9, v14, 5, v9
  v_lshrrev_b32 v14, 1, v6
  v_lshl_add_u32 v9, v14, 7, v9
  v_lshrrev_b32 v14, 4, v1
  v_mul_u32_u24 v14, 320, v14
  v_add_u32 v9, v9, v14
  v_and_b32 v7, 3, v7
  v_lshl_add_u32 v9, v7, 3, v9
  s_mul_i32 s53, s49, 12800
  s_add_u32 s53, s53, 60544
  v_add_u32 v9, s53, v9
  s_waitcnt lgkmcnt(0)
  v_add_f32 v10, v10, v11
  v_add_f32 v12, v12, v13
  v_add_f32 v10, v10, v12
  v_mul_f32 v10, 0xbfb8aa3b, v10
  v_exp_f32 v10, v10
  s_nop 0
  v_add_f32 v10, 1.0, v10
  v_rcp_f32 v200, v10
  v_mov_b32 v201, v9
  ds_read_b64_tr_b16 v[96:97], v9 offset:0
  ds_read_b64_tr_b16 v[98:99], v9 offset:160
  ds_read_b64_tr_b16 v[100:101], v9 offset:32
  ds_read_b64_tr_b16 v[102:103], v9 offset:192
  ds_read_b64_tr_b16 v[104:105], v9 offset:64
  ds_read_b64_tr_b16 v[106:107], v9 offset:224
  ds_read_b64_tr_b16 v[108:109], v9 offset:96
  ds_read_b64_tr_b16 v[110:111], v9 offset:256
  ds_read_b64_tr_b16 v[112:113], v9 offset:128
  ds_read_b64_tr_b16 v[114:115], v9 offset:288
  s_cmp_lg_u32 s44, 0
  s_cbranch_scc1 gated_mix__grouped_kv_mqa__spectral_gfnet__prompt_kernel_nf157
  s_mov_b64 exec, 0xff
  v_lshlrev_b32 v4, 2, v1
  s_lshl_b32 s53, s45, 7
  s_add_u32 s53, s53, 20480
gated_mix__grouped_kv_mqa__spectral_gfnet__prompt_kernel_po159:
  buffer_load_dword v5, v4, s[40:43], s53 offen sc1
  s_waitcnt vmcnt(0)
  v_cmp_ne_u32 vcc, s47, v5
  s_cbranch_vccz gated_mix__grouped_kv_mqa__spectral_gfnet__prompt_kernel_pod160
  s_sleep 1
  s_branch gated_mix__grouped_kv_mqa__spectral_gfnet__prompt_kernel_po159
gated_mix__grouped_kv_mqa__spectral_gfnet__prompt_kernel_pod160:
  s_mov_b64 exec, -1
  s_branch gated_mix__grouped_kv_mqa__spectral_gfnet__prompt_kernel_nf2158
gated_mix__grouped_kv_mqa__spectral_gfnet__prompt_kernel_nf157:
  s_cmp_lg_u32 s44, 1
  s_cbranch_scc1 gated_mix__grouped_kv_mqa__spectral_gfnet__prompt_kernel_nf2158
  s_lshr_b32 s48, s45, 4
  s_lshl_b32 s48, s48, 1
  s_bfe_u32 s49, s45, 0x10002
  s_add_u32 s48, s48, s49
  s_lshl_b32 s53, s48, 8
  s_add_u32 s53, s53, 16384
  s_mov_b64 s[56:57], exec
  v_lshlrev_b32 v4, 2, v1
gated_mix__grouped_kv_mqa__spectral_gfnet__prompt_kernel_poll161:
  buffer_load_dword v5, v4, s[40:43], s53 offen sc1
  s_waitcnt vmcnt(0)
  v_cmp_ne_u32 vcc, s47, v5
  s_cbranch_vccz gated_mix__grouped_kv_mqa__spectral_gfnet__prompt_kernel_polld162
  s_sleep 3
  s_branch gated_mix__grouped_kv_mqa__spectral_gfnet__prompt_kernel_poll161
gated_mix__grouped_kv_mqa__spectral_gfnet__prompt_kernel_polld162:
  s_mov_b64 exec, s[56:57]
  s_mov_b32 s48, 0xCCCCCCCD
  s_mul_i32 s49, s45, 81920
  s_mul_i32 s50, s46, 160
  s_add_u32 s49, s49, s50
  s_add_u32 s49, s49, 13631488
  v_add_u32 v3, 0, v1
  v_mul_hi_u32 v4, v3, s48
  v_lshrrev_b32 v4, 3, v4
  v_mul_u32_u24 v5, 10, v4
  v_sub_u32 v5, v3, v5
  v_mul_u32_u24 v4, 1280, v4
  v_lshl_add_u32 v4, v5, 4, v4
  buffer_load_dwordx4 v[140:143], v4, s[40:43], s49 offen sc1
  v_add_u32 v3, 64, v1
  v_mul_hi_u32 v4, v3, s48
  v_lshrrev_b32 v4, 3, v4
  v_mul_u32_u24 v5, 10, v4
  v_sub_u32 v5, v3, v5
  v_mul_u32_u24 v4, 1280, v4
  v_lshl_add_u32 v4, v5, 4, v4
  buffer_load_dwordx4 v[144:147], v4, s[40:43], s49 offen sc1
  v_add_u32 v3, 128, v1
  v_mul_hi_u32 v4, v3, s48
  v_lshrrev_b32 v4, 3, v4
  v_mul_u32_u24 v5, 10, v4
  v_sub_u32 v5, v3, v5
  v_mul_u32_u24 v4, 1280, v4
  v_lshl_add_u32 v4, v5, 4, v4
  buffer_load_dwordx4 v[148:151], v4, s[40:43], s49 offen sc1
  v_add_u32 v3, 192, v1
  v_mul_hi_u32 v4, v3, s48
  v_lshrrev_b32 v4, 3, v4
  v_mul_u32_u24 v5, 10, v4
  v_sub_u32 v5, v3, v5
  v_mul_u32_u24 v4, 1280, v4
  v_lshl_add_u32 v4, v5, 4, v4
  buffer_load_dwordx4 v[152:155], v4, s[40:43], s49 offen sc1
  v_add_u32 v3, 256, v1
  v_mul_hi_u32 v4, v3, s48
  v_lshrrev_b32 v4, 3, v4
  v_mul_u32_u24 v5, 10, v4
  v_sub_u32 v5, v3, v5
  v_mul_u32_u24 v4, 1280, v4
  v_lshl_add_u32 v4, v5, 4, v4
  buffer_load_dwordx4 v[156:159], v4, s[40:43], s49 offen sc1
  v_add_u32 v3, 320, v1
  v_mul_hi_u32 v4, v3, s48
  v_lshrrev_b32 v4, 3, v4
  v_mul_u32_u24 v5, 10, v4
  v_sub_u32 v5, v3, v5
  v_mul_u32_u24 v4, 1280, v4
  v_lshl_add_u32 v4, v5, 4, v4
  buffer_load_dwordx4 v[160:163], v4, s[40:43], s49 offen sc1
  v_add_u32 v3, 384, v1
  v_mul_hi_u32 v4, v3, s48
  v_lshrrev_b32 v4, 3, v4
  v_mul_u32_u24 v5, 10, v4
  v_sub_u32 v5, v3, v5
  v_mul_u32_u24 v4, 1280, v4
  v_lshl_add_u32 v4, v5, 4, v4
  buffer_load_dwordx4 v[164:167], v4, s[40:43], s49 offen sc1
  v_add_u32 v3, 448, v1
  v_mul_hi_u32 v4, v3, s48
  v_lshrrev_b32 v4, 3, v4
  v_mul_u32_u24 v5, 10, v4
  v_sub_u32 v5, v3, v5
  v_mul_u32_u24 v4, 1280, v4
  v_lshl_add_u32 v4, v5, 4, v4
  buffer_load_dwordx4 v[168:171], v4, s[40:43], s49 offen sc1
  v_add_u32 v3, 512, v1
  v_mul_hi_u32 v4, v3, s48
  v_lshrrev_b32 v4, 3, v4
  v_mul_u32_u24 v5, 10, v4
  v_sub_u32 v5, v3, v5
  v_mul_u32_u24 v4, 1280, v4
  v_lshl_add_u32 v4, v5, 4, v4
  buffer_load_dwordx4 v[172:175], v4, s[40:43], s49 offen sc1
  v_add_u32 v3, 576, v1
  v_mul_hi_u32 v4, v3, s48
  v_lshrrev_b32 v4, 3, v4
  v_mul_u32_u24 v5, 10, v4
  v_sub_u32 v5, v3, v5
  v_mul_u32_u24 v4, 1280, v4
  v_lshl_add_u32 v4, v5, 4, v4
  buffer_load_dwordx4 v[176:179], v4, s[40:43], s49 offen sc1
  v_lshlrev_b32 v3, 4, v1
  s_waitcnt vmcnt(9)
  ds_write_b128 v3, v[140:143] offset:0
  s_waitcnt vmcnt(8)
  ds_write_b128 v3, v[144:147] offset:1024
  s_waitcnt vmcnt(7)
  ds_write_b128 v3, v[148:151] offset:2048
  s_waitcnt vmcnt(6)
  ds_write_b128 v3, v[152:155] offset:3072
  s_waitcnt vmcnt(5)
  ds_write_b128 v3, v[156:159] offset:4096
  s_waitcnt vmcnt(4)
  ds_write_b128 v3, v[160:163] offset:5120
  s_waitcnt vmcnt(3)
  ds_write_b128 v3, v[164:167] offset:6144
  s_waitcnt vmcnt(2)
  ds_write_b128 v3, v[168:171] offset:7168
  s_waitcnt vmcnt(1)
  ds_write_b128 v3, v[172:175] offset:8192
  s_waitcnt vmcnt(0)
  ds_write_b128 v3, v[176:179] offset:9216
  s_waitcnt lgkmcnt(0)
gated_mix__grouped_kv_mqa__spectral_gfnet__prompt_kernel_nf2158:
  s_barrier
  v_lshlrev_b32 v3, 4, v1
  s_mov_b32 s50, s88
  buffer_load_dwordx4 v[16:19], v3, s[40:43], s50 offen sc1
  s_add_u32 s50, s50, 1024
  buffer_load_dwordx4 v[20:23], v3, s[40:43], s50 offen sc1
  s_add_u32 s50, s50, 1024
  buffer_load_dwordx4 v[24:27], v3, s[40:43], s50 offen sc1
  s_add_u32 s50, s50, 1024
  buffer_load_dwordx4 v[28:31], v3, s[40:43], s50 offen sc1
  s_add_u32 s50, s50, 1024
  buffer_load_dwordx4 v[32:35], v3, s[40:43], s50 offen sc1
  s_add_u32 s50, s50, 1024
  buffer_load_dwordx4 v[36:39], v3, s[40:43], s50 offen sc1
  s_add_u32 s50, s50, 1024
  buffer_load_dwordx4 v[40:43], v3, s[40:43], s50 offen sc1
  s_add_u32 s50, s50, 1024
  buffer_load_dwordx4 v[44:47], v3, s[40:43], s50 offen sc1
  s_add_u32 s50, s50, 1024
  buffer_load_dwordx4 v[48:51], v3, s[40:43], s50 offen sc1
  s_add_u32 s50, s50, 1024
  buffer_load_dwordx4 v[52:55], v3, s[40:43], s50 offen sc1
  s_add_u32 s50, s50, 1024
  s_and_b32 s48, s44, 3
  s_lshr_b32 s49, s44, 2
  v_mov_b32 v8, v200
  v_mov_b32 v9, v201
  ds_read_b64_tr_b16 v[116:117], v9 offset:1280
  ds_read_b64_tr_b16 v[118:119], v9 offset:1440
  ds_read_b64_tr_b16 v[120:121], v9 offset:1312
  ds_read_b64_tr_b16 v[122:123], v9 offset:1472
  ds_read_b64_tr_b16 v[124:125], v9 offset:1344
  ds_read_b64_tr_b16 v[126:127], v9 offset:1504
  ds_read_b64_tr_b16 v[128:129], v9 offset:1376
  ds_read_b64_tr_b16 v[130:131], v9 offset:1536
  ds_read_b64_tr_b16 v[132:133], v9 offset:1408
  ds_read_b64_tr_b16 v[134:135], v9 offset:1568
  s_waitcnt vmcnt(9) lgkmcnt(10)
  v_mfma_f32_16x16x32_bf16 v[64:67], v[96:99], v[16:19], 0
  v_mfma_f32_16x16x32_bf16 v[68:71], v[100:103], v[16:19], 0
  v_mfma_f32_16x16x32_bf16 v[72:75], v[104:107], v[16:19], 0
  v_mfma_f32_16x16x32_bf16 v[76:79], v[108:111], v[16:19], 0
  v_mfma_f32_16x16x32_bf16 v[80:83], v[112:115], v[16:19], 0
  ds_read_b64_tr_b16 v[96:97], v9 offset:2560
  ds_read_b64_tr_b16 v[98:99], v9 offset:2720
  ds_read_b64_tr_b16 v[100:101], v9 offset:2592
  ds_read_b64_tr_b16 v[102:103], v9 offset:2752
  ds_read_b64_tr_b16 v[104:105], v9 offset:2624
  ds_read_b64_tr_b16 v[106:107], v9 offset:2784
  ds_read_b64_tr_b16 v[108:109], v9 offset:2656
  ds_read_b64_tr_b16 v[110:111], v9 offset:2816
  ds_read_b64_tr_b16 v[112:113], v9 offset:2688
  ds_read_b64_tr_b16 v[114:115], v9 offset:2848
  s_waitcnt vmcnt(8) lgkmcnt(10)
  v_mfma_f32_16x16x32_bf16 v[64:67], v[116:119], v[20:23], v[64:67]
  v_mfma_f32_16x16x32_bf16 v[68:71], v[120:123], v[20:23], v[68:71]
  v_mfma_f32_16x16x32_bf16 v[72:75], v[124:127], v[20:23], v[72:75]
  v_mfma_f32_16x16x32_bf16 v[76:79], v[128:131], v[20:23], v[76:79]
  v_mfma_f32_16x16x32_bf16 v[80:83], v[132:135], v[20:23], v[80:83]
  ds_read_b64_tr_b16 v[116:117], v9 offset:3840
  ds_read_b64_tr_b16 v[118:119], v9 offset:4000
  ds_read_b64_tr_b16 v[120:121], v9 offset:3872
  ds_read_b64_tr_b16 v[122:123], v9 offset:4032
  ds_read_b64_tr_b16 v[124:125], v9 offset:3904
  ds_read_b64_tr_b16 v[126:127], v9 offset:4064
  ds_read_b64_tr_b16 v[128:129], v9 offset:3936
  ds_read_b64_tr_b16 v[130:131], v9 offset:4096
  ds_read_b64_tr_b16 v[132:133], v9 offset:3968
  ds_read_b64_tr_b16 v[134:135], v9 offset:4128
  s_waitcnt vmcnt(7) lgkmcnt(10)
  v_mfma_f32_16x16x32_bf16 v[64:67], v[96:99], v[24:27], v[64:67]
  v_mfma_f32_16x16x32_bf16 v[68:71], v[100:103], v[24:27], v[68:71]
  v_mfma_f32_16x16x32_bf16 v[72:75], v[104:107], v[24:27], v[72:75]
  v_mfma_f32_16x16x32_bf16 v[76:79], v[108:111], v[24:27], v[76:79]
  v_mfma_f32_16x16x32_bf16 v[80:83], v[112:115], v[24:27], v[80:83]
  ds_read_b64_tr_b16 v[96:97], v9 offset:5120
  ds_read_b64_tr_b16 v[98:99], v9 offset:5280
  ds_read_b64_tr_b16 v[100:101], v9 offset:5152
  ds_read_b64_tr_b16 v[102:103], v9 offset:5312
  ds_read_b64_tr_b16 v[104:105], v9 offset:5184
  ds_read_b64_tr_b16 v[106:107], v9 offset:5344
  ds_read_b64_tr_b16 v[108:109], v9 offset:5216
  ds_read_b64_tr_b16 v[110:111], v9 offset:5376
  ds_read_b64_tr_b16 v[112:113], v9 offset:5248
  ds_read_b64_tr_b16 v[114:115], v9 offset:5408
  s_waitcnt vmcnt(6) lgkmcnt(10)
  v_mfma_f32_16x16x32_bf16 v[64:67], v[116:119], v[28:31], v[64:67]
  v_mfma_f32_16x16x32_bf16 v[68:71], v[120:123], v[28:31], v[68:71]
  v_mfma_f32_16x16x32_bf16 v[72:75], v[124:127], v[28:31], v[72:75]
  v_mfma_f32_16x16x32_bf16 v[76:79], v[128:131], v[28:31], v[76:79]
  v_mfma_f32_16x16x32_bf16 v[80:83], v[132:135], v[28:31], v[80:83]
  ds_read_b64_tr_b16 v[116:117], v9 offset:6400
  ds_read_b64_tr_b16 v[118:119], v9 offset:6560
  ds_read_b64_tr_b16 v[120:121], v9 offset:6432
  ds_read_b64_tr_b16 v[122:123], v9 offset:6592
  ds_read_b64_tr_b16 v[124:125], v9 offset:6464
  ds_read_b64_tr_b16 v[126:127], v9 offset:6624
  ds_read_b64_tr_b16 v[128:129], v9 offset:6496
  ds_read_b64_tr_b16 v[130:131], v9 offset:6656
  ds_read_b64_tr_b16 v[132:133], v9 offset:6528
  ds_read_b64_tr_b16 v[134:135], v9 offset:6688
  s_waitcnt vmcnt(5) lgkmcnt(10)
  v_mfma_f32_16x16x32_bf16 v[64:67], v[96:99], v[32:35], v[64:67]
  v_mfma_f32_16x16x32_bf16 v[68:71], v[100:103], v[32:35], v[68:71]
  v_mfma_f32_16x16x32_bf16 v[72:75], v[104:107], v[32:35], v[72:75]
  v_mfma_f32_16x16x32_bf16 v[76:79], v[108:111], v[32:35], v[76:79]
  v_mfma_f32_16x16x32_bf16 v[80:83], v[112:115], v[32:35], v[80:83]
  ds_read_b64_tr_b16 v[96:97], v9 offset:7680
  ds_read_b64_tr_b16 v[98:99], v9 offset:7840
  ds_read_b64_tr_b16 v[100:101], v9 offset:7712
  ds_read_b64_tr_b16 v[102:103], v9 offset:7872
  ds_read_b64_tr_b16 v[104:105], v9 offset:7744
  ds_read_b64_tr_b16 v[106:107], v9 offset:7904
  ds_read_b64_tr_b16 v[108:109], v9 offset:7776
  ds_read_b64_tr_b16 v[110:111], v9 offset:7936
  ds_read_b64_tr_b16 v[112:113], v9 offset:7808
  ds_read_b64_tr_b16 v[114:115], v9 offset:7968
  s_waitcnt vmcnt(4) lgkmcnt(10)
  v_mfma_f32_16x16x32_bf16 v[64:67], v[116:119], v[36:39], v[64:67]
  v_mfma_f32_16x16x32_bf16 v[68:71], v[120:123], v[36:39], v[68:71]
  v_mfma_f32_16x16x32_bf16 v[72:75], v[124:127], v[36:39], v[72:75]
  v_mfma_f32_16x16x32_bf16 v[76:79], v[128:131], v[36:39], v[76:79]
  v_mfma_f32_16x16x32_bf16 v[80:83], v[132:135], v[36:39], v[80:83]
  ds_read_b64_tr_b16 v[116:117], v9 offset:8960
  ds_read_b64_tr_b16 v[118:119], v9 offset:9120
  ds_read_b64_tr_b16 v[120:121], v9 offset:8992
  ds_read_b64_tr_b16 v[122:123], v9 offset:9152
  ds_read_b64_tr_b16 v[124:125], v9 offset:9024
  ds_read_b64_tr_b16 v[126:127], v9 offset:9184
  ds_read_b64_tr_b16 v[128:129], v9 offset:9056
  ds_read_b64_tr_b16 v[130:131], v9 offset:9216
  ds_read_b64_tr_b16 v[132:133], v9 offset:9088
  ds_read_b64_tr_b16 v[134:135], v9 offset:9248
  s_waitcnt vmcnt(3) lgkmcnt(10)
  v_mfma_f32_16x16x32_bf16 v[64:67], v[96:99], v[40:43], v[64:67]
  v_mfma_f32_16x16x32_bf16 v[68:71], v[100:103], v[40:43], v[68:71]
  v_mfma_f32_16x16x32_bf16 v[72:75], v[104:107], v[40:43], v[72:75]
  v_mfma_f32_16x16x32_bf16 v[76:79], v[108:111], v[40:43], v[76:79]
  v_mfma_f32_16x16x32_bf16 v[80:83], v[112:115], v[40:43], v[80:83]
  ds_read_b64_tr_b16 v[96:97], v9 offset:10240
  ds_read_b64_tr_b16 v[98:99], v9 offset:10400
  ds_read_b64_tr_b16 v[100:101], v9 offset:10272
  ds_read_b64_tr_b16 v[102:103], v9 offset:10432
  ds_read_b64_tr_b16 v[104:105], v9 offset:10304
  ds_read_b64_tr_b16 v[106:107], v9 offset:10464
  ds_read_b64_tr_b16 v[108:109], v9 offset:10336
  ds_read_b64_tr_b16 v[110:111], v9 offset:10496
  ds_read_b64_tr_b16 v[112:113], v9 offset:10368
  ds_read_b64_tr_b16 v[114:115], v9 offset:10528
  s_waitcnt vmcnt(2) lgkmcnt(10)
  v_mfma_f32_16x16x32_bf16 v[64:67], v[116:119], v[44:47], v[64:67]
  v_mfma_f32_16x16x32_bf16 v[68:71], v[120:123], v[44:47], v[68:71]
  v_mfma_f32_16x16x32_bf16 v[72:75], v[124:127], v[44:47], v[72:75]
  v_mfma_f32_16x16x32_bf16 v[76:79], v[128:131], v[44:47], v[76:79]
  v_mfma_f32_16x16x32_bf16 v[80:83], v[132:135], v[44:47], v[80:83]
  ds_read_b64_tr_b16 v[116:117], v9 offset:11520
  ds_read_b64_tr_b16 v[118:119], v9 offset:11680
  ds_read_b64_tr_b16 v[120:121], v9 offset:11552
  ds_read_b64_tr_b16 v[122:123], v9 offset:11712
  ds_read_b64_tr_b16 v[124:125], v9 offset:11584
  ds_read_b64_tr_b16 v[126:127], v9 offset:11744
  ds_read_b64_tr_b16 v[128:129], v9 offset:11616
  ds_read_b64_tr_b16 v[130:131], v9 offset:11776
  ds_read_b64_tr_b16 v[132:133], v9 offset:11648
  ds_read_b64_tr_b16 v[134:135], v9 offset:11808
  s_waitcnt vmcnt(1) lgkmcnt(10)
  v_mfma_f32_16x16x32_bf16 v[64:67], v[96:99], v[48:51], v[64:67]
  v_mfma_f32_16x16x32_bf16 v[68:71], v[100:103], v[48:51], v[68:71]
  v_mfma_f32_16x16x32_bf16 v[72:75], v[104:107], v[48:51], v[72:75]
  v_mfma_f32_16x16x32_bf16 v[76:79], v[108:111], v[48:51], v[76:79]
  v_mfma_f32_16x16x32_bf16 v[80:83], v[112:115], v[48:51], v[80:83]
  s_waitcnt vmcnt(0) lgkmcnt(0)
  v_mfma_f32_16x16x32_bf16 v[64:67], v[116:119], v[52:55], v[64:67]
  v_mfma_f32_16x16x32_bf16 v[68:71], v[120:123], v[52:55], v[68:71]
  v_mfma_f32_16x16x32_bf16 v[72:75], v[124:127], v[52:55], v[72:75]
  v_mfma_f32_16x16x32_bf16 v[76:79], v[128:131], v[52:55], v[76:79]
  v_mfma_f32_16x16x32_bf16 v[80:83], v[132:135], v[52:55], v[80:83]
  s_nop 9
  s_mul_i32 s52, s48, 5120
  v_lshlrev_b32 v7, 4, v1
  v_add_u32 v7, s52, v7
  v_add_u32 v7, 11392, v7
  s_cmp_eq_u32 s49, 0
  s_cbranch_scc1 gated_mix__grouped_kv_mqa__spectral_gfnet__prompt_kernel_ra163
  ds_write_b128 v7, v[64:67] offset:0
  ds_write_b128 v7, v[68:71] offset:1024
  ds_write_b128 v7, v[72:75] offset:2048
  ds_write_b128 v7, v[76:79] offset:3072
  ds_write_b128 v7, v[80:83] offset:4096
  s_waitcnt lgkmcnt(0)
  s_barrier
  s_branch gated_mix__grouped_kv_mqa__spectral_gfnet__prompt_kernel_rb164
gated_mix__grouped_kv_mqa__spectral_gfnet__prompt_kernel_ra163:
  s_barrier
  ds_read_b128 v[96:99], v7 offset:0
  ds_read_b128 v[100:103], v7 offset:1024
  ds_read_b128 v[104:107], v7 offset:2048
  ds_read_b128 v[108:111], v7 offset:3072
  ds_read_b128 v[112:115], v7 offset:4096
  v_and_b32 v5, 15, v1
  s_lshl_b32 s52, s48, 4
  v_add_u32 v5, s52, v5
  v_mul_u32_u24 v5, 160, v5
  v_lshrrev_b32 v6, 4, v1
  v_lshl_add_u32 v5, v6, 3, v5
  ds_read_b64 v[136:137], v5 offset:0
  ds_read_b64 v[138:139], v5 offset:32
  ds_read_b64 v[140:141], v5 offset:64
  ds_read_b64 v[142:143], v5 offset:96
  ds_read_b64 v[144:145], v5 offset:128
  s_waitcnt lgkmcnt(0)
  v_add_f32 v64, v64, v96
  v_add_f32 v65, v65, v97
  v_add_f32 v66, v66, v98
  v_add_f32 v67, v67, v99
  v_add_f32 v68, v68, v100
  v_add_f32 v69, v69, v101
  v_add_f32 v70, v70, v102
  v_add_f32 v71, v71, v103
  v_add_f32 v72, v72, v104
  v_add_f32 v73, v73, v105
  v_add_f32 v74, v74, v106
  v_add_f32 v75, v75, v107
  v_add_f32 v76, v76, v108
  v_add_f32 v77, v77, v109
  v_add_f32 v78, v78, v110
  v_add_f32 v79, v79, v111
  v_add_f32 v80, v80, v112
  v_add_f32 v81, v81, v113
  v_add_f32 v82, v82, v114
  v_add_f32 v83, v83, v115
  v_sub_f32 v9, 1.0, v8
  v_lshlrev_b32 v10, 16, v136
  v_and_b32 v11, 0xffff0000, v136
  v_mul_f32 v10, v10, v9
  v_mul_f32 v11, v11, v9
  v_fma_f32 v64, v64, v8, v10
  v_fma_f32 v65, v65, v8, v11
  v_lshlrev_b32 v10, 16, v137
  v_and_b32 v11, 0xffff0000, v137
  v_mul_f32 v10, v10, v9
  v_mul_f32 v11, v11, v9
  v_fma_f32 v66, v66, v8, v10
  v_fma_f32 v67, v67, v8, v11
  v_lshlrev_b32 v10, 16, v138
  v_and_b32 v11, 0xffff0000, v138
  v_mul_f32 v10, v10, v9
  v_mul_f32 v11, v11, v9
  v_fma_f32 v68, v68, v8, v10
  v_fma_f32 v69, v69, v8, v11
  v_lshlrev_b32 v10, 16, v139
  v_and_b32 v11, 0xffff0000, v139
  v_mul_f32 v10, v10, v9
  v_mul_f32 v11, v11, v9
  v_fma_f32 v70, v70, v8, v10
  v_fma_f32 v71, v71, v8, v11
  v_lshlrev_b32 v10, 16, v140
  v_and_b32 v11, 0xffff0000, v140
  v_mul_f32 v10, v10, v9
  v_mul_f32 v11, v11, v9
  v_fma_f32 v72, v72, v8, v10
  v_fma_f32 v73, v73, v8, v11
  v_lshlrev_b32 v10, 16, v141
  v_and_b32 v11, 0xffff0000, v141
  v_mul_f32 v10, v10, v9
  v_mul_f32 v11, v11, v9
  v_fma_f32 v74, v74, v8, v10
  v_fma_f32 v75, v75, v8, v11
  v_lshlrev_b32 v10, 16, v142
  v_and_b32 v11, 0xffff0000, v142
  v_mul_f32 v10, v10, v9
  v_mul_f32 v11, v11, v9
  v_fma_f32 v76, v76, v8, v10
  v_fma_f32 v77, v77, v8, v11
  v_lshlrev_b32 v10, 16, v143
  v_and_b32 v11, 0xffff0000, v143
  v_mul_f32 v10, v10, v9
  v_mul_f32 v11, v11, v9
  v_fma_f32 v78, v78, v8, v10
  v_fma_f32 v79, v79, v8, v11
  v_lshlrev_b32 v10, 16, v144
  v_and_b32 v11, 0xffff0000, v144
  v_mul_f32 v10, v10, v9
  v_mul_f32 v11, v11, v9
  v_fma_f32 v80, v80, v8, v10
  v_fma_f32 v81, v81, v8, v11
  v_lshlrev_b32 v10, 16, v145
  v_and_b32 v11, 0xffff0000, v145
  v_mul_f32 v10, v10, v9
  v_mul_f32 v11, v11, v9
  v_fma_f32 v82, v82, v8, v10
  v_fma_f32 v83, v83, v8, v11
  v_cvt_pk_bf16_f32 v96, v64, v65
  v_cvt_pk_bf16_f32 v97, v66, v67
  v_cvt_pk_bf16_f32 v98, v68, v69
  v_cvt_pk_bf16_f32 v99, v70, v71
  v_cvt_pk_bf16_f32 v100, v72, v73
  v_cvt_pk_bf16_f32 v101, v74, v75
  v_cvt_pk_bf16_f32 v102, v76, v77
  v_cvt_pk_bf16_f32 v103, v78, v79
  v_cvt_pk_bf16_f32 v104, v80, v81
  v_cvt_pk_bf16_f32 v105, v82, v83
  ds_write_b64 v5, v[96:97] offset:0
  ds_write_b64 v5, v[98:99] offset:32
  ds_write_b64 v5, v[100:101] offset:64
  ds_write_b64 v5, v[102:103] offset:96
  ds_write_b64 v5, v[104:105] offset:128
  s_mul_i32 s52, s48, 2560
  v_lshlrev_b32 v6, 4, v1
  v_add_u32 v6, s52, v6
  s_mov_b32 s53, 0xCCCCCCCD
  s_lshl_b32 s54, s45, 6
  s_lshl_b32 s55, s48, 4
  s_add_u32 s54, s54, s55
  s_mul_i32 s54, s54, 1280
  s_mul_i32 s55, s46, 160
  s_add_u32 s54, s54, s55
  s_waitcnt lgkmcnt(0)
  ds_read_b128 v[112:115], v6 offset:0
  ds_read_b128 v[116:119], v6 offset:1024
  ds_read_b128 v[120:123], v6 offset:2048
  v_add_u32 v3, 0, v1
  v_mul_hi_u32 v4, v3, s53
  v_lshrrev_b32 v4, 3, v4
  v_mul_u32_u24 v10, 10, v4
  v_sub_u32 v10, v3, v10
  v_mul_u32_u24 v4, 1280, v4
  v_lshl_add_u32 v12, v10, 4, v4
  v_add_u32 v3, 64, v1
  v_mul_hi_u32 v4, v3, s53
  v_lshrrev_b32 v4, 3, v4
  v_mul_u32_u24 v10, 10, v4
  v_sub_u32 v10, v3, v10
  v_mul_u32_u24 v4, 1280, v4
  v_lshl_add_u32 v13, v10, 4, v4
  v_add_u32 v3, 128, v1
  v_mul_hi_u32 v4, v3, s53
  v_lshrrev_b32 v4, 3, v4
  v_mul_u32_u24 v10, 10, v4
  v_sub_u32 v10, v3, v10
  v_mul_u32_u24 v4, 1280, v4
  v_lshl_add_u32 v14, v10, 4, v4
  s_waitcnt lgkmcnt(0)
  buffer_store_dwordx4 v[112:115], v12, s[36:39], s54 offen sc1
  buffer_store_dwordx4 v[116:119], v13, s[36:39], s54 offen sc1
  s_mov_b32 exec_hi, 0
  buffer_store_dwordx4 v[120:123], v14, s[36:39], s54 offen sc1
  s_mov_b64 exec, -1
gated_mix__grouped_kv_mqa__spectral_gfnet__prompt_kernel_rb164:
gated_mix__grouped_kv_mqa__spectral_gfnet__prompt_kernel_end:
  s_endpgm
.p2align 8
.type gated_mix__grouped_kv_mqa__spectral_gfnet__prompt_kernel_tbl,@object
gated_mix__grouped_kv_mqa__spectral_gfnet__prompt_kernel_tbl:
.long 0x3f803f80,0x3f803f80,0x3f803f80,0x3f803f80,0x3f7b3f80,0x3f553f6d,0x3f0e3f35,0x3e483ec4
.long 0x3f6d3f80,0x3ec43f35,0xbec40000,0xbf6dbf35,0x3f553f80,0xbe483ec4,0xbf7bbf35,0xbf0ebf6d
.long 0x3f353f80,0xbf350000,0xbf35bf80,0x3f350000,0x3f0e3f80,0xbf7bbec4,0x3e48bf35,0x3f553f6d
.long 0x3ec43f80,0xbf6dbf35,0x3f6d0000,0xbec43f35,0x3e483f80,0xbf0ebf6d,0x3f553f35,0xbf7bbec4
.long 0x3f80,0xbf80,0x3f80,0xbf80,0xbe483f80,0x3f0ebf6d,0xbf553f35,0x3f7bbec4
.long 0xbec43f80,0x3f6dbf35,0xbf6d0000,0x3ec43f35,0xbf0e3f80,0x3f7bbec4,0xbe48bf35,0xbf553f6d
.long 0xbf353f80,0x3f350000,0x3f35bf80,0xbf350000,0xbf553f80,0x3e483ec4,0x3f7bbf35,0x3f0ebf6d
.long 0xbf6d3f80,0xbec43f35,0x3ec40000,0x3f6dbf35,0xbf7b3f80,0xbf553f6d,0xbf0e3f35,0xbe483ec4
.long 0xbf803f80,0xbf803f80,0xbf803f80,0xbf803f80,0xbf7b3f80,0xbf553f6d,0xbf0e3f35,0xbe483ec4
.long 0xbf6d3f80,0xbec43f35,0x3ec40000,0x3f6dbf35,0xbf553f80,0x3e483ec4,0x3f7bbf35,0x3f0ebf6d
.long 0xbf353f80,0x3f350000,0x3f35bf80,0xbf350000,0xbf0e3f80,0x3f7bbec4,0xbe48bf35,0xbf553f6d
.long 0xbec43f80,0x3f6dbf35,0xbf6d0000,0x3ec43f35,0xbe483f80,0x3f0ebf6d,0xbf553f35,0x3f7bbec4
.long 0x3f80,0xbf80,0x3f80,0xbf80,0x3e483f80,0xbf0ebf6d,0x3f553f35,0xbf7bbec4
.long 0x3ec43f80,0xbf6dbf35,0x3f6d0000,0xbec43f35,0x3f0e3f80,0xbf7bbec4,0x3e48bf35,0x3f553f6d
.long 0x3f353f80,0xbf350000,0xbf35bf80,0x3f350000,0x3f553f80,0xbe483ec4,0xbf7bbf35,0xbf0ebf6d
.long 0x3f6d3f80,0x3ec43f35,0xbec40000,0xbf6dbf35,0x3f7b3f80,0x3f553f6d,0x3f0e3f35,0x3e483ec4
.long 0x3f803f80,0x3f803f80,0x3f803f80,0x3f803f80,0xbe480000,0xbf0ebec4,0xbf55bf35,0xbf7bbf6d
.long 0xbf6dbf80,0xbec4bf35,0x3ec40000,0x3f6d3f35,0x3f0e0000,0x3f7b3f6d,0x3e483f35,0xbf55bec4
.long 0x3f353f80,0xbf350000,0xbf35bf80,0x3f350000,0xbf550000,0xbe48bf6d,0x3f7b3f35,0xbf0e3ec4
.long 0xbec4bf80,0x3f6d3f35,0xbf6d0000,0x3ec4bf35,0x3f7b0000,0xbf553ec4,0x3f0ebf35,0xbe483f6d
.long 0x3f80,0xbf80,0x3f80,0xbf80,0xbf7b0000,0x3f553ec4,0xbf0ebf35,0x3e483f6d
.long 0x3ec4bf80,0xbf6d3f35,0x3f6d0000,0xbec4bf35,0x3f550000,0x3e48bf6d,0xbf7b3f35,0x3f0e3ec4
.long 0xbf353f80,0x3f350000,0x3f35bf80,0xbf350000,0xbf0e0000,0xbf7b3f6d,0xbe483f35,0x3f55bec4
.long 0x3f6dbf80,0x3ec4bf35,0xbec40000,0xbf6d3f35,0x3e480000,0x3f0ebec4,0x3f55bf35,0x3f7bbf6d
.long 0xbf803f80,0xbf803f80,0xbf803f80,0xbf803f80,0x3e480000,0x3f0ebec4,0x3f55bf35,0x3f7bbf6d
.long 0x3f6dbf80,0x3ec4bf35,0xbec40000,0xbf6d3f35,0xbf0e0000,0xbf7b3f6d,0xbe483f35,0x3f55bec4
.long 0xbf353f80,0x3f350000,0x3f35bf80,0xbf350000,0x3f550000,0x3e48bf6d,0xbf7b3f35,0x3f0e3ec4
.long 0x3ec4bf80,0xbf6d3f35,0x3f6d0000,0xbec4bf35,0xbf7b0000,0x3f553ec4,0xbf0ebf35,0x3e483f6d
.long 0x3f80,0xbf80,0x3f80,0xbf80,0x3f7b0000,0xbf553ec4,0x3f0ebf35,0xbe483f6d
.long 0xbec4bf80,0x3f6d3f35,0xbf6d0000,0x3ec4bf35,0xbf550000,0xbe48bf6d,0x3f7b3f35,0xbf0e3ec4
.long 0x3f353f80,0xbf350000,0xbf35bf80,0x3f350000,0x3f0e0000,0x3f7b3f6d,0x3e483f35,0xbf55bec4
.long 0xbf6dbf80,0xbec4bf35,0x3ec40000,0x3f6d3f35,0xbe480000,0xbf0ebec4,0xbf55bf35,0xbf7bbf6d
.long 0x80008000,0x80008000,0x80008000,0x80008000,0xbe488000,0xbf0ebec4,0xbf55bf35,0xbf7bbf6d
.long 0xbec48000,0xbf6dbf35,0xbf6dbf80,0xbec4bf35,0xbf0e8000,0xbf7bbf6d,0xbe48bf35,0x3f553ec4
.long 0xbf358000,0xbf35bf80,0x3f358000,0x3f353f80,0xbf558000,0xbe48bf6d,0x3f7b3f35,0xbf0e3ec4
.long 0xbf6d8000,0x3ec4bf35,0x3ec43f80,0xbf6dbf35,0xbf7b8000,0x3f55bec4,0xbf0e3f35,0x3e48bf6d
.long 0xbf808000,0x3f808000,0xbf808000,0x3f808000,0xbf7b8000,0x3f553ec4,0xbf0ebf35,0x3e483f6d
.long 0xbf6d8000,0x3ec43f35,0x3ec4bf80,0xbf6d3f35,0xbf558000,0xbe483f6d,0x3f7bbf35,0xbf0ebec4
.long 0xbf358000,0xbf353f80,0x3f358000,0x3f35bf80,0xbf0e8000,0xbf7b3f6d,0xbe483f35,0x3f55bec4
.long 0xbec48000,0xbf6d3f35,0xbf6d3f80,0xbec43f35,0xbe488000,0xbf0e3ec4,0xbf553f35,0xbf7b3f6d
.long 0x80008000,0x80008000,0x80008000,0x80008000,0x3e488000,0x3f0ebec4,0x3f55bf35,0x3f7bbf6d
.long 0x3ec48000,0x3f6dbf35,0x3f6dbf80,0x3ec4bf35,0x3f0e8000,0x3f7bbf6d,0x3e48bf35,0xbf553ec4
.long 0x3f358000,0x3f35bf80,0xbf358000,0xbf353f80,0x3f558000,0x3e48bf6d,0xbf7b3f35,0x3f0e3ec4
.long 0x3f6d8000,0xbec4bf35,0xbec43f80,0x3f6dbf35,0x3f7b8000,0xbf55bec4,0x3f0e3f35,0xbe48bf6d
.long 0x3f808000,0xbf808000,0x3f808000,0xbf808000,0x3f7b8000,0xbf553ec4,0x3f0ebf35,0xbe483f6d
.long 0x3f6d8000,0xbec43f35,0xbec4bf80,0x3f6d3f35,0x3f558000,0x3e483f6d,0xbf7bbf35,0x3f0ebec4
.long 0x3f358000,0x3f353f80,0xbf358000,0xbf35bf80,0x3f0e8000,0x3f7b3f6d,0x3e483f35,0xbf55bec4
.long 0x3ec48000,0x3f6d3f35,0x3f6d3f80,0x3ec43f35,0x3e488000,0x3f0e3ec4,0x3f553f35,0x3f7b3f6d
.long 0x80008000,0x80008000,0x80008000,0x80008000,0xbf7bbf80,0xbf55bf6d,0xbf0ebf35,0xbe48bec4
.long 0x3ec48000,0x3f6d3f35,0x3f6d3f80,0x3ec43f35,0x3f553f80,0xbe483ec4,0xbf7bbf35,0xbf0ebf6d
.long 0xbf358000,0xbf35bf80,0x3f358000,0x3f353f80,0xbf0ebf80,0x3f7b3ec4,0xbe483f35,0xbf55bf6d
.long 0x3f6d8000,0xbec43f35,0xbec4bf80,0x3f6d3f35,0x3e483f80,0xbf0ebf6d,0x3f553f35,0xbf7bbec4
.long 0xbf808000,0x3f808000,0xbf808000,0x3f808000,0x3e48bf80,0xbf0e3f6d,0x3f55bf35,0xbf7b3ec4
.long 0x3f6d8000,0xbec4bf35,0xbec43f80,0x3f6dbf35,0xbf0e3f80,0x3f7bbec4,0xbe48bf35,0xbf553f6d
.long 0xbf358000,0xbf353f80,0x3f358000,0x3f35bf80,0x3f55bf80,0xbe48bec4,0xbf7b3f35,0xbf0e3f6d
.long 0x3ec48000,0x3f6dbf35,0x3f6dbf80,0x3ec4bf35,0xbf7b3f80,0xbf553f6d,0xbf0e3f35,0xbe483ec4
.long 0x80008000,0x80008000,0x80008000,0x80008000,0x3f7bbf80,0x3f55bf6d,0x3f0ebf35,0x3e48bec4
.long 0xbec48000,0xbf6d3f35,0xbf6d3f80,0xbec43f35,0xbf553f80,0x3e483ec4,0x3f7bbf35,0x3f0ebf6d
.long 0x3f358000,0x3f35bf80,0xbf358000,0xbf353f80,0x3f0ebf80,0xbf7b3ec4,0x3e483f35,0x3f55bf6d
.long 0xbf6d8000,0x3ec43f35,0x3ec4bf80,0xbf6d3f35,0xbe483f80,0x3f0ebf6d,0xbf553f35,0x3f7bbec4
.long 0x3f808000,0xbf808000,0x3f808000,0xbf808000,0xbe48bf80,0x3f0e3f6d,0xbf55bf35,0x3f7b3ec4
.long 0xbf6d8000,0x3ec4bf35,0x3ec43f80,0xbf6dbf35,0x3f0e3f80,0xbf7bbec4,0x3e48bf35,0x3f553f6d
.long 0x3f358000,0x3f353f80,0xbf358000,0xbf35bf80,0xbf55bf80,0x3e48bec4,0x3f7b3f35,0x3f0e3f6d
.long 0xbec48000,0xbf6dbf35,0xbf6dbf80,0xbec4bf35,0x3f7b3f80,0x3f553f6d,0x3f0e3f35,0x3e483ec4
.long 0x3f803f80,0x3f803f80,0x3f803f80,0x3f803f80,0xbf7bbf80,0xbf55bf6d,0xbf0ebf35,0xbe48bec4
.long 0x3f6d3f80,0x3ec43f35,0xbec40000,0xbf6dbf35,0xbf55bf80,0x3e48bec4,0x3f7b3f35,0x3f0e3f6d
.long 0x3f353f80,0xbf350000,0xbf35bf80,0x3f350000,0xbf0ebf80,0x3f7b3ec4,0xbe483f35,0xbf55bf6d
.long 0x3ec43f80,0xbf6dbf35,0x3f6d0000,0xbec43f35,0xbe48bf80,0x3f0e3f6d,0xbf55bf35,0x3f7b3ec4
.long 0x3f80,0xbf80,0x3f80,0xbf80,0x3e48bf80,0xbf0e3f6d,0x3f55bf35,0xbf7b3ec4
.long 0xbec43f80,0x3f6dbf35,0xbf6d0000,0x3ec43f35,0x3f0ebf80,0xbf7b3ec4,0x3e483f35,0x3f55bf6d
.long 0xbf353f80,0x3f350000,0x3f35bf80,0xbf350000,0x3f55bf80,0xbe48bec4,0xbf7b3f35,0xbf0e3f6d
.long 0xbf6d3f80,0xbec43f35,0x3ec40000,0x3f6dbf35,0x3f7bbf80,0x3f55bf6d,0x3f0ebf35,0x3e48bec4
.long 0xbf803f80,0xbf803f80,0xbf803f80,0xbf803f80,0x3f7bbf80,0x3f55bf6d,0x3f0ebf35,0x3e48bec4
.long 0xbf6d3f80,0xbec43f35,0x3ec40000,0x3f6dbf35,0x3f55bf80,0xbe48bec4,0xbf7b3f35,0xbf0e3f6d
.long 0xbf353f80,0x3f350000,0x3f35bf80,0xbf350000,0x3f0ebf80,0xbf7b3ec4,0x3e483f35,0x3f55bf6d
.long 0xbec43f80,0x3f6dbf35,0xbf6d0000,0x3ec43f35,0x3e48bf80,0xbf0e3f6d,0x3f55bf35,0xbf7b3ec4
.long 0x3f80,0xbf80,0x3f80,0xbf80,0xbe48bf80,0x3f0e3f6d,0xbf55bf35,0x3f7b3ec4
.long 0x3ec43f80,0xbf6dbf35,0x3f6d0000,0xbec43f35,0xbf0ebf80,0x3f7b3ec4,0xbe483f35,0xbf55bf6d
.long 0x3f353f80,0xbf350000,0xbf35bf80,0x3f350000,0xbf55bf80,0x3e48bec4,0x3f7b3f35,0x3f0e3f6d
.long 0x3f6d3f80,0x3ec43f35,0xbec40000,0xbf6dbf35,0xbf7bbf80,0xbf55bf6d,0xbf0ebf35,0xbe48bec4
.long 0x3f803f80,0x3f803f80,0x3f803f80,0x3f803f80,0x3e480000,0x3f0e3ec4,0x3f553f35,0x3f7b3f6d
.long 0xbf6dbf80,0xbec4bf35,0x3ec40000,0x3f6d3f35,0xbf0e0000,0xbf7bbf6d,0xbe48bf35,0x3f553ec4
.long 0x3f353f80,0xbf350000,0xbf35bf80,0x3f350000,0x3f550000,0x3e483f6d,0xbf7bbf35,0x3f0ebec4
.long 0xbec4bf80,0x3f6d3f35,0xbf6d0000,0x3ec4bf35,0xbf7b0000,0x3f55bec4,0xbf0e3f35,0x3e48bf6d
.long 0x3f80,0xbf80,0x3f80,0xbf80,0x3f7b0000,0xbf55bec4,0x3f0e3f35,0xbe48bf6d
.long 0x3ec4bf80,0xbf6d3f35,0x3f6d0000,0xbec4bf35,0xbf550000,0xbe483f6d,0x3f7bbf35,0xbf0ebec4
.long 0xbf353f80,0x3f350000,0x3f35bf80,0xbf350000,0x3f0e0000,0x3f7bbf6d,0x3e48bf35,0xbf553ec4
.long 0x3f6dbf80,0x3ec4bf35,0xbec40000,0xbf6d3f35,0xbe480000,0xbf0e3ec4,0xbf553f35,0xbf7b3f6d
.long 0xbf803f80,0xbf803f80,0xbf803f80,0xbf803f80,0xbe480000,0xbf0e3ec4,0xbf553f35,0xbf7b3f6d
.long 0x3f6dbf80,0x3ec4bf35,0xbec40000,0xbf6d3f35,0x3f0e0000,0x3f7bbf6d,0x3e48bf35,0xbf553ec4
.long 0xbf353f80,0x3f350000,0x3f35bf80,0xbf350000,0xbf550000,0xbe483f6d,0x3f7bbf35,0xbf0ebec4
.long 0x3ec4bf80,0xbf6d3f35,0x3f6d0000,0xbec4bf35,0x3f7b0000,0xbf55bec4,0x3f0e3f35,0xbe48bf6d
.long 0x3f80,0xbf80,0x3f80,0xbf80,0xbf7b0000,0x3f55bec4,0xbf0e3f35,0x3e48bf6d
.long 0xbec4bf80,0x3f6d3f35,0xbf6d0000,0x3ec4bf35,0x3f550000,0x3e483f6d,0xbf7bbf35,0x3f0ebec4
.long 0x3f353f80,0xbf350000,0xbf35bf80,0x3f350000,0xbf0e0000,0xbf7bbf6d,0xbe48bf35,0x3f553ec4
.long 0xbf6dbf80,0xbec4bf35,0x3ec40000,0x3f6d3f35,0x3e480000,0x3f0e3ec4,0x3f553f35,0x3f7b3f6d
.long 0x80008000,0x80008000,0x80008000,0x80008000,0x3e488000,0x3f0e3ec4,0x3f553f35,0x3f7b3f6d
.long 0xbec48000,0xbf6dbf35,0xbf6dbf80,0xbec4bf35,0x3f0e8000,0x3f7b3f6d,0x3e483f35,0xbf55bec4
.long 0xbf358000,0xbf35bf80,0x3f358000,0x3f353f80,0x3f558000,0x3e483f6d,0xbf7bbf35,0x3f0ebec4
.long 0xbf6d8000,0x3ec4bf35,0x3ec43f80,0xbf6dbf35,0x3f7b8000,0xbf553ec4,0x3f0ebf35,0xbe483f6d
.long 0xbf808000,0x3f808000,0xbf808000,0x3f808000,0x3f7b8000,0xbf55bec4,0x3f0e3f35,0xbe48bf6d
.long 0xbf6d8000,0x3ec43f35,0x3ec4bf80,0xbf6d3f35,0x3f558000,0x3e48bf6d,0xbf7b3f35,0x3f0e3ec4
.long 0xbf358000,0xbf353f80,0x3f358000,0x3f35bf80,0x3f0e8000,0x3f7bbf6d,0x3e48bf35,0xbf553ec4
.long 0xbec48000,0xbf6d3f35,0xbf6d3f80,0xbec43f35,0x3e488000,0x3f0ebec4,0x3f55bf35,0x3f7bbf6d
.long 0x80008000,0x80008000,0x80008000,0x80008000,0xbe488000,0xbf0e3ec4,0xbf553f35,0xbf7b3f6d
.long 0x3ec48000,0x3f6dbf35,0x3f6dbf80,0x3ec4bf35,0xbf0e8000,0xbf7b3f6d,0xbe483f35,0x3f55bec4
.long 0x3f358000,0x3f35bf80,0xbf358000,0xbf353f80,0xbf558000,0xbe483f6d,0x3f7bbf35,0xbf0ebec4
.long 0x3f6d8000,0xbec4bf35,0xbec43f80,0x3f6dbf35,0xbf7b8000,0x3f553ec4,0xbf0ebf35,0x3e483f6d
.long 0x3f808000,0xbf808000,0x3f808000,0xbf808000,0xbf7b8000,0x3f55bec4,0xbf0e3f35,0x3e48bf6d
.long 0x3f6d8000,0xbec43f35,0xbec4bf80,0x3f6d3f35,0xbf558000,0xbe48bf6d,0x3f7b3f35,0xbf0e3ec4
.long 0x3f358000,0x3f353f80,0xbf358000,0xbf35bf80,0xbf0e8000,0xbf7bbf6d,0xbe48bf35,0x3f553ec4
.long 0x3ec48000,0x3f6d3f35,0x3f6d3f80,0x3ec43f35,0xbe488000,0xbf0ebec4,0xbf55bf35,0xbf7bbf6d
.long 0x80008000,0x80008000,0x80008000,0x80008000,0x3f7b3f80,0x3f553f6d,0x3f0e3f35,0x3e483ec4
.long 0x3ec48000,0x3f6d3f35,0x3f6d3f80,0x3ec43f35,0xbf55bf80,0x3e48bec4,0x3f7b3f35,0x3f0e3f6d
.long 0xbf358000,0xbf35bf80,0x3f358000,0x3f353f80,0x3f0e3f80,0xbf7bbec4,0x3e48bf35,0x3f553f6d
.long 0x3f6d8000,0xbec43f35,0xbec4bf80,0x3f6d3f35,0xbe48bf80,0x3f0e3f6d,0xbf55bf35,0x3f7b3ec4
.long 0xbf808000,0x3f808000,0xbf808000,0x3f808000,0xbe483f80,0x3f0ebf6d,0xbf553f35,0x3f7bbec4
.long 0x3f6d8000,0xbec4bf35,0xbec43f80,0x3f6dbf35,0x3f0ebf80,0xbf7b3ec4,0x3e483f35,0x3f55bf6d
.long 0xbf358000,0xbf353f80,0x3f358000,0x3f35bf80,0xbf553f80,0x3e483ec4,0x3f7bbf35,0x3f0ebf6d
.long 0x3ec48000,0x3f6dbf35,0x3f6dbf80,0x3ec4bf35,0x3f7bbf80,0x3f55bf6d,0x3f0ebf35,0x3e48bec4
.long 0x80008000,0x80008000,0x80008000,0x80008000,0xbf7b3f80,0xbf553f6d,0xbf0e3f35,0xbe483ec4
.long 0xbec48000,0xbf6d3f35,0xbf6d3f80,0xbec43f35,0x3f55bf80,0xbe48bec4,0xbf7b3f35,0xbf0e3f6d
.long 0x3f358000,0x3f35bf80,0xbf358000,0xbf353f80,0xbf0e3f80,0x3f7bbec4,0xbe48bf35,0xbf553f6d
.long 0xbf6d8000,0x3ec43f35,0x3ec4bf80,0xbf6d3f35,0x3e48bf80,0xbf0e3f6d,0x3f55bf35,0xbf7b3ec4
.long 0x3f808000,0xbf808000,0x3f808000,0xbf808000,0x3e483f80,0xbf0ebf6d,0x3f553f35,0xbf7bbec4
.long 0xbf6d8000,0x3ec4bf35,0x3ec43f80,0xbf6dbf35,0xbf0ebf80,0x3f7b3ec4,0xbe483f35,0xbf55bf6d
.long 0x3f358000,0x3f353f80,0xbf358000,0xbf35bf80,0x3f553f80,0xbe483ec4,0xbf7bbf35,0xbf0ebf6d
.long 0xbec48000,0xbf6dbf35,0xbf6dbf80,0xbec4bf35,0xbf7bbf80,0xbf55bf6d,0xbf0ebf35,0xbe48bec4
.long 0x3f800000,0x3f800000,0x3f800000,0x3f800000,0x3f800000,0x3f7ffcd7,0x3f7ff35e,0x3f7fe394
.long 0x3f800000,0x3f7ff35e,0x3f7fcd79,0x3f7f8e56,0x3f800000,0x3f7fe394,0x3f7f8e56,0x3f7f0059
.long 0x3f800000,0x3f7fcd79,0x3f7f35f9,0x3f7e39bc,0x3f800000,0x3f7fb10f,0x3f7ec46d,0x3f7d3aac
.long 0x3f800000,0x3f7f8e56,0x3f7e39bc,0x3f7c0361,0x3f800000,0x3f7f654e,0x3f7d95f4,0x3f7a9421
.long 0x3f800000,0x3f7f35f9,0x3f7cd925,0x3f78ed3c,0x3f800000,0x3f7f0059,0x3f7c0361,0x3f770f11
.long 0x3f800000,0x3f7ec46d,0x3f7b14be,0x3f74fa0b,0x3f800000,0x3f7e8238,0x3f7a0d54,0x3f72ae9e
.long 0x3f800000,0x3f7e39bc,0x3f78ed3c,0x3f702d4f,0x3f800000,0x3f7deafa,0x3f77b493,0x3f6d76aa
.long 0x3f800000,0x3f7d95f4,0x3f766377,0x3f6a8b4b,0x3f800000,0x3f7d3aac,0x3f74fa0b,0x3f676bd8
.long 0x3f800000,0x3f7cd925,0x3f737871,0x3f641901,0x3f800000,0x3f7c7160,0x3f71decf,0x3f609384
.long 0x3f800000,0x3f7c0361,0x3f702d4f,0x3f5cdc29,0x3f800000,0x3f7b8f2a,0x3f6e641a,0x3f58f3c4
.long 0x3f800000,0x3f7b14be,0x3f6c835e,0x3f54db31,0x3f800000,0x3f7a9421,0x3f6a8b4b,0x3f50935b
.long 0x3f800000,0x3f7a0d54,0x3f687c12,0x3f4c1d35,0x3f800000,0x3f79805c,0x3f6655e7,0x3f4779bc
.long 0x3f800000,0x3f78ed3c,0x3f641901,0x3f42a9f7,0x3f800000,0x3f7853f8,0x3f61c598,0x3f3daef9
.long 0x3f800000,0x3f77b493,0x3f5f5be6,0x3f3889dc,0x3f800000,0x3f770f11,0x3f5cdc29,0x3f333bc6
.long 0x3f800000,0x3f766377,0x3f5a46a0,0x3f2dc5e3,0x3f800000,0x3f75b1c9,0x3f579b8c,0x3f28296a
.long 0x3f800000,0x3f74fa0b,0x3f54db31,0x3f226799,0x3f800000,0x3f743c41,0x3f5205d4,0x3f1c81b9
.long 0x3f800000,0x3f800000,0x3f800000,0x3f800000,0x3f7fcd79,0x3f7fb10f,0x3f7f8e56,0x3f7f654e
.long 0x3f7f35f9,0x3f7ec46d,0x3f7e39bc,0x3f7d95f4,0x3f7e39bc,0x3f7d3aac,0x3f7c0361,0x3f7a9421
.long 0x3f7cd925,0x3f7b14be,0x3f78ed3c,0x3f766377,0x3f7b14be,0x3f7853f8,0x3f74fa0b,0x3f710908
.long 0x3f78ed3c,0x3f74fa0b,0x3f702d4f,0x3f6a8b4b,0x3f766377,0x3f710908,0x3f6a8b4b,0x3f62f219
.long 0x3f737871,0x3f6c835e,0x3f641901,0x3f5a46a0,0x3f702d4f,0x3f676bd8,0x3f5cdc29,0x3f50935b
.long 0x3f6c835e,0x3f61c598,0x3f54db31,0x3f45e403,0x3f687c12,0x3f5b941a,0x3f4c1d35,0x3f3a4582
.long 0x3f641901,0x3f54db31,0x3f42a9f7,0x3f2dc5e3,0x3f5f5be6,0x3f4d9f02,0x3f3889dc,0x3f207440
.long 0x3f5a46a0,0x3f45e403,0x3f2dc5e3,0x3f1260b2,0x3f54db31,0x3f3daef9,0x3f226799,0x3f039c3d
.long 0x3f4f1bbd,0x3f3504f3,0x3f167918,0x3ee87171,0x3f490a88,0x3f2beb4a,0x3f0a04f8,0x3ec8917e
.long 0x3f42a9f7,0x3f226799,0x3efa2c90,0x3ea7bf25,0x3f3bfc8f,0x3f187fc0,0x3edf7108,0x3e862210
.long 0x3f3504f3,0x3f0e39da,0x3ec3ef15,0x3e47c5c2,0x3f2dc5e3,0x3f039c3d,0x3ea7bf25,0x3e0255f4
.long 0x3f26423a,0x3ef15aea,0x3e8afa3e,0x3d712283,0x3f1e7cf1,0x3edae880,0x3e5b73dc,0xbc20d8d2
.long 0x3f167918,0x3ec3ef15,0x3e20305b,0xbda0af2a,0x3f0e39da,0x3eac7cd4,0x3dc8bd36,0xbe164083
.long 0x3f05c277,0x3e94a031,0x3d20cee7,0xbe5b73dc,0x3efa2c90,0x3e78cfcc,0xbca0d6d6,0xbe8fcefe
.long 0x3ee87171,0x3e47c5c2,0xbda0af2a,0xbeb13641,0x3ed65a92,0x3e164083,0xbe0c4cf7,0xbed1c759
.long 0x3ec3ef15,0x3dc8bd36,0xbe47c5c2,0xbef15aea,0x3eb13641,0x3d48fb30,0xbe814693,0xbf07e565
.long 0x0,0x0,0x0,0x0,0x0,0x3c20d8d2,0x3ca0d6d6,0x3cf13d4c
.long 0x0,0x3ca0d6d6,0x3d20cee7,0x3d712283,0x0,0x3cf13d4c,0x3d712283,0x3db4b86a
.long 0x0,0x3d20cee7,0x3da0af2a,0x3df0b772,0x0,0x3d48fb30,0x3dc8bd36,0x3e164083
.long 0x0,0x3d712283,0x3df0b772,0x3e3403f1,0x0,0x3d8ca1f2,0x3e0c4cf7,0x3e519f65
.long 0x0,0x3da0af2a,0x3e20305b,0x3e6f0c4d,0x0,0x3db4b86a,0x3e3403f1,0x3e862210
.long 0x0,0x3dc8bd36,0x3e47c5c2,0x3e94a031,0x0,0x3ddcbd0d,0x3e5b73dc,0x3ea2fd52
.long 0x0,0x3df0b772,0x3e6f0c4d,0x3eb13641,0x0,0x3e0255f4,0x3e814693,0x3ebf47d7
.long 0x0,0x3e0c4cf7,0x3e8afa3e,0x3ecd2ef3,0x0,0x3e164083,0x3e94a031,0x3edae880
.long 0x0,0x3e20305b,0x3e9e377a,0x3ee87171,0x0,0x3e2a1c3f,0x3ea7bf25,0x3ef5c6c5
.long 0x0,0x3e3403f1,0x3eb13641,0x3f0172c3,0x0,0x3e3de731,0x3eba9be1,0x3f07e565
.long 0x0,0x3e47c5c2,0x3ec3ef15,0x3f0e39da,0x0,0x3e519f65,0x3ecd2ef3,0x3f146eba
.long 0x0,0x3e5b73dc,0x3ed65a92,0x3f1a82a4,0x0,0x3e6542e9,0x3edf7108,0x3f207440
.long 0x0,0x3e6f0c4d,0x3ee87171,0x3f26423a,0x0,0x3e78cfcc,0x3ef15aea,0x3f2beb4a
.long 0x0,0x3e814693,0x3efa2c90,0x3f316e2c,0x0,0x3e862210,0x3f0172c3,0x3f36c9a9
.long 0x0,0x3e8afa3e,0x3f05c277,0x3f3bfc8f,0x0,0x3e8fcefe,0x3f0a04f8,0x3f4105b8
.long 0x0,0x3e94a031,0x3f0e39da,0x3f45e403,0x0,0x3e996dba,0x3f1260b2,0x3f4a965e
.long 0x0,0x0,0x0,0x0,0x3d20cee7,0x3d48fb30,0x3d712283,0x3d8ca1f2
.long 0x3da0af2a,0x3dc8bd36,0x3df0b772,0x3e0c4cf7,0x3df0b772,0x3e164083,0x3e3403f1,0x3e519f65
.long 0x3e20305b,0x3e47c5c2,0x3e6f0c4d,0x3e8afa3e,0x3e47c5c2,0x3e78cfcc,0x3e94a031,0x3eac7cd4
.long 0x3e6f0c4d,0x3e94a031,0x3eb13641,0x3ecd2ef3,0x3e8afa3e,0x3eac7cd4,0x3ecd2ef3,0x3eece91a
.long 0x3e9e377a,0x3ec3ef15,0x3ee87171,0x3f05c277,0x3eb13641,0x3edae880,0x3f0172c3,0x3f146eba
.long 0x3ec3ef15,0x3ef15aea,0x3f0e39da,0x3f226799,0x3ed65a92,0x3f039c3d,0x3f1a82a4,0x3f2f9c32
.long 0x3ee87171,0x3f0e39da,0x3f26423a,0x3f3bfc8f,0x3efa2c90,0x3f187fc0,0x3f316e2c,0x3f4779bc
.long 0x3f05c277,0x3f226799,0x3f3bfc8f,0x3f5205d4,0x3f0e39da,0x3f2beb4a,0x3f45e403,0x3f5b941a
.long 0x3f167918,0x3f3504f3,0x3f4f1bbd,0x3f641901,0x3f1e7cf1,0x3f3daef9,0x3f579b8c,0x3f6b8a3d
.long 0x3f26423a,0x3f45e403,0x3f5f5be6,0x3f71decf,0x3f2dc5e3,0x3f4d9f02,0x3f6655e7,0x3f770f11
.long 0x3f3504f3,0x3f54db31,0x3f6c835e,0x3f7b14be,0x3f3bfc8f,0x3f5b941a,0x3f71decf,0x3f7deafa
.long 0x3f42a9f7,0x3f61c598,0x3f766377,0x3f7f8e56,0x3f490a88,0x3f676bd8,0x3f7a0d54,0x3f7ffcd7
.long 0x3f4f1bbd,0x3f6c835e,0x3f7cd925,0x3f7f35f9,0x3f54db31,0x3f710908,0x3f7ec46d,0x3f7d3aac
.long 0x3f5a46a0,0x3f74fa0b,0x3f7fcd79,0x3f7a0d54,0x3f5f5be6,0x3f7853f8,0x3f7ff35e,0x3f75b1c9
.long 0x3f641901,0x3f7b14be,0x3f7f35f9,0x3f702d4f,0x3f687c12,0x3f7d3aac,0x3f7d95f4,0x3f698690
.long 0x3f6c835e,0x3f7ec46d,0x3f7b14be,0x3f61c598,0x3f702d4f,0x3f7fb10f,0x3f77b493,0x3f58f3c4
.long 0x3f800000,0x3f800000,0x3f800000,0x3f800000,0x3f7f35f9,0x3f7f0059,0x3f7ec46d,0x3f7e8238
.long 0x3f7cd925,0x3f7c0361,0x3f7b14be,0x3f7a0d54,0x3f78ed3c,0x3f770f11,0x3f74fa0b,0x3f72ae9e
.long 0x3f737871,0x3f702d4f,0x3f6c835e,0x3f687c12,0x3f6c835e,0x3f676bd8,0x3f61c598,0x3f5b941a
.long 0x3f641901,0x3f5cdc29,0x3f54db31,0x3f4c1d35,0x3f5a46a0,0x3f50935b,0x3f45e403,0x3f3a4582
.long 0x3f4f1bbd,0x3f42a9f7,0x3f3504f3,0x3f26423a,0x3f42a9f7,0x3f333bc6,0x3f226799,0x3f104f0e
.long 0x3f3504f3,0x3f226799,0x3f0e39da,0x3ef15aea,0x3f26423a,0x3f104f0e,0x3ef15aea,0x3ebf47d7
.long 0x3f167918,0x3efa2c90,0x3ec3ef15,0x3e8afa3e,0x3f05c277,0x3ed1c759,0x3e94a031,0x3e2a1c3f
.long 0x3ee87171,0x3ea7bf25,0x3e47c5c2,0x3d712283,0x3ec3ef15,0x3e78cfcc,0x3dc8bd36,0xbd48fb30
.long 0x3e9e377a,0x3e20305b,0x0,0xbe20305b,0x3e6f0c4d,0x3d8ca1f2,0xbdc8bd36,0xbe862210
.long 0x3e20305b,0xbca0d6d6,0xbe47c5c2,0xbeba9be1,0x3da0af2a,0xbddcbd0d,0xbe94a031,0xbeece91a
.long 0x0,0xbe47c5c2,0xbec3ef15,0xbf0e39da,0xbda0af2a,0xbe8fcefe,0xbef15aea,0xbf2456f1
.long 0xbe20305b,0xbeba9be1,0xbf0e39da,0xbf3889dc,0xbe6f0c4d,0xbee3f40d,0xbf226799,0xbf4a965e
.long 0xbe9e377a,0xbf05c277,0xbf3504f3,0xbf5a46a0,0xbec3ef15,0xbf187fc0,0xbf45e403,0xbf676bd8
.long 0xbee87171,0xbf2a0c73,0xbf54db31,0xbf71decf,0xbf05c277,0xbf3a4582,0xbf61c598,0xbf79805c
.long 0xbf167918,0xbf490a88,0xbf6c835e,0xbf7e39bc,0xbf26423a,0xbf563e03,0xbf74fa0b,0xbf7ffcd7
.long 0xbf3504f3,0xbf61c598,0xbf7b14be,0xbf7ec46d,0xbf42a9f7,0xbf6b8a3d,0xbf7ec46d,0xbf7a9421
.long 0x3f800000,0x3f800000,0x3f800000,0x3f800000,0x3f7e39bc,0x3f7deafa,0x3f7d95f4,0x3f7d3aac
.long 0x3f78ed3c,0x3f77b493,0x3f766377,0x3f74fa0b,0x3f702d4f,0x3f6d76aa,0x3f6a8b4b,0x3f676bd8
.long 0x3f641901,0x3f5f5be6,0x3f5a46a0,0x3f54db31,0x3f54db31,0x3f4d9f02,0x3f45e403,0x3f3daef9
.long 0x3f42a9f7,0x3f3889dc,0x3f2dc5e3,0x3f226799,0x3f2dc5e3,0x3f207440,0x3f1260b2,0x3f039c3d
.long 0x3f167918,0x3f05c277,0x3ee87171,0x3ec3ef15,0x3efa2c90,0x3ed1c759,0x3ea7bf25,0x3e78cfcc
.long 0x3ec3ef15,0x3e94a031,0x3e47c5c2,0x3dc8bd36,0x3e8afa3e,0x3e2a1c3f,0x3d712283,0xbd48fb30
.long 0x3e20305b,0x3d20cee7,0xbda0af2a,0xbe47c5c2,0x3d20cee7,0xbdb4b86a,0xbe5b73dc,0xbeac7cd4
.long 0xbda0af2a,0xbe5b73dc,0xbeb13641,0xbef15aea,0xbe47c5c2,0xbeac7cd4,0xbef15aea,0xbf187fc0
.long 0xbe9e377a,0xbee87171,0xbf167918,0xbf3504f3,0xbed65a92,0xbf104f0e,0xbf316e2c,0xbf4d9f02
.long 0xbf05c277,0xbf2a0c73,0xbf490a88,0xbf61c598,0xbf1e7cf1,0xbf4105b8,0xbf5cdc29,0xbf710908
.long 0xbf3504f3,0xbf54db31,0xbf6c835e,0xbf7b14be,0xbf490a88,0xbf653a48,0xbf77b493,0xbf7fb10f
.long 0xbf5a46a0,0xbf71decf,0xbf7e39bc,0xbf7ec46d,0xbf687c12,0xbf7a9421,0xbf7ff35e,0xbf7853f8
.long 0xbf737871,0xbf7f35f9,0xbf7cd925,0xbf6c835e,0xbf7b14be,0xbf7fb10f,0xbf74fa0b,0xbf5b941a
.long 0xbf7f35f9,0xbf7c0361,0xbf687c12,0xbf45e403,0xbf7fcd79,0xbf743c41,0xbf579b8c,0xbf2beb4a
.long 0xbf7cd925,0xbf687c12,0xbf42a9f7,0xbf0e39da,0xbf766377,0xbf58f3c4,0xbf2a0c73,0xbedae880
.long 0xbf6c835e,0xbf45e403,0xbf0e39da,0xbe94a031,0xbf5f5be6,0xbf2f9c32,0xbedf7108,0xbe164083
.long 0x0,0x0,0x0,0x0,0x3da0af2a,0x3db4b86a,0x3dc8bd36,0x3ddcbd0d
.long 0x3e20305b,0x3e3403f1,0x3e47c5c2,0x3e5b73dc,0x3e6f0c4d,0x3e862210,0x3e94a031,0x3ea2fd52
.long 0x3e9e377a,0x3eb13641,0x3ec3ef15,0x3ed65a92,0x3ec3ef15,0x3edae880,0x3ef15aea,0x3f039c3d
.long 0x3ee87171,0x3f0172c3,0x3f0e39da,0x3f1a82a4,0x3f05c277,0x3f146eba,0x3f226799,0x3f2f9c32
.long 0x3f167918,0x3f26423a,0x3f3504f3,0x3f42a9f7,0x3f26423a,0x3f36c9a9,0x3f45e403,0x3f53731f
.long 0x3f3504f3,0x3f45e403,0x3f54db31,0x3f61c598,0x3f42a9f7,0x3f53731f,0x3f61c598,0x3f6d76aa
.long 0x3f4f1bbd,0x3f5f5be6,0x3f6c835e,0x3f766377,0x3f5a46a0,0x3f698690,0x3f74fa0b,0x3f7c7160
.long 0x3f641901,0x3f71decf,0x3f7b14be,0x3f7f8e56,0x3f6c835e,0x3f7853f8,0x3f7ec46d,0x3f7fb10f
.long 0x3f737871,0x3f7cd925,0x3f800000,0x3f7cd925,0x3f78ed3c,0x3f7f654e,0x3f7ec46d,0x3f770f11
.long 0x3f7cd925,0x3f7ff35e,0x3f7b14be,0x3f6e641a,0x3f7f35f9,0x3f7e8238,0x3f74fa0b,0x3f62f219
.long 0x3f800000,0x3f7b14be,0x3f6c835e,0x3f54db31,0x3f7f35f9,0x3f75b1c9,0x3f61c598,0x3f444969
.long 0x3f7cd925,0x3f6e641a,0x3f54db31,0x3f316e2c,0x3f78ed3c,0x3f653a48,0x3f45e403,0x3f1c81b9
.long 0x3f737871,0x3f5a46a0,0x3f3504f3,0x3f05c277,0x3f6c835e,0x3f4d9f02,0x3f226799,0x3edae880
.long 0x3f641901,0x3f3f5cb5,0x3f0e39da,0x3ea7bf25,0x3f5a46a0,0x3f2f9c32,0x3ef15aea,0x3e6542e9
.long 0x3f4f1bbd,0x3f1e7cf1,0x3ec3ef15,0x3df0b772,0x3f42a9f7,0x3f0c2124,0x3e94a031,0x3c20d8d2
.long 0x3f3504f3,0x3ef15aea,0x3e47c5c2,0xbdc8bd36,0x3f26423a,0x3ec8917e,0x3dc8bd36,0xbe519f65
.long 0x0,0x0,0x0,0x0,0x3df0b772,0x3e0255f4,0x3e0c4cf7,0x3e164083
.long 0x3e6f0c4d,0x3e814693,0x3e8afa3e,0x3e94a031,0x3eb13641,0x3ebf47d7,0x3ecd2ef3,0x3edae880
.long 0x3ee87171,0x3efa2c90,0x3f05c277,0x3f0e39da,0x3f0e39da,0x3f187fc0,0x3f226799,0x3f2beb4a
.long 0x3f26423a,0x3f316e2c,0x3f3bfc8f,0x3f45e403,0x3f3bfc8f,0x3f4779bc,0x3f5205d4,0x3f5b941a
.long 0x3f4f1bbd,0x3f5a46a0,0x3f641901,0x3f6c835e,0x3f5f5be6,0x3f698690,0x3f71decf,0x3f7853f8
.long 0x3f6c835e,0x3f74fa0b,0x3f7b14be,0x3f7ec46d,0x3f766377,0x3f7c7160,0x3f7f8e56,0x3f7fb10f
.long 0x3f7cd925,0x3f7fcd79,0x3f7f35f9,0x3f7b14be,0x3f7fcd79,0x3f7f0059,0x3f7a0d54,0x3f710908
.long 0x3f7f35f9,0x3f7a0d54,0x3f702d4f,0x3f61c598,0x3f7b14be,0x3f710908,0x3f61c598,0x3f4d9f02
.long 0x3f737871,0x3f641901,0x3f4f1bbd,0x3f3504f3,0x3f687c12,0x3f53731f,0x3f3889dc,0x3f187fc0
.long 0x3f5a46a0,0x3f3f5cb5,0x3f1e7cf1,0x3ef15aea,0x3f490a88,0x3f28296a,0x3f0172c3,0x3eac7cd4
.long 0x3f3504f3,0x3f0e39da,0x3ec3ef15,0x3e47c5c2,0x3f1e7cf1,0x3ee3f40d,0x3e814693,0x3d48fb30
.long 0x3f05c277,0x3ea7bf25,0x3df0b772,0xbdc8bd36,0x3ed65a92,0x3e519f65,0xbca0d6d6,0xbe78cfcc
.long 0x3e9e377a,0x3da0af2a,0xbe20305b,0xbec3ef15,0x3e47c5c2,0xbd48fb30,0xbe94a031,0xbf039c3d
.long 0x3da0af2a,0xbe3403f1,0xbed65a92,0xbf226799,0xbd20cee7,0xbe996dba,0xbf0a04f8,0xbf3daef9
.long 0xbe20305b,0xbed65a92,0xbf26423a,0xbf54db31,0xbe8afa3e,0xbf07e565,0xbf3f5cb5,0xbf676bd8
.long 0xbec3ef15,0xbf226799,0xbf54db31,0xbf74fa0b,0xbefa2c90,0xbf3a4582,0xbf6655e7,0xbf7d3aac
.long 0x3f800000,0x3f800000,0x3f800000,0x3f800000,0x3f7cd925,0x3f7c7160,0x3f7c0361,0x3f7b8f2a
.long 0x3f737871,0x3f71decf,0x3f702d4f,0x3f6e641a,0x3f641901,0x3f609384,0x3f5cdc29,0x3f58f3c4
.long 0x3f4f1bbd,0x3f490a88,0x3f42a9f7,0x3f3bfc8f,0x3f3504f3,0x3f2beb4a,0x3f226799,0x3f187fc0
.long 0x3f167918,0x3f0a04f8,0x3efa2c90,0x3edf7108,0x3ee87171,0x3ec8917e,0x3ea7bf25,0x3e862210
.long 0x3e9e377a,0x3e6f0c4d,0x3e20305b,0x3da0af2a,0x3e20305b,0x3d8ca1f2,0xbca0d6d6,0xbddcbd0d
.long 0x0,0xbdc8bd36,0xbe47c5c2,0xbe94a031,0xbe20305b,0xbe862210,0xbeba9be1,0xbeece91a
.long 0xbe9e377a,0xbed65a92,0xbf05c277,0xbf1e7cf1,0xbee87171,0xbf104f0e,0xbf2a0c73,0xbf4105b8
.long 0xbf167918,0xbf316e2c,0xbf490a88,0xbf5cdc29,0xbf3504f3,0xbf4d9f02,0xbf61c598,0xbf710908
.long 0xbf4f1bbd,0xbf641901,0xbf737871,0xbf7cd925,0xbf641901,0xbf743c41,0xbf7d95f4,0xbf7fe394
.long 0xbf737871,0xbf7d95f4,0xbf7fcd79,0xbf7a0d54,0xbf7cd925,0xbf7fe394,0xbf7a0d54,0xbf6b8a3d
.long 0xbf800000,0xbf7b14be,0xbf6c835e,0xbf54db31,0xbf7cd925,0xbf6f4ba8,0xbf579b8c,0xbf36c9a9
.long 0xbf737871,0xbf5cdc29,0xbf3bfc8f,0xbf1260b2,0xbf641901,0xbf444969,0xbf1a82a4,0xbed1c759
.long 0xbf4f1bbd,0xbf26423a,0xbee87171,0xbe6f0c4d,0xbf3504f3,0xbf039c3d,0xbe94a031,0xbd48fb30
.long 0xbf167918,0xbeba9be1,0xbdf0b772,0x3e0c4cf7,0xbee87171,0xbe519f65,0x3d712283,0x3ea2fd52
.long 0xbe9e377a,0xbd20cee7,0x3e6f0c4d,0x3efa2c90,0xbe20305b,0x3e0255f4,0x3ecd2ef3,0x3f2456f1
.long 0x0,0x3e94a031,0x3f0e39da,0x3f45e403,0x3e20305b,0x3ee3f40d,0x3f316e2c,0x3f609384
.long 0x3f800000,0x3f800000,0x3f800000,0x3f800000,0x3f7b14be,0x3f7a9421,0x3f7a0d54,0x3f79805c
.long 0x3f6c835e,0x3f6a8b4b,0x3f687c12,0x3f6655e7,0x3f54db31,0x3f50935b,0x3f4c1d35,0x3f4779bc
.long 0x3f3504f3,0x3f2dc5e3,0x3f26423a,0x3f1e7cf1,0x3f0e39da,0x3f039c3d,0x3ef15aea,0x3edae880
.long 0x3ec3ef15,0x3ea7bf25,0x3e8afa3e,0x3e5b73dc,0x3e47c5c2,0x3e0255f4,0x3d712283,0xbc20d8d2
.long 0x0,0xbda0af2a,0xbe20305b,0xbe6f0c4d,0xbe47c5c2,0xbe8fcefe,0xbeba9be1,0xbee3f40d
.long 0xbec3ef15,0xbef15aea,0xbf0e39da,0xbf226799,0xbf0e39da,0xbf2456f1,0xbf3889dc,0xbf4a965e
.long 0xbf3504f3,0xbf490a88,0xbf5a46a0,0xbf687c12,0xbf54db31,0xbf653a48,0xbf71decf,0xbf7a9421
.long 0xbf6c835e,0xbf77b493,0xbf7e39bc,0xbf7ff35e,0xbf7b14be,0xbf7fb10f,0xbf7ec46d,0xbf7853f8
.long 0xbf800000,0xbf7cd925,0xbf737871,0xbf641901,0xbf7b14be,0xbf6f4ba8,0xbf5cdc29,0xbf444969
.long 0xbf6c835e,0xbf579b8c,0xbf3bfc8f,0xbf1a82a4,0xbf54db31,0xbf36c9a9,0xbf1260b2,0xbed1c759
.long 0xbf3504f3,0xbf0e39da,0xbec3ef15,0xbe47c5c2,0xbf0e39da,0xbebf47d7,0xbe3403f1,0x3cf13d4c
.long 0xbec3ef15,0xbe3403f1,0x3d20cee7,0x3e814693,0xbe47c5c2,0x3cf13d4c,0x3e814693,0x3eece91a
.long 0x0,0x3e6f0c4d,0x3ee87171,0x3f26423a,0x3e47c5c2,0x3edae880,0x3f226799,0x3f4d9f02
.long 0x3ec3ef15,0x3f1a82a4,0x3f490a88,0x3f6a8b4b,0x3f0e39da,0x3f4105b8,0x3f6655e7,0x3f7b8f2a
.long 0x3f3504f3,0x3f5f5be6,0x3f78ed3c,0x3f7fcd79,0x3f54db31,0x3f743c41,0x3f7ff35e,0x3f770f11
.long 0x3f6c835e,0x3f7ec46d,0x3f7b14be,0x3f61c598,0x3f7b14be,0x3f7e8238,0x3f6a8b4b,0x3f4105b8
.long 0x0,0x0,0x0,0x0,0x3e20305b,0x3e2a1c3f,0x3e3403f1,0x3e3de731
.long 0x3e9e377a,0x3ea7bf25,0x3eb13641,0x3eba9be1,0x3ee87171,0x3ef5c6c5,0x3f0172c3,0x3f07e565
.long 0x3f167918,0x3f1e7cf1,0x3f26423a,0x3f2dc5e3,0x3f3504f3,0x3f3daef9,0x3f45e403,0x3f4d9f02
.long 0x3f4f1bbd,0x3f579b8c,0x3f5f5be6,0x3f6655e7,0x3f641901,0x3f6b8a3d,0x3f71decf,0x3f770f11
.long 0x3f737871,0x3f78ed3c,0x3f7cd925,0x3f7f35f9,0x3f7cd925,0x3f7f654e,0x3f7ff35e,0x3f7e8238
.long 0x3f800000,0x3f7ec46d,0x3f7b14be,0x3f74fa0b,0x3f7cd925,0x3f770f11,0x3f6e641a,0x3f62f219
.long 0x3f737871,0x3f687c12,0x3f5a46a0,0x3f490a88,0x3f641901,0x3f53731f,0x3f3f5cb5,0x3f28296a
.long 0x3f4f1bbd,0x3f3889dc,0x3f1e7cf1,0x3f0172c3,0x3f3504f3,0x3f187fc0,0x3ef15aea,0x3eac7cd4
.long 0x3f167918,0x3ee87171,0x3e9e377a,0x3e20305b,0x3ee87171,0x3e996dba,0x3e0c4cf7,0xbcf13d4c
.long 0x3e9e377a,0x3e0c4cf7,0xbd20cee7,0xbe5b73dc,0x3e20305b,0xbcf13d4c,0xbe5b73dc,0xbec8917e
.long 0x0,0xbe47c5c2,0xbec3ef15,0xbf0e39da,0xbe20305b,0xbeb5eb4f,0xbf0a04f8,0xbf333bc6
.long 0xbe9e377a,0xbf0172c3,0xbf2dc5e3,0xbf5205d4,0xbee87171,0xbf2456f1,0xbf4c1d35,0xbf698690
.long 0xbf167918,0xbf42a9f7,0xbf641901,0xbf78ed3c,0xbf3504f3,0xbf5b941a,0xbf74fa0b,0xbf7fb10f
.long 0xbf4f1bbd,0xbf6e641a,0xbf7e39bc,0xbf7d95f4,0xbf641901,0xbf7a9421,0xbf7f8e56,0xbf72ae9e
.long 0xbf737871,0xbf7fcd79,0xbf78ed3c,0xbf5f5be6,0xbf7cd925,0xbf7deafa,0xbf6a8b4b,0xbf444969
.long 0xbf800000,0xbf74fa0b,0xbf54db31,0xbf226799,0xbf7cd925,0xbf653a48,0xbf3889dc,0xbef5c6c5
.long 0x0,0x0,0x0,0x0,0x3e47c5c2,0x3e519f65,0x3e5b73dc,0x3e6542e9
.long 0x3ec3ef15,0x3ecd2ef3,0x3ed65a92,0x3edf7108,0x3f0e39da,0x3f146eba,0x3f1a82a4,0x3f207440
.long 0x3f3504f3,0x3f3bfc8f,0x3f42a9f7,0x3f490a88,0x3f54db31,0x3f5b941a,0x3f61c598,0x3f676bd8
.long 0x3f6c835e,0x3f71decf,0x3f766377,0x3f7a0d54,0x3f7b14be,0x3f7deafa,0x3f7f8e56,0x3f7ffcd7
.long 0x3f800000,0x3f7f35f9,0x3f7cd925,0x3f78ed3c,0x3f7b14be,0x3f75b1c9,0x3f6e641a,0x3f653a48
.long 0x3f6c835e,0x3f61c598,0x3f54db31,0x3f45e403,0x3f54db31,0x3f444969,0x3f316e2c,0x3f1c81b9
.long 0x3f3504f3,0x3f1e7cf1,0x3f05c277,0x3ed65a92,0x3f0e39da,0x3ee3f40d,0x3ea7bf25,0x3e519f65
.long 0x3ec3ef15,0x3e814693,0x3df0b772,0xbca0d6d6,0x3e47c5c2,0x3d48fb30,0xbdc8bd36,0xbe78cfcc
.long 0x0,0xbe20305b,0xbe9e377a,0xbee87171,0xbe47c5c2,0xbeb5eb4f,0xbf0172c3,0xbf2456f1
.long 0xbec3ef15,0xbf0a04f8,0xbf2dc5e3,0xbf4c1d35,0xbf0e39da,0xbf333bc6,0xbf5205d4,0xbf698690
.long 0xbf3504f3,0xbf54db31,0xbf6c835e,0xbf7b14be,0xbf54db31,0xbf6d76aa,0xbf7c0361,0xbf7fe394
.long 0xbf6c835e,0xbf7c0361,0xbf7fcd79,0xbf77b493,0xbf7b14be,0xbf7fe394,0xbf77b493,0xbf62f219
.long 0xbf800000,0xbf78ed3c,0xbf641901,0xbf42a9f7,0xbf7b14be,0xbf676bd8,0xbf45e403,0xbf187fc0
.long 0xbf6c835e,0xbf4c1d35,0xbf1e7cf1,0xbecd2ef3,0xbf54db31,0xbf28296a,0xbedf7108,0xbe3de731
.long 0xbf3504f3,0xbefa2c90,0xbe6f0c4d,0x3d20cee7,0xbf0e39da,0xbe996dba,0xbca0d6d6,0x3e862210
.long 0xbec3ef15,0xbdc8bd36,0x3e47c5c2,0x3ef15aea,0xbe47c5c2,0x3ddcbd0d,0x3ecd2ef3,0x3f28296a
.long 0x3f803f80,0x3f803f80,0x3f803f80,0x3f803f80,0x80008000,0x80008000,0x80008000,0x80008000
.long 0x3f733f80,0x3f163f4f,0xbf73bf4f,0xbf73bf80,0xbe9e8000,0xbf4fbf16,0xbe9ebf16,0x3e9e8000
.long 0x3f4f3f80,0xbe9e3e9e,0x3f4f3e9e,0x3f4f3f80,0xbf168000,0xbf73bf73,0x3f163f73,0xbf168000
.long 0x3f163f80,0xbf73be9e,0xbf163e9e,0xbf16bf80,0xbf4f8000,0xbe9ebf73,0xbf4fbf73,0x3f4f8000
.long 0x3e9e3f80,0xbf4fbf4f,0x3e9ebf4f,0x3e9e3f80,0xbf738000,0x3f16bf16,0x3f733f16,0xbf738000
.long 0x3f80,0xbf80,0x3f80,0xbf80,0xbf808000,0x3f808000,0xbf808000,0x3f808000
.long 0xbe9e3f80,0x3f4fbf4f,0xbe9ebf4f,0xbe9e3f80,0xbf738000,0x3f163f16,0x3f73bf16,0xbf738000
.long 0xbf163f80,0x3f73be9e,0x3f163e9e,0x3f16bf80,0xbf4f8000,0xbe9e3f73,0xbf4f3f73,0x3f4f8000
.long 0xbf4f3f80,0x3e9e3e9e,0xbf4f3e9e,0xbf4f3f80,0xbf168000,0xbf733f73,0x3f16bf73,0xbf168000
.long 0xbf733f80,0xbf163f4f,0x3f73bf4f,0x3f73bf80,0xbe9e8000,0xbf4f3f16,0xbe9e3f16,0x3e9e8000
.long 0xbf803f80,0xbf803f80,0xbf803f80,0xbf803f80,0x80008000,0x80008000,0x80008000,0x80008000
.long 0x0,0x0,0x0,0x0,0x0,0x0,0x0,0x0
.long 0x0,0x0,0x0,0x0,0x0,0x0,0x0,0x0
.long 0x0,0x0,0x0,0x0,0x0,0x0,0x0,0x0
.long 0x0,0x0,0x0,0x0,0x0,0x0,0x0,0x0
.long 0x0,0x0,0x0,0x0,0x0,0x0,0x0,0x0
.long 0x3f803f80,0x3f803f80,0x3f803f80,0x3f803f80,0x80008000,0x80008000,0x80008000,0x80008000
.long 0x3e9e,0xbf16be9e,0xbf16bf4f,0xbe9e,0xbf80bf73,0xbf4fbf73,0x3f4f3f16,0x3f803f73
.long 0xbf80bf4f,0xbe9ebf4f,0xbe9e3e9e,0xbf80bf4f,0x8000bf16,0x3f733f16,0xbf73bf73,0x8000bf16
.long 0xbf4f,0x3f733f4f,0x3f733e9e,0x3f4f,0x3f803f16,0xbe9e3f16,0x3e9e3f73,0xbf80bf16
.long 0x3f803e9e,0xbf4f3e9e,0xbf4fbf4f,0x3f803e9e,0x80003f73,0xbf16bf73,0x3f16bf16,0x80003f73
.long 0x3f80,0xbf80,0x3f80,0xbf80,0xbf808000,0x3f808000,0xbf808000,0x3f808000
.long 0xbf803e9e,0x3f4f3e9e,0x3f4fbf4f,0xbf803e9e,0x8000bf73,0xbf163f73,0x3f163f16,0x8000bf73
.long 0xbf4f,0xbf733f4f,0xbf733e9e,0x3f4f,0x3f80bf16,0xbe9ebf16,0x3e9ebf73,0xbf803f16
.long 0x3f80bf4f,0x3e9ebf4f,0x3e9e3e9e,0x3f80bf4f,0x80003f16,0x3f73bf16,0xbf733f73,0x80003f16
.long 0x3e9e,0x3f16be9e,0x3f16bf4f,0xbe9e,0xbf803f73,0xbf4f3f73,0x3f4fbf16,0x3f80bf73
.long 0xbf803f80,0xbf803f80,0xbf803f80,0xbf803f80,0x80008000,0x80008000,0x80008000,0x80008000
.long 0x0,0x0,0x0,0x0,0x0,0x0,0x0,0x0
.long 0x0,0x0,0x0,0x0,0x0,0x0,0x0,0x0
.long 0x0,0x0,0x0,0x0,0x0,0x0,0x0,0x0
.long 0x0,0x0,0x0,0x0,0x0,0x0,0x0,0x0
.long 0x0,0x0,0x0,0x0,0x0,0x0,0x0,0x0
.long 0x0,0x0,0x0,0x0,0x3f803f80,0x3f803f80,0x3f803f80,0x3f803f80
.long 0x3e9e0000,0x3f4f3f16,0x3e9e3f16,0xbe9e0000,0x3f733f80,0x3f163f4f,0xbf73bf4f,0xbf73bf80
.long 0x3f160000,0x3f733f73,0xbf16bf73,0x3f160000,0x3f4f3f80,0xbe9e3e9e,0x3f4f3e9e,0x3f4f3f80
.long 0x3f4f0000,0x3e9e3f73,0x3f4f3f73,0xbf4f0000,0x3f163f80,0xbf73be9e,0xbf163e9e,0xbf16bf80
.long 0x3f730000,0xbf163f16,0xbf73bf16,0x3f730000,0x3e9e3f80,0xbf4fbf4f,0x3e9ebf4f,0x3e9e3f80
.long 0x3f800000,0xbf800000,0x3f800000,0xbf800000,0x3f80,0xbf80,0x3f80,0xbf80
.long 0x3f730000,0xbf16bf16,0xbf733f16,0x3f730000,0xbe9e3f80,0x3f4fbf4f,0xbe9ebf4f,0xbe9e3f80
.long 0x3f4f0000,0x3e9ebf73,0x3f4fbf73,0xbf4f0000,0xbf163f80,0x3f73be9e,0x3f163e9e,0x3f16bf80
.long 0x3f160000,0x3f73bf73,0xbf163f73,0x3f160000,0xbf4f3f80,0x3e9e3e9e,0xbf4f3e9e,0xbf4f3f80
.long 0x3e9e0000,0x3f4fbf16,0x3e9ebf16,0xbe9e0000,0xbf733f80,0xbf163f4f,0x3f73bf4f,0x3f73bf80
.long 0x0,0x0,0x0,0x0,0xbf803f80,0xbf803f80,0xbf803f80,0xbf803f80
.long 0x0,0x0,0x0,0x0,0x0,0x0,0x0,0x0
.long 0x0,0x0,0x0,0x0,0x0,0x0,0x0,0x0
.long 0x0,0x0,0x0,0x0,0x0,0x0,0x0,0x0
.long 0x0,0x0,0x0,0x0,0x0,0x0,0x0,0x0
.long 0x0,0x0,0x0,0x0,0x0,0x0,0x0,0x0
.long 0x0,0x0,0x0,0x0,0x3f803f80,0x3f803f80,0x3f803f80,0x3f803f80
.long 0x3f803f73,0x3f4f3f73,0xbf4fbf16,0xbf80bf73,0x3e9e,0xbf16be9e,0xbf16bf4f,0xbe9e
.long 0x3f16,0xbf73bf16,0x3f733f73,0x3f16,0xbf80bf4f,0xbe9ebf4f,0xbe9e3e9e,0xbf80bf4f
.long 0xbf80bf16,0x3e9ebf16,0xbe9ebf73,0x3f803f16,0xbf4f,0x3f733f4f,0x3f733e9e,0x3f4f
.long 0xbf73,0x3f163f73,0xbf163f16,0xbf73,0x3f803e9e,0xbf4f3e9e,0xbf4fbf4f,0x3f803e9e
.long 0x3f800000,0xbf800000,0x3f800000,0xbf800000,0x3f80,0xbf80,0x3f80,0xbf80
.long 0x3f73,0x3f16bf73,0xbf16bf16,0x3f73,0xbf803e9e,0x3f4f3e9e,0x3f4fbf4f,0xbf803e9e
.long 0xbf803f16,0x3e9e3f16,0xbe9e3f73,0x3f80bf16,0xbf4f,0xbf733f4f,0xbf733e9e,0x3f4f
.long 0xbf16,0xbf733f16,0x3f73bf73,0xbf16,0x3f80bf4f,0x3e9ebf4f,0x3e9e3e9e,0x3f80bf4f
.long 0x3f80bf73,0x3f4fbf73,0xbf4f3f16,0xbf803f73,0x3e9e,0x3f16be9e,0x3f16bf4f,0xbe9e
.long 0x0,0x0,0x0,0x0,0xbf803f80,0xbf803f80,0xbf803f80,0xbf803f80
.long 0x0,0x0,0x0,0x0,0x0,0x0,0x0,0x0
.long 0x0,0x0,0x0,0x0,0x0,0x0,0x0,0x0
.long 0x0,0x0,0x0,0x0,0x0,0x0,0x0,0x0
.long 0x0,0x0,0x0,0x0,0x0,0x0,0x0,0x0
.long 0x0,0x0,0x0,0x0,0x0,0x0,0x0,0x0
.long 0x3f803f80,0x3f803f80,0x0,0x0,0x80008000,0x80008000,0x3f803f80,0x3f803f80
.long 0x3f163e9e,0x3f733f4f,0xbf4fbf73,0xbe9ebf16,0x3f4f3f73,0x3e9e3f16,0x3f163e9e,0x3f733f4f
.long 0xbe9ebf4f,0x3f4f3e9e,0xbf73bf16,0xbf16bf73,0x3f733f16,0x3f163f73,0xbe9ebf4f,0x3f4f3e9e
.long 0xbf73bf4f,0x3f16be9e,0xbe9e3f16,0xbf4fbf73,0x3e9ebf16,0x3f4f3f73,0xbf73bf4f,0x3f16be9e
.long 0xbf4f3e9e,0x3e9ebf4f,0x3f163f73,0xbf73bf16,0xbf16bf73,0x3f733f16,0xbf4f3e9e,0x3e9ebf4f
.long 0x3f80,0xbf80,0x3f800000,0xbf800000,0xbf808000,0x3f808000,0x3f80,0xbf80
.long 0x3f4f3e9e,0xbe9ebf4f,0x3f16bf73,0xbf733f16,0xbf163f73,0x3f73bf16,0x3f4f3e9e,0xbe9ebf4f
.long 0x3f73bf4f,0xbf16be9e,0xbe9ebf16,0xbf4f3f73,0x3e9e3f16,0x3f4fbf73,0x3f73bf4f,0xbf16be9e
.long 0x3e9ebf4f,0xbf4f3e9e,0xbf733f16,0xbf163f73,0x3f73bf16,0x3f16bf73,0x3e9ebf4f,0xbf4f3e9e
.long 0xbf163e9e,0xbf733f4f,0xbf4f3f73,0xbe9e3f16,0x3f4fbf73,0x3e9ebf16,0xbf163e9e,0xbf733f4f
.long 0xbf803f80,0xbf803f80,0x0,0x0,0x80008000,0x80008000,0xbf803f80,0xbf803f80
.long 0x0,0x0,0x0,0x0,0x0,0x0,0x0,0x0
.long 0x0,0x0,0x0,0x0,0x0,0x0,0x0,0x0
.long 0x0,0x0,0x0,0x0,0x0,0x0,0x0,0x0
.long 0x0,0x0,0x0,0x0,0x0,0x0,0x0,0x0
.long 0x0,0x0,0x0,0x0,0x0,0x0,0x0,0x0
.long 0x0,0x0,0x0,0x0,0x0,0x0,0x0,0x0
.long 0x0,0x0,0x0,0x0,0x0,0x0,0x0,0x0
.long 0x0,0x0,0x0,0x0,0x0,0x0,0x0,0x0
.long 0x0,0x0,0x0,0x0,0x0,0x0,0x0,0x0
.long 0x0,0x0,0x0,0x0,0x0,0x0,0x0,0x0
.long 0x0,0x0,0x0,0x0,0x0,0x0,0x0,0x0
.long 0x0,0x0,0x0,0x0,0x0,0x0,0x0,0x0
.long 0x0,0x0,0x0,0x0,0x0,0x0,0x0,0x0
.long 0x0,0x0,0x0,0x0,0x0,0x0,0x0,0x0
.long 0x0,0x0,0x0,0x0,0x0,0x0,0x0,0x0
.long 0x0,0x0,0x0,0x0,0x0,0x0,0x0,0x0
.long 0x0,0x0,0x0,0x0,0x0,0x0,0x0,0x0
.long 0x0,0x0,0x0,0x0,0x0,0x0,0x0,0x0
.long 0x0,0x0,0x0,0x0,0x0,0x0,0x0,0x0
.long 0x0,0x0,0x0,0x0,0x0,0x0,0x0,0x0
.long 0x0,0x0,0x0,0x0,0x0,0x0,0x0,0x0
.long 0x3f803f80,0x3f803f80,0x3f803f80,0x3f803f80,0x3f7f3f80,0x3f753f7b,0x3f223f35,0x3ef13f0e
.long 0x3f7b3f80,0x3f553f6d,0xbe480000,0xbf0ebec4,0x3f753f80,0x3f223f55,0xbf62bf35,0xbf7fbf7b
.long 0x3f6d3f80,0x3ec43f35,0xbf6dbf80,0xbec4bf35,0x3f623f80,0x3dc93f0e,0xbe95bf35,0x3f223e48
.long 0x3f553f80,0xbe483ec4,0x3f0e0000,0x3f7b3f6d,0x3f463f80,0xbef13e48,0x3f7f3f35,0x3e953f55
.long 0x3f353f80,0xbf350000,0x3f353f80,0xbf350000,0x3f223f80,0xbf62be48,0xbdc93f35,0xbf75bf55
.long 0x3f0e3f80,0xbf7bbec4,0xbf550000,0xbe48bf6d,0x3ef13f80,0xbf7fbf0e,0xbf75bf35,0x3f46be48
.long 0x3ec43f80,0xbf6dbf35,0xbec4bf80,0x3f6d3f35,0x3e953f80,0xbf46bf55,0x3ef1bf35,0x3dc93f7b
.long 0x3e483f80,0xbf0ebf6d,0x3f7b0000,0xbf553ec4,0x3dc93f80,0xbe95bf7b,0x3f463f35,0xbf62bf0e
.long 0x3f80,0xbf80,0x3f80,0xbf80,0xbdc93f80,0x3e95bf7b,0xbf463f35,0x3f62bf0e
.long 0xbe483f80,0x3f0ebf6d,0xbf7b0000,0x3f553ec4,0xbe953f80,0x3f46bf55,0xbef1bf35,0xbdc93f7b
.long 0xbec43f80,0x3f6dbf35,0x3ec4bf80,0xbf6d3f35,0xbef13f80,0x3f7fbf0e,0x3f75bf35,0xbf46be48
.long 0xbf0e3f80,0x3f7bbec4,0x3f550000,0x3e48bf6d,0xbf223f80,0x3f62be48,0x3dc93f35,0x3f75bf55
.long 0xbf353f80,0x3f350000,0xbf353f80,0x3f350000,0xbf463f80,0x3ef13e48,0xbf7f3f35,0xbe953f55
.long 0xbf553f80,0x3e483ec4,0xbf0e0000,0xbf7b3f6d,0xbf623f80,0xbdc93f0e,0x3e95bf35,0xbf223e48
.long 0xbf6d3f80,0xbec43f35,0x3f6dbf80,0x3ec4bf35,0xbf753f80,0xbf223f55,0x3f62bf35,0x3f7fbf7b
.long 0xbf7b3f80,0xbf553f6d,0x3e480000,0x3f0ebec4,0xbf7f3f80,0xbf753f7b,0xbf223f35,0xbef13f0e
.long 0x3f803f80,0x3f803f80,0x3f803f80,0x3f803f80,0x3f623f6d,0x3f463f55,0x3e953ec4,0x3dc93e48
.long 0x3f0e3f35,0x3e483ec4,0xbf55bf35,0xbf7bbf6d,0x3dc93ec4,0xbef1be48,0xbf46bf6d,0xbe95bf0e
.long 0xbec40000,0xbf6dbf35,0x3ec40000,0x3f6d3f35,0xbf46bec4,0xbf75bf7b,0x3f7f3f6d,0x3ef13f55
.long 0xbf7bbf35,0xbf0ebf6d,0x3e483f35,0xbf55bec4,0xbf75bf6d,0x3dc9bf0e,0xbf62bec4,0xbf22bf7b
.long 0xbf35bf80,0x3f350000,0xbf35bf80,0x3f350000,0xbe95bf6d,0x3f7f3f0e,0x3ef1bec4,0x3f463f7b
.long 0x3e48bf35,0x3f553f6d,0x3f7b3f35,0xbf0e3ec4,0x3f22bec4,0x3e953f7b,0x3dc93f6d,0xbf62bf55
.long 0x3f6d0000,0xbec43f35,0xbf6d0000,0x3ec4bf35,0x3f7f3ec4,0xbf623e48,0xbf22bf6d,0x3f753f0e
.long 0x3f553f35,0xbf7bbec4,0x3f0ebf35,0xbe483f6d,0x3ef13f6d,0xbf22bf55,0x3f753ec4,0xbf7fbe48
.long 0x3f80,0xbf80,0x3f80,0xbf80,0xbef13f6d,0x3f22bf55,0xbf753ec4,0x3f7fbe48
.long 0xbf553f35,0x3f7bbec4,0xbf0ebf35,0x3e483f6d,0xbf7f3ec4,0x3f623e48,0x3f22bf6d,0xbf753f0e
.long 0xbf6d0000,0x3ec43f35,0x3f6d0000,0xbec4bf35,0xbf22bec4,0xbe953f7b,0xbdc93f6d,0x3f62bf55
.long 0xbe48bf35,0xbf553f6d,0xbf7b3f35,0x3f0e3ec4,0x3e95bf6d,0xbf7f3f0e,0xbef1bec4,0xbf463f7b
.long 0x3f35bf80,0xbf350000,0x3f35bf80,0xbf350000,0x3f75bf6d,0xbdc9bf0e,0x3f62bec4,0x3f22bf7b
.long 0x3f7bbf35,0x3f0ebf6d,0xbe483f35,0x3f55bec4,0x3f46bec4,0x3f75bf7b,0xbf7f3f6d,0xbef13f55
.long 0x3ec40000,0x3f6dbf35,0xbec40000,0xbf6d3f35,0xbdc93ec4,0x3ef1be48,0x3f46bf6d,0x3e95bf0e
.long 0xbf0e3f35,0xbe483ec4,0x3f55bf35,0x3f7bbf6d,0xbf623f6d,0xbf463f55,0xbe953ec4,0xbdc93e48
.long 0x0,0x0,0x0,0x0,0x3dc90000,0x3e953e48,0x3f463f35,0x3f623f55
.long 0x3e480000,0x3f0e3ec4,0x3f7b3f80,0x3f553f6d,0x3e950000,0x3f463f0e,0x3ef13f35,0xbdc93e48
.long 0x3ec40000,0x3f6d3f35,0xbec40000,0xbf6dbf35,0x3ef10000,0x3f7f3f55,0xbf75bf35,0xbf46bf7b
.long 0x3f0e0000,0x3f7b3f6d,0xbf55bf80,0x3e48bec4,0x3f220000,0x3f623f7b,0xbdc9bf35,0x3f753f0e
.long 0x3f350000,0x3f353f80,0x3f350000,0x3f353f80,0x3f460000,0x3ef13f7b,0x3f7f3f35,0xbe953f0e
.long 0x3f550000,0x3e483f6d,0x3f0e3f80,0xbf7bbec4,0x3f620000,0xbdc93f55,0xbe953f35,0xbf22bf7b
.long 0x3f6d0000,0xbec43f35,0xbf6d0000,0x3ec4bf35,0x3f750000,0xbf223f0e,0xbf62bf35,0x3f7f3e48
.long 0x3f7b0000,0xbf553ec4,0xbe48bf80,0x3f0e3f6d,0x3f7f0000,0xbf753e48,0x3f22bf35,0xbef13f55
.long 0x3f800000,0xbf800000,0x3f800000,0xbf800000,0x3f7f0000,0xbf75be48,0x3f223f35,0xbef1bf55
.long 0x3f7b0000,0xbf55bec4,0xbe483f80,0x3f0ebf6d,0x3f750000,0xbf22bf0e,0xbf623f35,0x3f7fbe48
.long 0x3f6d0000,0xbec4bf35,0xbf6d0000,0x3ec43f35,0x3f620000,0xbdc9bf55,0xbe95bf35,0xbf223f7b
.long 0x3f550000,0x3e48bf6d,0x3f0ebf80,0xbf7b3ec4,0x3f460000,0x3ef1bf7b,0x3f7fbf35,0xbe95bf0e
.long 0x3f350000,0x3f35bf80,0x3f350000,0x3f35bf80,0x3f220000,0x3f62bf7b,0xbdc93f35,0x3f75bf0e
.long 0x3f0e0000,0x3f7bbf6d,0xbf553f80,0x3e483ec4,0x3ef10000,0x3f7fbf55,0xbf753f35,0xbf463f7b
.long 0x3ec40000,0x3f6dbf35,0xbec40000,0xbf6d3f35,0x3e950000,0x3f46bf0e,0x3ef1bf35,0xbdc9be48
.long 0x3e480000,0x3f0ebec4,0x3f7bbf80,0x3f55bf6d,0x3dc90000,0x3e95be48,0x3f46bf35,0x3f62bf55
.long 0x0,0x0,0x0,0x0,0x3ef13ec4,0x3f223f0e,0x3f753f6d,0x3f7f3f7b
.long 0x3f553f35,0x3f7b3f6d,0x3f0e3f35,0x3e483ec4,0x3f7f3f6d,0x3f623f7b,0xbf22bec4,0xbf75bf55
.long 0x3f6d3f80,0x3ec43f35,0xbf6dbf80,0xbec4bf35,0x3f223f6d,0xbe953e48,0x3dc9bec4,0x3f623f0e
.long 0x3e483f35,0xbf55bec4,0x3f7b3f35,0x3f0e3f6d,0xbe953ec4,0xbf7fbf55,0x3ef13f6d,0xbf46be48
.long 0xbf350000,0xbf35bf80,0xbf350000,0xbf35bf80,0xbf75bec4,0xbdc9bf55,0xbf62bf6d,0x3f22be48
.long 0xbf7bbf35,0x3f0ebec4,0x3e48bf35,0x3f553f6d,0xbf46bf6d,0x3f753e48,0x3f7f3ec4,0xbef13f0e
.long 0xbec4bf80,0x3f6d3f35,0x3ec43f80,0xbf6dbf35,0x3dc9bf6d,0x3ef13f7b,0xbf463ec4,0x3e95bf55
.long 0x3f0ebf35,0xbe483f6d,0xbf55bf35,0x3f7b3ec4,0x3f62bec4,0xbf463f0e,0x3e95bf6d,0xbdc93f7b
.long 0x3f800000,0xbf800000,0x3f800000,0xbf800000,0x3f623ec4,0xbf46bf0e,0x3e953f6d,0xbdc9bf7b
.long 0x3f0e3f35,0xbe48bf6d,0xbf553f35,0x3f7bbec4,0x3dc93f6d,0x3ef1bf7b,0xbf46bec4,0x3e953f55
.long 0xbec43f80,0x3f6dbf35,0x3ec4bf80,0xbf6d3f35,0xbf463f6d,0x3f75be48,0x3f7fbec4,0xbef1bf0e
.long 0xbf7b3f35,0x3f0e3ec4,0x3e483f35,0x3f55bf6d,0xbf753ec4,0xbdc93f55,0xbf623f6d,0x3f223e48
.long 0xbf350000,0xbf353f80,0xbf350000,0xbf353f80,0xbe95bec4,0xbf7f3f55,0x3ef1bf6d,0xbf463e48
.long 0x3e48bf35,0xbf553ec4,0x3f7bbf35,0x3f0ebf6d,0x3f22bf6d,0xbe95be48,0x3dc93ec4,0x3f62bf0e
.long 0x3f6dbf80,0x3ec4bf35,0xbf6d3f80,0xbec43f35,0x3f7fbf6d,0x3f62bf7b,0xbf223ec4,0xbf753f55
.long 0x3f55bf35,0x3f7bbf6d,0x3f0ebf35,0x3e48bec4,0x3ef1bec4,0x3f22bf0e,0x3f75bf6d,0x3f7fbf7b
.long 0x80008000,0x80008000,0x80008000,0x80008000,0xbdc98000,0xbe95be48,0xbf46bf35,0xbf62bf55
.long 0xbe488000,0xbf0ebec4,0xbf7bbf80,0xbf55bf6d,0xbe958000,0xbf46bf0e,0xbef1bf35,0x3dc9be48
.long 0xbec48000,0xbf6dbf35,0x3ec48000,0x3f6d3f35,0xbef18000,0xbf7fbf55,0x3f753f35,0x3f463f7b
.long 0xbf0e8000,0xbf7bbf6d,0x3f553f80,0xbe483ec4,0xbf228000,0xbf62bf7b,0x3dc93f35,0xbf75bf0e
.long 0xbf358000,0xbf35bf80,0xbf358000,0xbf35bf80,0xbf468000,0xbef1bf7b,0xbf7fbf35,0x3e95bf0e
.long 0xbf558000,0xbe48bf6d,0xbf0ebf80,0x3f7b3ec4,0xbf628000,0x3dc9bf55,0x3e95bf35,0x3f223f7b
.long 0xbf6d8000,0x3ec4bf35,0x3f6d8000,0xbec43f35,0xbf758000,0x3f22bf0e,0x3f623f35,0xbf7fbe48
.long 0xbf7b8000,0x3f55bec4,0x3e483f80,0xbf0ebf6d,0xbf7f8000,0x3f75be48,0xbf223f35,0x3ef1bf55
.long 0xbf808000,0x3f808000,0xbf808000,0x3f808000,0xbf7f8000,0x3f753e48,0xbf22bf35,0x3ef13f55
.long 0xbf7b8000,0x3f553ec4,0x3e48bf80,0xbf0e3f6d,0xbf758000,0x3f223f0e,0x3f62bf35,0xbf7f3e48
.long 0xbf6d8000,0x3ec43f35,0x3f6d8000,0xbec4bf35,0xbf628000,0x3dc93f55,0x3e953f35,0x3f22bf7b
.long 0xbf558000,0xbe483f6d,0xbf0e3f80,0x3f7bbec4,0xbf468000,0xbef13f7b,0xbf7f3f35,0x3e953f0e
.long 0xbf358000,0xbf353f80,0xbf358000,0xbf353f80,0xbf228000,0xbf623f7b,0x3dc9bf35,0xbf753f0e
.long 0xbf0e8000,0xbf7b3f6d,0x3f55bf80,0xbe48bec4,0xbef18000,0xbf7f3f55,0x3f75bf35,0x3f46bf7b
.long 0xbec48000,0xbf6d3f35,0x3ec48000,0x3f6dbf35,0xbe958000,0xbf463f0e,0xbef13f35,0x3dc93e48
.long 0xbe488000,0xbf0e3ec4,0xbf7b3f80,0xbf553f6d,0xbdc98000,0xbe953e48,0xbf463f35,0xbf623f55
.long 0x80008000,0x80008000,0x80008000,0x80008000,0xbef1bec4,0xbf22bf0e,0xbf75bf6d,0xbf7fbf7b
.long 0xbf55bf35,0xbf7bbf6d,0xbf0ebf35,0xbe48bec4,0xbf7fbf6d,0xbf62bf7b,0x3f223ec4,0x3f753f55
.long 0xbf6dbf80,0xbec4bf35,0x3f6d3f80,0x3ec43f35,0xbf22bf6d,0x3e95be48,0xbdc93ec4,0xbf62bf0e
.long 0xbe48bf35,0x3f553ec4,0xbf7bbf35,0xbf0ebf6d,0x3e95bec4,0x3f7f3f55,0xbef1bf6d,0x3f463e48
.long 0x3f358000,0x3f353f80,0x3f358000,0x3f353f80,0x3f753ec4,0x3dc93f55,0x3f623f6d,0xbf223e48
.long 0x3f7b3f35,0xbf0e3ec4,0xbe483f35,0xbf55bf6d,0x3f463f6d,0xbf75be48,0xbf7fbec4,0x3ef1bf0e
.long 0x3ec43f80,0xbf6dbf35,0xbec4bf80,0x3f6d3f35,0xbdc93f6d,0xbef1bf7b,0x3f46bec4,0xbe953f55
.long 0xbf0e3f35,0x3e48bf6d,0x3f553f35,0xbf7bbec4,0xbf623ec4,0x3f46bf0e,0xbe953f6d,0x3dc9bf7b
.long 0xbf808000,0x3f808000,0xbf808000,0x3f808000,0xbf62bec4,0x3f463f0e,0xbe95bf6d,0x3dc93f7b
.long 0xbf0ebf35,0x3e483f6d,0x3f55bf35,0xbf7b3ec4,0xbdc9bf6d,0xbef13f7b,0x3f463ec4,0xbe95bf55
.long 0x3ec4bf80,0xbf6d3f35,0xbec43f80,0x3f6dbf35,0x3f46bf6d,0xbf753e48,0xbf7f3ec4,0x3ef13f0e
.long 0x3f7bbf35,0xbf0ebec4,0xbe48bf35,0xbf553f6d,0x3f75bec4,0x3dc9bf55,0x3f62bf6d,0xbf22be48
.long 0x3f358000,0x3f35bf80,0x3f358000,0x3f35bf80,0x3e953ec4,0x3f7fbf55,0xbef13f6d,0x3f46be48
.long 0xbe483f35,0x3f55bec4,0xbf7b3f35,0xbf0e3f6d,0xbf223f6d,0x3e953e48,0xbdc9bec4,0xbf623f0e
.long 0xbf6d3f80,0xbec43f35,0x3f6dbf80,0x3ec4bf35,0xbf7f3f6d,0xbf623f7b,0x3f22bec4,0x3f75bf55
.long 0xbf553f35,0xbf7b3f6d,0xbf0e3f35,0xbe483ec4,0xbef13ec4,0xbf223f0e,0xbf753f6d,0xbf7f3f7b
.long 0x3f803f80,0x3f803f80,0x3f803f80,0x3f803f80,0xbdc90000,0xbe95be48,0xbf46bf35,0xbf62bf55
.long 0xbf7bbf80,0xbf55bf6d,0x3e480000,0x3f0e3ec4,0x3e950000,0x3f463f0e,0x3ef13f35,0xbdc93e48
.long 0x3f6d3f80,0x3ec43f35,0xbf6dbf80,0xbec4bf35,0xbef10000,0xbf7fbf55,0x3f753f35,0x3f463f7b
.long 0xbf55bf80,0x3e48bec4,0xbf0e0000,0xbf7bbf6d,0x3f220000,0x3f623f7b,0xbdc9bf35,0x3f753f0e
.long 0x3f353f80,0xbf350000,0x3f353f80,0xbf350000,0xbf460000,0xbef1bf7b,0xbf7fbf35,0x3e95bf0e
.long 0xbf0ebf80,0x3f7b3ec4,0x3f550000,0x3e483f6d,0x3f620000,0xbdc93f55,0xbe953f35,0xbf22bf7b
.long 0x3ec43f80,0xbf6dbf35,0xbec4bf80,0x3f6d3f35,0xbf750000,0x3f22bf0e,0x3f623f35,0xbf7fbe48
.long 0xbe48bf80,0x3f0e3f6d,0xbf7b0000,0x3f55bec4,0x3f7f0000,0xbf753e48,0x3f22bf35,0xbef13f55
.long 0x3f80,0xbf80,0x3f80,0xbf80,0xbf7f0000,0x3f753e48,0xbf22bf35,0x3ef13f55
.long 0x3e48bf80,0xbf0e3f6d,0x3f7b0000,0xbf55bec4,0x3f750000,0xbf22bf0e,0xbf623f35,0x3f7fbe48
.long 0xbec43f80,0x3f6dbf35,0x3ec4bf80,0xbf6d3f35,0xbf620000,0x3dc93f55,0x3e953f35,0x3f22bf7b
.long 0x3f0ebf80,0xbf7b3ec4,0xbf550000,0xbe483f6d,0x3f460000,0x3ef1bf7b,0x3f7fbf35,0xbe95bf0e
.long 0xbf353f80,0x3f350000,0xbf353f80,0x3f350000,0xbf220000,0xbf623f7b,0x3dc9bf35,0xbf753f0e
.long 0x3f55bf80,0xbe48bec4,0x3f0e0000,0x3f7bbf6d,0x3ef10000,0x3f7fbf55,0xbf753f35,0xbf463f7b
.long 0xbf6d3f80,0xbec43f35,0x3f6dbf80,0x3ec4bf35,0xbe950000,0xbf463f0e,0xbef13f35,0x3dc93e48
.long 0x3f7bbf80,0x3f55bf6d,0xbe480000,0xbf0e3ec4,0x3dc90000,0x3e95be48,0x3f46bf35,0x3f62bf55
.long 0x3f803f80,0x3f803f80,0x3f803f80,0x3f803f80,0xbef1bec4,0xbf22bf0e,0xbf75bf6d,0xbf7fbf7b
.long 0xbf0ebf35,0xbe48bec4,0x3f553f35,0x3f7b3f6d,0x3f7f3f6d,0x3f623f7b,0xbf22bec4,0xbf75bf55
.long 0xbec40000,0xbf6dbf35,0x3ec40000,0x3f6d3f35,0xbf22bf6d,0x3e95be48,0xbdc93ec4,0xbf62bf0e
.long 0x3f7b3f35,0x3f0e3f6d,0xbe48bf35,0x3f553ec4,0xbe953ec4,0xbf7fbf55,0x3ef13f6d,0xbf46be48
.long 0xbf35bf80,0x3f350000,0xbf35bf80,0x3f350000,0x3f753ec4,0x3dc93f55,0x3f623f6d,0xbf223e48
.long 0xbe483f35,0xbf55bf6d,0xbf7bbf35,0x3f0ebec4,0xbf46bf6d,0x3f753e48,0x3f7f3ec4,0xbef13f0e
.long 0x3f6d0000,0xbec43f35,0xbf6d0000,0x3ec4bf35,0xbdc93f6d,0xbef1bf7b,0x3f46bec4,0xbe953f55
.long 0xbf55bf35,0x3f7b3ec4,0xbf0e3f35,0x3e48bf6d,0x3f62bec4,0xbf463f0e,0x3e95bf6d,0xbdc93f7b
.long 0x3f80,0xbf80,0x3f80,0xbf80,0xbf62bec4,0x3f463f0e,0xbe95bf6d,0x3dc93f7b
.long 0x3f55bf35,0xbf7b3ec4,0x3f0e3f35,0xbe48bf6d,0x3dc93f6d,0x3ef1bf7b,0xbf46bec4,0x3e953f55
.long 0xbf6d0000,0x3ec43f35,0x3f6d0000,0xbec4bf35,0x3f46bf6d,0xbf753e48,0xbf7f3ec4,0x3ef13f0e
.long 0x3e483f35,0x3f55bf6d,0x3f7bbf35,0xbf0ebec4,0xbf753ec4,0xbdc93f55,0xbf623f6d,0x3f223e48
.long 0x3f35bf80,0xbf350000,0x3f35bf80,0xbf350000,0x3e953ec4,0x3f7fbf55,0xbef13f6d,0x3f46be48
.long 0xbf7b3f35,0xbf0e3f6d,0x3e48bf35,0xbf553ec4,0x3f22bf6d,0xbe95be48,0x3dc93ec4,0x3f62bf0e
.long 0x3ec40000,0x3f6dbf35,0xbec40000,0xbf6d3f35,0xbf7f3f6d,0xbf623f7b,0x3f22bec4,0x3f75bf55
.long 0x3f0ebf35,0x3e48bec4,0xbf553f35,0xbf7b3f6d,0x3ef1bec4,0x3f22bf0e,0x3f75bf6d,0x3f7fbf7b
.long 0x0,0x0,0x0,0x0,0x3f7f3f80,0x3f753f7b,0x3f223f35,0x3ef13f0e
.long 0xbe480000,0xbf0ebec4,0xbf7bbf80,0xbf55bf6d,0xbf75bf80,0xbf22bf55,0x3f623f35,0x3f7f3f7b
.long 0x3ec40000,0x3f6d3f35,0xbec40000,0xbf6dbf35,0x3f623f80,0x3dc93f0e,0xbe95bf35,0x3f223e48
.long 0xbf0e0000,0xbf7bbf6d,0x3f553f80,0xbe483ec4,0xbf46bf80,0x3ef1be48,0xbf7fbf35,0xbe95bf55
.long 0x3f350000,0x3f353f80,0x3f350000,0x3f353f80,0x3f223f80,0xbf62be48,0xbdc93f35,0xbf75bf55
.long 0xbf550000,0xbe48bf6d,0xbf0ebf80,0x3f7b3ec4,0xbef1bf80,0x3f7f3f0e,0x3f753f35,0xbf463e48
.long 0x3f6d0000,0xbec43f35,0xbf6d0000,0x3ec4bf35,0x3e953f80,0xbf46bf55,0x3ef1bf35,0x3dc93f7b
.long 0xbf7b0000,0x3f55bec4,0x3e483f80,0xbf0ebf6d,0xbdc9bf80,0x3e953f7b,0xbf46bf35,0x3f623f0e
.long 0x3f800000,0xbf800000,0x3f800000,0xbf800000,0xbdc93f80,0x3e95bf7b,0xbf463f35,0x3f62bf0e
.long 0xbf7b0000,0x3f553ec4,0x3e48bf80,0xbf0e3f6d,0x3e95bf80,0xbf463f55,0x3ef13f35,0x3dc9bf7b
.long 0x3f6d0000,0xbec4bf35,0xbf6d0000,0x3ec43f35,0xbef13f80,0x3f7fbf0e,0x3f75bf35,0xbf46be48
.long 0xbf550000,0xbe483f6d,0xbf0e3f80,0x3f7bbec4,0x3f22bf80,0xbf623e48,0xbdc9bf35,0xbf753f55
.long 0x3f350000,0x3f35bf80,0x3f350000,0x3f35bf80,0xbf463f80,0x3ef13e48,0xbf7f3f35,0xbe953f55
.long 0xbf0e0000,0xbf7b3f6d,0x3f55bf80,0xbe48bec4,0x3f62bf80,0x3dc9bf0e,0xbe953f35,0x3f22be48
.long 0x3ec40000,0x3f6dbf35,0xbec40000,0xbf6d3f35,0xbf753f80,0xbf223f55,0x3f62bf35,0x3f7fbf7b
.long 0xbe480000,0xbf0e3ec4,0xbf7b3f80,0xbf553f6d,0x3f7fbf80,0x3f75bf7b,0x3f22bf35,0x3ef1bf0e
.long 0x0,0x0,0x0,0x0,0x3f623f6d,0x3f463f55,0x3e953ec4,0x3dc93e48
.long 0xbf55bf35,0xbf7bbf6d,0xbf0ebf35,0xbe48bec4,0xbdc9bec4,0x3ef13e48,0x3f463f6d,0x3e953f0e
.long 0x3f6d3f80,0x3ec43f35,0xbf6dbf80,0xbec4bf35,0xbf46bec4,0xbf75bf7b,0x3f7f3f6d,0x3ef13f55
.long 0xbe48bf35,0x3f553ec4,0xbf7bbf35,0xbf0ebf6d,0x3f753f6d,0xbdc93f0e,0x3f623ec4,0x3f223f7b
.long 0xbf350000,0xbf35bf80,0xbf350000,0xbf35bf80,0xbe95bf6d,0x3f7f3f0e,0x3ef1bec4,0x3f463f7b
.long 0x3f7b3f35,0xbf0e3ec4,0xbe483f35,0xbf55bf6d,0xbf223ec4,0xbe95bf7b,0xbdc9bf6d,0x3f623f55
.long 0xbec4bf80,0x3f6d3f35,0x3ec43f80,0xbf6dbf35,0x3f7f3ec4,0xbf623e48,0xbf22bf6d,0x3f753f0e
.long 0xbf0e3f35,0x3e48bf6d,0x3f553f35,0xbf7bbec4,0xbef1bf6d,0x3f223f55,0xbf75bec4,0x3f7f3e48
.long 0x3f800000,0xbf800000,0x3f800000,0xbf800000,0xbef13f6d,0x3f22bf55,0xbf753ec4,0x3f7fbe48
.long 0xbf0ebf35,0x3e483f6d,0x3f55bf35,0xbf7b3ec4,0x3f7fbec4,0xbf62be48,0xbf223f6d,0x3f75bf0e
.long 0xbec43f80,0x3f6dbf35,0x3ec4bf80,0xbf6d3f35,0xbf22bec4,0xbe953f7b,0xbdc93f6d,0x3f62bf55
.long 0x3f7bbf35,0xbf0ebec4,0xbe48bf35,0xbf553f6d,0xbe953f6d,0x3f7fbf0e,0x3ef13ec4,0x3f46bf7b
.long 0xbf350000,0xbf353f80,0xbf350000,0xbf353f80,0x3f75bf6d,0xbdc9bf0e,0x3f62bec4,0x3f22bf7b
.long 0xbe483f35,0x3f55bec4,0xbf7b3f35,0xbf0e3f6d,0xbf463ec4,0xbf753f7b,0x3f7fbf6d,0x3ef1bf55
.long 0x3f6dbf80,0x3ec4bf35,0xbf6d3f80,0xbec43f35,0xbdc93ec4,0x3ef1be48,0x3f46bf6d,0x3e95bf0e
.long 0xbf553f35,0xbf7b3f6d,0xbf0e3f35,0xbe483ec4,0x3f62bf6d,0x3f46bf55,0x3e95bec4,0x3dc9be48
.long 0x80008000,0x80008000,0x80008000,0x80008000,0xbf7fbf80,0xbf75bf7b,0xbf22bf35,0xbef1bf0e
.long 0x3e488000,0x3f0e3ec4,0x3f7b3f80,0x3f553f6d,0x3f753f80,0x3f223f55,0xbf62bf35,0xbf7fbf7b
.long 0xbec48000,0xbf6dbf35,0x3ec48000,0x3f6d3f35,0xbf62bf80,0xbdc9bf0e,0x3e953f35,0xbf22be48
.long 0x3f0e8000,0x3f7b3f6d,0xbf55bf80,0x3e48bec4,0x3f463f80,0xbef13e48,0x3f7f3f35,0x3e953f55
.long 0xbf358000,0xbf35bf80,0xbf358000,0xbf35bf80,0xbf22bf80,0x3f623e48,0x3dc9bf35,0x3f753f55
.long 0x3f558000,0x3e483f6d,0x3f0e3f80,0xbf7bbec4,0x3ef13f80,0xbf7fbf0e,0xbf75bf35,0x3f46be48
.long 0xbf6d8000,0x3ec4bf35,0x3f6d8000,0xbec43f35,0xbe95bf80,0x3f463f55,0xbef13f35,0xbdc9bf7b
.long 0x3f7b8000,0xbf553ec4,0xbe48bf80,0x3f0e3f6d,0x3dc93f80,0xbe95bf7b,0x3f463f35,0xbf62bf0e
.long 0xbf808000,0x3f808000,0xbf808000,0x3f808000,0x3dc9bf80,0xbe953f7b,0x3f46bf35,0xbf623f0e
.long 0x3f7b8000,0xbf55bec4,0xbe483f80,0x3f0ebf6d,0xbe953f80,0x3f46bf55,0xbef1bf35,0xbdc93f7b
.long 0xbf6d8000,0x3ec43f35,0x3f6d8000,0xbec4bf35,0x3ef1bf80,0xbf7f3f0e,0xbf753f35,0x3f463e48
.long 0x3f558000,0x3e48bf6d,0x3f0ebf80,0xbf7b3ec4,0xbf223f80,0x3f62be48,0x3dc93f35,0x3f75bf55
.long 0xbf358000,0xbf353f80,0xbf358000,0xbf353f80,0x3f46bf80,0xbef1be48,0x3f7fbf35,0x3e95bf55
.long 0x3f0e8000,0x3f7bbf6d,0xbf553f80,0x3e483ec4,0xbf623f80,0xbdc93f0e,0x3e95bf35,0xbf223e48
.long 0xbec48000,0xbf6d3f35,0x3ec48000,0x3f6dbf35,0x3f75bf80,0x3f22bf55,0xbf623f35,0xbf7f3f7b
.long 0x3e488000,0x3f0ebec4,0x3f7bbf80,0x3f55bf6d,0xbf7f3f80,0xbf753f7b,0xbf223f35,0xbef13f0e
.long 0x80008000,0x80008000,0x80008000,0x80008000,0xbf62bf6d,0xbf46bf55,0xbe95bec4,0xbdc9be48
.long 0x3f553f35,0x3f7b3f6d,0x3f0e3f35,0x3e483ec4,0x3dc93ec4,0xbef1be48,0xbf46bf6d,0xbe95bf0e
.long 0xbf6dbf80,0xbec4bf35,0x3f6d3f80,0x3ec43f35,0x3f463ec4,0x3f753f7b,0xbf7fbf6d,0xbef1bf55
.long 0x3e483f35,0xbf55bec4,0x3f7b3f35,0x3f0e3f6d,0xbf75bf6d,0x3dc9bf0e,0xbf62bec4,0xbf22bf7b
.long 0x3f358000,0x3f353f80,0x3f358000,0x3f353f80,0x3e953f6d,0xbf7fbf0e,0xbef13ec4,0xbf46bf7b
.long 0xbf7bbf35,0x3f0ebec4,0x3e48bf35,0x3f553f6d,0x3f22bec4,0x3e953f7b,0x3dc93f6d,0xbf62bf55
.long 0x3ec43f80,0xbf6dbf35,0xbec4bf80,0x3f6d3f35,0xbf7fbec4,0x3f62be48,0x3f223f6d,0xbf75bf0e
.long 0x3f0ebf35,0xbe483f6d,0xbf55bf35,0x3f7b3ec4,0x3ef13f6d,0xbf22bf55,0x3f753ec4,0xbf7fbe48
.long 0xbf808000,0x3f808000,0xbf808000,0x3f808000,0x3ef1bf6d,0xbf223f55,0x3f75bec4,0xbf7f3e48
.long 0x3f0e3f35,0xbe48bf6d,0xbf553f35,0x3f7bbec4,0xbf7f3ec4,0x3f623e48,0x3f22bf6d,0xbf753f0e
.long 0x3ec4bf80,0xbf6d3f35,0xbec43f80,0x3f6dbf35,0x3f223ec4,0x3e95bf7b,0x3dc9bf6d,0xbf623f55
.long 0xbf7b3f35,0x3f0e3ec4,0x3e483f35,0x3f55bf6d,0x3e95bf6d,0xbf7f3f0e,0xbef1bec4,0xbf463f7b
.long 0x3f358000,0x3f35bf80,0x3f358000,0x3f35bf80,0xbf753f6d,0x3dc93f0e,0xbf623ec4,0xbf223f7b
.long 0x3e48bf35,0xbf553ec4,0x3f7bbf35,0x3f0ebf6d,0x3f46bec4,0x3f75bf7b,0xbf7f3f6d,0xbef13f55
.long 0xbf6d3f80,0xbec43f35,0x3f6dbf80,0x3ec4bf35,0x3dc9bec4,0xbef13e48,0xbf463f6d,0xbe953f0e
.long 0x3f55bf35,0x3f7bbf6d,0x3f0ebf35,0x3e48bec4,0xbf623f6d,0xbf463f55,0xbe953ec4,0xbdc93e48
.long 0x3f803f80,0x3f803f80,0x3f803f80,0x3f803f80,0xbf7fbf80,0xbf75bf7b,0xbf22bf35,0xbef1bf0e
.long 0x3f7b3f80,0x3f553f6d,0xbe480000,0xbf0ebec4,0xbf75bf80,0xbf22bf55,0x3f623f35,0x3f7f3f7b
.long 0x3f6d3f80,0x3ec43f35,0xbf6dbf80,0xbec4bf35,0xbf62bf80,0xbdc9bf0e,0x3e953f35,0xbf22be48
.long 0x3f553f80,0xbe483ec4,0x3f0e0000,0x3f7b3f6d,0xbf46bf80,0x3ef1be48,0xbf7fbf35,0xbe95bf55
.long 0x3f353f80,0xbf350000,0x3f353f80,0xbf350000,0xbf22bf80,0x3f623e48,0x3dc9bf35,0x3f753f55
.long 0x3f0e3f80,0xbf7bbec4,0xbf550000,0xbe48bf6d,0xbef1bf80,0x3f7f3f0e,0x3f753f35,0xbf463e48
.long 0x3ec43f80,0xbf6dbf35,0xbec4bf80,0x3f6d3f35,0xbe95bf80,0x3f463f55,0xbef13f35,0xbdc9bf7b
.long 0x3e483f80,0xbf0ebf6d,0x3f7b0000,0xbf553ec4,0xbdc9bf80,0x3e953f7b,0xbf46bf35,0x3f623f0e
.long 0x3f80,0xbf80,0x3f80,0xbf80,0x3dc9bf80,0xbe953f7b,0x3f46bf35,0xbf623f0e
.long 0xbe483f80,0x3f0ebf6d,0xbf7b0000,0x3f553ec4,0x3e95bf80,0xbf463f55,0x3ef13f35,0x3dc9bf7b
.long 0xbec43f80,0x3f6dbf35,0x3ec4bf80,0xbf6d3f35,0x3ef1bf80,0xbf7f3f0e,0xbf753f35,0x3f463e48
.long 0xbf0e3f80,0x3f7bbec4,0x3f550000,0x3e48bf6d,0x3f22bf80,0xbf623e48,0xbdc9bf35,0xbf753f55
.long 0xbf353f80,0x3f350000,0xbf353f80,0x3f350000,0x3f46bf80,0xbef1be48,0x3f7fbf35,0x3e95bf55
.long 0xbf553f80,0x3e483ec4,0xbf0e0000,0xbf7b3f6d,0x3f62bf80,0x3dc9bf0e,0xbe953f35,0x3f22be48
.long 0xbf6d3f80,0xbec43f35,0x3f6dbf80,0x3ec4bf35,0x3f75bf80,0x3f22bf55,0xbf623f35,0xbf7f3f7b
.long 0xbf7b3f80,0xbf553f6d,0x3e480000,0x3f0ebec4,0x3f7fbf80,0x3f75bf7b,0x3f22bf35,0x3ef1bf0e
.long 0x3f803f80,0x3f803f80,0x3f803f80,0x3f803f80,0xbf62bf6d,0xbf46bf55,0xbe95bec4,0xbdc9be48
.long 0x3f0e3f35,0x3e483ec4,0xbf55bf35,0xbf7bbf6d,0xbdc9bec4,0x3ef13e48,0x3f463f6d,0x3e953f0e
.long 0xbec40000,0xbf6dbf35,0x3ec40000,0x3f6d3f35,0x3f463ec4,0x3f753f7b,0xbf7fbf6d,0xbef1bf55
.long 0xbf7bbf35,0xbf0ebf6d,0x3e483f35,0xbf55bec4,0x3f753f6d,0xbdc93f0e,0x3f623ec4,0x3f223f7b
.long 0xbf35bf80,0x3f350000,0xbf35bf80,0x3f350000,0x3e953f6d,0xbf7fbf0e,0xbef13ec4,0xbf46bf7b
.long 0x3e48bf35,0x3f553f6d,0x3f7b3f35,0xbf0e3ec4,0xbf223ec4,0xbe95bf7b,0xbdc9bf6d,0x3f623f55
.long 0x3f6d0000,0xbec43f35,0xbf6d0000,0x3ec4bf35,0xbf7fbec4,0x3f62be48,0x3f223f6d,0xbf75bf0e
.long 0x3f553f35,0xbf7bbec4,0x3f0ebf35,0xbe483f6d,0xbef1bf6d,0x3f223f55,0xbf75bec4,0x3f7f3e48
.long 0x3f80,0xbf80,0x3f80,0xbf80,0x3ef1bf6d,0xbf223f55,0x3f75bec4,0xbf7f3e48
.long 0xbf553f35,0x3f7bbec4,0xbf0ebf35,0x3e483f6d,0x3f7fbec4,0xbf62be48,0xbf223f6d,0x3f75bf0e
.long 0xbf6d0000,0x3ec43f35,0x3f6d0000,0xbec4bf35,0x3f223ec4,0x3e95bf7b,0x3dc9bf6d,0xbf623f55
.long 0xbe48bf35,0xbf553f6d,0xbf7b3f35,0x3f0e3ec4,0xbe953f6d,0x3f7fbf0e,0x3ef13ec4,0x3f46bf7b
.long 0x3f35bf80,0xbf350000,0x3f35bf80,0xbf350000,0xbf753f6d,0x3dc93f0e,0xbf623ec4,0xbf223f7b
.long 0x3f7bbf35,0x3f0ebf6d,0xbe483f35,0x3f55bec4,0xbf463ec4,0xbf753f7b,0x3f7fbf6d,0x3ef1bf55
.long 0x3ec40000,0x3f6dbf35,0xbec40000,0xbf6d3f35,0x3dc9bec4,0xbef13e48,0xbf463f6d,0xbe953f0e
.long 0xbf0e3f35,0xbe483ec4,0x3f55bf35,0x3f7bbf6d,0x3f62bf6d,0x3f46bf55,0x3e95bec4,0x3dc9be48
.long 0x0,0x0,0x0,0x0,0xbdc90000,0xbe95be48,0xbf46bf35,0xbf62bf55
.long 0x3e480000,0x3f0e3ec4,0x3f7b3f80,0x3f553f6d,0xbe950000,0xbf46bf0e,0xbef1bf35,0x3dc9be48
.long 0x3ec40000,0x3f6d3f35,0xbec40000,0xbf6dbf35,0xbef10000,0xbf7fbf55,0x3f753f35,0x3f463f7b
.long 0x3f0e0000,0x3f7b3f6d,0xbf55bf80,0x3e48bec4,0xbf220000,0xbf62bf7b,0x3dc93f35,0xbf75bf0e
.long 0x3f350000,0x3f353f80,0x3f350000,0x3f353f80,0xbf460000,0xbef1bf7b,0xbf7fbf35,0x3e95bf0e
.long 0x3f550000,0x3e483f6d,0x3f0e3f80,0xbf7bbec4,0xbf620000,0x3dc9bf55,0x3e95bf35,0x3f223f7b
.long 0x3f6d0000,0xbec43f35,0xbf6d0000,0x3ec4bf35,0xbf750000,0x3f22bf0e,0x3f623f35,0xbf7fbe48
.long 0x3f7b0000,0xbf553ec4,0xbe48bf80,0x3f0e3f6d,0xbf7f0000,0x3f75be48,0xbf223f35,0x3ef1bf55
.long 0x3f800000,0xbf800000,0x3f800000,0xbf800000,0xbf7f0000,0x3f753e48,0xbf22bf35,0x3ef13f55
.long 0x3f7b0000,0xbf55bec4,0xbe483f80,0x3f0ebf6d,0xbf750000,0x3f223f0e,0x3f62bf35,0xbf7f3e48
.long 0x3f6d0000,0xbec4bf35,0xbf6d0000,0x3ec43f35,0xbf620000,0x3dc93f55,0x3e953f35,0x3f22bf7b
.long 0x3f550000,0x3e48bf6d,0x3f0ebf80,0xbf7b3ec4,0xbf460000,0xbef13f7b,0xbf7f3f35,0x3e953f0e
.long 0x3f350000,0x3f35bf80,0x3f350000,0x3f35bf80,0xbf220000,0xbf623f7b,0x3dc9bf35,0xbf753f0e
.long 0x3f0e0000,0x3f7bbf6d,0xbf553f80,0x3e483ec4,0xbef10000,0xbf7f3f55,0x3f75bf35,0x3f46bf7b
.long 0x3ec40000,0x3f6dbf35,0xbec40000,0xbf6d3f35,0xbe950000,0xbf463f0e,0xbef13f35,0x3dc93e48
.long 0x3e480000,0x3f0ebec4,0x3f7bbf80,0x3f55bf6d,0xbdc90000,0xbe953e48,0xbf463f35,0xbf623f55
.long 0x0,0x0,0x0,0x0,0xbef1bec4,0xbf22bf0e,0xbf75bf6d,0xbf7fbf7b
.long 0x3f553f35,0x3f7b3f6d,0x3f0e3f35,0x3e483ec4,0xbf7fbf6d,0xbf62bf7b,0x3f223ec4,0x3f753f55
.long 0x3f6d3f80,0x3ec43f35,0xbf6dbf80,0xbec4bf35,0xbf22bf6d,0x3e95be48,0xbdc93ec4,0xbf62bf0e
.long 0x3e483f35,0xbf55bec4,0x3f7b3f35,0x3f0e3f6d,0x3e95bec4,0x3f7f3f55,0xbef1bf6d,0x3f463e48
.long 0xbf350000,0xbf35bf80,0xbf350000,0xbf35bf80,0x3f753ec4,0x3dc93f55,0x3f623f6d,0xbf223e48
.long 0xbf7bbf35,0x3f0ebec4,0x3e48bf35,0x3f553f6d,0x3f463f6d,0xbf75be48,0xbf7fbec4,0x3ef1bf0e
.long 0xbec4bf80,0x3f6d3f35,0x3ec43f80,0xbf6dbf35,0xbdc93f6d,0xbef1bf7b,0x3f46bec4,0xbe953f55
.long 0x3f0ebf35,0xbe483f6d,0xbf55bf35,0x3f7b3ec4,0xbf623ec4,0x3f46bf0e,0xbe953f6d,0x3dc9bf7b
.long 0x3f800000,0xbf800000,0x3f800000,0xbf800000,0xbf62bec4,0x3f463f0e,0xbe95bf6d,0x3dc93f7b
.long 0x3f0e3f35,0xbe48bf6d,0xbf553f35,0x3f7bbec4,0xbdc9bf6d,0xbef13f7b,0x3f463ec4,0xbe95bf55
.long 0xbec43f80,0x3f6dbf35,0x3ec4bf80,0xbf6d3f35,0x3f46bf6d,0xbf753e48,0xbf7f3ec4,0x3ef13f0e
.long 0xbf7b3f35,0x3f0e3ec4,0x3e483f35,0x3f55bf6d,0x3f75bec4,0x3dc9bf55,0x3f62bf6d,0xbf22be48
.long 0xbf350000,0xbf353f80,0xbf350000,0xbf353f80,0x3e953ec4,0x3f7fbf55,0xbef13f6d,0x3f46be48
.long 0x3e48bf35,0xbf553ec4,0x3f7bbf35,0x3f0ebf6d,0xbf223f6d,0x3e953e48,0xbdc9bec4,0xbf623f0e
.long 0x3f6dbf80,0x3ec4bf35,0xbf6d3f80,0xbec43f35,0xbf7f3f6d,0xbf623f7b,0x3f22bec4,0x3f75bf55
.long 0x3f55bf35,0x3f7bbf6d,0x3f0ebf35,0x3e48bec4,0xbef13ec4,0xbf223f0e,0xbf753f6d,0xbf7f3f7b
.long 0x80008000,0x80008000,0x80008000,0x80008000,0x3dc98000,0x3e953e48,0x3f463f35,0x3f623f55
.long 0xbe488000,0xbf0ebec4,0xbf7bbf80,0xbf55bf6d,0x3e958000,0x3f463f0e,0x3ef13f35,0xbdc93e48
.long 0xbec48000,0xbf6dbf35,0x3ec48000,0x3f6d3f35,0x3ef18000,0x3f7f3f55,0xbf75bf35,0xbf46bf7b
.long 0xbf0e8000,0xbf7bbf6d,0x3f553f80,0xbe483ec4,0x3f228000,0x3f623f7b,0xbdc9bf35,0x3f753f0e
.long 0xbf358000,0xbf35bf80,0xbf358000,0xbf35bf80,0x3f468000,0x3ef13f7b,0x3f7f3f35,0xbe953f0e
.long 0xbf558000,0xbe48bf6d,0xbf0ebf80,0x3f7b3ec4,0x3f628000,0xbdc93f55,0xbe953f35,0xbf22bf7b
.long 0xbf6d8000,0x3ec4bf35,0x3f6d8000,0xbec43f35,0x3f758000,0xbf223f0e,0xbf62bf35,0x3f7f3e48
.long 0xbf7b8000,0x3f55bec4,0x3e483f80,0xbf0ebf6d,0x3f7f8000,0xbf753e48,0x3f22bf35,0xbef13f55
.long 0xbf808000,0x3f808000,0xbf808000,0x3f808000,0x3f7f8000,0xbf75be48,0x3f223f35,0xbef1bf55
.long 0xbf7b8000,0x3f553ec4,0x3e48bf80,0xbf0e3f6d,0x3f758000,0xbf22bf0e,0xbf623f35,0x3f7fbe48
.long 0xbf6d8000,0x3ec43f35,0x3f6d8000,0xbec4bf35,0x3f628000,0xbdc9bf55,0xbe95bf35,0xbf223f7b
.long 0xbf558000,0xbe483f6d,0xbf0e3f80,0x3f7bbec4,0x3f468000,0x3ef1bf7b,0x3f7fbf35,0xbe95bf0e
.long 0xbf358000,0xbf353f80,0xbf358000,0xbf353f80,0x3f228000,0x3f62bf7b,0xbdc93f35,0x3f75bf0e
.long 0xbf0e8000,0xbf7b3f6d,0x3f55bf80,0xbe48bec4,0x3ef18000,0x3f7fbf55,0xbf753f35,0xbf463f7b
.long 0xbec48000,0xbf6d3f35,0x3ec48000,0x3f6dbf35,0x3e958000,0x3f46bf0e,0x3ef1bf35,0xbdc9be48
.long 0xbe488000,0xbf0e3ec4,0xbf7b3f80,0xbf553f6d,0x3dc98000,0x3e95be48,0x3f46bf35,0x3f62bf55
.long 0x80008000,0x80008000,0x80008000,0x80008000,0x3ef13ec4,0x3f223f0e,0x3f753f6d,0x3f7f3f7b
.long 0xbf55bf35,0xbf7bbf6d,0xbf0ebf35,0xbe48bec4,0x3f7f3f6d,0x3f623f7b,0xbf22bec4,0xbf75bf55
.long 0xbf6dbf80,0xbec4bf35,0x3f6d3f80,0x3ec43f35,0x3f223f6d,0xbe953e48,0x3dc9bec4,0x3f623f0e
.long 0xbe48bf35,0x3f553ec4,0xbf7bbf35,0xbf0ebf6d,0xbe953ec4,0xbf7fbf55,0x3ef13f6d,0xbf46be48
.long 0x3f358000,0x3f353f80,0x3f358000,0x3f353f80,0xbf75bec4,0xbdc9bf55,0xbf62bf6d,0x3f22be48
.long 0x3f7b3f35,0xbf0e3ec4,0xbe483f35,0xbf55bf6d,0xbf46bf6d,0x3f753e48,0x3f7f3ec4,0xbef13f0e
.long 0x3ec43f80,0xbf6dbf35,0xbec4bf80,0x3f6d3f35,0x3dc9bf6d,0x3ef13f7b,0xbf463ec4,0x3e95bf55
.long 0xbf0e3f35,0x3e48bf6d,0x3f553f35,0xbf7bbec4,0x3f62bec4,0xbf463f0e,0x3e95bf6d,0xbdc93f7b
.long 0xbf808000,0x3f808000,0xbf808000,0x3f808000,0x3f623ec4,0xbf46bf0e,0x3e953f6d,0xbdc9bf7b
.long 0xbf0ebf35,0x3e483f6d,0x3f55bf35,0xbf7b3ec4,0x3dc93f6d,0x3ef1bf7b,0xbf46bec4,0x3e953f55
.long 0x3ec4bf80,0xbf6d3f35,0xbec43f80,0x3f6dbf35,0xbf463f6d,0x3f75be48,0x3f7fbec4,0xbef1bf0e
.long 0x3f7bbf35,0xbf0ebec4,0xbe48bf35,0xbf553f6d,0xbf753ec4,0xbdc93f55,0xbf623f6d,0x3f223e48
.long 0x3f358000,0x3f35bf80,0x3f358000,0x3f35bf80,0xbe95bec4,0xbf7f3f55,0x3ef1bf6d,0xbf463e48
.long 0xbe483f35,0x3f55bec4,0xbf7b3f35,0xbf0e3f6d,0x3f22bf6d,0xbe95be48,0x3dc93ec4,0x3f62bf0e
.long 0xbf6d3f80,0xbec43f35,0x3f6dbf80,0x3ec4bf35,0x3f7fbf6d,0x3f62bf7b,0xbf223ec4,0xbf753f55
.long 0xbf553f35,0xbf7b3f6d,0xbf0e3f35,0xbe483ec4,0x3ef1bec4,0x3f22bf0e,0x3f75bf6d,0x3f7fbf7b
.long 0x3f803f80,0x3f803f80,0x3f803f80,0x3f803f80,0x3dc90000,0x3e953e48,0x3f463f35,0x3f623f55
.long 0xbf7bbf80,0xbf55bf6d,0x3e480000,0x3f0e3ec4,0xbe950000,0xbf46bf0e,0xbef1bf35,0x3dc9be48
.long 0x3f6d3f80,0x3ec43f35,0xbf6dbf80,0xbec4bf35,0x3ef10000,0x3f7f3f55,0xbf75bf35,0xbf46bf7b
.long 0xbf55bf80,0x3e48bec4,0xbf0e0000,0xbf7bbf6d,0xbf220000,0xbf62bf7b,0x3dc93f35,0xbf75bf0e
.long 0x3f353f80,0xbf350000,0x3f353f80,0xbf350000,0x3f460000,0x3ef13f7b,0x3f7f3f35,0xbe953f0e
.long 0xbf0ebf80,0x3f7b3ec4,0x3f550000,0x3e483f6d,0xbf620000,0x3dc9bf55,0x3e95bf35,0x3f223f7b
.long 0x3ec43f80,0xbf6dbf35,0xbec4bf80,0x3f6d3f35,0x3f750000,0xbf223f0e,0xbf62bf35,0x3f7f3e48
.long 0xbe48bf80,0x3f0e3f6d,0xbf7b0000,0x3f55bec4,0xbf7f0000,0x3f75be48,0xbf223f35,0x3ef1bf55
.long 0x3f80,0xbf80,0x3f80,0xbf80,0x3f7f0000,0xbf75be48,0x3f223f35,0xbef1bf55
.long 0x3e48bf80,0xbf0e3f6d,0x3f7b0000,0xbf55bec4,0xbf750000,0x3f223f0e,0x3f62bf35,0xbf7f3e48
.long 0xbec43f80,0x3f6dbf35,0x3ec4bf80,0xbf6d3f35,0x3f620000,0xbdc9bf55,0xbe95bf35,0xbf223f7b
.long 0x3f0ebf80,0xbf7b3ec4,0xbf550000,0xbe483f6d,0xbf460000,0xbef13f7b,0xbf7f3f35,0x3e953f0e
.long 0xbf353f80,0x3f350000,0xbf353f80,0x3f350000,0x3f220000,0x3f62bf7b,0xbdc93f35,0x3f75bf0e
.long 0x3f55bf80,0xbe48bec4,0x3f0e0000,0x3f7bbf6d,0xbef10000,0xbf7f3f55,0x3f75bf35,0x3f46bf7b
.long 0xbf6d3f80,0xbec43f35,0x3f6dbf80,0x3ec4bf35,0x3e950000,0x3f46bf0e,0x3ef1bf35,0xbdc9be48
.long 0x3f7bbf80,0x3f55bf6d,0xbe480000,0xbf0e3ec4,0xbdc90000,0xbe953e48,0xbf463f35,0xbf623f55
.long 0x3f803f80,0x3f803f80,0x3f803f80,0x3f803f80,0x3ef13ec4,0x3f223f0e,0x3f753f6d,0x3f7f3f7b
.long 0xbf0ebf35,0xbe48bec4,0x3f553f35,0x3f7b3f6d,0xbf7fbf6d,0xbf62bf7b,0x3f223ec4,0x3f753f55
.long 0xbec40000,0xbf6dbf35,0x3ec40000,0x3f6d3f35,0x3f223f6d,0xbe953e48,0x3dc9bec4,0x3f623f0e
.long 0x3f7b3f35,0x3f0e3f6d,0xbe48bf35,0x3f553ec4,0x3e95bec4,0x3f7f3f55,0xbef1bf6d,0x3f463e48
.long 0xbf35bf80,0x3f350000,0xbf35bf80,0x3f350000,0xbf75bec4,0xbdc9bf55,0xbf62bf6d,0x3f22be48
.long 0xbe483f35,0xbf55bf6d,0xbf7bbf35,0x3f0ebec4,0x3f463f6d,0xbf75be48,0xbf7fbec4,0x3ef1bf0e
.long 0x3f6d0000,0xbec43f35,0xbf6d0000,0x3ec4bf35,0x3dc9bf6d,0x3ef13f7b,0xbf463ec4,0x3e95bf55
.long 0xbf55bf35,0x3f7b3ec4,0xbf0e3f35,0x3e48bf6d,0xbf623ec4,0x3f46bf0e,0xbe953f6d,0x3dc9bf7b
.long 0x3f80,0xbf80,0x3f80,0xbf80,0x3f623ec4,0xbf46bf0e,0x3e953f6d,0xbdc9bf7b
.long 0x3f55bf35,0xbf7b3ec4,0x3f0e3f35,0xbe48bf6d,0xbdc9bf6d,0xbef13f7b,0x3f463ec4,0xbe95bf55
.long 0xbf6d0000,0x3ec43f35,0x3f6d0000,0xbec4bf35,0xbf463f6d,0x3f75be48,0x3f7fbec4,0xbef1bf0e
.long 0x3e483f35,0x3f55bf6d,0x3f7bbf35,0xbf0ebec4,0x3f75bec4,0x3dc9bf55,0x3f62bf6d,0xbf22be48
.long 0x3f35bf80,0xbf350000,0x3f35bf80,0xbf350000,0xbe95bec4,0xbf7f3f55,0x3ef1bf6d,0xbf463e48
.long 0xbf7b3f35,0xbf0e3f6d,0x3e48bf35,0xbf553ec4,0xbf223f6d,0x3e953e48,0xbdc9bec4,0xbf623f0e
.long 0x3ec40000,0x3f6dbf35,0xbec40000,0xbf6d3f35,0x3f7fbf6d,0x3f62bf7b,0xbf223ec4,0xbf753f55
.long 0x3f0ebf35,0x3e48bec4,0xbf553f35,0xbf7b3f6d,0xbef13ec4,0xbf223f0e,0xbf753f6d,0xbf7f3f7b
.long 0x0,0x0,0x0,0x0,0xbf7fbf80,0xbf75bf7b,0xbf22bf35,0xbef1bf0e
.long 0xbe480000,0xbf0ebec4,0xbf7bbf80,0xbf55bf6d,0x3f753f80,0x3f223f55,0xbf62bf35,0xbf7fbf7b
.long 0x3ec40000,0x3f6d3f35,0xbec40000,0xbf6dbf35,0xbf62bf80,0xbdc9bf0e,0x3e953f35,0xbf22be48
.long 0xbf0e0000,0xbf7bbf6d,0x3f553f80,0xbe483ec4,0x3f463f80,0xbef13e48,0x3f7f3f35,0x3e953f55
.long 0x3f350000,0x3f353f80,0x3f350000,0x3f353f80,0xbf22bf80,0x3f623e48,0x3dc9bf35,0x3f753f55
.long 0xbf550000,0xbe48bf6d,0xbf0ebf80,0x3f7b3ec4,0x3ef13f80,0xbf7fbf0e,0xbf75bf35,0x3f46be48
.long 0x3f6d0000,0xbec43f35,0xbf6d0000,0x3ec4bf35,0xbe95bf80,0x3f463f55,0xbef13f35,0xbdc9bf7b
.long 0xbf7b0000,0x3f55bec4,0x3e483f80,0xbf0ebf6d,0x3dc93f80,0xbe95bf7b,0x3f463f35,0xbf62bf0e
.long 0x3f800000,0xbf800000,0x3f800000,0xbf800000,0x3dc9bf80,0xbe953f7b,0x3f46bf35,0xbf623f0e
.long 0xbf7b0000,0x3f553ec4,0x3e48bf80,0xbf0e3f6d,0xbe953f80,0x3f46bf55,0xbef1bf35,0xbdc93f7b
.long 0x3f6d0000,0xbec4bf35,0xbf6d0000,0x3ec43f35,0x3ef1bf80,0xbf7f3f0e,0xbf753f35,0x3f463e48
.long 0xbf550000,0xbe483f6d,0xbf0e3f80,0x3f7bbec4,0xbf223f80,0x3f62be48,0x3dc93f35,0x3f75bf55
.long 0x3f350000,0x3f35bf80,0x3f350000,0x3f35bf80,0x3f46bf80,0xbef1be48,0x3f7fbf35,0x3e95bf55
.long 0xbf0e0000,0xbf7b3f6d,0x3f55bf80,0xbe48bec4,0xbf623f80,0xbdc93f0e,0x3e95bf35,0xbf223e48
.long 0x3ec40000,0x3f6dbf35,0xbec40000,0xbf6d3f35,0x3f75bf80,0x3f22bf55,0xbf623f35,0xbf7f3f7b
.long 0xbe480000,0xbf0e3ec4,0xbf7b3f80,0xbf553f6d,0xbf7f3f80,0xbf753f7b,0xbf223f35,0xbef13f0e
.long 0x0,0x0,0x0,0x0,0xbf62bf6d,0xbf46bf55,0xbe95bec4,0xbdc9be48
.long 0xbf55bf35,0xbf7bbf6d,0xbf0ebf35,0xbe48bec4,0x3dc93ec4,0xbef1be48,0xbf46bf6d,0xbe95bf0e
.long 0x3f6d3f80,0x3ec43f35,0xbf6dbf80,0xbec4bf35,0x3f463ec4,0x3f753f7b,0xbf7fbf6d,0xbef1bf55
.long 0xbe48bf35,0x3f553ec4,0xbf7bbf35,0xbf0ebf6d,0xbf75bf6d,0x3dc9bf0e,0xbf62bec4,0xbf22bf7b
.long 0xbf350000,0xbf35bf80,0xbf350000,0xbf35bf80,0x3e953f6d,0xbf7fbf0e,0xbef13ec4,0xbf46bf7b
.long 0x3f7b3f35,0xbf0e3ec4,0xbe483f35,0xbf55bf6d,0x3f22bec4,0x3e953f7b,0x3dc93f6d,0xbf62bf55
.long 0xbec4bf80,0x3f6d3f35,0x3ec43f80,0xbf6dbf35,0xbf7fbec4,0x3f62be48,0x3f223f6d,0xbf75bf0e
.long 0xbf0e3f35,0x3e48bf6d,0x3f553f35,0xbf7bbec4,0x3ef13f6d,0xbf22bf55,0x3f753ec4,0xbf7fbe48
.long 0x3f800000,0xbf800000,0x3f800000,0xbf800000,0x3ef1bf6d,0xbf223f55,0x3f75bec4,0xbf7f3e48
.long 0xbf0ebf35,0x3e483f6d,0x3f55bf35,0xbf7b3ec4,0xbf7f3ec4,0x3f623e48,0x3f22bf6d,0xbf753f0e
.long 0xbec43f80,0x3f6dbf35,0x3ec4bf80,0xbf6d3f35,0x3f223ec4,0x3e95bf7b,0x3dc9bf6d,0xbf623f55
.long 0x3f7bbf35,0xbf0ebec4,0xbe48bf35,0xbf553f6d,0x3e95bf6d,0xbf7f3f0e,0xbef1bec4,0xbf463f7b
.long 0xbf350000,0xbf353f80,0xbf350000,0xbf353f80,0xbf753f6d,0x3dc93f0e,0xbf623ec4,0xbf223f7b
.long 0xbe483f35,0x3f55bec4,0xbf7b3f35,0xbf0e3f6d,0x3f46bec4,0x3f75bf7b,0xbf7f3f6d,0xbef13f55
.long 0x3f6dbf80,0x3ec4bf35,0xbf6d3f80,0xbec43f35,0x3dc9bec4,0xbef13e48,0xbf463f6d,0xbe953f0e
.long 0xbf553f35,0xbf7b3f6d,0xbf0e3f35,0xbe483ec4,0xbf623f6d,0xbf463f55,0xbe953ec4,0xbdc93e48
.long 0x80008000,0x80008000,0x80008000,0x80008000,0x3f7f3f80,0x3f753f7b,0x3f223f35,0x3ef13f0e
.long 0x3e488000,0x3f0e3ec4,0x3f7b3f80,0x3f553f6d,0xbf75bf80,0xbf22bf55,0x3f623f35,0x3f7f3f7b
.long 0xbec48000,0xbf6dbf35,0x3ec48000,0x3f6d3f35,0x3f623f80,0x3dc93f0e,0xbe95bf35,0x3f223e48
.long 0x3f0e8000,0x3f7b3f6d,0xbf55bf80,0x3e48bec4,0xbf46bf80,0x3ef1be48,0xbf7fbf35,0xbe95bf55
.long 0xbf358000,0xbf35bf80,0xbf358000,0xbf35bf80,0x3f223f80,0xbf62be48,0xbdc93f35,0xbf75bf55
.long 0x3f558000,0x3e483f6d,0x3f0e3f80,0xbf7bbec4,0xbef1bf80,0x3f7f3f0e,0x3f753f35,0xbf463e48
.long 0xbf6d8000,0x3ec4bf35,0x3f6d8000,0xbec43f35,0x3e953f80,0xbf46bf55,0x3ef1bf35,0x3dc93f7b
.long 0x3f7b8000,0xbf553ec4,0xbe48bf80,0x3f0e3f6d,0xbdc9bf80,0x3e953f7b,0xbf46bf35,0x3f623f0e
.long 0xbf808000,0x3f808000,0xbf808000,0x3f808000,0xbdc93f80,0x3e95bf7b,0xbf463f35,0x3f62bf0e
.long 0x3f7b8000,0xbf55bec4,0xbe483f80,0x3f0ebf6d,0x3e95bf80,0xbf463f55,0x3ef13f35,0x3dc9bf7b
.long 0xbf6d8000,0x3ec43f35,0x3f6d8000,0xbec4bf35,0xbef13f80,0x3f7fbf0e,0x3f75bf35,0xbf46be48
.long 0x3f558000,0x3e48bf6d,0x3f0ebf80,0xbf7b3ec4,0x3f22bf80,0xbf623e48,0xbdc9bf35,0xbf753f55
.long 0xbf358000,0xbf353f80,0xbf358000,0xbf353f80,0xbf463f80,0x3ef13e48,0xbf7f3f35,0xbe953f55
.long 0x3f0e8000,0x3f7bbf6d,0xbf553f80,0x3e483ec4,0x3f62bf80,0x3dc9bf0e,0xbe953f35,0x3f22be48
.long 0xbec48000,0xbf6d3f35,0x3ec48000,0x3f6dbf35,0xbf753f80,0xbf223f55,0x3f62bf35,0x3f7fbf7b
.long 0x3e488000,0x3f0ebec4,0x3f7bbf80,0x3f55bf6d,0x3f7fbf80,0x3f75bf7b,0x3f22bf35,0x3ef1bf0e
.long 0x80008000,0x80008000,0x80008000,0x80008000,0x3f623f6d,0x3f463f55,0x3e953ec4,0x3dc93e48
.long 0x3f553f35,0x3f7b3f6d,0x3f0e3f35,0x3e483ec4,0xbdc9bec4,0x3ef13e48,0x3f463f6d,0x3e953f0e
.long 0xbf6dbf80,0xbec4bf35,0x3f6d3f80,0x3ec43f35,0xbf46bec4,0xbf75bf7b,0x3f7f3f6d,0x3ef13f55
.long 0x3e483f35,0xbf55bec4,0x3f7b3f35,0x3f0e3f6d,0x3f753f6d,0xbdc93f0e,0x3f623ec4,0x3f223f7b
.long 0x3f358000,0x3f353f80,0x3f358000,0x3f353f80,0xbe95bf6d,0x3f7f3f0e,0x3ef1bec4,0x3f463f7b
.long 0xbf7bbf35,0x3f0ebec4,0x3e48bf35,0x3f553f6d,0xbf223ec4,0xbe95bf7b,0xbdc9bf6d,0x3f623f55
.long 0x3ec43f80,0xbf6dbf35,0xbec4bf80,0x3f6d3f35,0x3f7f3ec4,0xbf623e48,0xbf22bf6d,0x3f753f0e
.long 0x3f0ebf35,0xbe483f6d,0xbf55bf35,0x3f7b3ec4,0xbef1bf6d,0x3f223f55,0xbf75bec4,0x3f7f3e48
.long 0xbf808000,0x3f808000,0xbf808000,0x3f808000,0xbef13f6d,0x3f22bf55,0xbf753ec4,0x3f7fbe48
.long 0x3f0e3f35,0xbe48bf6d,0xbf553f35,0x3f7bbec4,0x3f7fbec4,0xbf62be48,0xbf223f6d,0x3f75bf0e
.long 0x3ec4bf80,0xbf6d3f35,0xbec43f80,0x3f6dbf35,0xbf22bec4,0xbe953f7b,0xbdc93f6d,0x3f62bf55
.long 0xbf7b3f35,0x3f0e3ec4,0x3e483f35,0x3f55bf6d,0xbe953f6d,0x3f7fbf0e,0x3ef13ec4,0x3f46bf7b
.long 0x3f358000,0x3f35bf80,0x3f358000,0x3f35bf80,0x3f75bf6d,0xbdc9bf0e,0x3f62bec4,0x3f22bf7b
.long 0x3e48bf35,0xbf553ec4,0x3f7bbf35,0x3f0ebf6d,0xbf463ec4,0xbf753f7b,0x3f7fbf6d,0x3ef1bf55
.long 0xbf6d3f80,0xbec43f35,0x3f6dbf80,0x3ec4bf35,0xbdc93ec4,0x3ef1be48,0x3f46bf6d,0x3e95bf0e
.long 0x3f55bf35,0x3f7bbf6d,0x3f0ebf35,0x3e48bec4,0x3f62bf6d,0x3f46bf55,0x3e95bec4,0x3dc9be48
.long 0xbf803f80,0xbf803f80,0xbf803f80,0xbf803f80,0xbf7f3f80,0xbf753f7b,0xbf223f35,0xbef13f0e
.long 0xbf7b3f80,0xbf553f6d,0x3e480000,0x3f0ebec4,0xbf753f80,0xbf223f55,0x3f62bf35,0x3f7fbf7b
.long 0xbf6d3f80,0xbec43f35,0x3f6dbf80,0x3ec4bf35,0xbf623f80,0xbdc93f0e,0x3e95bf35,0xbf223e48
.long 0xbf553f80,0x3e483ec4,0xbf0e0000,0xbf7b3f6d,0xbf463f80,0x3ef13e48,0xbf7f3f35,0xbe953f55
.long 0xbf353f80,0x3f350000,0xbf353f80,0x3f350000,0xbf223f80,0x3f62be48,0x3dc93f35,0x3f75bf55
.long 0xbf0e3f80,0x3f7bbec4,0x3f550000,0x3e48bf6d,0xbef13f80,0x3f7fbf0e,0x3f75bf35,0xbf46be48
.long 0xbec43f80,0x3f6dbf35,0x3ec4bf80,0xbf6d3f35,0xbe953f80,0x3f46bf55,0xbef1bf35,0xbdc93f7b
.long 0xbe483f80,0x3f0ebf6d,0xbf7b0000,0x3f553ec4,0xbdc93f80,0x3e95bf7b,0xbf463f35,0x3f62bf0e
.long 0x3f80,0xbf80,0x3f80,0xbf80,0x3dc93f80,0xbe95bf7b,0x3f463f35,0xbf62bf0e
.long 0x3e483f80,0xbf0ebf6d,0x3f7b0000,0xbf553ec4,0x3e953f80,0xbf46bf55,0x3ef1bf35,0x3dc93f7b
.long 0x3ec43f80,0xbf6dbf35,0xbec4bf80,0x3f6d3f35,0x3ef13f80,0xbf7fbf0e,0xbf75bf35,0x3f46be48
.long 0x3f0e3f80,0xbf7bbec4,0xbf550000,0xbe48bf6d,0x3f223f80,0xbf62be48,0xbdc93f35,0xbf75bf55
.long 0x3f353f80,0xbf350000,0x3f353f80,0xbf350000,0x3f463f80,0xbef13e48,0x3f7f3f35,0x3e953f55
.long 0x3f553f80,0xbe483ec4,0x3f0e0000,0x3f7b3f6d,0x3f623f80,0x3dc93f0e,0xbe95bf35,0x3f223e48
.long 0x3f6d3f80,0x3ec43f35,0xbf6dbf80,0xbec4bf35,0x3f753f80,0x3f223f55,0xbf62bf35,0xbf7fbf7b
.long 0x3f7b3f80,0x3f553f6d,0xbe480000,0xbf0ebec4,0x3f7f3f80,0x3f753f7b,0x3f223f35,0x3ef13f0e
.long 0xbf803f80,0xbf803f80,0xbf803f80,0xbf803f80,0xbf623f6d,0xbf463f55,0xbe953ec4,0xbdc93e48
.long 0xbf0e3f35,0xbe483ec4,0x3f55bf35,0x3f7bbf6d,0xbdc93ec4,0x3ef1be48,0x3f46bf6d,0x3e95bf0e
.long 0x3ec40000,0x3f6dbf35,0xbec40000,0xbf6d3f35,0x3f46bec4,0x3f75bf7b,0xbf7f3f6d,0xbef13f55
.long 0x3f7bbf35,0x3f0ebf6d,0xbe483f35,0x3f55bec4,0x3f75bf6d,0xbdc9bf0e,0x3f62bec4,0x3f22bf7b
.long 0x3f35bf80,0xbf350000,0x3f35bf80,0xbf350000,0x3e95bf6d,0xbf7f3f0e,0xbef1bec4,0xbf463f7b
.long 0xbe48bf35,0xbf553f6d,0xbf7b3f35,0x3f0e3ec4,0xbf22bec4,0xbe953f7b,0xbdc93f6d,0x3f62bf55
.long 0xbf6d0000,0x3ec43f35,0x3f6d0000,0xbec4bf35,0xbf7f3ec4,0x3f623e48,0x3f22bf6d,0xbf753f0e
.long 0xbf553f35,0x3f7bbec4,0xbf0ebf35,0x3e483f6d,0xbef13f6d,0x3f22bf55,0xbf753ec4,0x3f7fbe48
.long 0x3f80,0xbf80,0x3f80,0xbf80,0x3ef13f6d,0xbf22bf55,0x3f753ec4,0xbf7fbe48
.long 0x3f553f35,0xbf7bbec4,0x3f0ebf35,0xbe483f6d,0x3f7f3ec4,0xbf623e48,0xbf22bf6d,0x3f753f0e
.long 0x3f6d0000,0xbec43f35,0xbf6d0000,0x3ec4bf35,0x3f22bec4,0x3e953f7b,0x3dc93f6d,0xbf62bf55
.long 0x3e48bf35,0x3f553f6d,0x3f7b3f35,0xbf0e3ec4,0xbe95bf6d,0x3f7f3f0e,0x3ef1bec4,0x3f463f7b
.long 0xbf35bf80,0x3f350000,0xbf35bf80,0x3f350000,0xbf75bf6d,0x3dc9bf0e,0xbf62bec4,0xbf22bf7b
.long 0xbf7bbf35,0xbf0ebf6d,0x3e483f35,0xbf55bec4,0xbf46bec4,0xbf75bf7b,0x3f7f3f6d,0x3ef13f55
.long 0xbec40000,0xbf6dbf35,0x3ec40000,0x3f6d3f35,0x3dc93ec4,0xbef1be48,0xbf46bf6d,0xbe95bf0e
.long 0x3f0e3f35,0x3e483ec4,0xbf55bf35,0xbf7bbf6d,0x3f623f6d,0x3f463f55,0x3e953ec4,0x3dc93e48
.long 0x0,0x0,0x0,0x0,0xbdc90000,0xbe953e48,0xbf463f35,0xbf623f55
.long 0xbe480000,0xbf0e3ec4,0xbf7b3f80,0xbf553f6d,0xbe950000,0xbf463f0e,0xbef13f35,0x3dc93e48
.long 0xbec40000,0xbf6d3f35,0x3ec40000,0x3f6dbf35,0xbef10000,0xbf7f3f55,0x3f75bf35,0x3f46bf7b
.long 0xbf0e0000,0xbf7b3f6d,0x3f55bf80,0xbe48bec4,0xbf220000,0xbf623f7b,0x3dc9bf35,0xbf753f0e
.long 0xbf350000,0xbf353f80,0xbf350000,0xbf353f80,0xbf460000,0xbef13f7b,0xbf7f3f35,0x3e953f0e
.long 0xbf550000,0xbe483f6d,0xbf0e3f80,0x3f7bbec4,0xbf620000,0x3dc93f55,0x3e953f35,0x3f22bf7b
.long 0xbf6d0000,0x3ec43f35,0x3f6d0000,0xbec4bf35,0xbf750000,0x3f223f0e,0x3f62bf35,0xbf7f3e48
.long 0xbf7b0000,0x3f553ec4,0x3e48bf80,0xbf0e3f6d,0xbf7f0000,0x3f753e48,0xbf22bf35,0x3ef13f55
.long 0xbf800000,0x3f800000,0xbf800000,0x3f800000,0xbf7f0000,0x3f75be48,0xbf223f35,0x3ef1bf55
.long 0xbf7b0000,0x3f55bec4,0x3e483f80,0xbf0ebf6d,0xbf750000,0x3f22bf0e,0x3f623f35,0xbf7fbe48
.long 0xbf6d0000,0x3ec4bf35,0x3f6d0000,0xbec43f35,0xbf620000,0x3dc9bf55,0x3e95bf35,0x3f223f7b
.long 0xbf550000,0xbe48bf6d,0xbf0ebf80,0x3f7b3ec4,0xbf460000,0xbef1bf7b,0xbf7fbf35,0x3e95bf0e
.long 0xbf350000,0xbf35bf80,0xbf350000,0xbf35bf80,0xbf220000,0xbf62bf7b,0x3dc93f35,0xbf75bf0e
.long 0xbf0e0000,0xbf7bbf6d,0x3f553f80,0xbe483ec4,0xbef10000,0xbf7fbf55,0x3f753f35,0x3f463f7b
.long 0xbec40000,0xbf6dbf35,0x3ec40000,0x3f6d3f35,0xbe950000,0xbf46bf0e,0xbef1bf35,0x3dc9be48
.long 0xbe480000,0xbf0ebec4,0xbf7bbf80,0xbf55bf6d,0xbdc90000,0xbe95be48,0xbf46bf35,0xbf62bf55
.long 0x0,0x0,0x0,0x0,0xbef13ec4,0xbf223f0e,0xbf753f6d,0xbf7f3f7b
.long 0xbf553f35,0xbf7b3f6d,0xbf0e3f35,0xbe483ec4,0xbf7f3f6d,0xbf623f7b,0x3f22bec4,0x3f75bf55
.long 0xbf6d3f80,0xbec43f35,0x3f6dbf80,0x3ec4bf35,0xbf223f6d,0x3e953e48,0xbdc9bec4,0xbf623f0e
.long 0xbe483f35,0x3f55bec4,0xbf7b3f35,0xbf0e3f6d,0x3e953ec4,0x3f7fbf55,0xbef13f6d,0x3f46be48
.long 0x3f350000,0x3f35bf80,0x3f350000,0x3f35bf80,0x3f75bec4,0x3dc9bf55,0x3f62bf6d,0xbf22be48
.long 0x3f7bbf35,0xbf0ebec4,0xbe48bf35,0xbf553f6d,0x3f46bf6d,0xbf753e48,0xbf7f3ec4,0x3ef13f0e
.long 0x3ec4bf80,0xbf6d3f35,0xbec43f80,0x3f6dbf35,0xbdc9bf6d,0xbef13f7b,0x3f463ec4,0xbe95bf55
.long 0xbf0ebf35,0x3e483f6d,0x3f55bf35,0xbf7b3ec4,0xbf62bec4,0x3f463f0e,0xbe95bf6d,0x3dc93f7b
.long 0xbf800000,0x3f800000,0xbf800000,0x3f800000,0xbf623ec4,0x3f46bf0e,0xbe953f6d,0x3dc9bf7b
.long 0xbf0e3f35,0x3e48bf6d,0x3f553f35,0xbf7bbec4,0xbdc93f6d,0xbef1bf7b,0x3f46bec4,0xbe953f55
.long 0x3ec43f80,0xbf6dbf35,0xbec4bf80,0x3f6d3f35,0x3f463f6d,0xbf75be48,0xbf7fbec4,0x3ef1bf0e
.long 0x3f7b3f35,0xbf0e3ec4,0xbe483f35,0xbf55bf6d,0x3f753ec4,0x3dc93f55,0x3f623f6d,0xbf223e48
.long 0x3f350000,0x3f353f80,0x3f350000,0x3f353f80,0x3e95bec4,0x3f7f3f55,0xbef1bf6d,0x3f463e48
.long 0xbe48bf35,0x3f553ec4,0xbf7bbf35,0xbf0ebf6d,0xbf22bf6d,0x3e95be48,0xbdc93ec4,0xbf62bf0e
.long 0xbf6dbf80,0xbec4bf35,0x3f6d3f80,0x3ec43f35,0xbf7fbf6d,0xbf62bf7b,0x3f223ec4,0x3f753f55
.long 0xbf55bf35,0xbf7bbf6d,0xbf0ebf35,0xbe48bec4,0xbef1bec4,0xbf22bf0e,0xbf75bf6d,0xbf7fbf7b
.long 0x80008000,0x80008000,0x80008000,0x80008000,0x3dc98000,0x3e95be48,0x3f46bf35,0x3f62bf55
.long 0x3e488000,0x3f0ebec4,0x3f7bbf80,0x3f55bf6d,0x3e958000,0x3f46bf0e,0x3ef1bf35,0xbdc9be48
.long 0x3ec48000,0x3f6dbf35,0xbec48000,0xbf6d3f35,0x3ef18000,0x3f7fbf55,0xbf753f35,0xbf463f7b
.long 0x3f0e8000,0x3f7bbf6d,0xbf553f80,0x3e483ec4,0x3f228000,0x3f62bf7b,0xbdc93f35,0x3f75bf0e
.long 0x3f358000,0x3f35bf80,0x3f358000,0x3f35bf80,0x3f468000,0x3ef1bf7b,0x3f7fbf35,0xbe95bf0e
.long 0x3f558000,0x3e48bf6d,0x3f0ebf80,0xbf7b3ec4,0x3f628000,0xbdc9bf55,0xbe95bf35,0xbf223f7b
.long 0x3f6d8000,0xbec4bf35,0xbf6d8000,0x3ec43f35,0x3f758000,0xbf22bf0e,0xbf623f35,0x3f7fbe48
.long 0x3f7b8000,0xbf55bec4,0xbe483f80,0x3f0ebf6d,0x3f7f8000,0xbf75be48,0x3f223f35,0xbef1bf55
.long 0x3f808000,0xbf808000,0x3f808000,0xbf808000,0x3f7f8000,0xbf753e48,0x3f22bf35,0xbef13f55
.long 0x3f7b8000,0xbf553ec4,0xbe48bf80,0x3f0e3f6d,0x3f758000,0xbf223f0e,0xbf62bf35,0x3f7f3e48
.long 0x3f6d8000,0xbec43f35,0xbf6d8000,0x3ec4bf35,0x3f628000,0xbdc93f55,0xbe953f35,0xbf22bf7b
.long 0x3f558000,0x3e483f6d,0x3f0e3f80,0xbf7bbec4,0x3f468000,0x3ef13f7b,0x3f7f3f35,0xbe953f0e
.long 0x3f358000,0x3f353f80,0x3f358000,0x3f353f80,0x3f228000,0x3f623f7b,0xbdc9bf35,0x3f753f0e
.long 0x3f0e8000,0x3f7b3f6d,0xbf55bf80,0x3e48bec4,0x3ef18000,0x3f7f3f55,0xbf75bf35,0xbf46bf7b
.long 0x3ec48000,0x3f6d3f35,0xbec48000,0xbf6dbf35,0x3e958000,0x3f463f0e,0x3ef13f35,0xbdc93e48
.long 0x3e488000,0x3f0e3ec4,0x3f7b3f80,0x3f553f6d,0x3dc98000,0x3e953e48,0x3f463f35,0x3f623f55
.long 0x80008000,0x80008000,0x80008000,0x80008000,0x3ef1bec4,0x3f22bf0e,0x3f75bf6d,0x3f7fbf7b
.long 0x3f55bf35,0x3f7bbf6d,0x3f0ebf35,0x3e48bec4,0x3f7fbf6d,0x3f62bf7b,0xbf223ec4,0xbf753f55
.long 0x3f6dbf80,0x3ec4bf35,0xbf6d3f80,0xbec43f35,0x3f22bf6d,0xbe95be48,0x3dc93ec4,0x3f62bf0e
.long 0x3e48bf35,0xbf553ec4,0x3f7bbf35,0x3f0ebf6d,0xbe95bec4,0xbf7f3f55,0x3ef1bf6d,0xbf463e48
.long 0xbf358000,0xbf353f80,0xbf358000,0xbf353f80,0xbf753ec4,0xbdc93f55,0xbf623f6d,0x3f223e48
.long 0xbf7b3f35,0x3f0e3ec4,0x3e483f35,0x3f55bf6d,0xbf463f6d,0x3f75be48,0x3f7fbec4,0xbef1bf0e
.long 0xbec43f80,0x3f6dbf35,0x3ec4bf80,0xbf6d3f35,0x3dc93f6d,0x3ef1bf7b,0xbf46bec4,0x3e953f55
.long 0x3f0e3f35,0xbe48bf6d,0xbf553f35,0x3f7bbec4,0x3f623ec4,0xbf46bf0e,0x3e953f6d,0xbdc9bf7b
.long 0x3f808000,0xbf808000,0x3f808000,0xbf808000,0x3f62bec4,0xbf463f0e,0x3e95bf6d,0xbdc93f7b
.long 0x3f0ebf35,0xbe483f6d,0xbf55bf35,0x3f7b3ec4,0x3dc9bf6d,0x3ef13f7b,0xbf463ec4,0x3e95bf55
.long 0xbec4bf80,0x3f6d3f35,0x3ec43f80,0xbf6dbf35,0xbf46bf6d,0x3f753e48,0x3f7f3ec4,0xbef13f0e
.long 0xbf7bbf35,0x3f0ebec4,0x3e48bf35,0x3f553f6d,0xbf75bec4,0xbdc9bf55,0xbf62bf6d,0x3f22be48
.long 0xbf358000,0xbf35bf80,0xbf358000,0xbf35bf80,0xbe953ec4,0xbf7fbf55,0x3ef13f6d,0xbf46be48
.long 0x3e483f35,0xbf55bec4,0x3f7b3f35,0x3f0e3f6d,0x3f223f6d,0xbe953e48,0x3dc9bec4,0x3f623f0e
.long 0x3f6d3f80,0x3ec43f35,0xbf6dbf80,0xbec4bf35,0x3f7f3f6d,0x3f623f7b,0xbf22bec4,0xbf75bf55
.long 0x3f553f35,0x3f7b3f6d,0x3f0e3f35,0x3e483ec4,0x3ef13ec4,0x3f223f0e,0x3f753f6d,0x3f7f3f7b
.long 0xbf803f80,0xbf803f80,0xbf803f80,0xbf803f80,0x3dc90000,0x3e95be48,0x3f46bf35,0x3f62bf55
.long 0x3f7bbf80,0x3f55bf6d,0xbe480000,0xbf0e3ec4,0xbe950000,0xbf463f0e,0xbef13f35,0x3dc93e48
.long 0xbf6d3f80,0xbec43f35,0x3f6dbf80,0x3ec4bf35,0x3ef10000,0x3f7fbf55,0xbf753f35,0xbf463f7b
.long 0x3f55bf80,0xbe48bec4,0x3f0e0000,0x3f7bbf6d,0xbf220000,0xbf623f7b,0x3dc9bf35,0xbf753f0e
.long 0xbf353f80,0x3f350000,0xbf353f80,0x3f350000,0x3f460000,0x3ef1bf7b,0x3f7fbf35,0xbe95bf0e
.long 0x3f0ebf80,0xbf7b3ec4,0xbf550000,0xbe483f6d,0xbf620000,0x3dc93f55,0x3e953f35,0x3f22bf7b
.long 0xbec43f80,0x3f6dbf35,0x3ec4bf80,0xbf6d3f35,0x3f750000,0xbf22bf0e,0xbf623f35,0x3f7fbe48
.long 0x3e48bf80,0xbf0e3f6d,0x3f7b0000,0xbf55bec4,0xbf7f0000,0x3f753e48,0xbf22bf35,0x3ef13f55
.long 0x3f80,0xbf80,0x3f80,0xbf80,0x3f7f0000,0xbf753e48,0x3f22bf35,0xbef13f55
.long 0xbe48bf80,0x3f0e3f6d,0xbf7b0000,0x3f55bec4,0xbf750000,0x3f22bf0e,0x3f623f35,0xbf7fbe48
.long 0x3ec43f80,0xbf6dbf35,0xbec4bf80,0x3f6d3f35,0x3f620000,0xbdc93f55,0xbe953f35,0xbf22bf7b
.long 0xbf0ebf80,0x3f7b3ec4,0x3f550000,0x3e483f6d,0xbf460000,0xbef1bf7b,0xbf7fbf35,0x3e95bf0e
.long 0x3f353f80,0xbf350000,0x3f353f80,0xbf350000,0x3f220000,0x3f623f7b,0xbdc9bf35,0x3f753f0e
.long 0xbf55bf80,0x3e48bec4,0xbf0e0000,0xbf7bbf6d,0xbef10000,0xbf7fbf55,0x3f753f35,0x3f463f7b
.long 0x3f6d3f80,0x3ec43f35,0xbf6dbf80,0xbec4bf35,0x3e950000,0x3f463f0e,0x3ef13f35,0xbdc93e48
.long 0xbf7bbf80,0xbf55bf6d,0x3e480000,0x3f0e3ec4,0xbdc90000,0xbe95be48,0xbf46bf35,0xbf62bf55
.long 0xbf803f80,0xbf803f80,0xbf803f80,0xbf803f80,0x3ef1bec4,0x3f22bf0e,0x3f75bf6d,0x3f7fbf7b
.long 0x3f0ebf35,0x3e48bec4,0xbf553f35,0xbf7b3f6d,0xbf7f3f6d,0xbf623f7b,0x3f22bec4,0x3f75bf55
.long 0x3ec40000,0x3f6dbf35,0xbec40000,0xbf6d3f35,0x3f22bf6d,0xbe95be48,0x3dc93ec4,0x3f62bf0e
.long 0xbf7b3f35,0xbf0e3f6d,0x3e48bf35,0xbf553ec4,0x3e953ec4,0x3f7fbf55,0xbef13f6d,0x3f46be48
.long 0x3f35bf80,0xbf350000,0x3f35bf80,0xbf350000,0xbf753ec4,0xbdc93f55,0xbf623f6d,0x3f223e48
.long 0x3e483f35,0x3f55bf6d,0x3f7bbf35,0xbf0ebec4,0x3f46bf6d,0xbf753e48,0xbf7f3ec4,0x3ef13f0e
.long 0xbf6d0000,0x3ec43f35,0x3f6d0000,0xbec4bf35,0x3dc93f6d,0x3ef1bf7b,0xbf46bec4,0x3e953f55
.long 0x3f55bf35,0xbf7b3ec4,0x3f0e3f35,0xbe48bf6d,0xbf62bec4,0x3f463f0e,0xbe95bf6d,0x3dc93f7b
.long 0x3f80,0xbf80,0x3f80,0xbf80,0x3f62bec4,0xbf463f0e,0x3e95bf6d,0xbdc93f7b
.long 0xbf55bf35,0x3f7b3ec4,0xbf0e3f35,0x3e48bf6d,0xbdc93f6d,0xbef1bf7b,0x3f46bec4,0xbe953f55
.long 0x3f6d0000,0xbec43f35,0xbf6d0000,0x3ec4bf35,0xbf46bf6d,0x3f753e48,0x3f7f3ec4,0xbef13f0e
.long 0xbe483f35,0xbf55bf6d,0xbf7bbf35,0x3f0ebec4,0x3f753ec4,0x3dc93f55,0x3f623f6d,0xbf223e48
.long 0xbf35bf80,0x3f350000,0xbf35bf80,0x3f350000,0xbe953ec4,0xbf7fbf55,0x3ef13f6d,0xbf46be48
.long 0x3f7b3f35,0x3f0e3f6d,0xbe48bf35,0x3f553ec4,0xbf22bf6d,0x3e95be48,0xbdc93ec4,0xbf62bf0e
.long 0xbec40000,0xbf6dbf35,0x3ec40000,0x3f6d3f35,0x3f7f3f6d,0x3f623f7b,0xbf22bec4,0xbf75bf55
.long 0xbf0ebf35,0xbe48bec4,0x3f553f35,0x3f7b3f6d,0xbef1bec4,0xbf22bf0e,0xbf75bf6d,0xbf7fbf7b
.long 0x0,0x0,0x0,0x0,0xbf7f3f80,0xbf753f7b,0xbf223f35,0xbef13f0e
.long 0x3e480000,0x3f0ebec4,0x3f7bbf80,0x3f55bf6d,0x3f75bf80,0x3f22bf55,0xbf623f35,0xbf7f3f7b
.long 0xbec40000,0xbf6d3f35,0x3ec40000,0x3f6dbf35,0xbf623f80,0xbdc93f0e,0x3e95bf35,0xbf223e48
.long 0x3f0e0000,0x3f7bbf6d,0xbf553f80,0x3e483ec4,0x3f46bf80,0xbef1be48,0x3f7fbf35,0x3e95bf55
.long 0xbf350000,0xbf353f80,0xbf350000,0xbf353f80,0xbf223f80,0x3f62be48,0x3dc93f35,0x3f75bf55
.long 0x3f550000,0x3e48bf6d,0x3f0ebf80,0xbf7b3ec4,0x3ef1bf80,0xbf7f3f0e,0xbf753f35,0x3f463e48
.long 0xbf6d0000,0x3ec43f35,0x3f6d0000,0xbec4bf35,0xbe953f80,0x3f46bf55,0xbef1bf35,0xbdc93f7b
.long 0x3f7b0000,0xbf55bec4,0xbe483f80,0x3f0ebf6d,0x3dc9bf80,0xbe953f7b,0x3f46bf35,0xbf623f0e
.long 0xbf800000,0x3f800000,0xbf800000,0x3f800000,0x3dc93f80,0xbe95bf7b,0x3f463f35,0xbf62bf0e
.long 0x3f7b0000,0xbf553ec4,0xbe48bf80,0x3f0e3f6d,0xbe95bf80,0x3f463f55,0xbef13f35,0xbdc9bf7b
.long 0xbf6d0000,0x3ec4bf35,0x3f6d0000,0xbec43f35,0x3ef13f80,0xbf7fbf0e,0xbf75bf35,0x3f46be48
.long 0x3f550000,0x3e483f6d,0x3f0e3f80,0xbf7bbec4,0xbf22bf80,0x3f623e48,0x3dc9bf35,0x3f753f55
.long 0xbf350000,0xbf35bf80,0xbf350000,0xbf35bf80,0x3f463f80,0xbef13e48,0x3f7f3f35,0x3e953f55
.long 0x3f0e0000,0x3f7b3f6d,0xbf55bf80,0x3e48bec4,0xbf62bf80,0xbdc9bf0e,0x3e953f35,0xbf22be48
.long 0xbec40000,0xbf6dbf35,0x3ec40000,0x3f6d3f35,0x3f753f80,0x3f223f55,0xbf62bf35,0xbf7fbf7b
.long 0x3e480000,0x3f0e3ec4,0x3f7b3f80,0x3f553f6d,0xbf7fbf80,0xbf75bf7b,0xbf22bf35,0xbef1bf0e
.long 0x0,0x0,0x0,0x0,0xbf623f6d,0xbf463f55,0xbe953ec4,0xbdc93e48
.long 0x3f55bf35,0x3f7bbf6d,0x3f0ebf35,0x3e48bec4,0x3dc9bec4,0xbef13e48,0xbf463f6d,0xbe953f0e
.long 0xbf6d3f80,0xbec43f35,0x3f6dbf80,0x3ec4bf35,0x3f46bec4,0x3f75bf7b,0xbf7f3f6d,0xbef13f55
.long 0x3e48bf35,0xbf553ec4,0x3f7bbf35,0x3f0ebf6d,0xbf753f6d,0x3dc93f0e,0xbf623ec4,0xbf223f7b
.long 0x3f350000,0x3f35bf80,0x3f350000,0x3f35bf80,0x3e95bf6d,0xbf7f3f0e,0xbef1bec4,0xbf463f7b
.long 0xbf7b3f35,0x3f0e3ec4,0x3e483f35,0x3f55bf6d,0x3f223ec4,0x3e95bf7b,0x3dc9bf6d,0xbf623f55
.long 0x3ec4bf80,0xbf6d3f35,0xbec43f80,0x3f6dbf35,0xbf7f3ec4,0x3f623e48,0x3f22bf6d,0xbf753f0e
.long 0x3f0e3f35,0xbe48bf6d,0xbf553f35,0x3f7bbec4,0x3ef1bf6d,0xbf223f55,0x3f75bec4,0xbf7f3e48
.long 0xbf800000,0x3f800000,0xbf800000,0x3f800000,0x3ef13f6d,0xbf22bf55,0x3f753ec4,0xbf7fbe48
.long 0x3f0ebf35,0xbe483f6d,0xbf55bf35,0x3f7b3ec4,0xbf7fbec4,0x3f62be48,0x3f223f6d,0xbf75bf0e
.long 0x3ec43f80,0xbf6dbf35,0xbec4bf80,0x3f6d3f35,0x3f22bec4,0x3e953f7b,0x3dc93f6d,0xbf62bf55
.long 0xbf7bbf35,0x3f0ebec4,0x3e48bf35,0x3f553f6d,0x3e953f6d,0xbf7fbf0e,0xbef13ec4,0xbf46bf7b
.long 0x3f350000,0x3f353f80,0x3f350000,0x3f353f80,0xbf75bf6d,0x3dc9bf0e,0xbf62bec4,0xbf22bf7b
.long 0x3e483f35,0xbf55bec4,0x3f7b3f35,0x3f0e3f6d,0x3f463ec4,0x3f753f7b,0xbf7fbf6d,0xbef1bf55
.long 0xbf6dbf80,0xbec4bf35,0x3f6d3f80,0x3ec43f35,0x3dc93ec4,0xbef1be48,0xbf46bf6d,0xbe95bf0e
.long 0x3f553f35,0x3f7b3f6d,0x3f0e3f35,0x3e483ec4,0xbf62bf6d,0xbf46bf55,0xbe95bec4,0xbdc9be48
.long 0x80008000,0x80008000,0x80008000,0x80008000,0x3f7fbf80,0x3f75bf7b,0x3f22bf35,0x3ef1bf0e
.long 0xbe488000,0xbf0e3ec4,0xbf7b3f80,0xbf553f6d,0xbf753f80,0xbf223f55,0x3f62bf35,0x3f7fbf7b
.long 0x3ec48000,0x3f6dbf35,0xbec48000,0xbf6d3f35,0x3f62bf80,0x3dc9bf0e,0xbe953f35,0x3f22be48
.long 0xbf0e8000,0xbf7b3f6d,0x3f55bf80,0xbe48bec4,0xbf463f80,0x3ef13e48,0xbf7f3f35,0xbe953f55
.long 0x3f358000,0x3f35bf80,0x3f358000,0x3f35bf80,0x3f22bf80,0xbf623e48,0xbdc9bf35,0xbf753f55
.long 0xbf558000,0xbe483f6d,0xbf0e3f80,0x3f7bbec4,0xbef13f80,0x3f7fbf0e,0x3f75bf35,0xbf46be48
.long 0x3f6d8000,0xbec4bf35,0xbf6d8000,0x3ec43f35,0x3e95bf80,0xbf463f55,0x3ef13f35,0x3dc9bf7b
.long 0xbf7b8000,0x3f553ec4,0x3e48bf80,0xbf0e3f6d,0xbdc93f80,0x3e95bf7b,0xbf463f35,0x3f62bf0e
.long 0x3f808000,0xbf808000,0x3f808000,0xbf808000,0xbdc9bf80,0x3e953f7b,0xbf46bf35,0x3f623f0e
.long 0xbf7b8000,0x3f55bec4,0x3e483f80,0xbf0ebf6d,0x3e953f80,0xbf46bf55,0x3ef1bf35,0x3dc93f7b
.long 0x3f6d8000,0xbec43f35,0xbf6d8000,0x3ec4bf35,0xbef1bf80,0x3f7f3f0e,0x3f753f35,0xbf463e48
.long 0xbf558000,0xbe48bf6d,0xbf0ebf80,0x3f7b3ec4,0x3f223f80,0xbf62be48,0xbdc93f35,0xbf75bf55
.long 0x3f358000,0x3f353f80,0x3f358000,0x3f353f80,0xbf46bf80,0x3ef1be48,0xbf7fbf35,0xbe95bf55
.long 0xbf0e8000,0xbf7bbf6d,0x3f553f80,0xbe483ec4,0x3f623f80,0x3dc93f0e,0xbe95bf35,0x3f223e48
.long 0x3ec48000,0x3f6d3f35,0xbec48000,0xbf6dbf35,0xbf75bf80,0xbf22bf55,0x3f623f35,0x3f7f3f7b
.long 0xbe488000,0xbf0ebec4,0xbf7bbf80,0xbf55bf6d,0x3f7f3f80,0x3f753f7b,0x3f223f35,0x3ef13f0e
.long 0x80008000,0x80008000,0x80008000,0x80008000,0x3f62bf6d,0x3f46bf55,0x3e95bec4,0x3dc9be48
.long 0xbf553f35,0xbf7b3f6d,0xbf0e3f35,0xbe483ec4,0xbdc93ec4,0x3ef1be48,0x3f46bf6d,0x3e95bf0e
.long 0x3f6dbf80,0x3ec4bf35,0xbf6d3f80,0xbec43f35,0xbf463ec4,0xbf753f7b,0x3f7fbf6d,0x3ef1bf55
.long 0xbe483f35,0x3f55bec4,0xbf7b3f35,0xbf0e3f6d,0x3f75bf6d,0xbdc9bf0e,0x3f62bec4,0x3f22bf7b
.long 0xbf358000,0xbf353f80,0xbf358000,0xbf353f80,0xbe953f6d,0x3f7fbf0e,0x3ef13ec4,0x3f46bf7b
.long 0x3f7bbf35,0xbf0ebec4,0xbe48bf35,0xbf553f6d,0xbf22bec4,0xbe953f7b,0xbdc93f6d,0x3f62bf55
.long 0xbec43f80,0x3f6dbf35,0x3ec4bf80,0xbf6d3f35,0x3f7fbec4,0xbf62be48,0xbf223f6d,0x3f75bf0e
.long 0xbf0ebf35,0x3e483f6d,0x3f55bf35,0xbf7b3ec4,0xbef13f6d,0x3f22bf55,0xbf753ec4,0x3f7fbe48
.long 0x3f808000,0xbf808000,0x3f808000,0xbf808000,0xbef1bf6d,0x3f223f55,0xbf75bec4,0x3f7f3e48
.long 0xbf0e3f35,0x3e48bf6d,0x3f553f35,0xbf7bbec4,0x3f7f3ec4,0xbf623e48,0xbf22bf6d,0x3f753f0e
.long 0xbec4bf80,0x3f6d3f35,0x3ec43f80,0xbf6dbf35,0xbf223ec4,0xbe95bf7b,0xbdc9bf6d,0x3f623f55
.long 0x3f7b3f35,0xbf0e3ec4,0xbe483f35,0xbf55bf6d,0xbe95bf6d,0x3f7f3f0e,0x3ef1bec4,0x3f463f7b
.long 0xbf358000,0xbf35bf80,0xbf358000,0xbf35bf80,0x3f753f6d,0xbdc93f0e,0x3f623ec4,0x3f223f7b
.long 0xbe48bf35,0x3f553ec4,0xbf7bbf35,0xbf0ebf6d,0xbf46bec4,0xbf75bf7b,0x3f7f3f6d,0x3ef13f55
.long 0x3f6d3f80,0x3ec43f35,0xbf6dbf80,0xbec4bf35,0xbdc9bec4,0x3ef13e48,0x3f463f6d,0x3e953f0e
.long 0xbf55bf35,0xbf7bbf6d,0xbf0ebf35,0xbe48bec4,0x3f623f6d,0x3f463f55,0x3e953ec4,0x3dc93e48
.long 0xbf803f80,0xbf803f80,0xbf803f80,0xbf803f80,0x3f7fbf80,0x3f75bf7b,0x3f22bf35,0x3ef1bf0e
.long 0xbf7b3f80,0xbf553f6d,0x3e480000,0x3f0ebec4,0x3f75bf80,0x3f22bf55,0xbf623f35,0xbf7f3f7b
.long 0xbf6d3f80,0xbec43f35,0x3f6dbf80,0x3ec4bf35,0x3f62bf80,0x3dc9bf0e,0xbe953f35,0x3f22be48
.long 0xbf553f80,0x3e483ec4,0xbf0e0000,0xbf7b3f6d,0x3f46bf80,0xbef1be48,0x3f7fbf35,0x3e95bf55
.long 0xbf353f80,0x3f350000,0xbf353f80,0x3f350000,0x3f22bf80,0xbf623e48,0xbdc9bf35,0xbf753f55
.long 0xbf0e3f80,0x3f7bbec4,0x3f550000,0x3e48bf6d,0x3ef1bf80,0xbf7f3f0e,0xbf753f35,0x3f463e48
.long 0xbec43f80,0x3f6dbf35,0x3ec4bf80,0xbf6d3f35,0x3e95bf80,0xbf463f55,0x3ef13f35,0x3dc9bf7b
.long 0xbe483f80,0x3f0ebf6d,0xbf7b0000,0x3f553ec4,0x3dc9bf80,0xbe953f7b,0x3f46bf35,0xbf623f0e
.long 0x3f80,0xbf80,0x3f80,0xbf80,0xbdc9bf80,0x3e953f7b,0xbf46bf35,0x3f623f0e
.long 0x3e483f80,0xbf0ebf6d,0x3f7b0000,0xbf553ec4,0xbe95bf80,0x3f463f55,0xbef13f35,0xbdc9bf7b
.long 0x3ec43f80,0xbf6dbf35,0xbec4bf80,0x3f6d3f35,0xbef1bf80,0x3f7f3f0e,0x3f753f35,0xbf463e48
.long 0x3f0e3f80,0xbf7bbec4,0xbf550000,0xbe48bf6d,0xbf22bf80,0x3f623e48,0x3dc9bf35,0x3f753f55
.long 0x3f353f80,0xbf350000,0x3f353f80,0xbf350000,0xbf46bf80,0x3ef1be48,0xbf7fbf35,0xbe95bf55
.long 0x3f553f80,0xbe483ec4,0x3f0e0000,0x3f7b3f6d,0xbf62bf80,0xbdc9bf0e,0x3e953f35,0xbf22be48
.long 0x3f6d3f80,0x3ec43f35,0xbf6dbf80,0xbec4bf35,0xbf75bf80,0xbf22bf55,0x3f623f35,0x3f7f3f7b
.long 0x3f7b3f80,0x3f553f6d,0xbe480000,0xbf0ebec4,0xbf7fbf80,0xbf75bf7b,0xbf22bf35,0xbef1bf0e
.long 0xbf803f80,0xbf803f80,0xbf803f80,0xbf803f80,0x3f62bf6d,0x3f46bf55,0x3e95bec4,0x3dc9be48
.long 0xbf0e3f35,0xbe483ec4,0x3f55bf35,0x3f7bbf6d,0x3dc9bec4,0xbef13e48,0xbf463f6d,0xbe953f0e
.long 0x3ec40000,0x3f6dbf35,0xbec40000,0xbf6d3f35,0xbf463ec4,0xbf753f7b,0x3f7fbf6d,0x3ef1bf55
.long 0x3f7bbf35,0x3f0ebf6d,0xbe483f35,0x3f55bec4,0xbf753f6d,0x3dc93f0e,0xbf623ec4,0xbf223f7b
.long 0x3f35bf80,0xbf350000,0x3f35bf80,0xbf350000,0xbe953f6d,0x3f7fbf0e,0x3ef13ec4,0x3f46bf7b
.long 0xbe48bf35,0xbf553f6d,0xbf7b3f35,0x3f0e3ec4,0x3f223ec4,0x3e95bf7b,0x3dc9bf6d,0xbf623f55
.long 0xbf6d0000,0x3ec43f35,0x3f6d0000,0xbec4bf35,0x3f7fbec4,0xbf62be48,0xbf223f6d,0x3f75bf0e
.long 0xbf553f35,0x3f7bbec4,0xbf0ebf35,0x3e483f6d,0x3ef1bf6d,0xbf223f55,0x3f75bec4,0xbf7f3e48
.long 0x3f80,0xbf80,0x3f80,0xbf80,0xbef1bf6d,0x3f223f55,0xbf75bec4,0x3f7f3e48
.long 0x3f553f35,0xbf7bbec4,0x3f0ebf35,0xbe483f6d,0xbf7fbec4,0x3f62be48,0x3f223f6d,0xbf75bf0e
.long 0x3f6d0000,0xbec43f35,0xbf6d0000,0x3ec4bf35,0xbf223ec4,0xbe95bf7b,0xbdc9bf6d,0x3f623f55
.long 0x3e48bf35,0x3f553f6d,0x3f7b3f35,0xbf0e3ec4,0x3e953f6d,0xbf7fbf0e,0xbef13ec4,0xbf46bf7b
.long 0xbf35bf80,0x3f350000,0xbf35bf80,0x3f350000,0x3f753f6d,0xbdc93f0e,0x3f623ec4,0x3f223f7b
.long 0xbf7bbf35,0xbf0ebf6d,0x3e483f35,0xbf55bec4,0x3f463ec4,0x3f753f7b,0xbf7fbf6d,0xbef1bf55
.long 0xbec40000,0xbf6dbf35,0x3ec40000,0x3f6d3f35,0xbdc9bec4,0x3ef13e48,0x3f463f6d,0x3e953f0e
.long 0x3f0e3f35,0x3e483ec4,0xbf55bf35,0xbf7bbf6d,0xbf62bf6d,0xbf46bf55,0xbe95bec4,0xbdc9be48
.long 0x0,0x0,0x0,0x0,0x3dc90000,0x3e95be48,0x3f46bf35,0x3f62bf55
.long 0xbe480000,0xbf0e3ec4,0xbf7b3f80,0xbf553f6d,0x3e950000,0x3f46bf0e,0x3ef1bf35,0xbdc9be48
.long 0xbec40000,0xbf6d3f35,0x3ec40000,0x3f6dbf35,0x3ef10000,0x3f7fbf55,0xbf753f35,0xbf463f7b
.long 0xbf0e0000,0xbf7b3f6d,0x3f55bf80,0xbe48bec4,0x3f220000,0x3f62bf7b,0xbdc93f35,0x3f75bf0e
.long 0xbf350000,0xbf353f80,0xbf350000,0xbf353f80,0x3f460000,0x3ef1bf7b,0x3f7fbf35,0xbe95bf0e
.long 0xbf550000,0xbe483f6d,0xbf0e3f80,0x3f7bbec4,0x3f620000,0xbdc9bf55,0xbe95bf35,0xbf223f7b
.long 0xbf6d0000,0x3ec43f35,0x3f6d0000,0xbec4bf35,0x3f750000,0xbf22bf0e,0xbf623f35,0x3f7fbe48
.long 0xbf7b0000,0x3f553ec4,0x3e48bf80,0xbf0e3f6d,0x3f7f0000,0xbf75be48,0x3f223f35,0xbef1bf55
.long 0xbf800000,0x3f800000,0xbf800000,0x3f800000,0x3f7f0000,0xbf753e48,0x3f22bf35,0xbef13f55
.long 0xbf7b0000,0x3f55bec4,0x3e483f80,0xbf0ebf6d,0x3f750000,0xbf223f0e,0xbf62bf35,0x3f7f3e48
.long 0xbf6d0000,0x3ec4bf35,0x3f6d0000,0xbec43f35,0x3f620000,0xbdc93f55,0xbe953f35,0xbf22bf7b
.long 0xbf550000,0xbe48bf6d,0xbf0ebf80,0x3f7b3ec4,0x3f460000,0x3ef13f7b,0x3f7f3f35,0xbe953f0e
.long 0xbf350000,0xbf35bf80,0xbf350000,0xbf35bf80,0x3f220000,0x3f623f7b,0xbdc9bf35,0x3f753f0e
.long 0xbf0e0000,0xbf7bbf6d,0x3f553f80,0xbe483ec4,0x3ef10000,0x3f7f3f55,0xbf75bf35,0xbf46bf7b
.long 0xbec40000,0xbf6dbf35,0x3ec40000,0x3f6d3f35,0x3e950000,0x3f463f0e,0x3ef13f35,0xbdc93e48
.long 0xbe480000,0xbf0ebec4,0xbf7bbf80,0xbf55bf6d,0x3dc90000,0x3e953e48,0x3f463f35,0x3f623f55
.long 0x0,0x0,0x0,0x0,0x3ef1bec4,0x3f22bf0e,0x3f75bf6d,0x3f7fbf7b
.long 0xbf553f35,0xbf7b3f6d,0xbf0e3f35,0xbe483ec4,0x3f7fbf6d,0x3f62bf7b,0xbf223ec4,0xbf753f55
.long 0xbf6d3f80,0xbec43f35,0x3f6dbf80,0x3ec4bf35,0x3f22bf6d,0xbe95be48,0x3dc93ec4,0x3f62bf0e
.long 0xbe483f35,0x3f55bec4,0xbf7b3f35,0xbf0e3f6d,0xbe95bec4,0xbf7f3f55,0x3ef1bf6d,0xbf463e48
.long 0x3f350000,0x3f35bf80,0x3f350000,0x3f35bf80,0xbf753ec4,0xbdc93f55,0xbf623f6d,0x3f223e48
.long 0x3f7bbf35,0xbf0ebec4,0xbe48bf35,0xbf553f6d,0xbf463f6d,0x3f75be48,0x3f7fbec4,0xbef1bf0e
.long 0x3ec4bf80,0xbf6d3f35,0xbec43f80,0x3f6dbf35,0x3dc93f6d,0x3ef1bf7b,0xbf46bec4,0x3e953f55
.long 0xbf0ebf35,0x3e483f6d,0x3f55bf35,0xbf7b3ec4,0x3f623ec4,0xbf46bf0e,0x3e953f6d,0xbdc9bf7b
.long 0xbf800000,0x3f800000,0xbf800000,0x3f800000,0x3f62bec4,0xbf463f0e,0x3e95bf6d,0xbdc93f7b
.long 0xbf0e3f35,0x3e48bf6d,0x3f553f35,0xbf7bbec4,0x3dc9bf6d,0x3ef13f7b,0xbf463ec4,0x3e95bf55
.long 0x3ec43f80,0xbf6dbf35,0xbec4bf80,0x3f6d3f35,0xbf46bf6d,0x3f753e48,0x3f7f3ec4,0xbef13f0e
.long 0x3f7b3f35,0xbf0e3ec4,0xbe483f35,0xbf55bf6d,0xbf75bec4,0xbdc9bf55,0xbf62bf6d,0x3f22be48
.long 0x3f350000,0x3f353f80,0x3f350000,0x3f353f80,0xbe953ec4,0xbf7fbf55,0x3ef13f6d,0xbf46be48
.long 0xbe48bf35,0x3f553ec4,0xbf7bbf35,0xbf0ebf6d,0x3f223f6d,0xbe953e48,0x3dc9bec4,0x3f623f0e
.long 0xbf6dbf80,0xbec4bf35,0x3f6d3f80,0x3ec43f35,0x3f7f3f6d,0x3f623f7b,0xbf22bec4,0xbf75bf55
.long 0xbf55bf35,0xbf7bbf6d,0xbf0ebf35,0xbe48bec4,0x3ef13ec4,0x3f223f0e,0x3f753f6d,0x3f7f3f7b
.long 0x80008000,0x80008000,0x80008000,0x80008000,0xbdc98000,0xbe953e48,0xbf463f35,0xbf623f55
.long 0x3e488000,0x3f0ebec4,0x3f7bbf80,0x3f55bf6d,0xbe958000,0xbf463f0e,0xbef13f35,0x3dc93e48
.long 0x3ec48000,0x3f6dbf35,0xbec48000,0xbf6d3f35,0xbef18000,0xbf7f3f55,0x3f75bf35,0x3f46bf7b
.long 0x3f0e8000,0x3f7bbf6d,0xbf553f80,0x3e483ec4,0xbf228000,0xbf623f7b,0x3dc9bf35,0xbf753f0e
.long 0x3f358000,0x3f35bf80,0x3f358000,0x3f35bf80,0xbf468000,0xbef13f7b,0xbf7f3f35,0x3e953f0e
.long 0x3f558000,0x3e48bf6d,0x3f0ebf80,0xbf7b3ec4,0xbf628000,0x3dc93f55,0x3e953f35,0x3f22bf7b
.long 0x3f6d8000,0xbec4bf35,0xbf6d8000,0x3ec43f35,0xbf758000,0x3f223f0e,0x3f62bf35,0xbf7f3e48
.long 0x3f7b8000,0xbf55bec4,0xbe483f80,0x3f0ebf6d,0xbf7f8000,0x3f753e48,0xbf22bf35,0x3ef13f55
.long 0x3f808000,0xbf808000,0x3f808000,0xbf808000,0xbf7f8000,0x3f75be48,0xbf223f35,0x3ef1bf55
.long 0x3f7b8000,0xbf553ec4,0xbe48bf80,0x3f0e3f6d,0xbf758000,0x3f22bf0e,0x3f623f35,0xbf7fbe48
.long 0x3f6d8000,0xbec43f35,0xbf6d8000,0x3ec4bf35,0xbf628000,0x3dc9bf55,0x3e95bf35,0x3f223f7b
.long 0x3f558000,0x3e483f6d,0x3f0e3f80,0xbf7bbec4,0xbf468000,0xbef1bf7b,0xbf7fbf35,0x3e95bf0e
.long 0x3f358000,0x3f353f80,0x3f358000,0x3f353f80,0xbf228000,0xbf62bf7b,0x3dc93f35,0xbf75bf0e
.long 0x3f0e8000,0x3f7b3f6d,0xbf55bf80,0x3e48bec4,0xbef18000,0xbf7fbf55,0x3f753f35,0x3f463f7b
.long 0x3ec48000,0x3f6d3f35,0xbec48000,0xbf6dbf35,0xbe958000,0xbf46bf0e,0xbef1bf35,0x3dc9be48
.long 0x3e488000,0x3f0e3ec4,0x3f7b3f80,0x3f553f6d,0xbdc98000,0xbe95be48,0xbf46bf35,0xbf62bf55
.long 0x80008000,0x80008000,0x80008000,0x80008000,0xbef13ec4,0xbf223f0e,0xbf753f6d,0xbf7f3f7b
.long 0x3f55bf35,0x3f7bbf6d,0x3f0ebf35,0x3e48bec4,0xbf7f3f6d,0xbf623f7b,0x3f22bec4,0x3f75bf55
.long 0x3f6dbf80,0x3ec4bf35,0xbf6d3f80,0xbec43f35,0xbf223f6d,0x3e953e48,0xbdc9bec4,0xbf623f0e
.long 0x3e48bf35,0xbf553ec4,0x3f7bbf35,0x3f0ebf6d,0x3e953ec4,0x3f7fbf55,0xbef13f6d,0x3f46be48
.long 0xbf358000,0xbf353f80,0xbf358000,0xbf353f80,0x3f75bec4,0x3dc9bf55,0x3f62bf6d,0xbf22be48
.long 0xbf7b3f35,0x3f0e3ec4,0x3e483f35,0x3f55bf6d,0x3f46bf6d,0xbf753e48,0xbf7f3ec4,0x3ef13f0e
.long 0xbec43f80,0x3f6dbf35,0x3ec4bf80,0xbf6d3f35,0xbdc9bf6d,0xbef13f7b,0x3f463ec4,0xbe95bf55
.long 0x3f0e3f35,0xbe48bf6d,0xbf553f35,0x3f7bbec4,0xbf62bec4,0x3f463f0e,0xbe95bf6d,0x3dc93f7b
.long 0x3f808000,0xbf808000,0x3f808000,0xbf808000,0xbf623ec4,0x3f46bf0e,0xbe953f6d,0x3dc9bf7b
.long 0x3f0ebf35,0xbe483f6d,0xbf55bf35,0x3f7b3ec4,0xbdc93f6d,0xbef1bf7b,0x3f46bec4,0xbe953f55
.long 0xbec4bf80,0x3f6d3f35,0x3ec43f80,0xbf6dbf35,0x3f463f6d,0xbf75be48,0xbf7fbec4,0x3ef1bf0e
.long 0xbf7bbf35,0x3f0ebec4,0x3e48bf35,0x3f553f6d,0x3f753ec4,0x3dc93f55,0x3f623f6d,0xbf223e48
.long 0xbf358000,0xbf35bf80,0xbf358000,0xbf35bf80,0x3e95bec4,0x3f7f3f55,0xbef1bf6d,0x3f463e48
.long 0x3e483f35,0xbf55bec4,0x3f7b3f35,0x3f0e3f6d,0xbf22bf6d,0x3e95be48,0xbdc93ec4,0xbf62bf0e
.long 0x3f6d3f80,0x3ec43f35,0xbf6dbf80,0xbec4bf35,0xbf7fbf6d,0xbf62bf7b,0x3f223ec4,0x3f753f55
.long 0x3f553f35,0x3f7b3f6d,0x3f0e3f35,0x3e483ec4,0xbef1bec4,0xbf22bf0e,0xbf75bf6d,0xbf7fbf7b
.long 0xbf803f80,0xbf803f80,0xbf803f80,0xbf803f80,0xbdc90000,0xbe953e48,0xbf463f35,0xbf623f55
.long 0x3f7bbf80,0x3f55bf6d,0xbe480000,0xbf0e3ec4,0x3e950000,0x3f46bf0e,0x3ef1bf35,0xbdc9be48
.long 0xbf6d3f80,0xbec43f35,0x3f6dbf80,0x3ec4bf35,0xbef10000,0xbf7f3f55,0x3f75bf35,0x3f46bf7b
.long 0x3f55bf80,0xbe48bec4,0x3f0e0000,0x3f7bbf6d,0x3f220000,0x3f62bf7b,0xbdc93f35,0x3f75bf0e
.long 0xbf353f80,0x3f350000,0xbf353f80,0x3f350000,0xbf460000,0xbef13f7b,0xbf7f3f35,0x3e953f0e
.long 0x3f0ebf80,0xbf7b3ec4,0xbf550000,0xbe483f6d,0x3f620000,0xbdc9bf55,0xbe95bf35,0xbf223f7b
.long 0xbec43f80,0x3f6dbf35,0x3ec4bf80,0xbf6d3f35,0xbf750000,0x3f223f0e,0x3f62bf35,0xbf7f3e48
.long 0x3e48bf80,0xbf0e3f6d,0x3f7b0000,0xbf55bec4,0x3f7f0000,0xbf75be48,0x3f223f35,0xbef1bf55
.long 0x3f80,0xbf80,0x3f80,0xbf80,0xbf7f0000,0x3f75be48,0xbf223f35,0x3ef1bf55
.long 0xbe48bf80,0x3f0e3f6d,0xbf7b0000,0x3f55bec4,0x3f750000,0xbf223f0e,0xbf62bf35,0x3f7f3e48
.long 0x3ec43f80,0xbf6dbf35,0xbec4bf80,0x3f6d3f35,0xbf620000,0x3dc9bf55,0x3e95bf35,0x3f223f7b
.long 0xbf0ebf80,0x3f7b3ec4,0x3f550000,0x3e483f6d,0x3f460000,0x3ef13f7b,0x3f7f3f35,0xbe953f0e
.long 0x3f353f80,0xbf350000,0x3f353f80,0xbf350000,0xbf220000,0xbf62bf7b,0x3dc93f35,0xbf75bf0e
.long 0xbf55bf80,0x3e48bec4,0xbf0e0000,0xbf7bbf6d,0x3ef10000,0x3f7f3f55,0xbf75bf35,0xbf46bf7b
.long 0x3f6d3f80,0x3ec43f35,0xbf6dbf80,0xbec4bf35,0xbe950000,0xbf46bf0e,0xbef1bf35,0x3dc9be48
.long 0xbf7bbf80,0xbf55bf6d,0x3e480000,0x3f0e3ec4,0x3dc90000,0x3e953e48,0x3f463f35,0x3f623f55
.long 0xbf803f80,0xbf803f80,0xbf803f80,0xbf803f80,0xbef13ec4,0xbf223f0e,0xbf753f6d,0xbf7f3f7b
.long 0x3f0ebf35,0x3e48bec4,0xbf553f35,0xbf7b3f6d,0x3f7fbf6d,0x3f62bf7b,0xbf223ec4,0xbf753f55
.long 0x3ec40000,0x3f6dbf35,0xbec40000,0xbf6d3f35,0xbf223f6d,0x3e953e48,0xbdc9bec4,0xbf623f0e
.long 0xbf7b3f35,0xbf0e3f6d,0x3e48bf35,0xbf553ec4,0xbe95bec4,0xbf7f3f55,0x3ef1bf6d,0xbf463e48
.long 0x3f35bf80,0xbf350000,0x3f35bf80,0xbf350000,0x3f75bec4,0x3dc9bf55,0x3f62bf6d,0xbf22be48
.long 0x3e483f35,0x3f55bf6d,0x3f7bbf35,0xbf0ebec4,0xbf463f6d,0x3f75be48,0x3f7fbec4,0xbef1bf0e
.long 0xbf6d0000,0x3ec43f35,0x3f6d0000,0xbec4bf35,0xbdc9bf6d,0xbef13f7b,0x3f463ec4,0xbe95bf55
.long 0x3f55bf35,0xbf7b3ec4,0x3f0e3f35,0xbe48bf6d,0x3f623ec4,0xbf46bf0e,0x3e953f6d,0xbdc9bf7b
.long 0x3f80,0xbf80,0x3f80,0xbf80,0xbf623ec4,0x3f46bf0e,0xbe953f6d,0x3dc9bf7b
.long 0xbf55bf35,0x3f7b3ec4,0xbf0e3f35,0x3e48bf6d,0x3dc9bf6d,0x3ef13f7b,0xbf463ec4,0x3e95bf55
.long 0x3f6d0000,0xbec43f35,0xbf6d0000,0x3ec4bf35,0x3f463f6d,0xbf75be48,0xbf7fbec4,0x3ef1bf0e
.long 0xbe483f35,0xbf55bf6d,0xbf7bbf35,0x3f0ebec4,0xbf75bec4,0xbdc9bf55,0xbf62bf6d,0x3f22be48
.long 0xbf35bf80,0x3f350000,0xbf35bf80,0x3f350000,0x3e95bec4,0x3f7f3f55,0xbef1bf6d,0x3f463e48
.long 0x3f7b3f35,0x3f0e3f6d,0xbe48bf35,0x3f553ec4,0x3f223f6d,0xbe953e48,0x3dc9bec4,0x3f623f0e
.long 0xbec40000,0xbf6dbf35,0x3ec40000,0x3f6d3f35,0xbf7fbf6d,0xbf62bf7b,0x3f223ec4,0x3f753f55
.long 0xbf0ebf35,0xbe48bec4,0x3f553f35,0x3f7b3f6d,0x3ef13ec4,0x3f223f0e,0x3f753f6d,0x3f7f3f7b
.long 0x0,0x0,0x0,0x0,0x3f7fbf80,0x3f75bf7b,0x3f22bf35,0x3ef1bf0e
.long 0x3e480000,0x3f0ebec4,0x3f7bbf80,0x3f55bf6d,0xbf753f80,0xbf223f55,0x3f62bf35,0x3f7fbf7b
.long 0xbec40000,0xbf6d3f35,0x3ec40000,0x3f6dbf35,0x3f62bf80,0x3dc9bf0e,0xbe953f35,0x3f22be48
.long 0x3f0e0000,0x3f7bbf6d,0xbf553f80,0x3e483ec4,0xbf463f80,0x3ef13e48,0xbf7f3f35,0xbe953f55
.long 0xbf350000,0xbf353f80,0xbf350000,0xbf353f80,0x3f22bf80,0xbf623e48,0xbdc9bf35,0xbf753f55
.long 0x3f550000,0x3e48bf6d,0x3f0ebf80,0xbf7b3ec4,0xbef13f80,0x3f7fbf0e,0x3f75bf35,0xbf46be48
.long 0xbf6d0000,0x3ec43f35,0x3f6d0000,0xbec4bf35,0x3e95bf80,0xbf463f55,0x3ef13f35,0x3dc9bf7b
.long 0x3f7b0000,0xbf55bec4,0xbe483f80,0x3f0ebf6d,0xbdc93f80,0x3e95bf7b,0xbf463f35,0x3f62bf0e
.long 0xbf800000,0x3f800000,0xbf800000,0x3f800000,0xbdc9bf80,0x3e953f7b,0xbf46bf35,0x3f623f0e
.long 0x3f7b0000,0xbf553ec4,0xbe48bf80,0x3f0e3f6d,0x3e953f80,0xbf46bf55,0x3ef1bf35,0x3dc93f7b
.long 0xbf6d0000,0x3ec4bf35,0x3f6d0000,0xbec43f35,0xbef1bf80,0x3f7f3f0e,0x3f753f35,0xbf463e48
.long 0x3f550000,0x3e483f6d,0x3f0e3f80,0xbf7bbec4,0x3f223f80,0xbf62be48,0xbdc93f35,0xbf75bf55
.long 0xbf350000,0xbf35bf80,0xbf350000,0xbf35bf80,0xbf46bf80,0x3ef1be48,0xbf7fbf35,0xbe95bf55
.long 0x3f0e0000,0x3f7b3f6d,0xbf55bf80,0x3e48bec4,0x3f623f80,0x3dc93f0e,0xbe95bf35,0x3f223e48
.long 0xbec40000,0xbf6dbf35,0x3ec40000,0x3f6d3f35,0xbf75bf80,0xbf22bf55,0x3f623f35,0x3f7f3f7b
.long 0x3e480000,0x3f0e3ec4,0x3f7b3f80,0x3f553f6d,0x3f7f3f80,0x3f753f7b,0x3f223f35,0x3ef13f0e
.long 0x0,0x0,0x0,0x0,0x3f62bf6d,0x3f46bf55,0x3e95bec4,0x3dc9be48
.long 0x3f55bf35,0x3f7bbf6d,0x3f0ebf35,0x3e48bec4,0xbdc93ec4,0x3ef1be48,0x3f46bf6d,0x3e95bf0e
.long 0xbf6d3f80,0xbec43f35,0x3f6dbf80,0x3ec4bf35,0xbf463ec4,0xbf753f7b,0x3f7fbf6d,0x3ef1bf55
.long 0x3e48bf35,0xbf553ec4,0x3f7bbf35,0x3f0ebf6d,0x3f75bf6d,0xbdc9bf0e,0x3f62bec4,0x3f22bf7b
.long 0x3f350000,0x3f35bf80,0x3f350000,0x3f35bf80,0xbe953f6d,0x3f7fbf0e,0x3ef13ec4,0x3f46bf7b
.long 0xbf7b3f35,0x3f0e3ec4,0x3e483f35,0x3f55bf6d,0xbf22bec4,0xbe953f7b,0xbdc93f6d,0x3f62bf55
.long 0x3ec4bf80,0xbf6d3f35,0xbec43f80,0x3f6dbf35,0x3f7fbec4,0xbf62be48,0xbf223f6d,0x3f75bf0e
.long 0x3f0e3f35,0xbe48bf6d,0xbf553f35,0x3f7bbec4,0xbef13f6d,0x3f22bf55,0xbf753ec4,0x3f7fbe48
.long 0xbf800000,0x3f800000,0xbf800000,0x3f800000,0xbef1bf6d,0x3f223f55,0xbf75bec4,0x3f7f3e48
.long 0x3f0ebf35,0xbe483f6d,0xbf55bf35,0x3f7b3ec4,0x3f7f3ec4,0xbf623e48,0xbf22bf6d,0x3f753f0e
.long 0x3ec43f80,0xbf6dbf35,0xbec4bf80,0x3f6d3f35,0xbf223ec4,0xbe95bf7b,0xbdc9bf6d,0x3f623f55
.long 0xbf7bbf35,0x3f0ebec4,0x3e48bf35,0x3f553f6d,0xbe95bf6d,0x3f7f3f0e,0x3ef1bec4,0x3f463f7b
.long 0x3f350000,0x3f353f80,0x3f350000,0x3f353f80,0x3f753f6d,0xbdc93f0e,0x3f623ec4,0x3f223f7b
.long 0x3e483f35,0xbf55bec4,0x3f7b3f35,0x3f0e3f6d,0xbf46bec4,0xbf75bf7b,0x3f7f3f6d,0x3ef13f55
.long 0xbf6dbf80,0xbec4bf35,0x3f6d3f80,0x3ec43f35,0xbdc9bec4,0x3ef13e48,0x3f463f6d,0x3e953f0e
.long 0x3f553f35,0x3f7b3f6d,0x3f0e3f35,0x3e483ec4,0x3f623f6d,0x3f463f55,0x3e953ec4,0x3dc93e48
.long 0x80008000,0x80008000,0x80008000,0x80008000,0xbf7f3f80,0xbf753f7b,0xbf223f35,0xbef13f0e
.long 0xbe488000,0xbf0e3ec4,0xbf7b3f80,0xbf553f6d,0x3f75bf80,0x3f22bf55,0xbf623f35,0xbf7f3f7b
.long 0x3ec48000,0x3f6dbf35,0xbec48000,0xbf6d3f35,0xbf623f80,0xbdc93f0e,0x3e95bf35,0xbf223e48
.long 0xbf0e8000,0xbf7b3f6d,0x3f55bf80,0xbe48bec4,0x3f46bf80,0xbef1be48,0x3f7fbf35,0x3e95bf55
.long 0x3f358000,0x3f35bf80,0x3f358000,0x3f35bf80,0xbf223f80,0x3f62be48,0x3dc93f35,0x3f75bf55
.long 0xbf558000,0xbe483f6d,0xbf0e3f80,0x3f7bbec4,0x3ef1bf80,0xbf7f3f0e,0xbf753f35,0x3f463e48
.long 0x3f6d8000,0xbec4bf35,0xbf6d8000,0x3ec43f35,0xbe953f80,0x3f46bf55,0xbef1bf35,0xbdc93f7b
.long 0xbf7b8000,0x3f553ec4,0x3e48bf80,0xbf0e3f6d,0x3dc9bf80,0xbe953f7b,0x3f46bf35,0xbf623f0e
.long 0x3f808000,0xbf808000,0x3f808000,0xbf808000,0x3dc93f80,0xbe95bf7b,0x3f463f35,0xbf62bf0e
.long 0xbf7b8000,0x3f55bec4,0x3e483f80,0xbf0ebf6d,0xbe95bf80,0x3f463f55,0xbef13f35,0xbdc9bf7b
.long 0x3f6d8000,0xbec43f35,0xbf6d8000,0x3ec4bf35,0x3ef13f80,0xbf7fbf0e,0xbf75bf35,0x3f46be48
.long 0xbf558000,0xbe48bf6d,0xbf0ebf80,0x3f7b3ec4,0xbf22bf80,0x3f623e48,0x3dc9bf35,0x3f753f55
.long 0x3f358000,0x3f353f80,0x3f358000,0x3f353f80,0x3f463f80,0xbef13e48,0x3f7f3f35,0x3e953f55
.long 0xbf0e8000,0xbf7bbf6d,0x3f553f80,0xbe483ec4,0xbf62bf80,0xbdc9bf0e,0x3e953f35,0xbf22be48
.long 0x3ec48000,0x3f6d3f35,0xbec48000,0xbf6dbf35,0x3f753f80,0x3f223f55,0xbf62bf35,0xbf7fbf7b
.long 0xbe488000,0xbf0ebec4,0xbf7bbf80,0xbf55bf6d,0xbf7fbf80,0xbf75bf7b,0xbf22bf35,0xbef1bf0e
.long 0x80008000,0x80008000,0x80008000,0x80008000,0xbf623f6d,0xbf463f55,0xbe953ec4,0xbdc93e48
.long 0xbf553f35,0xbf7b3f6d,0xbf0e3f35,0xbe483ec4,0x3dc9bec4,0xbef13e48,0xbf463f6d,0xbe953f0e
.long 0x3f6dbf80,0x3ec4bf35,0xbf6d3f80,0xbec43f35,0x3f46bec4,0x3f75bf7b,0xbf7f3f6d,0xbef13f55
.long 0xbe483f35,0x3f55bec4,0xbf7b3f35,0xbf0e3f6d,0xbf753f6d,0x3dc93f0e,0xbf623ec4,0xbf223f7b
.long 0xbf358000,0xbf353f80,0xbf358000,0xbf353f80,0x3e95bf6d,0xbf7f3f0e,0xbef1bec4,0xbf463f7b
.long 0x3f7bbf35,0xbf0ebec4,0xbe48bf35,0xbf553f6d,0x3f223ec4,0x3e95bf7b,0x3dc9bf6d,0xbf623f55
.long 0xbec43f80,0x3f6dbf35,0x3ec4bf80,0xbf6d3f35,0xbf7f3ec4,0x3f623e48,0x3f22bf6d,0xbf753f0e
.long 0xbf0ebf35,0x3e483f6d,0x3f55bf35,0xbf7b3ec4,0x3ef1bf6d,0xbf223f55,0x3f75bec4,0xbf7f3e48
.long 0x3f808000,0xbf808000,0x3f808000,0xbf808000,0x3ef13f6d,0xbf22bf55,0x3f753ec4,0xbf7fbe48
.long 0xbf0e3f35,0x3e48bf6d,0x3f553f35,0xbf7bbec4,0xbf7fbec4,0x3f62be48,0x3f223f6d,0xbf75bf0e
.long 0xbec4bf80,0x3f6d3f35,0x3ec43f80,0xbf6dbf35,0x3f22bec4,0x3e953f7b,0x3dc93f6d,0xbf62bf55
.long 0x3f7b3f35,0xbf0e3ec4,0xbe483f35,0xbf55bf6d,0x3e953f6d,0xbf7fbf0e,0xbef13ec4,0xbf46bf7b
.long 0xbf358000,0xbf35bf80,0xbf358000,0xbf35bf80,0xbf75bf6d,0x3dc9bf0e,0xbf62bec4,0xbf22bf7b
.long 0xbe48bf35,0x3f553ec4,0xbf7bbf35,0xbf0ebf6d,0x3f463ec4,0x3f753f7b,0xbf7fbf6d,0xbef1bf55
.long 0x3f6d3f80,0x3ec43f35,0xbf6dbf80,0xbec4bf35,0x3dc93ec4,0xbef1be48,0xbf46bf6d,0xbe95bf0e
.long 0xbf55bf35,0xbf7bbf6d,0xbf0ebf35,0xbe48bec4,0xbf62bf6d,0xbf46bf55,0xbe95bec4,0xbdc9be48
.long 0x3f803f80,0x3f803f80,0x3f803f80,0x3f803f80,0x3f7b3f80,0x3f553f6d,0xbe480000,0xbf0ebec4
.long 0x3f6d3f80,0x3ec43f35,0xbf6dbf80,0xbec4bf35,0x3f553f80,0xbe483ec4,0x3f0e0000,0x3f7b3f6d
.long 0x3f353f80,0xbf350000,0x3f353f80,0xbf350000,0x3f0e3f80,0xbf7bbec4,0xbf550000,0xbe48bf6d
.long 0x3ec43f80,0xbf6dbf35,0xbec4bf80,0x3f6d3f35,0x3e483f80,0xbf0ebf6d,0x3f7b0000,0xbf553ec4
.long 0x3f80,0xbf80,0x3f80,0xbf80,0xbe483f80,0x3f0ebf6d,0xbf7b0000,0x3f553ec4
.long 0xbec43f80,0x3f6dbf35,0x3ec4bf80,0xbf6d3f35,0xbf0e3f80,0x3f7bbec4,0x3f550000,0x3e48bf6d
.long 0xbf353f80,0x3f350000,0xbf353f80,0x3f350000,0xbf553f80,0x3e483ec4,0xbf0e0000,0xbf7b3f6d
.long 0xbf6d3f80,0xbec43f35,0x3f6dbf80,0x3ec4bf35,0xbf7b3f80,0xbf553f6d,0x3e480000,0x3f0ebec4
.long 0xbf803f80,0xbf803f80,0xbf803f80,0xbf803f80,0xbf7b3f80,0xbf553f6d,0x3e480000,0x3f0ebec4
.long 0xbf6d3f80,0xbec43f35,0x3f6dbf80,0x3ec4bf35,0xbf553f80,0x3e483ec4,0xbf0e0000,0xbf7b3f6d
.long 0xbf353f80,0x3f350000,0xbf353f80,0x3f350000,0xbf0e3f80,0x3f7bbec4,0x3f550000,0x3e48bf6d
.long 0xbec43f80,0x3f6dbf35,0x3ec4bf80,0xbf6d3f35,0xbe483f80,0x3f0ebf6d,0xbf7b0000,0x3f553ec4
.long 0x3f80,0xbf80,0x3f80,0xbf80,0x3e483f80,0xbf0ebf6d,0x3f7b0000,0xbf553ec4
.long 0x3ec43f80,0xbf6dbf35,0xbec4bf80,0x3f6d3f35,0x3f0e3f80,0xbf7bbec4,0xbf550000,0xbe48bf6d
.long 0x3f353f80,0xbf350000,0x3f353f80,0xbf350000,0x3f553f80,0xbe483ec4,0x3f0e0000,0x3f7b3f6d
.long 0x3f6d3f80,0x3ec43f35,0xbf6dbf80,0xbec4bf35,0x3f7b3f80,0x3f553f6d,0xbe480000,0xbf0ebec4
.long 0x3f803f80,0x3f803f80,0x3f803f80,0x3f803f80,0x3f0e3f35,0x3e483ec4,0xbf55bf35,0xbf7bbf6d
.long 0xbec40000,0xbf6dbf35,0x3ec40000,0x3f6d3f35,0xbf7bbf35,0xbf0ebf6d,0x3e483f35,0xbf55bec4
.long 0xbf35bf80,0x3f350000,0xbf35bf80,0x3f350000,0x3e48bf35,0x3f553f6d,0x3f7b3f35,0xbf0e3ec4
.long 0x3f6d0000,0xbec43f35,0xbf6d0000,0x3ec4bf35,0x3f553f35,0xbf7bbec4,0x3f0ebf35,0xbe483f6d
.long 0x3f80,0xbf80,0x3f80,0xbf80,0xbf553f35,0x3f7bbec4,0xbf0ebf35,0x3e483f6d
.long 0xbf6d0000,0x3ec43f35,0x3f6d0000,0xbec4bf35,0xbe48bf35,0xbf553f6d,0xbf7b3f35,0x3f0e3ec4
.long 0x3f35bf80,0xbf350000,0x3f35bf80,0xbf350000,0x3f7bbf35,0x3f0ebf6d,0xbe483f35,0x3f55bec4
.long 0x3ec40000,0x3f6dbf35,0xbec40000,0xbf6d3f35,0xbf0e3f35,0xbe483ec4,0x3f55bf35,0x3f7bbf6d
.long 0xbf803f80,0xbf803f80,0xbf803f80,0xbf803f80,0xbf0e3f35,0xbe483ec4,0x3f55bf35,0x3f7bbf6d
.long 0x3ec40000,0x3f6dbf35,0xbec40000,0xbf6d3f35,0x3f7bbf35,0x3f0ebf6d,0xbe483f35,0x3f55bec4
.long 0x3f35bf80,0xbf350000,0x3f35bf80,0xbf350000,0xbe48bf35,0xbf553f6d,0xbf7b3f35,0x3f0e3ec4
.long 0xbf6d0000,0x3ec43f35,0x3f6d0000,0xbec4bf35,0xbf553f35,0x3f7bbec4,0xbf0ebf35,0x3e483f6d
.long 0x3f80,0xbf80,0x3f80,0xbf80,0x3f553f35,0xbf7bbec4,0x3f0ebf35,0xbe483f6d
.long 0x3f6d0000,0xbec43f35,0xbf6d0000,0x3ec4bf35,0x3e48bf35,0x3f553f6d,0x3f7b3f35,0xbf0e3ec4
.long 0xbf35bf80,0x3f350000,0xbf35bf80,0x3f350000,0xbf7bbf35,0xbf0ebf6d,0x3e483f35,0xbf55bec4
.long 0xbec40000,0xbf6dbf35,0x3ec40000,0x3f6d3f35,0x3f0e3f35,0x3e483ec4,0xbf55bf35,0xbf7bbf6d
.long 0x0,0x0,0x0,0x0,0x3e480000,0x3f0e3ec4,0x3f7b3f80,0x3f553f6d
.long 0x3ec40000,0x3f6d3f35,0xbec40000,0xbf6dbf35,0x3f0e0000,0x3f7b3f6d,0xbf55bf80,0x3e48bec4
.long 0x3f350000,0x3f353f80,0x3f350000,0x3f353f80,0x3f550000,0x3e483f6d,0x3f0e3f80,0xbf7bbec4
.long 0x3f6d0000,0xbec43f35,0xbf6d0000,0x3ec4bf35,0x3f7b0000,0xbf553ec4,0xbe48bf80,0x3f0e3f6d
.long 0x3f800000,0xbf800000,0x3f800000,0xbf800000,0x3f7b0000,0xbf55bec4,0xbe483f80,0x3f0ebf6d
.long 0x3f6d0000,0xbec4bf35,0xbf6d0000,0x3ec43f35,0x3f550000,0x3e48bf6d,0x3f0ebf80,0xbf7b3ec4
.long 0x3f350000,0x3f35bf80,0x3f350000,0x3f35bf80,0x3f0e0000,0x3f7bbf6d,0xbf553f80,0x3e483ec4
.long 0x3ec40000,0x3f6dbf35,0xbec40000,0xbf6d3f35,0x3e480000,0x3f0ebec4,0x3f7bbf80,0x3f55bf6d
.long 0x0,0x0,0x0,0x0,0xbe480000,0xbf0e3ec4,0xbf7b3f80,0xbf553f6d
.long 0xbec40000,0xbf6d3f35,0x3ec40000,0x3f6dbf35,0xbf0e0000,0xbf7b3f6d,0x3f55bf80,0xbe48bec4
.long 0xbf350000,0xbf353f80,0xbf350000,0xbf353f80,0xbf550000,0xbe483f6d,0xbf0e3f80,0x3f7bbec4
.long 0xbf6d0000,0x3ec43f35,0x3f6d0000,0xbec4bf35,0xbf7b0000,0x3f553ec4,0x3e48bf80,0xbf0e3f6d
.long 0xbf800000,0x3f800000,0xbf800000,0x3f800000,0xbf7b0000,0x3f55bec4,0x3e483f80,0xbf0ebf6d
.long 0xbf6d0000,0x3ec4bf35,0x3f6d0000,0xbec43f35,0xbf550000,0xbe48bf6d,0xbf0ebf80,0x3f7b3ec4
.long 0xbf350000,0xbf35bf80,0xbf350000,0xbf35bf80,0xbf0e0000,0xbf7bbf6d,0x3f553f80,0xbe483ec4
.long 0xbec40000,0xbf6dbf35,0x3ec40000,0x3f6d3f35,0xbe480000,0xbf0ebec4,0xbf7bbf80,0xbf55bf6d
.long 0x0,0x0,0x0,0x0,0x3f553f35,0x3f7b3f6d,0x3f0e3f35,0x3e483ec4
.long 0x3f6d3f80,0x3ec43f35,0xbf6dbf80,0xbec4bf35,0x3e483f35,0xbf55bec4,0x3f7b3f35,0x3f0e3f6d
.long 0xbf350000,0xbf35bf80,0xbf350000,0xbf35bf80,0xbf7bbf35,0x3f0ebec4,0x3e48bf35,0x3f553f6d
.long 0xbec4bf80,0x3f6d3f35,0x3ec43f80,0xbf6dbf35,0x3f0ebf35,0xbe483f6d,0xbf55bf35,0x3f7b3ec4
.long 0x3f800000,0xbf800000,0x3f800000,0xbf800000,0x3f0e3f35,0xbe48bf6d,0xbf553f35,0x3f7bbec4
.long 0xbec43f80,0x3f6dbf35,0x3ec4bf80,0xbf6d3f35,0xbf7b3f35,0x3f0e3ec4,0x3e483f35,0x3f55bf6d
.long 0xbf350000,0xbf353f80,0xbf350000,0xbf353f80,0x3e48bf35,0xbf553ec4,0x3f7bbf35,0x3f0ebf6d
.long 0x3f6dbf80,0x3ec4bf35,0xbf6d3f80,0xbec43f35,0x3f55bf35,0x3f7bbf6d,0x3f0ebf35,0x3e48bec4
.long 0x0,0x0,0x0,0x0,0xbf553f35,0xbf7b3f6d,0xbf0e3f35,0xbe483ec4
.long 0xbf6d3f80,0xbec43f35,0x3f6dbf80,0x3ec4bf35,0xbe483f35,0x3f55bec4,0xbf7b3f35,0xbf0e3f6d
.long 0x3f350000,0x3f35bf80,0x3f350000,0x3f35bf80,0x3f7bbf35,0xbf0ebec4,0xbe48bf35,0xbf553f6d
.long 0x3ec4bf80,0xbf6d3f35,0xbec43f80,0x3f6dbf35,0xbf0ebf35,0x3e483f6d,0x3f55bf35,0xbf7b3ec4
.long 0xbf800000,0x3f800000,0xbf800000,0x3f800000,0xbf0e3f35,0x3e48bf6d,0x3f553f35,0xbf7bbec4
.long 0x3ec43f80,0xbf6dbf35,0xbec4bf80,0x3f6d3f35,0x3f7b3f35,0xbf0e3ec4,0xbe483f35,0xbf55bf6d
.long 0x3f350000,0x3f353f80,0x3f350000,0x3f353f80,0xbe48bf35,0x3f553ec4,0xbf7bbf35,0xbf0ebf6d
.long 0xbf6dbf80,0xbec4bf35,0x3f6d3f80,0x3ec43f35,0xbf55bf35,0xbf7bbf6d,0xbf0ebf35,0xbe48bec4
.long 0x80008000,0x80008000,0x80008000,0x80008000,0xbe488000,0xbf0ebec4,0xbf7bbf80,0xbf55bf6d
.long 0xbec48000,0xbf6dbf35,0x3ec48000,0x3f6d3f35,0xbf0e8000,0xbf7bbf6d,0x3f553f80,0xbe483ec4
.long 0xbf358000,0xbf35bf80,0xbf358000,0xbf35bf80,0xbf558000,0xbe48bf6d,0xbf0ebf80,0x3f7b3ec4
.long 0xbf6d8000,0x3ec4bf35,0x3f6d8000,0xbec43f35,0xbf7b8000,0x3f55bec4,0x3e483f80,0xbf0ebf6d
.long 0xbf808000,0x3f808000,0xbf808000,0x3f808000,0xbf7b8000,0x3f553ec4,0x3e48bf80,0xbf0e3f6d
.long 0xbf6d8000,0x3ec43f35,0x3f6d8000,0xbec4bf35,0xbf558000,0xbe483f6d,0xbf0e3f80,0x3f7bbec4
.long 0xbf358000,0xbf353f80,0xbf358000,0xbf353f80,0xbf0e8000,0xbf7b3f6d,0x3f55bf80,0xbe48bec4
.long 0xbec48000,0xbf6d3f35,0x3ec48000,0x3f6dbf35,0xbe488000,0xbf0e3ec4,0xbf7b3f80,0xbf553f6d
.long 0x80008000,0x80008000,0x80008000,0x80008000,0x3e488000,0x3f0ebec4,0x3f7bbf80,0x3f55bf6d
.long 0x3ec48000,0x3f6dbf35,0xbec48000,0xbf6d3f35,0x3f0e8000,0x3f7bbf6d,0xbf553f80,0x3e483ec4
.long 0x3f358000,0x3f35bf80,0x3f358000,0x3f35bf80,0x3f558000,0x3e48bf6d,0x3f0ebf80,0xbf7b3ec4
.long 0x3f6d8000,0xbec4bf35,0xbf6d8000,0x3ec43f35,0x3f7b8000,0xbf55bec4,0xbe483f80,0x3f0ebf6d
.long 0x3f808000,0xbf808000,0x3f808000,0xbf808000,0x3f7b8000,0xbf553ec4,0xbe48bf80,0x3f0e3f6d
.long 0x3f6d8000,0xbec43f35,0xbf6d8000,0x3ec4bf35,0x3f558000,0x3e483f6d,0x3f0e3f80,0xbf7bbec4
.long 0x3f358000,0x3f353f80,0x3f358000,0x3f353f80,0x3f0e8000,0x3f7b3f6d,0xbf55bf80,0x3e48bec4
.long 0x3ec48000,0x3f6d3f35,0xbec48000,0xbf6dbf35,0x3e488000,0x3f0e3ec4,0x3f7b3f80,0x3f553f6d
.long 0x80008000,0x80008000,0x80008000,0x80008000,0xbf55bf35,0xbf7bbf6d,0xbf0ebf35,0xbe48bec4
.long 0xbf6dbf80,0xbec4bf35,0x3f6d3f80,0x3ec43f35,0xbe48bf35,0x3f553ec4,0xbf7bbf35,0xbf0ebf6d
.long 0x3f358000,0x3f353f80,0x3f358000,0x3f353f80,0x3f7b3f35,0xbf0e3ec4,0xbe483f35,0xbf55bf6d
.long 0x3ec43f80,0xbf6dbf35,0xbec4bf80,0x3f6d3f35,0xbf0e3f35,0x3e48bf6d,0x3f553f35,0xbf7bbec4
.long 0xbf808000,0x3f808000,0xbf808000,0x3f808000,0xbf0ebf35,0x3e483f6d,0x3f55bf35,0xbf7b3ec4
.long 0x3ec4bf80,0xbf6d3f35,0xbec43f80,0x3f6dbf35,0x3f7bbf35,0xbf0ebec4,0xbe48bf35,0xbf553f6d
.long 0x3f358000,0x3f35bf80,0x3f358000,0x3f35bf80,0xbe483f35,0x3f55bec4,0xbf7b3f35,0xbf0e3f6d
.long 0xbf6d3f80,0xbec43f35,0x3f6dbf80,0x3ec4bf35,0xbf553f35,0xbf7b3f6d,0xbf0e3f35,0xbe483ec4
.long 0x80008000,0x80008000,0x80008000,0x80008000,0x3f55bf35,0x3f7bbf6d,0x3f0ebf35,0x3e48bec4
.long 0x3f6dbf80,0x3ec4bf35,0xbf6d3f80,0xbec43f35,0x3e48bf35,0xbf553ec4,0x3f7bbf35,0x3f0ebf6d
.long 0xbf358000,0xbf353f80,0xbf358000,0xbf353f80,0xbf7b3f35,0x3f0e3ec4,0x3e483f35,0x3f55bf6d
.long 0xbec43f80,0x3f6dbf35,0x3ec4bf80,0xbf6d3f35,0x3f0e3f35,0xbe48bf6d,0xbf553f35,0x3f7bbec4
.long 0x3f808000,0xbf808000,0x3f808000,0xbf808000,0x3f0ebf35,0xbe483f6d,0xbf55bf35,0x3f7b3ec4
.long 0xbec4bf80,0x3f6d3f35,0x3ec43f80,0xbf6dbf35,0xbf7bbf35,0x3f0ebec4,0x3e48bf35,0x3f553f6d
.long 0xbf358000,0xbf35bf80,0xbf358000,0xbf35bf80,0x3e483f35,0xbf55bec4,0x3f7b3f35,0x3f0e3f6d
.long 0x3f6d3f80,0x3ec43f35,0xbf6dbf80,0xbec4bf35,0x3f553f35,0x3f7b3f6d,0x3f0e3f35,0x3e483ec4
.long 0x3f803f80,0x3f803f80,0x3f803f80,0x3f803f80,0xbf7bbf80,0xbf55bf6d,0x3e480000,0x3f0e3ec4
.long 0x3f6d3f80,0x3ec43f35,0xbf6dbf80,0xbec4bf35,0xbf55bf80,0x3e48bec4,0xbf0e0000,0xbf7bbf6d
.long 0x3f353f80,0xbf350000,0x3f353f80,0xbf350000,0xbf0ebf80,0x3f7b3ec4,0x3f550000,0x3e483f6d
.long 0x3ec43f80,0xbf6dbf35,0xbec4bf80,0x3f6d3f35,0xbe48bf80,0x3f0e3f6d,0xbf7b0000,0x3f55bec4
.long 0x3f80,0xbf80,0x3f80,0xbf80,0x3e48bf80,0xbf0e3f6d,0x3f7b0000,0xbf55bec4
.long 0xbec43f80,0x3f6dbf35,0x3ec4bf80,0xbf6d3f35,0x3f0ebf80,0xbf7b3ec4,0xbf550000,0xbe483f6d
.long 0xbf353f80,0x3f350000,0xbf353f80,0x3f350000,0x3f55bf80,0xbe48bec4,0x3f0e0000,0x3f7bbf6d
.long 0xbf6d3f80,0xbec43f35,0x3f6dbf80,0x3ec4bf35,0x3f7bbf80,0x3f55bf6d,0xbe480000,0xbf0e3ec4
.long 0xbf803f80,0xbf803f80,0xbf803f80,0xbf803f80,0x3f7bbf80,0x3f55bf6d,0xbe480000,0xbf0e3ec4
.long 0xbf6d3f80,0xbec43f35,0x3f6dbf80,0x3ec4bf35,0x3f55bf80,0xbe48bec4,0x3f0e0000,0x3f7bbf6d
.long 0xbf353f80,0x3f350000,0xbf353f80,0x3f350000,0x3f0ebf80,0xbf7b3ec4,0xbf550000,0xbe483f6d
.long 0xbec43f80,0x3f6dbf35,0x3ec4bf80,0xbf6d3f35,0x3e48bf80,0xbf0e3f6d,0x3f7b0000,0xbf55bec4
.long 0x3f80,0xbf80,0x3f80,0xbf80,0xbe48bf80,0x3f0e3f6d,0xbf7b0000,0x3f55bec4
.long 0x3ec43f80,0xbf6dbf35,0xbec4bf80,0x3f6d3f35,0xbf0ebf80,0x3f7b3ec4,0x3f550000,0x3e483f6d
.long 0x3f353f80,0xbf350000,0x3f353f80,0xbf350000,0xbf55bf80,0x3e48bec4,0xbf0e0000,0xbf7bbf6d
.long 0x3f6d3f80,0x3ec43f35,0xbf6dbf80,0xbec4bf35,0xbf7bbf80,0xbf55bf6d,0x3e480000,0x3f0e3ec4
.long 0x3f803f80,0x3f803f80,0x3f803f80,0x3f803f80,0xbf0ebf35,0xbe48bec4,0x3f553f35,0x3f7b3f6d
.long 0xbec40000,0xbf6dbf35,0x3ec40000,0x3f6d3f35,0x3f7b3f35,0x3f0e3f6d,0xbe48bf35,0x3f553ec4
.long 0xbf35bf80,0x3f350000,0xbf35bf80,0x3f350000,0xbe483f35,0xbf55bf6d,0xbf7bbf35,0x3f0ebec4
.long 0x3f6d0000,0xbec43f35,0xbf6d0000,0x3ec4bf35,0xbf55bf35,0x3f7b3ec4,0xbf0e3f35,0x3e48bf6d
.long 0x3f80,0xbf80,0x3f80,0xbf80,0x3f55bf35,0xbf7b3ec4,0x3f0e3f35,0xbe48bf6d
.long 0xbf6d0000,0x3ec43f35,0x3f6d0000,0xbec4bf35,0x3e483f35,0x3f55bf6d,0x3f7bbf35,0xbf0ebec4
.long 0x3f35bf80,0xbf350000,0x3f35bf80,0xbf350000,0xbf7b3f35,0xbf0e3f6d,0x3e48bf35,0xbf553ec4
.long 0x3ec40000,0x3f6dbf35,0xbec40000,0xbf6d3f35,0x3f0ebf35,0x3e48bec4,0xbf553f35,0xbf7b3f6d
.long 0xbf803f80,0xbf803f80,0xbf803f80,0xbf803f80,0x3f0ebf35,0x3e48bec4,0xbf553f35,0xbf7b3f6d
.long 0x3ec40000,0x3f6dbf35,0xbec40000,0xbf6d3f35,0xbf7b3f35,0xbf0e3f6d,0x3e48bf35,0xbf553ec4
.long 0x3f35bf80,0xbf350000,0x3f35bf80,0xbf350000,0x3e483f35,0x3f55bf6d,0x3f7bbf35,0xbf0ebec4
.long 0xbf6d0000,0x3ec43f35,0x3f6d0000,0xbec4bf35,0x3f55bf35,0xbf7b3ec4,0x3f0e3f35,0xbe48bf6d
.long 0x3f80,0xbf80,0x3f80,0xbf80,0xbf55bf35,0x3f7b3ec4,0xbf0e3f35,0x3e48bf6d
.long 0x3f6d0000,0xbec43f35,0xbf6d0000,0x3ec4bf35,0xbe483f35,0xbf55bf6d,0xbf7bbf35,0x3f0ebec4
.long 0xbf35bf80,0x3f350000,0xbf35bf80,0x3f350000,0x3f7b3f35,0x3f0e3f6d,0xbe48bf35,0x3f553ec4
.long 0xbec40000,0xbf6dbf35,0x3ec40000,0x3f6d3f35,0xbf0ebf35,0xbe48bec4,0x3f553f35,0x3f7b3f6d
.long 0x0,0x0,0x0,0x0,0xbe480000,0xbf0ebec4,0xbf7bbf80,0xbf55bf6d
.long 0x3ec40000,0x3f6d3f35,0xbec40000,0xbf6dbf35,0xbf0e0000,0xbf7bbf6d,0x3f553f80,0xbe483ec4
.long 0x3f350000,0x3f353f80,0x3f350000,0x3f353f80,0xbf550000,0xbe48bf6d,0xbf0ebf80,0x3f7b3ec4
.long 0x3f6d0000,0xbec43f35,0xbf6d0000,0x3ec4bf35,0xbf7b0000,0x3f55bec4,0x3e483f80,0xbf0ebf6d
.long 0x3f800000,0xbf800000,0x3f800000,0xbf800000,0xbf7b0000,0x3f553ec4,0x3e48bf80,0xbf0e3f6d
.long 0x3f6d0000,0xbec4bf35,0xbf6d0000,0x3ec43f35,0xbf550000,0xbe483f6d,0xbf0e3f80,0x3f7bbec4
.long 0x3f350000,0x3f35bf80,0x3f350000,0x3f35bf80,0xbf0e0000,0xbf7b3f6d,0x3f55bf80,0xbe48bec4
.long 0x3ec40000,0x3f6dbf35,0xbec40000,0xbf6d3f35,0xbe480000,0xbf0e3ec4,0xbf7b3f80,0xbf553f6d
.long 0x0,0x0,0x0,0x0,0x3e480000,0x3f0ebec4,0x3f7bbf80,0x3f55bf6d
.long 0xbec40000,0xbf6d3f35,0x3ec40000,0x3f6dbf35,0x3f0e0000,0x3f7bbf6d,0xbf553f80,0x3e483ec4
.long 0xbf350000,0xbf353f80,0xbf350000,0xbf353f80,0x3f550000,0x3e48bf6d,0x3f0ebf80,0xbf7b3ec4
.long 0xbf6d0000,0x3ec43f35,0x3f6d0000,0xbec4bf35,0x3f7b0000,0xbf55bec4,0xbe483f80,0x3f0ebf6d
.long 0xbf800000,0x3f800000,0xbf800000,0x3f800000,0x3f7b0000,0xbf553ec4,0xbe48bf80,0x3f0e3f6d
.long 0xbf6d0000,0x3ec4bf35,0x3f6d0000,0xbec43f35,0x3f550000,0x3e483f6d,0x3f0e3f80,0xbf7bbec4
.long 0xbf350000,0xbf35bf80,0xbf350000,0xbf35bf80,0x3f0e0000,0x3f7b3f6d,0xbf55bf80,0x3e48bec4
.long 0xbec40000,0xbf6dbf35,0x3ec40000,0x3f6d3f35,0x3e480000,0x3f0e3ec4,0x3f7b3f80,0x3f553f6d
.long 0x0,0x0,0x0,0x0,0xbf55bf35,0xbf7bbf6d,0xbf0ebf35,0xbe48bec4
.long 0x3f6d3f80,0x3ec43f35,0xbf6dbf80,0xbec4bf35,0xbe48bf35,0x3f553ec4,0xbf7bbf35,0xbf0ebf6d
.long 0xbf350000,0xbf35bf80,0xbf350000,0xbf35bf80,0x3f7b3f35,0xbf0e3ec4,0xbe483f35,0xbf55bf6d
.long 0xbec4bf80,0x3f6d3f35,0x3ec43f80,0xbf6dbf35,0xbf0e3f35,0x3e48bf6d,0x3f553f35,0xbf7bbec4
.long 0x3f800000,0xbf800000,0x3f800000,0xbf800000,0xbf0ebf35,0x3e483f6d,0x3f55bf35,0xbf7b3ec4
.long 0xbec43f80,0x3f6dbf35,0x3ec4bf80,0xbf6d3f35,0x3f7bbf35,0xbf0ebec4,0xbe48bf35,0xbf553f6d
.long 0xbf350000,0xbf353f80,0xbf350000,0xbf353f80,0xbe483f35,0x3f55bec4,0xbf7b3f35,0xbf0e3f6d
.long 0x3f6dbf80,0x3ec4bf35,0xbf6d3f80,0xbec43f35,0xbf553f35,0xbf7b3f6d,0xbf0e3f35,0xbe483ec4
.long 0x0,0x0,0x0,0x0,0x3f55bf35,0x3f7bbf6d,0x3f0ebf35,0x3e48bec4
.long 0xbf6d3f80,0xbec43f35,0x3f6dbf80,0x3ec4bf35,0x3e48bf35,0xbf553ec4,0x3f7bbf35,0x3f0ebf6d
.long 0x3f350000,0x3f35bf80,0x3f350000,0x3f35bf80,0xbf7b3f35,0x3f0e3ec4,0x3e483f35,0x3f55bf6d
.long 0x3ec4bf80,0xbf6d3f35,0xbec43f80,0x3f6dbf35,0x3f0e3f35,0xbe48bf6d,0xbf553f35,0x3f7bbec4
.long 0xbf800000,0x3f800000,0xbf800000,0x3f800000,0x3f0ebf35,0xbe483f6d,0xbf55bf35,0x3f7b3ec4
.long 0x3ec43f80,0xbf6dbf35,0xbec4bf80,0x3f6d3f35,0xbf7bbf35,0x3f0ebec4,0x3e48bf35,0x3f553f6d
.long 0x3f350000,0x3f353f80,0x3f350000,0x3f353f80,0x3e483f35,0xbf55bec4,0x3f7b3f35,0x3f0e3f6d
.long 0xbf6dbf80,0xbec4bf35,0x3f6d3f80,0x3ec43f35,0x3f553f35,0x3f7b3f6d,0x3f0e3f35,0x3e483ec4
.long 0x80008000,0x80008000,0x80008000,0x80008000,0x3e488000,0x3f0e3ec4,0x3f7b3f80,0x3f553f6d
.long 0xbec48000,0xbf6dbf35,0x3ec48000,0x3f6d3f35,0x3f0e8000,0x3f7b3f6d,0xbf55bf80,0x3e48bec4
.long 0xbf358000,0xbf35bf80,0xbf358000,0xbf35bf80,0x3f558000,0x3e483f6d,0x3f0e3f80,0xbf7bbec4
.long 0xbf6d8000,0x3ec4bf35,0x3f6d8000,0xbec43f35,0x3f7b8000,0xbf553ec4,0xbe48bf80,0x3f0e3f6d
.long 0xbf808000,0x3f808000,0xbf808000,0x3f808000,0x3f7b8000,0xbf55bec4,0xbe483f80,0x3f0ebf6d
.long 0xbf6d8000,0x3ec43f35,0x3f6d8000,0xbec4bf35,0x3f558000,0x3e48bf6d,0x3f0ebf80,0xbf7b3ec4
.long 0xbf358000,0xbf353f80,0xbf358000,0xbf353f80,0x3f0e8000,0x3f7bbf6d,0xbf553f80,0x3e483ec4
.long 0xbec48000,0xbf6d3f35,0x3ec48000,0x3f6dbf35,0x3e488000,0x3f0ebec4,0x3f7bbf80,0x3f55bf6d
.long 0x80008000,0x80008000,0x80008000,0x80008000,0xbe488000,0xbf0e3ec4,0xbf7b3f80,0xbf553f6d
.long 0x3ec48000,0x3f6dbf35,0xbec48000,0xbf6d3f35,0xbf0e8000,0xbf7b3f6d,0x3f55bf80,0xbe48bec4
.long 0x3f358000,0x3f35bf80,0x3f358000,0x3f35bf80,0xbf558000,0xbe483f6d,0xbf0e3f80,0x3f7bbec4
.long 0x3f6d8000,0xbec4bf35,0xbf6d8000,0x3ec43f35,0xbf7b8000,0x3f553ec4,0x3e48bf80,0xbf0e3f6d
.long 0x3f808000,0xbf808000,0x3f808000,0xbf808000,0xbf7b8000,0x3f55bec4,0x3e483f80,0xbf0ebf6d
.long 0x3f6d8000,0xbec43f35,0xbf6d8000,0x3ec4bf35,0xbf558000,0xbe48bf6d,0xbf0ebf80,0x3f7b3ec4
.long 0x3f358000,0x3f353f80,0x3f358000,0x3f353f80,0xbf0e8000,0xbf7bbf6d,0x3f553f80,0xbe483ec4
.long 0x3ec48000,0x3f6d3f35,0xbec48000,0xbf6dbf35,0xbe488000,0xbf0ebec4,0xbf7bbf80,0xbf55bf6d
.long 0x80008000,0x80008000,0x80008000,0x80008000,0x3f553f35,0x3f7b3f6d,0x3f0e3f35,0x3e483ec4
.long 0xbf6dbf80,0xbec4bf35,0x3f6d3f80,0x3ec43f35,0x3e483f35,0xbf55bec4,0x3f7b3f35,0x3f0e3f6d
.long 0x3f358000,0x3f353f80,0x3f358000,0x3f353f80,0xbf7bbf35,0x3f0ebec4,0x3e48bf35,0x3f553f6d
.long 0x3ec43f80,0xbf6dbf35,0xbec4bf80,0x3f6d3f35,0x3f0ebf35,0xbe483f6d,0xbf55bf35,0x3f7b3ec4
.long 0xbf808000,0x3f808000,0xbf808000,0x3f808000,0x3f0e3f35,0xbe48bf6d,0xbf553f35,0x3f7bbec4
.long 0x3ec4bf80,0xbf6d3f35,0xbec43f80,0x3f6dbf35,0xbf7b3f35,0x3f0e3ec4,0x3e483f35,0x3f55bf6d
.long 0x3f358000,0x3f35bf80,0x3f358000,0x3f35bf80,0x3e48bf35,0xbf553ec4,0x3f7bbf35,0x3f0ebf6d
.long 0xbf6d3f80,0xbec43f35,0x3f6dbf80,0x3ec4bf35,0x3f55bf35,0x3f7bbf6d,0x3f0ebf35,0x3e48bec4
.long 0x80008000,0x80008000,0x80008000,0x80008000,0xbf553f35,0xbf7b3f6d,0xbf0e3f35,0xbe483ec4
.long 0x3f6dbf80,0x3ec4bf35,0xbf6d3f80,0xbec43f35,0xbe483f35,0x3f55bec4,0xbf7b3f35,0xbf0e3f6d
.long 0xbf358000,0xbf353f80,0xbf358000,0xbf353f80,0x3f7bbf35,0xbf0ebec4,0xbe48bf35,0xbf553f6d
.long 0xbec43f80,0x3f6dbf35,0x3ec4bf80,0xbf6d3f35,0xbf0ebf35,0x3e483f6d,0x3f55bf35,0xbf7b3ec4
.long 0x3f808000,0xbf808000,0x3f808000,0xbf808000,0xbf0e3f35,0x3e48bf6d,0x3f553f35,0xbf7bbec4
.long 0xbec4bf80,0x3f6d3f35,0x3ec43f80,0xbf6dbf35,0x3f7b3f35,0xbf0e3ec4,0xbe483f35,0xbf55bf6d
.long 0xbf358000,0xbf35bf80,0xbf358000,0xbf35bf80,0xbe48bf35,0x3f553ec4,0xbf7bbf35,0xbf0ebf6d
.long 0x3f6d3f80,0x3ec43f35,0xbf6dbf80,0xbec4bf35,0xbf55bf35,0xbf7bbf6d,0xbf0ebf35,0xbe48bec4
.long 0x3f800000,0x3f800000,0x3f800000,0x3f800000,0x3f800000,0x3f7fffb1,0x3f7ffec4,0x3f7ffd39
.long 0x3f800000,0x3f7ffec4,0x3f7ffb11,0x3f7ff4e6,0x3f800000,0x3f7ffd39,0x3f7ff4e6,0x3f7fe705
.long 0x3f800000,0x3f7ffb11,0x3f7fec43,0x3f7fd397,0x3f800000,0x3f7ff84a,0x3f7fe129,0x3f7fba9e
.long 0x3f800000,0x3f7ff4e6,0x3f7fd397,0x3f7f9c18,0x3f800000,0x3f7ff0e3,0x3f7fc38f,0x3f7f7808
.long 0x3f800000,0x3f7fec43,0x3f7fb10f,0x3f7f4e6d,0x3f800000,0x3f7fe705,0x3f7f9c18,0x3f7f1f49
.long 0x3f800000,0x3f7fe129,0x3f7f84ab,0x3f7eea9d,0x3f800000,0x3f7fdaaf,0x3f7f6ac7,0x3f7eb069
.long 0x3f800000,0x3f7fd397,0x3f7f4e6d,0x3f7e70b0,0x3f800000,0x3f7fcbe2,0x3f7f2f9d,0x3f7e2b72
.long 0x3f800000,0x3f7fc38f,0x3f7f0e58,0x3f7de0b1,0x3f800000,0x3f7fba9e,0x3f7eea9d,0x3f7d906e
.long 0x3f800000,0x3f7fb10f,0x3f7ec46d,0x3f7d3aac,0x3f800000,0x3f7fa6e3,0x3f7e9bc9,0x3f7cdf6c
.long 0x3f800000,0x3f7f9c18,0x3f7e70b0,0x3f7c7eb0,0x3f800000,0x3f7f90b1,0x3f7e4323,0x3f7c187a
.long 0x3f800000,0x3f7f84ab,0x3f7e1324,0x3f7baccd,0x3f800000,0x3f7f7808,0x3f7de0b1,0x3f7b3bab
.long 0x3f800000,0x3f7f6ac7,0x3f7dabcc,0x3f7ac516,0x3f800000,0x3f7f5ce9,0x3f7d7474,0x3f7a4910
.long 0x3f800000,0x3f7f4e6d,0x3f7d3aac,0x3f79c79d,0x3f800000,0x3f7f3f54,0x3f7cfe73,0x3f7940c0
.long 0x3f800000,0x3f7f2f9d,0x3f7cbfc9,0x3f78b47b,0x3f800000,0x3f7f1f49,0x3f7c7eb0,0x3f7822d1
.long 0x3f800000,0x3f7f0e58,0x3f7c3b28,0x3f778bc5,0x3f800000,0x3f7efcc9,0x3f7bf531,0x3f76ef5b
.long 0x3f800000,0x3f7eea9d,0x3f7baccd,0x3f764d97,0x3f800000,0x3f7ed7d4,0x3f7b61fc,0x3f75a67b
.long 0x3f800000,0x3f800000,0x3f800000,0x3f800000,0x3f7ffb11,0x3f7ff84a,0x3f7ff4e6,0x3f7ff0e3
.long 0x3f7fec43,0x3f7fe129,0x3f7fd397,0x3f7fc38f,0x3f7fd397,0x3f7fba9e,0x3f7f9c18,0x3f7f7808
.long 0x3f7fb10f,0x3f7f84ab,0x3f7f4e6d,0x3f7f0e58,0x3f7f84ab,0x3f7f3f54,0x3f7eea9d,0x3f7e868b
.long 0x3f7f4e6d,0x3f7eea9d,0x3f7e70b0,0x3f7de0b1,0x3f7f0e58,0x3f7e868b,0x3f7de0b1,0x3f7d1cdd
.long 0x3f7ec46d,0x3f7e1324,0x3f7d3aac,0x3f7c3b28,0x3f7e70b0,0x3f7d906e,0x3f7c7eb0,0x3f7b3bab
.long 0x3f7e1324,0x3f7cfe73,0x3f7baccd,0x3f7a1e84,0x3f7dabcc,0x3f7c5d3a,0x3f7ac516,0x3f78e3d6
.long 0x3f7d3aac,0x3f7baccd,0x3f79c79d,0x3f778bc5,0x3f7cbfc9,0x3f7aed37,0x3f78b47b,0x3f76167a
.long 0x3f7c3b28,0x3f7a1e84,0x3f778bc5,0x3f748422,0x3f7baccd,0x3f7940c0,0x3f764d97,0x3f72d4eb
.long 0x3f7b14be,0x3f7853f8,0x3f74fa0b,0x3f710908,0x3f7a7302,0x3f77583a,0x3f73913f,0x3f6f20b0
.long 0x3f79c79d,0x3f764d97,0x3f721352,0x3f6d1c1d,0x3f791298,0x3f75341d,0x3f708066,0x3f6afb8c
.long 0x3f7853f8,0x3f740bdd,0x3f6ed89e,0x3f68bf3c,0x3f778bc5,0x3f72d4eb,0x3f6d1c1d,0x3f666771
.long 0x3f76ba07,0x3f718f57,0x3f6b4b0c,0x3f63f473,0x3f75dec6,0x3f703b37,0x3f696591,0x3f61668a
.long 0x3f74fa0b,0x3f6ed89e,0x3f676bd8,0x3f5ebe05,0x3f740bdd,0x3f6d67a1,0x3f655e0b,0x3f5bfb34
.long 0x3f731447,0x3f6be858,0x3f633c5a,0x3f591e6a,0x3f721352,0x3f6a5ad9,0x3f6106f2,0x3f5627fe
.long 0x3f710908,0x3f68bf3c,0x3f5ebe05,0x3f531849,0x3f6ff573,0x3f671599,0x3f5c61c7,0x3f4fefa8
.long 0x3f6ed89e,0x3f655e0b,0x3f59f26a,0x3f4cae79,0x3f6db293,0x3f6398ac,0x3f577026,0x3f495521
.long 0x0,0x0,0x0,0x0,0x0,0x3b490fc6,0x3bc90f88,0x3c16cb58
.long 0x0,0x3bc90f88,0x3c490e90,0x3c96c9b6,0x0,0x3c16cb58,0x3c96c9b6,0x3ce22a7a
.long 0x0,0x3c490e90,0x3cc90ab0,0x3d16c32c,0x0,0x3c7b514b,0x3cfb49ba,0x3d3c6dd5
.long 0x0,0x3c96c9b6,0x3d16c32c,0x3d621469,0x0,0x3cafea69,0x3d2fe007,0x3d83db0a
.long 0x0,0x3cc90ab0,0x3d48fb30,0x3d96a905,0x0,0x3ce22a7a,0x3d621469,0x3da973ba
.long 0x0,0x3cfb49ba,0x3d7b2b74,0x3dbc3ac3,0x0,0x3d0a342f,0x3d8a200a,0x3dcefdb7
.long 0x0,0x3d16c32c,0x3d96a905,0x3de1bc2e,0x0,0x3d2351cb,0x3da3308c,0x3df475c0
.long 0x0,0x3d2fe007,0x3dafb680,0x3e039502,0x0,0x3d3c6dd5,0x3dbc3ac3,0x3e0cec4a
.long 0x0,0x3d48fb30,0x3dc8bd36,0x3e164083,0x0,0x3d55880e,0x3dd53db9,0x3e1f917b
.long 0x0,0x3d621469,0x3de1bc2e,0x3e28defc,0x0,0x3d6ea038,0x3dee3876,0x3e3228d4
.long 0x0,0x3d7b2b74,0x3dfab273,0x3e3b6ecf,0x0,0x3d83db0a,0x3e039502,0x3e44b0b9
.long 0x0,0x3d8a200a,0x3e09cf86,0x3e4dee60,0x0,0x3d9064b4,0x3e1008b7,0x3e57278f
.long 0x0,0x3d96a905,0x3e164083,0x3e605c13,0x0,0x3d9cecf9,0x3e1c76de,0x3e698bba
.long 0x0,0x3da3308c,0x3e22abb6,0x3e72b651,0x0,0x3da973ba,0x3e28defc,0x3e7bdba4
.long 0x0,0x3dafb680,0x3e2f10a2,0x3e827dc0,0x0,0x3db5f8da,0x3e354098,0x3e870ada
.long 0x0,0x3dbc3ac3,0x3e3b6ecf,0x3e8b9507,0x0,0x3dc27c39,0x3e419b37,0x3e901c2c
.long 0x0,0x0,0x0,0x0,0x3c490e90,0x3c7b514b,0x3c96c9b6,0x3cafea69
.long 0x3cc90ab0,0x3cfb49ba,0x3d16c32c,0x3d2fe007,0x3d16c32c,0x3d3c6dd5,0x3d621469,0x3d83db0a
.long 0x3d48fb30,0x3d7b2b74,0x3d96a905,0x3dafb680,0x3d7b2b74,0x3d9cecf9,0x3dbc3ac3,0x3ddb7d37
.long 0x3d96a905,0x3dbc3ac3,0x3de1bc2e,0x3e039502,0x3dafb680,0x3ddb7d37,0x3e039502,0x3e195be0
.long 0x3dc8bd36,0x3dfab273,0x3e164083,0x3e2f10a2,0x3de1bc2e,0x3e0cec4a,0x3e28defc,0x3e44b0b9
.long 0x3dfab273,0x3e1c76de,0x3e3b6ecf,0x3e5a3997,0x3e09cf86,0x3e2bf804,0x3e4dee60,0x3e6fa8b2
.long 0x3e164083,0x3e3b6ecf,0x3e605c13,0x3e827dc0,0x3e22abb6,0x3e4ada4f,0x3e72b651,0x3e8d17c0
.long 0x3e2f10a2,0x3e5a3997,0x3e827dc0,0x3e97a117,0x3e3b6ecf,0x3e698bba,0x3e8b9507,0x3ea21887
.long 0x3e47c5c2,0x3e78cfcc,0x3e94a031,0x3eac7cd4,0x3e541501,0x3e840270,0x3e9d9e78,0x3eb6ccc3
.long 0x3e605c13,0x3e8b9507,0x3ea68f12,0x3ec1071e,0x3e6c9a7f,0x3e931f35,0x3eaf713a,0x3ecb2aae
.long 0x3e78cfcc,0x3e9aa086,0x3eb8442a,0x3ed53641,0x3e827dc0,0x3ea21887,0x3ec1071e,0x3edf28a9
.long 0x3e888e93,0x3ea986c4,0x3ec9b953,0x3ee900b7,0x3e8e9a22,0x3eb0eacb,0x3ed25a09,0x3ef2bd43
.long 0x3e94a031,0x3eb8442a,0x3edae880,0x3efc5d27,0x3e9aa086,0x3ebf926f,0x3ee363fa,0x3f02ef9f
.long 0x3ea09ae5,0x3ec6d529,0x3eebcbbb,0x3f07a136,0x3ea68f12,0x3ece0bea,0x3ef41f07,0x3f0c42c9
.long 0x3eac7cd4,0x3ed53641,0x3efc5d27,0x3f10d3cd,0x3eb263ef,0x3edc53c1,0x3f0242b1,0x3f1553b7
.long 0x3eb8442a,0x3ee363fa,0x3f064b82,0x3f19c200,0x3ebe1d4a,0x3eea6681,0x3f0a48ad,0x3f1e1e22
.long 0x3f800000,0x3f800000,0x3f800000,0x3f800000,0x3f7fec43,0x3f7fe705,0x3f7fe129,0x3f7fdaaf
.long 0x3f7fb10f,0x3f7f9c18,0x3f7f84ab,0x3f7f6ac7,0x3f7f4e6d,0x3f7f1f49,0x3f7eea9d,0x3f7eb069
.long 0x3f7ec46d,0x3f7e70b0,0x3f7e1324,0x3f7dabcc,0x3f7e1324,0x3f7d906e,0x3f7cfe73,0x3f7c5d3a
.long 0x3f7d3aac,0x3f7c7eb0,0x3f7baccd,0x3f7ac516,0x3f7c3b28,0x3f7b3bab,0x3f7a1e84,0x3f78e3d6
.long 0x3f7b14be,0x3f79c79d,0x3f7853f8,0x3f76ba07,0x3f79c79d,0x3f7822d1,0x3f764d97,0x3f74484b
.long 0x3f7853f8,0x3f764d97,0x3f740bdd,0x3f718f57,0x3f76ba07,0x3f74484b,0x3f718f57,0x3f6e8ff8
.long 0x3f74fa0b,0x3f721352,0x3f6ed89e,0x3f6b4b0c,0x3f731447,0x3f6faf1b,0x3f6be858,0x3f67c187
.long 0x3f710908,0x3f6d1c1d,0x3f68bf3c,0x3f63f473,0x3f6ed89e,0x3f6a5ad9,0x3f655e0b,0x3f5fe4e9
.long 0x3f6c835e,0x3f676bd8,0x3f61c598,0x3f5b941a,0x3f6a09a7,0x3f644fac,0x3f5df6be,0x3f570348
.long 0x3f676bd8,0x3f6106f2,0x3f59f26a,0x3f5233c6,0x3f64aa59,0x3f5d924d,0x3f55b993,0x3f4d26fd
.long 0x3f61c598,0x3f59f26a,0x3f514d3d,0x3f47de65,0x3f5ebe05,0x3f5627fe,0x3f4cae79,0x3f425b89
.long 0x3f5b941a,0x3f5233c6,0x3f47de65,0x3f3ca003,0x3f584853,0x3f4e1689,0x3f42de29,0x3f36ad7f
.long 0x3f54db31,0x3f49d112,0x3f3daef9,0x3f3085bb,0x3f514d3d,0x3f456439,0x3f385216,0x3f2a2a80
.long 0x3f4d9f02,0x3f40d0da,0x3f32c8c9,0x3f239da9,0x3f49d112,0x3f3c17d9,0x3f2d1469,0x3f1ce11f
.long 0x3f45e403,0x3f373a23,0x3f273656,0x3f15f6d9,0x3f41d870,0x3f3238aa,0x3f212ff9,0x3f0ee0db
.long 0x3f3daef9,0x3f2d1469,0x3f1b02c6,0x3f07a136,0x3f396842,0x3f27ce61,0x3f14b039,0x3f003a06
.long 0x3f800000,0x3f800000,0x3f800000,0x3f800000,0x3f7fd397,0x3f7fcbe2,0x3f7fc38f,0x3f7fba9e
.long 0x3f7f4e6d,0x3f7f2f9d,0x3f7f0e58,0x3f7eea9d,0x3f7e70b0,0x3f7e2b72,0x3f7de0b1,0x3f7d906e
.long 0x3f7d3aac,0x3f7cbfc9,0x3f7c3b28,0x3f7baccd,0x3f7baccd,0x3f7aed37,0x3f7a1e84,0x3f7940c0
.long 0x3f79c79d,0x3f78b47b,0x3f778bc5,0x3f764d97,0x3f778bc5,0x3f76167a,0x3f748422,0x3f72d4eb
.long 0x3f74fa0b,0x3f731447,0x3f710908,0x3f6ed89e,0x3f721352,0x3f6faf1b,0x3f6d1c1d,0x3f6a5ad9
.long 0x3f6ed89e,0x3f6be858,0x3f68bf3c,0x3f655e0b,0x3f6b4b0c,0x3f67c187,0x3f63f473,0x3f5fe4e9
.long 0x3f676bd8,0x3f633c5a,0x3f5ebe05,0x3f59f26a,0x3f633c5a,0x3f5e5aa6,0x3f591e6a,0x3f5389c7
.long 0x3f5ebe05,0x3f591e6a,0x3f531849,0x3f4cae79,0x3f59f26a,0x3f5389c7,0x3f4cae79,0x3f456439
.long 0x3f54db31,0x3f4d9f02,0x3f45e403,0x3f3daef9,0x3f4f7a1f,0x3f476085,0x3f3ebc1b,0x3f3592e7
.long 0x3f49d112,0x3f40d0da,0x3f373a23,0x3f2d1469,0x3f43e200,0x3f39f2ac,0x3f2f61a5,0x3f24381a
.long 0x3f3daef9,0x3f32c8c9,0x3f273656,0x3f1b02c6,0x3f373a23,0x3f2b561b,0x3f1ebc12,0x3f11796b
.long 0x3f3085bb,0x3f239da9,0x3f15f6d9,0x3f07a136,0x3f299415,0x3f1ba299,0x3f0cead0,0x3efafef7
.long 0x3f226799,0x3f13682a,0x3f039c3d,0x3ee63375,0x3f1b02c6,0x3f0af1b7,0x3ef41f07,0x3ed0eb2a
.long 0x3f13682a,0x3f0242b1,0x3ee0924f,0x3ebb31a0,0x3f0b9a6b,0x3ef2bd43,0x3ecc9b8b,0x3ea5129f
.long 0x3f039c3d,0x3ee0924f,0x3eb8442a,0x3e8e9a22,0x3ef6e0cb,0x3ece0bea,0x3ea395c5,0x3e6fa8b2
.long 0x3ee63375,0x3ebb31a0,0x3e8e9a22,0x3e419b37,0x3ed53641,0x3ea80b1f,0x3e72b651,0x3e1324ca
.long 0x0,0x0,0x0,0x0,0x3cc90ab0,0x3ce22a7a,0x3cfb49ba,0x3d0a342f
.long 0x3d48fb30,0x3d621469,0x3d7b2b74,0x3d8a200a,0x3d96a905,0x3da973ba,0x3dbc3ac3,0x3dcefdb7
.long 0x3dc8bd36,0x3de1bc2e,0x3dfab273,0x3e09cf86,0x3dfab273,0x3e0cec4a,0x3e1c76de,0x3e2bf804
.long 0x3e164083,0x3e28defc,0x3e3b6ecf,0x3e4dee60,0x3e2f10a2,0x3e44b0b9,0x3e5a3997,0x3e6fa8b2
.long 0x3e47c5c2,0x3e605c13,0x3e78cfcc,0x3e888e93,0x3e605c13,0x3e7bdba4,0x3e8b9507,0x3e9920fe
.long 0x3e78cfcc,0x3e8b9507,0x3e9aa086,0x3ea986c4,0x3e888e93,0x3e9920fe,0x3ea986c4,0x3eb9bb1e
.long 0x3e94a031,0x3ea68f12,0x3eb8442a,0x3ec9b953,0x3ea09ae5,0x3eb3dca5,0x3ec6d529,0x3ed97cb9
.long 0x3eac7cd4,0x3ec1071e,0x3ed53641,0x3ee900b7,0x3eb8442a,0x3ece0bea,0x3ee363fa,0x3ef840c8
.long 0x3ec3ef15,0x3edae880,0x3ef15aea,0x3f039c3d,0x3ecf7bca,0x3ee79a5d,0x3eff17b2,0x3f0af1b7
.long 0x3edae880,0x3ef41f07,0x3f064b82,0x3f121eb0,0x3ee63375,0x3f003a06,0x3f0cead0,0x3f19210f
.long 0x3ef15aea,0x3f064b82,0x3f13682a,0x3f1ff6cb,0x3efc5d27,0x3f0c42c9,0x3f19c200,0x3f269de3
.long 0x3f039c3d,0x3f121eb0,0x3f1ff6cb,0x3f2d1469,0x3f08f59b,0x3f17de12,0x3f26050a,0x3f33587a
.long 0x3f0e39da,0x3f1d7fd1,0x3f2beb4a,0x3f396842,0x3f13682a,0x3f2302d3,0x3f31a81d,0x3f3f41fc
.long 0x3f187fc0,0x3f286605,0x3f373a23,0x3f44e3f5,0x3f1d7fd1,0x3f2da859,0x3f3ca003,0x3f4a4c87
.long 0x3f226799,0x3f32c8c9,0x3f41d870,0x3f4f7a1f,0x3f273656,0x3f37c655,0x3f46e22a,0x3f546b3b
.long 0x3f2beb4a,0x3f3ca003,0x3f4bbbf8,0x3f591e6a,0x3f3085bb,0x3f4154e1,0x3f5064af,0x3f5d924d
.long 0x0,0x0,0x0,0x0,0x3d16c32c,0x3d2351cb,0x3d2fe007,0x3d3c6dd5
.long 0x3d96a905,0x3da3308c,0x3dafb680,0x3dbc3ac3,0x3de1bc2e,0x3df475c0,0x3e039502,0x3e0cec4a
.long 0x3e164083,0x3e22abb6,0x3e2f10a2,0x3e3b6ecf,0x3e3b6ecf,0x3e4ada4f,0x3e5a3997,0x3e698bba
.long 0x3e605c13,0x3e72b651,0x3e827dc0,0x3e8b9507,0x3e827dc0,0x3e8d17c0,0x3e97a117,0x3ea21887
.long 0x3e94a031,0x3ea09ae5,0x3eac7cd4,0x3eb8442a,0x3ea68f12,0x3eb3dca5,0x3ec1071e,0x3ece0bea
.long 0x3eb8442a,0x3ec6d529,0x3ed53641,0x3ee363fa,0x3ec9b953,0x3ed97cb9,0x3ee900b7,0x3ef840c8
.long 0x3edae880,0x3eebcbbb,0x3efc5d27,0x3f064b82,0x3eebcbbb,0x3efdbabb,0x3f07a136,0x3f102dd5
.long 0x3efc5d27,0x3f07a136,0x3f10d3cd,0x3f19c200,0x3f064b82,0x3f102dd5,0x3f19c200,0x3f2302d3
.long 0x3f0e39da,0x3f187fc0,0x3f226799,0x3f2beb4a,0x3f15f6d9,0x3f209393,0x3f2ac082,0x3f34768f
.long 0x3f1d7fd1,0x3f286605,0x3f32c8c9,0x3f3ca003,0x3f24d225,0x3f2ff3e6,0x3f3a7ca4,0x3f446337
.long 0x3f2beb4a,0x3f373a23,0x3f41d870,0x3f4bbbf8,0x3f32c8c9,0x3f3e35c5,0x3f48d8b3,0x3f52a649
.long 0x3f396842,0x3f44e3f5,0x3f4f7a1f,0x3f591e6a,0x3f3fc767,0x3f4b41fa,0x3f55b993,0x3f5f20db
.long 0x3f45e403,0x3f514d3d,0x3f5b941a,0x3f64aa59,0x3f4bbbf8,0x3f570348,0x3f6106f2,0x3f69b7e4
.long 0x3f514d3d,0x3f5c61c7,0x3f660f88,0x3f6e46be,0x3f5695e5,0x3f61668a,0x3f6aab7b,0x3f725470
.long 0x3f5b941a,0x3f660f88,0x3f6ed89e,0x3f75dec6,0x3f604621,0x3f6a5ad9,0x3f7294f8,0x3f78e3d6
.long 0x3f64aa59,0x3f6e46be,0x3f75dec6,0x3f7b61fc,0x3f68bf3c,0x3f71d19f,0x3f78b47b,0x3f7d57de
.long 0x3f800000,0x3f800000,0x3f800000,0x3f800000,0x3f7fb10f,0x3f7fa6e3,0x3f7f9c18,0x3f7f90b1
.long 0x3f7ec46d,0x3f7e9bc9,0x3f7e70b0,0x3f7e4323,0x3f7d3aac,0x3f7cdf6c,0x3f7c7eb0,0x3f7c187a
.long 0x3f7b14be,0x3f7a7302,0x3f79c79d,0x3f791298,0x3f7853f8,0x3f77583a,0x3f764d97,0x3f75341d
.long 0x3f74fa0b,0x3f73913f,0x3f721352,0x3f708066,0x3f710908,0x3f6f20b0,0x3f6d1c1d,0x3f6afb8c
.long 0x3f6c835e,0x3f6a09a7,0x3f676bd8,0x3f64aa59,0x3f676bd8,0x3f644fac,0x3f6106f2,0x3f5d924d
.long 0x3f61c598,0x3f5df6be,0x3f59f26a,0x3f55b993,0x3f5b941a,0x3f570348,0x3f5233c6,0x3f4d26fd
.long 0x3f54db31,0x3f4f7a1f,0x3f49d112,0x3f43e200,0x3f4d9f02,0x3f476085,0x3f40d0da,0x3f39f2ac
.long 0x3f45e403,0x3f3ebc1b,0x3f373a23,0x3f2f61a5,0x3f3daef9,0x3f3592e7,0x3f2d1469,0x3f24381a
.long 0x3f3504f3,0x3f2beb4a,0x3f226799,0x3f187fc0,0x3f2beb4a,0x3f21cbfb,0x3f173c07,0x3f0c42c9
.long 0x3f226799,0x3f173c07,0x3f0b9a6b,0x3eff17b2,0x3f187fc0,0x3f0c42c9,0x3eff17b2,0x3ee4cbfe
.long 0x3f0e39da,0x3f00e7e4,0x3ee63375,0x3ec9b953,0x3f039c3d,0x3eea6681,0x3ecc9b8b,0x3eadf73c
.long 0x3ef15aea,0x3ed25a09,0x3eb263ef,0x3e919ddd,0x3edae880,0x3eb9bb1e,0x3e97a117,0x3e698bba
.long 0x3ec3ef15,0x3ea09ae5,0x3e78cfcc,0x3e2f10a2,0x3eac7cd4,0x3e870ada,0x3e419b37,0x3de7fa9a
.long 0x3e94a031,0x3e5a3997,0x3e09cf86,0x3d621469,0x3e78cfcc,0x3e25c58c,0x3da3308c,0xbb490fc6
.long 0x3e47c5c2,0x3de1bc2e,0x3cc90ab0,0xbd7b2b74,0x3e164083,0x3d6ea038,0xbcfb49ba,0xbdf475c0
.long 0x3dc8bd36,0x3bc90f88,0xbdafb680,0xbe354098,0x3d48fb30,0xbd3c6dd5,0xbe1008b7,0xbe6fa8b2
.long 0x3f800000,0x3f800000,0x3f800000,0x3f800000,0x3f7f84ab,0x3f7f7808,0x3f7f6ac7,0x3f7f5ce9
.long 0x3f7e1324,0x3f7de0b1,0x3f7dabcc,0x3f7d7474,0x3f7baccd,0x3f7b3bab,0x3f7ac516,0x3f7a4910
.long 0x3f7853f8,0x3f778bc5,0x3f76ba07,0x3f75dec6,0x3f740bdd,0x3f72d4eb,0x3f718f57,0x3f703b37
.long 0x3f6ed89e,0x3f6d1c1d,0x3f6b4b0c,0x3f696591,0x3f68bf3c,0x3f666771,0x3f63f473,0x3f61668a
.long 0x3f61c598,0x3f5ebe05,0x3f5b941a,0x3f584853,0x3f59f26a,0x3f5627fe,0x3f5233c6,0x3f4e1689
.long 0x3f514d3d,0x3f4cae79,0x3f47de65,0x3f42de29,0x3f47de65,0x3f425b89,0x3f3ca003,0x3f36ad7f
.long 0x3f3daef9,0x3f373a23,0x3f3085bb,0x3f299415,0x3f32c8c9,0x3f2b561b,0x3f239da9,0x3f1ba299
.long 0x3f273656,0x3f1ebc12,0x3f15f6d9,0x3f0cead0,0x3f1b02c6,0x3f11796b,0x3f07a136,0x3efafef7
.long 0x3f0e39da,0x3f039c3d,0x3ef15aea,0x3edae880,0x3f00e7e4,0x3eea6681,0x3ed25a09,0x3eb9bb1e
.long 0x3ee63375,0x3ecc9b8b,0x3eb263ef,0x3e97a117,0x3ec9b953,0x3eadf73c,0x3e919ddd,0x3e698bba
.long 0x3eac7cd4,0x3e8e9a22,0x3e605c13,0x3e22abb6,0x3e8e9a22,0x3e5d4b1a,0x3e1c76de,0x3db5f8da
.long 0x3e605c13,0x3e1c76de,0x3dafb680,0x3c96c9b6,0x3e22abb6,0x3db5f8da,0x3c96c9b6,0xbd55880e
.long 0x3dc8bd36,0x3cc90ab0,0xbd48fb30,0xbdfab273,0x3d16c32c,0xbd2351cb,0xbdee3876,0xbe44b0b9
.long 0xbcc90ab0,0xbdd53db9,0xbe3b6ecf,0xbe8586ce,0xbdafb680,0xbe2bf804,0xbe7ee6e1,0xbea80b1f
.long 0xbe164083,0xbe6c9a7f,0xbea09ae5,0xbec9b953,0xbe541501,0xbe9620d2,0xbec1071e,0xbeea6681
.long 0xbe888e93,0xbeb554ec,0xbee0924f,0xbf04f484,0xbea68f12,0xbed3c867,0xbeff17b2,0xbf140c5f
.long 0x0,0x0,0x0,0x0,0x3d48fb30,0x3d55880e,0x3d621469,0x3d6ea038
.long 0x3dc8bd36,0x3dd53db9,0x3de1bc2e,0x3dee3876,0x3e164083,0x3e1f917b,0x3e28defc,0x3e3228d4
.long 0x3e47c5c2,0x3e541501,0x3e605c13,0x3e6c9a7f,0x3e78cfcc,0x3e840270,0x3e8b9507,0x3e931f35
.long 0x3e94a031,0x3e9d9e78,0x3ea68f12,0x3eaf713a,0x3eac7cd4,0x3eb6ccc3,0x3ec1071e,0x3ecb2aae
.long 0x3ec3ef15,0x3ecf7bca,0x3edae880,0x3ee63375,0x3edae880,0x3ee79a5d,0x3ef41f07,0x3f003a06
.long 0x3ef15aea,0x3eff17b2,0x3f064b82,0x3f0cead0,0x3f039c3d,0x3f0af1b7,0x3f121eb0,0x3f19210f
.long 0x3f0e39da,0x3f15f6d9,0x3f1d7fd1,0x3f24d225,0x3f187fc0,0x3f209393,0x3f286605,0x3f2ff3e6
.long 0x3f226799,0x3f2ac082,0x3f32c8c9,0x3f3a7ca4,0x3f2beb4a,0x3f34768f,0x3f3ca003,0x3f446337
.long 0x3f3504f3,0x3f3daef9,0x3f45e403,0x3f4d9f02,0x3f3daef9,0x3f466354,0x3f4e8d90,0x3f5627fe
.long 0x3f45e403,0x3f4e8d90,0x3f5695e5,0x3f5df6be,0x3f4d9f02,0x3f5627fe,0x3f5df6be,0x3f650479
.long 0x3f54db31,0x3f5d2d53,0x3f64aa59,0x3f6b4b0c,0x3f5b941a,0x3f6398ac,0x3f6aab7b,0x3f70c501
.long 0x3f61c598,0x3f696591,0x3f6ff573,0x3f756d97,0x3f676bd8,0x3f6e8ff8,0x3f748422,0x3f7940c0
.long 0x3f6c835e,0x3f731447,0x3f7853f8,0x3f7c3b28,0x3f710908,0x3f76ef5b,0x3f7b61fc,0x3f7e5a38
.long 0x3f74fa0b,0x3f7a1e84,0x3f7dabcc,0x3f7f9c18,0x3f7853f8,0x3f7c9f8a,0x3f7f2f9d,0x3f7fffb1
.long 0x3f7b14be,0x3f7e70b0,0x3f7fec43,0x3f7f84ab,0x3f7d3aac,0x3f7f90b1,0x3f7fe129,0x3f7e2b72
.long 0x3f7ec46d,0x3f7ffec4,0x3f7f0e58,0x3f7bf531,0x3f7fb10f,0x3f7fba9e,0x3f7d7474,0x3f78e3d6
.long 0x0,0x0,0x0,0x0,0x3d7b2b74,0x3d83db0a,0x3d8a200a,0x3d9064b4
.long 0x3dfab273,0x3e039502,0x3e09cf86,0x3e1008b7,0x3e3b6ecf,0x3e44b0b9,0x3e4dee60,0x3e57278f
.long 0x3e78cfcc,0x3e827dc0,0x3e888e93,0x3e8e9a22,0x3e9aa086,0x3ea21887,0x3ea986c4,0x3eb0eacb
.long 0x3eb8442a,0x3ec1071e,0x3ec9b953,0x3ed25a09,0x3ed53641,0x3edf28a9,0x3ee900b7,0x3ef2bd43
.long 0x3ef15aea,0x3efc5d27,0x3f039c3d,0x3f08f59b,0x3f064b82,0x3f0c42c9,0x3f121eb0,0x3f17de12
.long 0x3f13682a,0x3f19c200,0x3f1ff6cb,0x3f26050a,0x3f1ff6cb,0x3f269de3,0x3f2d1469,0x3f33587a
.long 0x3f2beb4a,0x3f32c8c9,0x3f396842,0x3f3fc767,0x3f373a23,0x3f3e35c5,0x3f44e3f5,0x3f4b41fa
.long 0x3f41d870,0x3f48d8b3,0x3f4f7a1f,0x3f55b993,0x3f4bbbf8,0x3f52a649,0x3f591e6a,0x3f5f20db
.long 0x3f54db31,0x3f5b941a,0x3f61c598,0x3f676bd8,0x3f5d2d53,0x3f6398ac,0x3f696591,0x3f6e8ff8
.long 0x3f64aa59,0x3f6aab7b,0x3f6ff573,0x3f748422,0x3f6b4b0c,0x3f70c501,0x3f756d97,0x3f7940c0
.long 0x3f710908,0x3f75dec6,0x3f79c79d,0x3f7cbfc9,0x3f75dec6,0x3f79f35e,0x3f7cfe73,0x3f7efcc9
.long 0x3f79c79d,0x3f7cfe73,0x3f7f0e58,0x3f7ff4e6,0x3f7cbfc9,0x3f7efcc9,0x3f7ff4e6,0x3f7fa6e3
.long 0x3f7ec46d,0x3f7fec43,0x3f7fb10f,0x3f7e1324,0x3f7fd397,0x3f7fcbe2,0x3f7e4323,0x3f7b3bab
.long 0x3f7fec43,0x3f7e9bc9,0x3f7baccd,0x3f772417,0x3f7f0e58,0x3f7c5d3a,0x3f77f110,0x3f71d19f
.long 0x3f7d3aac,0x3f791298,0x3f731447,0x3f6b4b0c,0x3f7a7302,0x3f74bf62,0x3f6d1c1d,0x3f6398ac
.long 0x3f76ba07,0x3f6f6830,0x3f660f88,0x3f5ac450,0x3f721352,0x3f6912ae,0x3f5df6be,0x3f50d937
.long 0x3f800000,0x3f800000,0x3f800000,0x3f800000,0x3f7f4e6d,0x3f7f3f54,0x3f7f2f9d,0x3f7f1f49
.long 0x3f7d3aac,0x3f7cfe73,0x3f7cbfc9,0x3f7c7eb0,0x3f79c79d,0x3f7940c0,0x3f78b47b,0x3f7822d1
.long 0x3f74fa0b,0x3f740bdd,0x3f731447,0x3f721352,0x3f6ed89e,0x3f6d67a1,0x3f6be858,0x3f6a5ad9
.long 0x3f676bd8,0x3f655e0b,0x3f633c5a,0x3f6106f2,0x3f5ebe05,0x3f5bfb34,0x3f591e6a,0x3f5627fe
.long 0x3f54db31,0x3f514d3d,0x3f4d9f02,0x3f49d112,0x3f49d112,0x3f456439,0x3f40d0da,0x3f3c17d9
.long 0x3f3daef9,0x3f385216,0x3f32c8c9,0x3f2d1469,0x3f3085bb,0x3f2a2a80,0x3f239da9,0x3f1ce11f
.long 0x3f226799,0x3f1b02c6,0x3f13682a,0x3f0b9a6b,0x3f13682a,0x3f0af1b7,0x3f0242b1,0x3ef2bd43
.long 0x3f039c3d,0x3ef41f07,0x3ee0924f,0x3ecc9b8b,0x3ee63375,0x3ed0eb2a,0x3ebb31a0,0x3ea5129f
.long 0x3ec3ef15,0x3eac7cd4,0x3e94a031,0x3e78cfcc,0x3ea09ae5,0x3e870ada,0x3e5a3997,0x3e25c58c
.long 0x3e78cfcc,0x3e419b37,0x3e09cf86,0x3da3308c,0x3e2f10a2,0x3de7fa9a,0x3d621469,0xbb490fc6
.long 0x3dc8bd36,0x3d16c32c,0xbcc90ab0,0xbdafb680,0x3cc90ab0,0xbd2351cb,0xbdd53db9,0xbe2bf804
.long 0xbd48fb30,0xbdee3876,0xbe3b6ecf,0xbe7ee6e1,0xbdfab273,0xbe44b0b9,0xbe8586ce,0xbea80b1f
.long 0xbe47c5c2,0xbe888e93,0xbeac7cd4,0xbecf7bca,0xbe888e93,0xbeadf73c,0xbed25a09,0xbef58035
.long 0xbeac7cd4,0xbed25a09,0xbef6e0cb,0xbf0cead0,0xbecf7bca,0xbef58035,0xbf0cead0,0xbf1e1e22
.long 0xbef15aea,0xbf0b9a6b,0xbf1d7fd1,0xbf2e3bde,0xbf08f59b,0xbf1ba299,0xbf2d1469,0xbf3d27b8
.long 0xbf187fc0,0xbf2ac082,0xbf3b8f3b,0xbf4ac77f,0xbf273656,0xbf38dd65,0xbf48d8b3,0xbf570348
.long 0x3f800000,0x3f800000,0x3f800000,0x3f800000,0x3f7f0e58,0x3f7efcc9,0x3f7eea9d,0x3f7ed7d4
.long 0x3f7c3b28,0x3f7bf531,0x3f7baccd,0x3f7b61fc,0x3f778bc5,0x3f76ef5b,0x3f764d97,0x3f75a67b
.long 0x3f710908,0x3f6ff573,0x3f6ed89e,0x3f6db293,0x3f68bf3c,0x3f671599,0x3f655e0b,0x3f6398ac
.long 0x3f5ebe05,0x3f5c61c7,0x3f59f26a,0x3f577026,0x3f531849,0x3f4fefa8,0x3f4cae79,0x3f495521
.long 0x3f45e403,0x3f41d870,0x3f3daef9,0x3f396842,0x3f373a23,0x3f3238aa,0x3f2d1469,0x3f27ce61
.long 0x3f273656,0x3f212ff9,0x3f1b02c6,0x3f14b039,0x3f15f6d9,0x3f0ee0db,0x3f07a136,0x3f003a06
.long 0x3f039c3d,0x3ef6e0cb,0x3ee63375,0x3ed53641,0x3ee0924f,0x3ece0bea,0x3ebb31a0,0x3ea80b1f
.long 0x3eb8442a,0x3ea395c5,0x3e8e9a22,0x3e72b651,0x3e8e9a22,0x3e6fa8b2,0x3e419b37,0x3e1324ca
.long 0x3e47c5c2,0x3e164083,0x3dc8bd36,0x3d48fb30,0x3de1bc2e,0x3d6ea038,0x3bc90f88,0xbd3c6dd5
.long 0x3cc90ab0,0xbcfb49ba,0xbdafb680,0xbe1008b7,0xbd7b2b74,0xbdf475c0,0xbe354098,0xbe6fa8b2
.long 0xbe164083,0xbe541501,0xbe888e93,0xbea68f12,0xbe6c9a7f,0xbe9620d2,0xbeb554ec,0xbed3c867
.long 0xbea09ae5,0xbec1071e,0xbee0924f,0xbeff17b2,0xbec9b953,0xbeea6681,0xbf04f484,0xbf140c5f
.long 0xbef15aea,0xbf08f59b,0xbf187fc0,0xbf273656,0xbf0b9a6b,0xbf1ba299,0xbf2ac082,0xbf38dd65
.long 0xbf1d7fd1,0xbf2d1469,0xbf3b8f3b,0xbf48d8b3,0xbf2e3bde,0xbf3d27b8,0xbf4ac77f,0xbf570348
.long 0xbf3daef9,0xbf4bbbf8,0xbf584853,0xbf633c5a,0xbf4bbbf8,0xbf58b3a1,0xbf63f473,0xbf6d67a1
.long 0xbf584853,0xbf63f473,0xbf6db293,0xbf756d97,0xbf633c5a,0xbf6d67a1,0xbf756d97,0xbf7b3bab
.long 0x0,0x0,0x0,0x0,0x3d96a905,0x3d9cecf9,0x3da3308c,0x3da973ba
.long 0x3e164083,0x3e1c76de,0x3e22abb6,0x3e28defc,0x3e605c13,0x3e698bba,0x3e72b651,0x3e7bdba4
.long 0x3e94a031,0x3e9aa086,0x3ea09ae5,0x3ea68f12,0x3eb8442a,0x3ebf926f,0x3ec6d529,0x3ece0bea
.long 0x3edae880,0x3ee363fa,0x3eebcbbb,0x3ef41f07,0x3efc5d27,0x3f02ef9f,0x3f07a136,0x3f0c42c9
.long 0x3f0e39da,0x3f13682a,0x3f187fc0,0x3f1d7fd1,0x3f1d7fd1,0x3f2302d3,0x3f286605,0x3f2da859
.long 0x3f2beb4a,0x3f31a81d,0x3f373a23,0x3f3ca003,0x3f396842,0x3f3f41fc,0x3f44e3f5,0x3f4a4c87
.long 0x3f45e403,0x3f4bbbf8,0x3f514d3d,0x3f5695e5,0x3f514d3d,0x3f570348,0x3f5c61c7,0x3f61668a
.long 0x3f5b941a,0x3f6106f2,0x3f660f88,0x3f6aab7b,0x3f64aa59,0x3f69b7e4,0x3f6e46be,0x3f725470
.long 0x3f6c835e,0x3f710908,0x3f74fa0b,0x3f7853f8,0x3f731447,0x3f76ef5b,0x3f7a1e84,0x3f7c9f8a
.long 0x3f7853f8,0x3f7b61fc,0x3f7dabcc,0x3f7f2f9d,0x3f7c3b28,0x3f7e5a38,0x3f7f9c18,0x3f7fffb1
.long 0x3f7ec46d,0x3f7fd397,0x3f7fec43,0x3f7f0e58,0x3f7fec43,0x3f7fcbe2,0x3f7e9bc9,0x3f7c5d3a
.long 0x3f7fb10f,0x3f7e4323,0x3f7baccd,0x3f77f110,0x3f7e1324,0x3f7b3bab,0x3f772417,0x3f71d19f
.long 0x3f7b14be,0x3f76ba07,0x3f710908,0x3f6a09a7,0x3f76ba07,0x3f70c501,0x3f696591,0x3f60a6cf
.long 0x3f710908,0x3f696591,0x3f604621,0x3f55b993,0x3f6a09a7,0x3f60a6cf,0x3f55b993,0x3f495521
.long 0x3f61c598,0x3f5695e5,0x3f49d112,0x3f3b8f3b,0x3f584853,0x3f4b41fa,0x3f3ca003,0x3f2c800f
.long 0x3f4d9f02,0x3f3ebc1b,0x3f2e3bde,0x3f1c420c,0x3f41d870,0x3f311722,0x3f1ebc12,0x3f0af1b7
.long 0x0,0x0,0x0,0x0,0x3dafb680,0x3db5f8da,0x3dbc3ac3,0x3dc27c39
.long 0x3e2f10a2,0x3e354098,0x3e3b6ecf,0x3e419b37,0x3e827dc0,0x3e870ada,0x3e8b9507,0x3e901c2c
.long 0x3eac7cd4,0x3eb263ef,0x3eb8442a,0x3ebe1d4a,0x3ed53641,0x3edc53c1,0x3ee363fa,0x3eea6681
.long 0x3efc5d27,0x3f0242b1,0x3f064b82,0x3f0a48ad,0x3f10d3cd,0x3f1553b7,0x3f19c200,0x3f1e1e22
.long 0x3f226799,0x3f273656,0x3f2beb4a,0x3f3085bb,0x3f32c8c9,0x3f37c655,0x3f3ca003,0x3f4154e1
.long 0x3f41d870,0x3f46e22a,0x3f4bbbf8,0x3f5064af,0x3f4f7a1f,0x3f546b3b,0x3f591e6a,0x3f5d924d
.long 0x3f5b941a,0x3f604621,0x3f64aa59,0x3f68bf3c,0x3f660f88,0x3f6a5ad9,0x3f6e46be,0x3f71d19f
.long 0x3f6ed89e,0x3f7294f8,0x3f75dec6,0x3f78b47b,0x3f75dec6,0x3f78e3d6,0x3f7b61fc,0x3f7d57de
.long 0x3f7b14be,0x3f7d3aac,0x3f7ec46d,0x3f7fb10f,0x3f7e70b0,0x3f7f90b1,0x3f7ffec4,0x3f7fba9e
.long 0x3f7fec43,0x3f7fe129,0x3f7f0e58,0x3f7d7474,0x3f7f84ab,0x3f7e2b72,0x3f7bf531,0x3f78e3d6
.long 0x3f7d3aac,0x3f7a7302,0x3f76ba07,0x3f721352,0x3f791298,0x3f74bf62,0x3f6f6830,0x3f6912ae
.long 0x3f731447,0x3f6d1c1d,0x3f660f88,0x3f5df6be,0x3f6b4b0c,0x3f6398ac,0x3f5ac450,0x3f50d937
.long 0x3f61c598,0x3f584853,0x3f4d9f02,0x3f41d870,0x3f5695e5,0x3f4b41fa,0x3f3ebc1b,0x3f311722
.long 0x3f49d112,0x3f3ca003,0x3f2e3bde,0x3f1ebc12,0x3f3b8f3b,0x3f2c800f,0x3f1c420c,0x3f0af1b7
.long 0x3f2beb4a,0x3f1b02c6,0x3f08f59b,0x3eebcbbb,0x3f1b02c6,0x3f084b92,0x3ee900b7,0x3ebf926f
.long 0x3f08f59b,0x3ee900b7,0x3ebe1d4a,0x3e919ddd,0x3eebcbbb,0x3ebf926f,0x3e919ddd,0x3e44b0b9
.long 0x3f800000,0x3f800000,0x3f800000,0x3f800000,0x3f7ec46d,0x3f7eb069,0x3f7e9bc9,0x3f7e868b
.long 0x3f7b14be,0x3f7ac516,0x3f7a7302,0x3f7a1e84,0x3f74fa0b,0x3f74484b,0x3f73913f,0x3f72d4eb
.long 0x3f6c835e,0x3f6b4b0c,0x3f6a09a7,0x3f68bf3c,0x3f61c598,0x3f5fe4e9,0x3f5df6be,0x3f5bfb34
.long 0x3f54db31,0x3f5233c6,0x3f4f7a1f,0x3f4cae79,0x3f45e403,0x3f425b89,0x3f3ebc1b,0x3f3b0629
.long 0x3f3504f3,0x3f3085bb,0x3f2beb4a,0x3f273656,0x3f226799,0x3f1ce11f,0x3f173c07,0x3f11796b
.long 0x3f0e39da,0x3f07a136,0x3f00e7e4,0x3ef41f07,0x3ef15aea,0x3ee1fb6a,0x3ed25a09,0x3ec27b55
.long 0x3ec3ef15,0x3eb263ef,0x3ea09ae5,0x3e8e9a22,0x3e94a031,0x3e80f8c0,0x3e5a3997,0x3e3228d4
.long 0x3e47c5c2,0x3e1c76de,0x3de1bc2e,0x3d8a200a,0x3dc8bd36,0x3d55880e,0x3bc90f88,0xbd2351cb
.long 0x0,0xbd48fb30,0xbdc8bd36,0xbe164083,0xbdc8bd36,0xbe195be0,0xbe4dee60,0xbe80f8c0
.long 0xbe47c5c2,0xbe7ee6e1,0xbe9aa086,0xbeb554ec,0xbe94a031,0xbeb0eacb,0xbecc9b8b,0xbee79a5d
.long 0xbec3ef15,0xbee0924f,0xbefc5d27,0xbf0b9a6b,0xbef15aea,0xbf06f686,0xbf14b039,0xbf21cbfb
.long 0xbf0e39da,0xbf1c420c,0xbf299415,0xbf36206c,0xbf226799,0xbf2ff3e6,0xbf3ca003,0xbf485bca
.long 0xbf3504f3,0xbf41d870,0xbf4d9f02,0xbf584853,0xbf45e403,0xbf51c0c2,0xbf5c61c7,0xbf65b710
.long 0xbf54db31,0xbf5f8327,0xbf68bf3c,0xbf708066,0xbf61c598,0xbf6afb8c,0xbf7294f8,0xbf788486
.long 0xbf6c835e,0xbf740bdd,0xbf79c79d,0xbf7dabcc,0xbf74fa0b,0xbf7a9c59,0xbf7e4323,0xbf7fe705
.long 0xbf7b14be,0xbf7e9bc9,0xbf7ffb11,0xbf7f2f9d,0xbf7ec46d,0xbf7fffb1,0xbf7eea9d,0xbf7b87b2
.long 0x3f800000,0x3f800000,0x3f800000,0x3f800000,0x3f7e70b0,0x3f7e5a38,0x3f7e4323,0x3f7e2b72
.long 0x3f79c79d,0x3f796e4e,0x3f791298,0x3f78b47b,0x3f721352,0x3f714c7a,0x3f708066,0x3f6faf1b
.long 0x3f676bd8,0x3f660f88,0x3f64aa59,0x3f633c5a,0x3f59f26a,0x3f57dc7f,0x3f55b993,0x3f5389c7
.long 0x3f49d112,0x3f46e22a,0x3f43e200,0x3f40d0da,0x3f373a23,0x3f33587a,0x3f2f61a5,0x3f2b561b
.long 0x3f226799,0x3f1d7fd1,0x3f187fc0,0x3f13682a,0x3f0b9a6b,0x3f05a02c,0x3eff17b2,0x3ef2bd43
.long 0x3ee63375,0x3ed8106b,0x3ec9b953,0x3ebb31a0,0x3eb263ef,0x3ea21887,0x3e919ddd,0x3e80f8c0
.long 0x3e78cfcc,0x3e541501,0x3e2f10a2,0x3e09cf86,0x3e09cf86,0x3dc27c39,0x3d621469,0x3c7b514b
.long 0x3cc90ab0,0xbc96c9b6,0xbd7b2b74,0xbdd53db9,0xbdafb680,0xbe06b26e,0xbe354098,0xbe636c83
.long 0xbe47c5c2,0xbe78cfcc,0xbe94a031,0xbeac7cd4,0xbe9aa086,0xbeb3dca5,0xbecc9b8b,0xbee4cbfe
.long 0xbecf7bca,0xbee900b7,0xbf00e7e4,0xbf0cead0,0xbf00e7e4,0xbf0d9281,0xbf19c200,0xbf256bcb
.long 0xbf187fc0,0xbf24d225,0xbf3085bb,0xbf3b8f3b,0xbf2e3bde,0xbf39f2ac,0xbf44e3f5,0xbf4f0417
.long 0xbf41d870,0xbf4cae79,0xbf5695e5,0xbf5f8327,0xbf531849,0xbf5cc7d1,0xbf655e0b,0xbf6cd007
.long 0xbf61c598,0xbf6a09a7,0xbf710908,0xbf76ba07,0xbf6db293,0xbf74484b,0xbf796e4e,0xbf7d1cdd
.long 0xbf76ba07,0xbf7b61fc,0xbf7e70b0,0xbf7fe129,0xbf7cbfc9,0xbf7f3f54,0xbf7ffec4,0xbf7efcc9
.long 0xbf7fb10f,0xbf7fd397,0xbf7e1324,0xbf7a7302,0xbf7f84ab,0xbf7d1cdd,0xbf78b47b,0xbf725470
.long 0xbf7c3b28,0xbf772417,0xbf6ff573,0xbf66becc,0xbf75dec6,0xbf6dfcf2,0xbf63f473,0xbf57dc7f
.long 0x0,0x0,0x0,0x0,0x3dc8bd36,0x3dcefdb7,0x3dd53db9,0x3ddb7d37
.long 0x3e47c5c2,0x3e4dee60,0x3e541501,0x3e5a3997,0x3e94a031,0x3e9920fe,0x3e9d9e78,0x3ea21887
.long 0x3ec3ef15,0x3ec9b953,0x3ecf7bca,0x3ed53641,0x3ef15aea,0x3ef840c8,0x3eff17b2,0x3f02ef9f
.long 0x3f0e39da,0x3f121eb0,0x3f15f6d9,0x3f19c200,0x3f226799,0x3f269de3,0x3f2ac082,0x3f2ecef7
.long 0x3f3504f3,0x3f396842,0x3f3daef9,0x3f41d870,0x3f45e403,0x3f4a4c87,0x3f4e8d90,0x3f52a649
.long 0x3f54db31,0x3f591e6a,0x3f5d2d53,0x3f6106f2,0x3f61c598,0x3f65b710,0x3f696591,0x3f6cd007
.long 0x3f6c835e,0x3f6ff573,0x3f731447,0x3f75dec6,0x3f74fa0b,0x3f77beb7,0x3f7a1e84,0x3f7c187a
.long 0x3f7b14be,0x3f7cfe73,0x3f7e70b0,0x3f7f6ac7,0x3f7ec46d,0x3f7fa6e3,0x3f7ffec4,0x3f7fcbe2
.long 0x3f800000,0x3f7fb10f,0x3f7ec46d,0x3f7d3aac,0x3f7ec46d,0x3f7d1cdd,0x3f7ac516,0x3f77beb7
.long 0x3f7b14be,0x3f77f110,0x3f740bdd,0x3f6f6830,0x3f74fa0b,0x3f703b37,0x3f6aab7b,0x3f644fac
.long 0x3f6c835e,0x3f660f88,0x3f5ebe05,0x3f5695e5,0x3f61c598,0x3f5988ad,0x3f5064af,0x3f466354
.long 0x3f54db31,0x3f4ac77f,0x3f3fc767,0x3f33e7bc,0x3f45e403,0x3f39f2ac,0x3f2d1469,0x3f1f599f
.long 0x3f3504f3,0x3f273656,0x3f187fc0,0x3f08f59b,0x3f226799,0x3f12c39a,0x3f0242b1,0x3ee1fb6a
.long 0x3f0e39da,0x3ef9a02d,0x3ed53641,0x3eaf713a,0x3ef15aea,0x3ecb2aae,0x3ea395c5,0x3e75c35a
.long 0x3ec3ef15,0x3e9aa086,0x3e605c13,0x3e09cf86,0x3e94a031,0x3e5101f1,0x3dee3876,0x3ce22a7a
.long 0x3e47c5c2,0x3dd53db9,0x3c490e90,0xbda3308c,0x3dc8bd36,0x3b490fc6,0xbdbc3ac3,0xbe3e853e
.long 0x0,0x0,0x0,0x0,0x3de1bc2e,0x3de7fa9a,0x3dee3876,0x3df475c0
.long 0x3e605c13,0x3e667c66,0x3e6c9a7f,0x3e72b651,0x3ea68f12,0x3eab0201,0x3eaf713a,0x3eb3dca5
.long 0x3edae880,0x3ee0924f,0x3ee63375,0x3eebcbbb,0x3f064b82,0x3f099f4e,0x3f0cead0,0x3f102dd5
.long 0x3f1d7fd1,0x3f212ff9,0x3f24d225,0x3f286605,0x3f32c8c9,0x3f36ad7f,0x3f3a7ca4,0x3f3e35c5
.long 0x3f45e403,0x3f49d112,0x3f4d9f02,0x3f514d3d,0x3f5695e5,0x3f5a5ba0,0x3f5df6be,0x3f61668a
.long 0x3f64aa59,0x3f6816a8,0x3f6b4b0c,0x3f6e46be,0x3f6ff573,0x3f72d4eb,0x3f756d97,0x3f77beb7
.long 0x3f7853f8,0x3f7a7302,0x3f7c3b28,0x3f7dabcc,0x3f7dabcc,0x3f7ed7d4,0x3f7f9c18,0x3f7ff84a
.long 0x3f7fec43,0x3f7ff4e6,0x3f7f84ab,0x3f7e9bc9,0x3f7f0e58,0x3f7dc68c,0x3f7bf531,0x3f799b43
.long 0x3f7b14be,0x3f7853f8,0x3f74fa0b,0x3f710908,0x3f740bdd,0x3f6faf1b,0x3f6aab7b,0x3f650479
.long 0x3f6a09a7,0x3f63f473,0x3f5d2d53,0x3f55b993,0x3f5d2d53,0x3f554aa4,0x3f4cae79,0x3f436051
.long 0x3f4d9f02,0x3f43e200,0x3f396842,0x3f2e3bde,0x3f3b8f3b,0x3f2ff3e6,0x3f239da9,0x3f16999f
.long 0x3f273656,0x3f19c200,0x3f0b9a6b,0x3ef9a02d,0x3f10d3cd,0x3f019573,0x3ee363fa,0x3ec27b55
.long 0x3ef15aea,0x3ecf7bca,0x3eac7cd4,0x3e888e93,0x3ebe1d4a,0x3e9920fe,0x3e667c66,0x3e195be0
.long 0x3e888e93,0x3e419b37,0x3de1bc2e,0x3cfb49ba,0x3e22abb6,0x3d9cecf9,0xbbc90f88,0xbdb5f8da
.long 0x3d48fb30,0xbd16c32c,0xbdfab273,0xbe541501,0xbd7b2b74,0xbe195be0,0xbe72b651,0xbea5129f
.long 0xbe2f10a2,0xbe8586ce,0xbeb263ef,0xbeddbe79,0xbe8e9a22,0xbebca7af,0xbee900b7,0xbf099f4e
.long 0x3f800000,0x3f800000,0x3f800000,0x3f800000,0x3f7e1324,0x3f7dfa38,0x3f7de0b1,0x3f7dc68c
.long 0x3f7853f8,0x3f77f110,0x3f778bc5,0x3f772417,0x3f6ed89e,0x3f6dfcf2,0x3f6d1c1d,0x3f6c3624
.long 0x3f61c598,0x3f604621,0x3f5ebe05,0x3f5d2d53,0x3f514d3d,0x3f4f0417,0x3f4cae79,0x3f4a4c87
.long 0x3f3daef9,0x3f3a7ca4,0x3f373a23,0x3f33e7bc,0x3f273656,0x3f2302d3,0x3f1ebc12,0x3f1a6293
.long 0x3f0e39da,0x3f08f59b,0x3f039c3d,0x3efc5d27,0x3ee63375,0x3ed97cb9,0x3ecc9b8b,0x3ebf926f
.long 0x3eac7cd4,0x3e9d9e78,0x3e8e9a22,0x3e7ee6e1,0x3e605c13,0x3e3e853e,0x3e1c76de,0x3df475c0
.long 0x3dc8bd36,0x3d7b2b74,0x3cc90ab0,0xbc490e90,0xbcc90ab0,0xbd83db0a,0xbdd53db9,0xbe1324ca
.long 0xbe164083,0xbe419b37,0xbe6c9a7f,0xbe8b9507,0xbe888e93,0xbe9f1cdf,0xbeb554ec,0xbecb2aae
.long 0xbec3ef15,0xbedae880,0xbef15aea,0xbf039c3d,0xbefc5d27,0xbf099f4e,0xbf14b039,0xbf1f599f
.long 0xbf187fc0,0xbf239da9,0xbf2e3bde,0xbf385216,0xbf3085bb,0xbf3b0629,0xbf44e3f5,0xbf4e1689
.long 0xbf45e403,0xbf4f7a1f,0xbf584853,0xbf604621,0xbf584853,0xbf60a6cf,0xbf6816a8,0xbf6e8ff8
.long 0xbf676bd8,0xbf6e46be,0xbf740bdd,0xbf78b47b,0xbf731447,0xbf7822d1,0xbf7bf531,0xbf7e868b
.long 0xbf7b14be,0xbf7e1324,0xbf7fb10f,0xbf7fec43,0xbf7f4e6d,0xbf7fffb1,0xbf7f2f9d,0xbf7cdf6c
.long 0xbf7fb10f,0xbf7de0b1,0xbf7a7302,0xbf756d97,0xbf7c3b28,0xbf77beb7,0xbf718f57,0xbf69b7e4
.long 0xbf74fa0b,0xbf6db293,0xbf64aa59,0xbf59f26a,0xbf6a09a7,0xbf5fe4e9,0xbf53fac3,0xbf466354
.long 0xbf5b941a,0xbf4e8d90,0xbf3fc767,0xbf2f61a5,0xbf49d112,0xbf39f2ac,0xbf286605,0xbf1553b7
.long 0x3f800000,0x3f800000,0x3f800000,0x3f800000,0x3f7dabcc,0x3f7d906e,0x3f7d7474,0x3f7d57de
.long 0x3f76ba07,0x3f764d97,0x3f75dec6,0x3f756d97,0x3f6b4b0c,0x3f6a5ad9,0x3f696591,0x3f686b39
.long 0x3f5b941a,0x3f59f26a,0x3f584853,0x3f5695e5,0x3f47de65,0x3f456439,0x3f42de29,0x3f404c5c
.long 0x3f3085bb,0x3f2d1469,0x3f299415,0x3f26050a,0x3f15f6d9,0x3f11796b,0x3f0cead0,0x3f084b92
.long 0x3ef15aea,0x3ee63375,0x3edae880,0x3ecf7bca,0x3eb263ef,0x3ea5129f,0x3e97a117,0x3e8a11f7
.long 0x3e605c13,0x3e419b37,0x3e22abb6,0x3e039502,0x3dafb680,0x3d55880e,0x3c96c9b6,0xbc7b514b
.long 0xbd48fb30,0xbdafb680,0xbdfab273,0xbe22abb6,0xbe3b6ecf,0xbe636c83,0xbe8586ce,0xbe9920fe
.long 0xbea09ae5,0xbeb554ec,0xbec9b953,0xbeddbe79,0xbee0924f,0xbef58035,0xbf04f484,0xbf0ee0db
.long 0xbf0e39da,0xbf187fc0,0xbf226799,0xbf2beb4a,0xbf299415,0xbf33587a,0xbf3ca003,0xbf456439
.long 0xbf41d870,0xbf4ac77f,0xbf531849,0xbf5ac450,0xbf5695e5,0xbf5e5aa6,0xbf655e0b,0xbf6b99fb
.long 0xbf676bd8,0xbf6db293,0xbf731447,0xbf778bc5,0xbf740bdd,0xbf788486,0xbf7bf531,0xbf7e5a38
.long 0xbf7c3b28,0xbf7e9bc9,0xbf7fd397,0xbf7fe129,0xbf7fd397,0xbf7fdaaf,0xbf7e9bc9,0xbf7c187a
.long 0xbf7ec46d,0xbf7c3b28,0xbf7853f8,0xbf731447,0xbf791298,0xbf73ced9,0xbf6d1c1d,0xbf650479
.long 0xbf6ed89e,0xbf66becc,0xbf5d2d53,0xbf5233c6,0xbf604621,0xbf554aa4,0xbf48d8b3,0xbf3b0629
.long 0xbf4d9f02,0xbf3fc767,0xbf3085bb,0xbf1ff6cb,0xbf373a23,0xbf269de3,0xbf14b039,0xbf019573
.long 0xbf1d7fd1,0xbf0a48ad,0xbeebcbbb,0xbec1071e,0xbf00e7e4,0xbed6a399,0xbea986c4,0xbe75c35a
.long 0x0,0x0,0x0,0x0,0x3dfab273,0x3e007745,0x3e039502,0x3e06b26e
.long 0x3e78cfcc,0x3e7ee6e1,0x3e827dc0,0x3e8586ce,0x3eb8442a,0x3ebca7af,0x3ec1071e,0x3ec5625c
.long 0x3ef15aea,0x3ef6e0cb,0x3efc5d27,0x3f00e7e4,0x3f13682a,0x3f16999f,0x3f19c200,0x3f1ce11f
.long 0x3f2beb4a,0x3f2f61a5,0x3f32c8c9,0x3f36206c,0x3f41d870,0x3f456439,0x3f48d8b3,0x3f4c3578
.long 0x3f54db31,0x3f584853,0x3f5b941a,0x3f5ebe05,0x3f64aa59,0x3f67c187,0x3f6aab7b,0x3f6d67a1
.long 0x3f710908,0x3f73913f,0x3f75dec6,0x3f77f110,0x3f79c79d,0x3f7b87b2,0x3f7cfe73,0x3f7e2b72
.long 0x3f7ec46d,0x3f7f84ab,0x3f7fec43,0x3f7ffb11,0x3f7fec43,0x3f7f7808,0x3f7e9bc9,0x3f7d57de
.long 0x3f7d3aac,0x3f7b61fc,0x3f791298,0x3f764d97,0x3f76ba07,0x3f73530e,0x3f6f6830,0x3f6afb8c
.long 0x3f6c835e,0x3f676bd8,0x3f61c598,0x3f5b941a,0x3f5ebe05,0x3f57dc7f,0x3f5064af,0x3f485bca
.long 0x3f4d9f02,0x3f44e3f5,0x3f3b8f3b,0x3f31a81d,0x3f396842,0x3f2ecef7,0x3f239da9,0x3f17de12
.long 0x3f226799,0x3f15f6d9,0x3f08f59b,0x3ef6e0cb,0x3f08f59b,0x3ef58035,0x3ed8106b,0x3eb9bb1e
.long 0x3edae880,0x3ebb31a0,0x3e9aa086,0x3e72b651,0x3ea09ae5,0x3e7bdba4,0x3e354098,0x3ddb7d37
.long 0x3e47c5c2,0x3dfab273,0x3d48fb30,0xbcc90ab0,0x3d96a905,0xbb490fc6,0xbda3308c,0xbe1f917b
.long 0xbd48fb30,0xbe039502,0xbe541501,0xbe919ddd,0xbe2f10a2,0xbe80f8c0,0xbea986c4,0xbed0eb2a
.long 0xbe94a031,0xbebe1d4a,0xbee63375,0xbf064b82,0xbecf7bca,0xbef840c8,0xbf0f8784,0xbf21cbfb
.long 0xbf039c3d,0xbf173c07,0xbf299415,0xbf3a7ca4,0xbf1d7fd1,0xbf2ff3e6,0xbf40d0da,0xbf4fefa8
.long 0x0,0x0,0x0,0x0,0x3e09cf86,0x3e0cec4a,0x3e1008b7,0x3e1324ca
.long 0x3e888e93,0x3e8b9507,0x3e8e9a22,0x3e919ddd,0x3ec9b953,0x3ece0bea,0x3ed25a09,0x3ed6a399
.long 0x3f039c3d,0x3f064b82,0x3f08f59b,0x3f0b9a6b,0x3f1ff6cb,0x3f2302d3,0x3f26050a,0x3f28fd41
.long 0x3f396842,0x3f3ca003,0x3f3fc767,0x3f42de29,0x3f4f7a1f,0x3f52a649,0x3f55b993,0x3f58b3a1
.long 0x3f61c598,0x3f64aa59,0x3f676bd8,0x3f6a09a7,0x3f6ff573,0x3f725470,0x3f748422,0x3f76841b
.long 0x3f79c79d,0x3f7b61fc,0x3f7cbfc9,0x3f7de0b1,0x3f7f0e58,0x3f7fa6e3,0x3f7ff4e6,0x3f7ff84a
.long 0x3f7fb10f,0x3f7f0e58,0x3f7e1324,0x3f7cbfc9,0x3f7baccd,0x3f799b43,0x3f772417,0x3f74484b
.long 0x3f731447,0x3f6f6830,0x3f6b4b0c,0x3f66becc,0x3f660f88,0x3f60a6cf,0x3f5ac450,0x3f546b3b
.long 0x3f54db31,0x3f4d9f02,0x3f45e403,0x3f3daef9,0x3f3fc767,0x3f36ad7f,0x3f2d1469,0x3f2302d3
.long 0x3f273656,0x3f1c420c,0x3f10d3cd,0x3f04f484,0x3f0b9a6b,0x3efdbabb,0x3ee363fa,0x3ec8477c
.long 0x3edae880,0x3ebe1d4a,0x3ea09ae5,0x3e827dc0,0x3e9aa086,0x3e75c35a,0x3e354098,0x3de7fa9a
.long 0x3e2f10a2,0x3dd53db9,0x3d16c32c,0xbcfb49ba,0x3d16c32c,0xbd0a342f,0xbdd53db9,0xbe3228d4
.long 0xbdc8bd36,0xbe2f10a2,0xbe78cfcc,0xbea09ae5,0xbe6c9a7f,0xbe9c1faf,0xbec1071e,0xbee4cbfe
.long 0xbeb8442a,0xbeddbe79,0xbf00e7e4,0xbf121eb0,0xbef6e0cb,0xbf0d9281,0xbf1ebc12,0xbf2ecef7
.long 0xbf187fc0,0xbf299415,0xbf396842,0xbf47de65,0xbf32c8c9,0xbf425b89,0xbf5064af,0xbf5cc7d1
.long 0xbf49d112,0xbf577026,0xbf633c5a,0xbf6d1c1d,0xbf5d2d53,0xbf686b39,0xbf718f57,0xbf788486
.long 0x3f800000,0x3f800000,0x3f800000,0x3f800000,0x3f7d3aac,0x3f7d1cdd,0x3f7cfe73,0x3f7cdf6c
.long 0x3f74fa0b,0x3f748422,0x3f740bdd,0x3f73913f,0x3f676bd8,0x3f666771,0x3f655e0b,0x3f644fac
.long 0x3f54db31,0x3f531849,0x3f514d3d,0x3f4f7a1f,0x3f3daef9,0x3f3b0629,0x3f385216,0x3f3592e7
.long 0x3f226799,0x3f1ebc12,0x3f1b02c6,0x3f173c07,0x3f039c3d,0x3efdbabb,0x3ef41f07,0x3eea6681
.long 0x3ec3ef15,0x3eb8442a,0x3eac7cd4,0x3ea09ae5,0x3e78cfcc,0x3e5d4b1a,0x3e419b37,0x3e25c58c
.long 0x3dc8bd36,0x3d8a200a,0x3d16c32c,0x3bc90f88,0xbd48fb30,0xbda973ba,0xbdee3876,0xbe195be0
.long 0xbe47c5c2,0xbe6c9a7f,0xbe888e93,0xbe9aa086,0xbeac7cd4,0xbebf926f,0xbed25a09,0xbee4cbfe
.long 0xbef15aea,0xbf0242b1,0xbf0b9a6b,0xbf14b039,0xbf187fc0,0xbf21cbfb,0xbf2ac082,0xbf33587a
.long 0xbf3504f3,0xbf3daef9,0xbf45e403,0xbf4d9f02,0xbf4d9f02,0xbf554aa4,0xbf5c61c7,0xbf62df7b
.long 0xbf61c598,0xbf6816a8,0xbf6db293,0xbf7294f8,0xbf710908,0xbf75a67b,0xbf796e4e,0xbf7c5d3a
.long 0xbf7b14be,0xbf7dabcc,0xbf7f4e6d,0xbf7ffb11,0xbf7fb10f,0xbf7ff84a,0xbf7f2f9d,0xbf7d57de
.long 0xbf7ec46d,0xbf7c7eb0,0xbf791298,0xbf748422,0xbf7853f8,0xbf73530e,0xbf6d1c1d,0xbf65b710
.long 0xbf6c835e,0xbf64aa59,0xbf5b941a,0xbf514d3d,0xbf5b941a,0xbf50d937,0xbf44e3f5,0xbf37c655
.long 0xbf45e403,0xbf385216,0xbf299415,0xbf19c200,0xbf2beb4a,0xbf1ba299,0xbf0a48ad,0xbeeff7fb
.long 0xbf0e39da,0xbef6e0cb,0xbecf7bca,0xbea68f12,0xbedae880,0xbeb0eacb,0xbe8586ce,0xbe3228d4
.long 0xbe94a031,0xbe4dee60,0xbde1bc2e,0xbc96c9b6,0xbe164083,0xbd55880e,0x3d2fe007,0x3e0cec4a
.long 0x3f800000,0x3f800000,0x3f800000,0x3f800000,0x3f7cbfc9,0x3f7c9f8a,0x3f7c7eb0,0x3f7c5d3a
.long 0x3f731447,0x3f7294f8,0x3f721352,0x3f718f57,0x3f633c5a,0x3f62241a,0x3f6106f2,0x3f5fe4e9
.long 0x3f4d9f02,0x3f4bbbf8,0x3f49d112,0x3f47de65,0x3f32c8c9,0x3f2ff3e6,0x3f2d1469,0x3f2a2a80
.long 0x3f13682a,0x3f0f8784,0x3f0b9a6b,0x3f07a136,0x3ee0924f,0x3ed6a399,0x3ecc9b8b,0x3ec27b55
.long 0x3e94a031,0x3e888e93,0x3e78cfcc,0x3e605c13,0x3e09cf86,0x3ddb7d37,0x3da3308c,0x3d55880e
.long 0xbcc90ab0,0xbd621469,0xbdafb680,0xbdee3876,0xbe3b6ecf,0xbe5d4b1a,0xbe7ee6e1,0xbe901c2c
.long 0xbeac7cd4,0xbebe1d4a,0xbecf7bca,0xbee0924f,0xbef6e0cb,0xbf044889,0xbf0cead0,0xbf1553b7
.long 0xbf1d7fd1,0xbf26050a,0xbf2e3bde,0xbf36206c,0xbf3b8f3b,0xbf436051,0xbf4ac77f,0xbf51c0c2
.long 0xbf54db31,0xbf5b941a,0xbf61c598,0xbf676bd8,0xbf68bf3c,0xbf6dfcf2,0xbf7294f8,0xbf76841b
.long 0xbf76ba07,0xbf7a1e84,0xbf7cbfc9,0xbf7e9bc9,0xbf7e70b0,0xbf7fa6e3,0xbf7ffec4,0xbf7f7808
.long 0xbf7fb10f,0xbf7e70b0,0xbf7c3b28,0xbf791298,0xbf7a7302,0xbf76841b,0xbf718f57,0xbf6b99fb
.long 0xbf6ed89e,0xbf6816a8,0xbf604621,0xbf577026,0xbf5d2d53,0xbf5389c7,0xbf48d8b3,0xbf3d27b8
.long 0xbf45e403,0xbf396842,0xbf2beb4a,0xbf1d7fd1,0xbf299415,0xbf1a6293,0xbf0a48ad,0xbef2bd43
.long 0xbf08f59b,0xbeee9479,0xbec9b953,0xbea395c5,0xbec9b953,0xbea21887,0xbe72b651,0xbe1f917b
.long 0xbe78cfcc,0xbe22abb6,0xbd96a905,0x3c490e90,0xbdafb680,0x3b490fc6,0x3dbc3ac3,0x3e3857ec
.long 0x3d96a905,0x3e28defc,0x3e827dc0,0x3eaf713a,0x3e6c9a7f,0x3ea5129f,0x3ed25a09,0x3efdbabb
.long 0x0,0x0,0x0,0x0,0x3e164083,0x3e195be0,0x3e1c76de,0x3e1f917b
.long 0x3e94a031,0x3e97a117,0x3e9aa086,0x3e9d9e78,0x3edae880,0x3edf28a9,0x3ee363fa,0x3ee79a5d
.long 0x3f0e39da,0x3f10d3cd,0x3f13682a,0x3f15f6d9,0x3f2beb4a,0x3f2ecef7,0x3f31a81d,0x3f34768f
.long 0x3f45e403,0x3f48d8b3,0x3f4bbbf8,0x3f4e8d90,0x3f5b941a,0x3f5e5aa6,0x3f6106f2,0x3f6398ac
.long 0x3f6c835e,0x3f6ed89e,0x3f710908,0x3f731447,0x3f7853f8,0x3f79f35e,0x3f7b61fc,0x3f7c9f8a
.long 0x3f7ec46d,0x3f7f6ac7,0x3f7fd397,0x3f7ffec4,0x3f7fb10f,0x3f7f1f49,0x3f7e4323,0x3f7d1cdd
.long 0x3f7b14be,0x3f791298,0x3f76ba07,0x3f740bdd,0x3f710908,0x3f6d67a1,0x3f696591,0x3f650479
.long 0x3f61c598,0x3f5c61c7,0x3f5695e5,0x3f5064af,0x3f4d9f02,0x3f466354,0x3f3ebc1b,0x3f36ad7f
.long 0x3f3504f3,0x3f2beb4a,0x3f226799,0x3f187fc0,0x3f187fc0,0x3f0d9281,0x3f0242b1,0x3eed3063
.long 0x3ef15aea,0x3ed8106b,0x3ebe1d4a,0x3ea395c5,0x3eac7cd4,0x3e901c2c,0x3e667c66,0x3e2bf804
.long 0x3e47c5c2,0x3e09cf86,0x3d96a905,0x3c490e90,0x3d48fb30,0xbc7b514b,0xbda3308c,0xbe1324ca
.long 0xbdc8bd36,0xbe28defc,0xbe6c9a7f,0xbe97a117,0xbe78cfcc,0xbe9f1cdf,0xbec1071e,0xbee1fb6a
.long 0xbec3ef15,0xbee63375,0xbf039c3d,0xbf13682a,0xbf039c3d,0xbf140c5f,0xbf239da9,0xbf3238aa
.long 0xbf226799,0xbf31a81d,0xbf3fc767,0xbf4cae79,0xbf3daef9,0xbf4b41fa,0xbf577026,0xbf62241a
.long 0xbf54db31,0xbf604621,0xbf6a09a7,0xbf721352,0xbf676bd8,0xbf703b37,0xbf772417,0xbf7c187a
.long 0xbf74fa0b,0xbf7ac516,0xbf7e70b0,0xbf7ff4e6,0xbf7d3aac,0xbf7fa6e3,0xbf7fc38f,0xbf7d906e
.long 0x0,0x0,0x0,0x0,0x3e22abb6,0x3e25c58c,0x3e28defc,0x3e2bf804
.long 0x3ea09ae5,0x3ea395c5,0x3ea68f12,0x3ea986c4,0x3eebcbbb,0x3eeff7fb,0x3ef41f07,0x3ef840c8
.long 0x3f187fc0,0x3f1b02c6,0x3f1d7fd1,0x3f1ff6cb,0x3f373a23,0x3f39f2ac,0x3f3ca003,0x3f3f41fc
.long 0x3f514d3d,0x3f53fac3,0x3f5695e5,0x3f591e6a,0x3f660f88,0x3f686b39,0x3f6aab7b,0x3f6cd007
.long 0x3f74fa0b,0x3f76ba07,0x3f7853f8,0x3f79c79d,0x3f7dabcc,0x3f7e868b,0x3f7f2f9d,0x3f7fa6e3
.long 0x3f7fec43,0x3f7f9c18,0x3f7f0e58,0x3f7e4323,0x3f7baccd,0x3f79f35e,0x3f77f110,0x3f75a67b
.long 0x3f710908,0x3f6db293,0x3f6a09a7,0x3f660f88,0x3f604621,0x3f5b2c79,0x3f55b993,0x3f4fefa8
.long 0x3f49d112,0x3f42de29,0x3f3b8f3b,0x3f33e7bc,0x3f2e3bde,0x3f256bcb,0x3f1c420c,0x3f12c39a
.long 0x3f0e39da,0x3f039c3d,0x3ef15aea,0x3edae880,0x3ed53641,0x3ebca7af,0x3ea395c5,0x3e8a11f7
.long 0x3e888e93,0x3e5a3997,0x3e22abb6,0x3dd53db9,0x3de1bc2e,0x3d55880e,0xbbc90f88,0xbd83db0a
.long 0xbd48fb30,0xbde1bc2e,0xbe2f10a2,0xbe6c9a7f,0xbe541501,0xbe8a11f7,0xbea986c4,0xbec8477c
.long 0xbeb8442a,0xbed8106b,0xbef6e0cb,0xbf0a48ad,0xbf00e7e4,0xbf102dd5,0xbf1ebc12,0xbf2c800f
.long 0xbf226799,0xbf3085bb,0xbf3daef9,0xbf49d112,0xbf3fc767,0xbf4c3578,0xbf577026,0xbf61668a
.long 0xbf584853,0xbf628210,0xbf6b4b0c,0xbf7294f8,0xbf6b4b0c,0xbf72d4eb,0xbf78b47b,0xbf7cdf6c
.long 0xbf7853f8,0xbf7cbfc9,0xbf7f4e6d,0xbf7ffb11,0xbf7f0e58,0xbf7fffb1,0xbf7eea9d,0xbf7bd14d
.long 0xbf7f4e6d,0xbf7c7eb0,0xbf778bc5,0xbf708066,0xbf791298,0xbf725470,0xbf696591,0xbf5e5aa6
.long 0x3f800000,0x3f800000,0x3f800000,0x3f800000,0x3f7c3b28,0x3f7c187a,0x3f7bf531,0x3f7bd14d
.long 0x3f710908,0x3f708066,0x3f6ff573,0x3f6f6830,0x3f5ebe05,0x3f5d924d,0x3f5c61c7,0x3f5b2c79
.long 0x3f45e403,0x3f43e200,0x3f41d870,0x3f3fc767,0x3f273656,0x3f24381a,0x3f212ff9,0x3f1e1e22
.long 0x3f039c3d,0x3eff17b2,0x3ef6e0cb,0x3eee9479,0x3eb8442a,0x3eadf73c,0x3ea395c5,0x3e9920fe
.long 0x3e47c5c2,0x3e2f10a2,0x3e164083,0x3dfab273,0x3cc90ab0,0xbb490fc6,0xbcfb49ba,0xbd6ea038
.long 0xbe164083,0xbe354098,0xbe541501,0xbe72b651,0xbea09ae5,0xbeb0eacb,0xbec1071e,0xbed0eb2a
.long 0xbef15aea,0xbf00e7e4,0xbf08f59b,0xbf10d3cd,0xbf1d7fd1,0xbf256bcb,0xbf2d1469,0xbf34768f
.long 0xbf3daef9,0xbf44e3f5,0xbf4bbbf8,0xbf5233c6,0xbf584853,0xbf5e5aa6,0xbf63f473,0xbf6912ae
.long 0xbf6c835e,0xbf710908,0xbf74fa0b,0xbf7853f8,0xbf79c79d,0xbf7c5d3a,0xbf7e4323,0xbf7f7808
.long 0xbf7fb10f,0xbf7ffec4,0xbf7f84ab,0xbf7e4323,0xbf7e1324,0xbf7bd14d,0xbf78b47b,0xbf74bf62
.long 0xbf74fa0b,0xbf6ff573,0xbf6a09a7,0xbf633c5a,0xbf64aa59,0xbf5cc7d1,0xbf53fac3,0xbf4a4c87
.long 0xbf4d9f02,0xbf42de29,0xbf373a23,0xbf2ac082,0xbf3085bb,0xbf2302d3,0xbf14b039,0xbf05a02c
.long 0xbf0e39da,0xbefc5d27,0xbedae880,0xbeb8442a,0xbecf7bca,0xbeab0201,0xbe8586ce,0xbe3e853e
.long 0xbe78cfcc,0xbe28defc,0xbdafb680,0xbbc90f88,0xbd96a905,0x3c16cb58,0x3dbc3ac3,0x3e3228d4
.long 0x3dc8bd36,0x3e3b6ecf,0x3e888e93,0x3eb263ef,0x3e888e93,0x3eb3dca5,0x3eddbe79,0x3f02ef9f
.long 0x3edae880,0x3f0242b1,0x3f15f6d9,0x3f286605,0x3f13682a,0x3f269de3,0x3f385216,0x3f485bca
.long 0x3f800000,0x3f800000,0x3f800000,0x3f800000,0x3f7baccd,0x3f7b87b2,0x3f7b61fc,0x3f7b3bab
.long 0x3f6ed89e,0x3f6e46be,0x3f6db293,0x3f6d1c1d,0x3f59f26a,0x3f58b3a1,0x3f577026,0x3f5627fe
.long 0x3f3daef9,0x3f3b8f3b,0x3f396842,0x3f373a23,0x3f1b02c6,0x3f17de12,0x3f14b039,0x3f11796b
.long 0x3ee63375,0x3eddbe79,0x3ed53641,0x3ecc9b8b,0x3e8e9a22,0x3e840270,0x3e72b651,0x3e5d4b1a
.long 0x3dc8bd36,0x3d96a905,0x3d48fb30,0x3cc90ab0,0xbdafb680,0xbde7fa9a,0xbe1008b7,0xbe2bf804
.long 0xbe888e93,0xbe97a117,0xbea68f12,0xbeb554ec,0xbee0924f,0xbeeff7fb,0xbeff17b2,0xbf06f686
.long 0xbf187fc0,0xbf1ff6cb,0xbf273656,0xbf2e3bde,0xbf3b8f3b,0xbf425b89,0xbf48d8b3,0xbf4f0417
.long 0xbf584853,0xbf5df6be,0xbf633c5a,0xbf6816a8,0xbf6db293,0xbf71d19f,0xbf756d97,0xbf788486
.long 0xbf7b14be,0xbf7d3aac,0xbf7ec46d,0xbf7fb10f,0xbf7ffb11,0xbf7fcbe2,0xbf7eea9d,0xbf7d57de
.long 0xbf7c3b28,0xbf796e4e,0xbf75dec6,0xbf718f57,0xbf6ff573,0xbf6a5ad9,0xbf63f473,0xbf5cc7d1
.long 0xbf5b941a,0xbf531849,0xbf49d112,0xbf3fc767,0xbf3fc767,0xbf34768f,0xbf286605,0xbf1ba299
.long 0xbf1d7fd1,0xbf0f8784,0xbf00e7e4,0xbee363fa,0xbeebcbbb,0xbecb2aae,0xbea986c4,0xbe870ada
.long 0xbe94a031,0xbe605c13,0xbe164083,0xbd96a905,0xbde1bc2e,0xbd0a342f,0x3d2fe007,0x3df475c0
.long 0x3d96a905,0x3e1c76de,0x3e6c9a7f,0x3e9d9e78,0x3e827dc0,0x3eab0201,0x3ed25a09,0x3ef840c8
.long 0x3edae880,0x3f00e7e4,0x3f13682a,0x3f24d225,0x3f15f6d9,0x3f27ce61,0x3f385216,0x3f476085
.long 0x3f396842,0x3f48d8b3,0x3f5695e5,0x3f628210,0x3f5695e5,0x3f62df7b,0x3f6d1c1d,0x3f75341d
.long 0x0,0x0,0x0,0x0,0x3e2f10a2,0x3e3228d4,0x3e354098,0x3e3857ec
.long 0x3eac7cd4,0x3eaf713a,0x3eb263ef,0x3eb554ec,0x3efc5d27,0x3f003a06,0x3f0242b1,0x3f044889
.long 0x3f226799,0x3f24d225,0x3f273656,0x3f299415,0x3f41d870,0x3f446337,0x3f46e22a,0x3f495521
.long 0x3f5b941a,0x3f5df6be,0x3f604621,0x3f628210,0x3f6ed89e,0x3f70c501,0x3f7294f8,0x3f74484b
.long 0x3f7b14be,0x3f7c3b28,0x3f7d3aac,0x3f7e1324,0x3f7fec43,0x3f7fffb1,0x3f7fe129,0x3f7f90b1
.long 0x3f7d3aac,0x3f7bf531,0x3f7a7302,0x3f78b47b,0x3f731447,0x3f703b37,0x3f6d1c1d,0x3f69b7e4
.long 0x3f61c598,0x3f5d2d53,0x3f584853,0x3f531849,0x3f49d112,0x3f436051,0x3f3ca003,0x3f3592e7
.long 0x3f2beb4a,0x3f239da9,0x3f1b02c6,0x3f121eb0,0x3f08f59b,0x3efdbabb,0x3ee900b7,0x3ed3c867
.long 0x3ec3ef15,0x3eac7cd4,0x3e94a031,0x3e78cfcc,0x3e605c13,0x3e2bf804,0x3dee3876,0x3d83db0a
.long 0x3d48fb30,0xbbc90f88,0xbd7b2b74,0xbdee3876,0xbdfab273,0xbe3857ec,0xbe72b651,0xbe9620d2
.long 0xbe94a031,0xbeb263ef,0xbecf7bca,0xbeebcbbb,0xbee63375,0xbf019573,0xbf0f8784,0xbf1ce11f
.long 0xbf187fc0,0xbf26050a,0xbf32c8c9,0xbf3ebc1b,0xbf396842,0xbf456439,0xbf5064af,0xbf5a5ba0
.long 0xbf54db31,0xbf5ebe05,0xbf676bd8,0xbf6ed89e,0xbf6a09a7,0xbf714c7a,0xbf772417,0xbf7b87b2
.long 0xbf7853f8,0xbf7c7eb0,0xbf7f0e58,0xbf7ffec4,0xbf7f4e6d,0xbf7ffd39,0xbf7eea9d,0xbf7c187a
.long 0xbf7ec46d,0xbf7baccd,0xbf76ba07,0xbf6ff573,0xbf76ba07,0xbf6faf1b,0xbf66becc,0xbf5bfb34
.long 0xbf676bd8,0xbf5c61c7,0xbf4f7a1f,0xbf40d0da,0xbf514d3d,0xbf425b89,0xbf31a81d,0xbf1f599f
.long 0x0,0x0,0x0,0x0,0x3e3b6ecf,0x3e3e853e,0x3e419b37,0x3e44b0b9
.long 0x3eb8442a,0x3ebb31a0,0x3ebe1d4a,0x3ec1071e,0x3f064b82,0x3f084b92,0x3f0a48ad,0x3f0c42c9
.long 0x3f2beb4a,0x3f2e3bde,0x3f3085bb,0x3f32c8c9,0x3f4bbbf8,0x3f4e1689,0x3f5064af,0x3f52a649
.long 0x3f64aa59,0x3f66becc,0x3f68bf3c,0x3f6aab7b,0x3f75dec6,0x3f77583a,0x3f78b47b,0x3f79f35e
.long 0x3f7ec46d,0x3f7f4e6d,0x3f7fb10f,0x3f7fec43,0x3f7f0e58,0x3f7e5a38,0x3f7d7474,0x3f7c5d3a
.long 0x3f76ba07,0x3f748422,0x3f721352,0x3f6f6830,0x3f660f88,0x3f62241a,0x3f5df6be,0x3f5988ad
.long 0x3f4d9f02,0x3f47de65,0x3f41d870,0x3f3b8f3b,0x3f2e3bde,0x3f269de3,0x3f1ebc12,0x3f16999f
.long 0x3f08f59b,0x3eff17b2,0x3eebcbbb,0x3ed8106b,0x3ebe1d4a,0x3ea80b1f,0x3e919ddd,0x3e75c35a
.long 0x3e47c5c2,0x3e164083,0x3dc8bd36,0x3d48fb30,0x3c490e90,0xbd2351cb,0xbdbc3ac3,0xbe1324ca
.long 0xbe2f10a2,0xbe667c66,0xbe8e9a22,0xbea986c4,0xbeb263ef,0xbece0bea,0xbee900b7,0xbf019573
.long 0xbf039c3d,0xbf10d3cd,0xbf1d7fd1,0xbf299415,0xbf299415,0xbf3592e7,0xbf40d0da,0xbf4b41fa
.long 0xbf49d112,0xbf53fac3,0xbf5d2d53,0xbf655e0b,0xbf633c5a,0xbf6afb8c,0xbf718f57,0xbf76ef5b
.long 0xbf74fa0b,0xbf79c79d,0xbf7d3aac,0xbf7f4e6d,0xbf7e70b0,0xbf7fdaaf,0xbf7fc38f,0xbf7e2b72
.long 0xbf7f4e6d,0xbf7cfe73,0xbf791298,0xbf73913f,0xbf778bc5,0xbf714c7a,0xbf696591,0xbf5fe4e9
.long 0xbf676bd8,0xbf5d2d53,0xbf514d3d,0xbf43e200,0xbf4f7a1f,0xbf4154e1,0xbf31a81d,0xbf209393
.long 0xbf3085bb,0xbf1ebc12,0xbf0b9a6b,0xbeee9479,0xbf0b9a6b,0xbeed3063,0xbec1071e,0xbe931f35
.long 0x35cccccd,0x35cccccd,0x35cccccd,0x35cccccd,0x35cccccd,0x35cccc8e,0x35cccbd0,0x35ccca94
.long 0x35cccccd,0x35cccbd0,0x35ccc8da,0x35ccc3eb,0x35cccccd,0x35ccca94,0x35ccc3eb,0x35ccb8d1
.long 0x35cccccd,0x35ccc8da,0x35ccbd02,0x35cca946,0x35cccccd,0x35ccc6a2,0x35ccb421,0x35cc954b
.long 0x35cccccd,0x35ccc3eb,0x35cca946,0x35cc7ce0,0x35cccccd,0x35ccc0b6,0x35cc9c72,0x35cc6006
.long 0x35cccccd,0x35ccbd02,0x35cc8da6,0x35cc3ebe,0x35cccccd,0x35ccb8d1,0x35cc7ce0,0x35cc1907
.long 0x35cccccd,0x35ccb421,0x35cc6a23,0x35cbeee4,0x35cccccd,0x35ccaef3,0x35cc556c,0x35cbc054
.long 0x35cccccd,0x35cca946,0x35cc3ebe,0x35cb8d5a,0x35cccccd,0x35cca31b,0x35cc2618,0x35cb55f5
.long 0x35cccccd,0x35cc9c72,0x35cc0b7a,0x35cb1a27,0x35cccccd,0x35cc954b,0x35cbeee4,0x35cad9f2
.long 0x35cccccd,0x35cc8da6,0x35cbd057,0x35ca9556,0x35cccccd,0x35cc8582,0x35cbafd4,0x35ca4c56
.long 0x35cccccd,0x35cc7ce0,0x35cb8d5a,0x35c9fef3,0x35cccccd,0x35cc73c1,0x35cb68e9,0x35c9ad2f
.long 0x35cccccd,0x35cc6a23,0x35cb4283,0x35c9570a,0x35cccccd,0x35cc6006,0x35cb1a27,0x35c8fc89
.long 0x35cccccd,0x35cc556c,0x35caefd6,0x35c89dab,0x35cccccd,0x35cc4a54,0x35cac390,0x35c83a73
.long 0x35cccccd,0x35cc3ebe,0x35ca9556,0x35c7d2e4,0x35cccccd,0x35cc32aa,0x35ca6529,0x35c76700
.long 0x35cccccd,0x35cc2618,0x35ca3307,0x35c6f6c8,0x35cccccd,0x35cc1907,0x35c9fef3,0x35c68241
.long 0x35cccccd,0x35cc0b7a,0x35c9c8ed,0x35c6096a,0x35cccccd,0x35cbfd6e,0x35c990f4,0x35c58c49
.long 0x35cccccd,0x35cbeee4,0x35c9570a,0x35c50adf,0x35cccccd,0x35cbdfdd,0x35c91b30,0x35c4852f
.long 0x35cccccd,0x35cccccd,0x35cccccd,0x35cccccd,0x35ccc8da,0x35ccc6a2,0x35ccc3eb,0x35ccc0b6
.long 0x35ccbd02,0x35ccb421,0x35cca946,0x35cc9c72,0x35cca946,0x35cc954b,0x35cc7ce0,0x35cc6006
.long 0x35cc8da6,0x35cc6a23,0x35cc3ebe,0x35cc0b7a,0x35cc6a23,0x35cc32aa,0x35cbeee4,0x35cb9ed5
.long 0x35cc3ebe,0x35cbeee4,0x35cb8d5a,0x35cb1a27,0x35cc0b7a,0x35cb9ed5,0x35cb1a27,0x35ca7d7e
.long 0x35cbd057,0x35cb4283,0x35ca9556,0x35c9c8ed,0x35cb8d5a,0x35cad9f2,0x35c9fef3,0x35c8fc89
.long 0x35cb4283,0x35ca6529,0x35c9570a,0x35c8186a,0x35caefd6,0x35c9e42e,0x35c89dab,0x35c71cab
.long 0x35ca9556,0x35c9570a,0x35c7d2e4,0x35c6096a,0x35ca3307,0x35c8bdc6,0x35c6f6c8,0x35c4dec8
.long 0x35c9c8ed,0x35c8186a,0x35c6096a,0x35c39ce8,0x35c9570a,0x35c76700,0x35c50adf,0x35c243ef
.long 0x35c8dd65,0x35c6a993,0x35c3fb3c,0x35c0d407,0x35c85c01,0x35c5e02f,0x35c2da99,0x35bf4d5a
.long 0x35c7d2e4,0x35c50adf,0x35c1a90f,0x35bdb017,0x35c74213,0x35c429b0,0x35c066b8,0x35bbfc70
.long 0x35c6a993,0x35c33cb1,0x35bf13b1,0x35ba3296,0x35c6096a,0x35c243ef,0x35bdb017,0x35b852c1
.long 0x35c5619f,0x35c13f79,0x35bc3c09,0x35b65d28,0x35c4b238,0x35c02f5f,0x35bab7a7,0x35b45208
.long 0x35c3fb3c,0x35bf13b1,0x35b92313,0x35b2319e,0x35c33cb1,0x35bdec81,0x35b77e6f,0x35affc2a
.long 0x35c276a0,0x35bcb9e0,0x35b5c9e1,0x35adb1ef,0x35c1a90f,0x35bb7be1,0x35b4058e,0x35ab5332
.long 0x35c0d407,0x35ba3296,0x35b2319e,0x35a8e03a,0x35bff78f,0x35b8de14,0x35b04e38,0x35a65953
.long 0x35bf13b1,0x35b77e6f,0x35ae5b88,0x35a3bec8,0x35be2876,0x35b613bd,0x35ac59b8,0x35a110e7
.long 0x0,0x0,0x0,0x0,0x0,0x31a0d96b,0x3220d93a,0x3271455a
.long 0x0,0x3220d93a,0x32a0d873,0x32f142bd,0x0,0x3271455a,0x32f142bd,0x3334eec8
.long 0x0,0x32a0d873,0x3320d559,0x33713846,0x0,0x32c90dd6,0x334907c8,0x3396be44
.long 0x0,0x32f142bd,0x33713846,0x33b4dd20,0x0,0x330cbb87,0x338cb338,0x33d2f811
.long 0x0,0x3320d559,0x33a0c8f3,0x33f10e6e,0x0,0x3334eec8,0x33b4dd20,0x34078fc8
.long 0x0,0x334907c8,0x33c8ef90,0x34169569,0x0,0x335d204b,0x33dd000f,0x342597c6
.long 0x0,0x33713846,0x33f10e6e,0x3434968b,0x0,0x3382a7d6,0x34028d3d,0x34439166
.long 0x0,0x338cb338,0x340c9200,0x34528804,0x0,0x3396be44,0x34169569,0x34617a10
.long 0x0,0x33a0c8f3,0x3420975e,0x34706739,0x0,0x33aad33e,0x342a97c7,0x347f4f2b
.long 0x0,0x33b4dd20,0x3434968b,0x348718ca,0x0,0x33bee693,0x343e9392,0x348e8710
.long 0x0,0x33c8ef90,0x34488ec2,0x3495f23f,0x0,0x33d2f811,0x34528804,0x349d5a2e
.long 0x0,0x33dd000f,0x345c7f3e,0x34a4beb3,0x0,0x33e70786,0x34667457,0x34ac1fa5
.long 0x0,0x33f10e6e,0x34706739,0x34b37cdc,0x0,0x33fb14c1,0x347a57c9,0x34bad62f
.long 0x0,0x34028d3d,0x348222f8,0x34c22b74,0x0,0x34078fc8,0x348718ca,0x34c97c83
.long 0x0,0x340c9200,0x348c0d4f,0x34d0c934,0x0,0x341193e2,0x3491007a,0x34d8115e
.long 0x0,0x34169569,0x3495f23f,0x34df54d8,0x0,0x341b9694,0x349ae293,0x34e6937a
.long 0x0,0x0,0x0,0x0,0x32a0d873,0x32c90dd6,0x32f142bd,0x330cbb87
.long 0x3320d559,0x334907c8,0x33713846,0x338cb338,0x33713846,0x3396be44,0x33b4dd20,0x33d2f811
.long 0x33a0c8f3,0x33c8ef90,0x33f10e6e,0x340c9200,0x33c8ef90,0x33fb14c1,0x34169569,0x342f9760
.long 0x33f10e6e,0x34169569,0x3434968b,0x34528804,0x340c9200,0x342f9760,0x34528804,0x34755fcc
.long 0x3420975e,0x34488ec2,0x34706739,0x348c0d4f,0x3434968b,0x34617a10,0x348718ca,0x349d5a2e
.long 0x34488ec2,0x347a57c9,0x3495f23f,0x34ae9479,0x345c7f3e,0x34899337,0x34a4beb3,0x34bfba28
.long 0x34706739,0x3495f23f,0x34b37cdc,0x34d0c934,0x348222f8,0x34a2483f,0x34c22b74,0x34e1bf99
.long 0x348c0d4f,0x34ae9479,0x34d0c934,0x34f29b58,0x3495f23f,0x34bad62f,0x34df54d8,0x3501ad39
.long 0x349fd168,0x34c70ca3,0x34edcd1c,0x3509fd76,0x34a9aa67,0x34d3371a,0x34fc30c0,0x35123d69
.long 0x34b37cdc,0x34df54d8,0x35053f42,0x351a6c18,0x34bd4866,0x34eb6521,0x350c5a95,0x3522888b
.long 0x34c70ca3,0x34f7673d,0x351369bb,0x352a91ce,0x34d0c934,0x3501ad39,0x351a6c18,0x353286ed
.long 0x34da7db8,0x35079f03,0x3521610f,0x353a66f9,0x34e429d0,0x350d88a2,0x35284807,0x35423103
.long 0x34edcd1c,0x351369bb,0x352f2067,0x3549e41f,0x34f7673d,0x351941f2,0x3535e995,0x35517f65
.long 0x35007bea,0x351f10ee,0x353ca2fc,0x355901f0,0x35053f42,0x3524d655,0x35434c06,0x35606adb
.long 0x3509fd76,0x352a91ce,0x3549e41f,0x3567b948,0x350eb659,0x35304301,0x35506ab5,0x356eec58
.long 0x351369bb,0x3535e995,0x3556df37,0x35760334,0x3518176e,0x353b8534,0x355d4116,0x357cfd04
.long 0x35cccccd,0x35cccccd,0x35cccccd,0x35cccccd,0x35ccbd02,0x35ccb8d1,0x35ccb421,0x35ccaef3
.long 0x35cc8da6,0x35cc7ce0,0x35cc6a23,0x35cc556c,0x35cc3ebe,0x35cc1907,0x35cbeee4,0x35cbc054
.long 0x35cbd057,0x35cb8d5a,0x35cb4283,0x35caefd6,0x35cb4283,0x35cad9f2,0x35ca6529,0x35c9e42e
.long 0x35ca9556,0x35c9fef3,0x35c9570a,0x35c89dab,0x35c9c8ed,0x35c8fc89,0x35c8186a,0x35c71cab
.long 0x35c8dd65,0x35c7d2e4,0x35c6a993,0x35c5619f,0x35c7d2e4,0x35c68241,0x35c50adf,0x35c36d09
.long 0x35c6a993,0x35c50adf,0x35c33cb1,0x35c13f79,0x35c5619f,0x35c36d09,0x35c13f79,0x35bed993
.long 0x35c3fb3c,0x35c1a90f,0x35bf13b1,0x35bc3c09,0x35c276a0,0x35bfbf49,0x35bcb9e0,0x35b9679f
.long 0x35c0d407,0x35bdb017,0x35ba3296,0x35b65d28,0x35bf13b1,0x35bb7be1,0x35b77e6f,0x35b31d87
.long 0x35bd35e5,0x35b92313,0x35b49e13,0x35afa9af,0x35bb3aec,0x35b6a623,0x35b19232,0x35ac02a0
.long 0x35b92313,0x35b4058e,0x35ae5b88,0x35a8296b,0x35b6eeae,0x35b141d7,0x35aafadc,0x35a41f31
.long 0x35b49e13,0x35ae5b88,0x35a770fe,0x359fe51e,0x35b2319e,0x35ab5332,0x35a3bec8,0x359b7c6d
.long 0x35afa9af,0x35a8296b,0x359fe51e,0x3596e669,0x35ad06a9,0x35a4ded4,0x359be4ed,0x35922466
.long 0x35aa48f4,0x35a1740f,0x3597bf2e,0x358d37c9,0x35a770fe,0x359de9c7,0x359374de,0x35882200
.long 0x35a47f35,0x359a40ae,0x358f0707,0x3582e487,0x35a1740f,0x3596797a,0x358a76bb,0x357b01cb
.long 0x359e5003,0x359294e9,0x3585c511,0x356ff15b,0x359b138d,0x358e93bb,0x3580f32d,0x35649af8
.long 0x3597bf2e,0x358a76bb,0x3578046f,0x355901f0,0x35945368,0x35863eb4,0x356de6c2,0x354d29a4
.long 0x35cccccd,0x35cccccd,0x35cccccd,0x35cccccd,0x35cca946,0x35cca31b,0x35cc9c72,0x35cc954b
.long 0x35cc3ebe,0x35cc2618,0x35cc0b7a,0x35cbeee4,0x35cb8d5a,0x35cb55f5,0x35cb1a27,0x35cad9f2
.long 0x35ca9556,0x35ca3307,0x35c9c8ed,0x35c9570a,0x35c9570a,0x35c8bdc6,0x35c8186a,0x35c76700
.long 0x35c7d2e4,0x35c6f6c8,0x35c6096a,0x35c50adf,0x35c6096a,0x35c4dec8,0x35c39ce8,0x35c243ef
.long 0x35c3fb3c,0x35c276a0,0x35c0d407,0x35bf13b1,0x35c1a90f,0x35bfbf49,0x35bdb017,0x35bb7be1
.long 0x35bf13b1,0x35bcb9e0,0x35ba3296,0x35b77e6f,0x35bc3c09,0x35b9679f,0x35b65d28,0x35b31d87
.long 0x35b92313,0x35b5c9e1,0x35b2319e,0x35ae5b88,0x35b5c9e1,0x35b1e21f,0x35adb1ef,0x35a93b06
.long 0x35b2319e,0x35adb1ef,0x35a8e03a,0x35a3bec8,0x35ae5b88,0x35a93b06,0x35a3bec8,0x359de9c7
.long 0x35aa48f4,0x35a47f35,0x359e5003,0x3597bf2e,0x35a5fb4c,0x359f806a,0x3598967c,0x35914253
.long 0x35a1740f,0x359a40ae,0x359294e9,0x358a76bb,0x359cb4cd,0x3594c224,0x358c4e1d,0x35836014
.long 0x3597bf2e,0x358f0707,0x3585c511,0x3578046f,0x359294e9,0x358911af,0x357df9b6,0x3568c245
.long 0x358d37c9,0x3582e487,0x356ff15b,0x355901f0,0x3587a9aa,0x35790428,0x356177b4,0x3548cbf9
.long 0x3581ec7b,0x356bd9dd,0x35529394,0x3538292a,0x3578046f,0x355e4f8b,0x35434c06,0x35272288
.long 0x356bd9dd,0x35506ab5,0x3533a83f,0x3515c14d,0x355f5d78,0x35423103,0x3523afa2,0x35040ee5
.long 0x35529394,0x3533a83f,0x351369bb,0x34e429d0,0x354580a2,0x3524d655,0x3502de37,0x34bfba28
.long 0x3538292a,0x3515c14d,0x34e429d0,0x349ae293,0x352a91ce,0x35066f4c,0x34c22b74,0x346b6e11
.long 0x0,0x0,0x0,0x0,0x3320d559,0x3334eec8,0x334907c8,0x335d204b
.long 0x33a0c8f3,0x33b4dd20,0x33c8ef90,0x33dd000f,0x33f10e6e,0x34078fc8,0x34169569,0x342597c6
.long 0x3420975e,0x3434968b,0x34488ec2,0x345c7f3e,0x34488ec2,0x34617a10,0x347a57c9,0x34899337
.long 0x34706739,0x348718ca,0x3495f23f,0x34a4beb3,0x348c0d4f,0x349d5a2e,0x34ae9479,0x34bfba28
.long 0x349fd168,0x34b37cdc,0x34c70ca3,0x34da7db8,0x34b37cdc,0x34c97c83,0x34df54d8,0x34f50196
.long 0x34c70ca3,0x34df54d8,0x34f7673d,0x35079f03,0x34da7db8,0x34f50196,0x35079f03,0x351495b2
.long 0x34edcd1c,0x35053f42,0x351369bb,0x3521610f,0x35007bea,0x350fe3b7,0x351f10ee,0x352dfd61
.long 0x3509fd76,0x351a6c18,0x352a91ce,0x353a66f9,0x351369bb,0x3524d655,0x3535e995,0x35469a3a
.long 0x351cbf44,0x352f2067,0x35411588,0x35529394,0x3525fca2,0x3539484b,0x354c12f5,0x355e4f8b
.long 0x352f2067,0x35434c06,0x3556df37,0x3569cab3,0x3538292a,0x354d29a4,0x356177b4,0x357501b2
.long 0x35411588,0x3556df37,0x356bd9dd,0x357ff144,0x3549e41f,0x35606adb,0x35760334,0x35854b1c
.long 0x35529394,0x3569cab3,0x357ff144,0x358a76bb,0x355b2291,0x3572fcea,0x3584d0d5,0x358f79fb
.long 0x35638fc3,0x357bffb5,0x35898908,0x35945368,0x356bd9dd,0x358268a9,0x358e2017,0x35990197
.long 0x3573ff99,0x3586b804,0x359294e9,0x359d832a,0x357bffb5,0x358aed14,0x3596e669,0x35a1d6d2
.long 0x3581ec7b,0x358f0707,0x359b138d,0x35a5fb4c,0x3585c511,0x35930511,0x359f1b54,0x35a9ef63
.long 0x35898908,0x3596e669,0x35a2fcc6,0x35adb1ef,0x358d37c9,0x359aaa4d,0x35a6b6f3,0x35b141d7
.long 0x0,0x0,0x0,0x0,0x33713846,0x3382a7d6,0x338cb338,0x3396be44
.long 0x33f10e6e,0x34028d3d,0x340c9200,0x34169569,0x3434968b,0x34439166,0x34528804,0x34617a10
.long 0x34706739,0x348222f8,0x348c0d4f,0x3495f23f,0x3495f23f,0x34a2483f,0x34ae9479,0x34bad62f
.long 0x34b37cdc,0x34c22b74,0x34d0c934,0x34df54d8,0x34d0c934,0x34e1bf99,0x34f29b58,0x3501ad39
.long 0x34edcd1c,0x35007bea,0x3509fd76,0x351369bb,0x35053f42,0x350fe3b7,0x351a6c18,0x3524d655
.long 0x351369bb,0x351f10ee,0x352a91ce,0x3535e995,0x3521610f,0x352dfd61,0x353a66f9,0x35469a3a
.long 0x352f2067,0x353ca2fc,0x3549e41f,0x3556df37,0x353ca2fc,0x354afbc9,0x355901f0,0x3566afbb
.long 0x3549e41f,0x355901f0,0x3567b948,0x35760334,0x3556df37,0x3566afbb,0x35760334,0x358268a9
.long 0x35638fc3,0x3573ff99,0x3581ec7b,0x35898908,0x356ff15b,0x3580760f,0x35889a01,0x35905ed9
.long 0x357bffb5,0x3586b804,0x358f0707,0x3596e669,0x3583db51,0x358cc31e,0x35953084,0x359d1c2c
.long 0x35898908,0x359294e9,0x359b138d,0x35a2fcc6,0x358f0707,0x35982b04,0x35a0ad5c,0x35a88507
.long 0x35945368,0x359d832a,0x35a5fb4c,0x35adb1ef,0x35996c52,0x35a29b2e,0x35aafadc,0x35b280af
.long 0x359e5003,0x35a770fe,0x35afa9af,0x35b6eeae,0x35a2fcc6,0x35ac02a0,0x35b4058e,0x35baf983
.long 0x35a770fe,0x35b04e38,0x35b80c6c,0x35be9eff,0x35abab1e,0x35b45208,0x35bbbc62,0x35c1dd26
.long 0x35afa9af,0x35b80c6c,0x35bf13b1,0x35c4b238,0x35b36b4e,0x35bb7be1,0x35c210c7,0x35c71cab
.long 0x35b6eeae,0x35be9eff,0x35c4b238,0x35c91b30,0x35ba3296,0x35c17480,0x35c6f6c8,0x35caacb2
.long 0x35cccccd,0x35cccccd,0x35cccccd,0x35cccccd,0x35cc8da6,0x35cc8582,0x35cc7ce0,0x35cc73c1
.long 0x35cbd057,0x35cbafd4,0x35cb8d5a,0x35cb68e9,0x35ca9556,0x35ca4c56,0x35c9fef3,0x35c9ad2f
.long 0x35c8dd65,0x35c85c01,0x35c7d2e4,0x35c74213,0x35c6a993,0x35c5e02f,0x35c50adf,0x35c429b0
.long 0x35c3fb3c,0x35c2da99,0x35c1a90f,0x35c066b8,0x35c0d407,0x35bf4d5a,0x35bdb017,0x35bbfc70
.long 0x35bd35e5,0x35bb3aec,0x35b92313,0x35b6eeae,0x35b92313,0x35b6a623,0x35b4058e,0x35b141d7
.long 0x35b49e13,0x35b19232,0x35ae5b88,0x35aafadc,0x35afa9af,0x35ac02a0,0x35a8296b,0x35a41f31
.long 0x35aa48f4,0x35a5fb4c,0x35a1740f,0x359cb4cd,0x35a47f35,0x359f806a,0x359a40ae,0x3594c224
.long 0x359e5003,0x3598967c,0x359294e9,0x358c4e1d,0x3597bf2e,0x35914253,0x358a76bb,0x35836014
.long 0x3590d0c3,0x35898908,0x3581ec7b,0x3573ff99,0x35898908,0x35816ffc,0x3571f9a5,0x35606adb
.long 0x3581ec7b,0x3571f9a5,0x355f5d78,0x354c12f5,0x3573ff99,0x35606adb,0x354c12f5,0x35370998
.long 0x35638fc3,0x354e3fd4,0x3538292a,0x3521610f,0x35529394,0x353b8534,0x3523afa2,0x350b2c30
.long 0x35411588,0x35284807,0x350eb659,0x34e8fc95,0x352f2067,0x351495b2,0x34f29b58,0x34bad62f
.long 0x351cbf44,0x35007bea,0x34c70ca3,0x348c0d4f,0x3509fd76,0x34d8115e,0x349ae293,0x34399548
.long 0x34edcd1c,0x34ae9479,0x345c7f3e,0x33b4dd20,0x34c70ca3,0x34849e0a,0x34028d3d,0xb1a0d96b
.long 0x349fd168,0x3434968b,0x3320d559,0xb3c8ef90,0x34706739,0x33bee693,0xb34907c8,0xb4439166
.long 0x3420975e,0x3220d93a,0xb40c9200,0xb491007a,0x33a0c8f3,0xb396be44,0xb4667457,0xb4bfba28
.long 0x35cccccd,0x35cccccd,0x35cccccd,0x35cccccd,0x35cc6a23,0x35cc6006,0x35cc556c,0x35cc4a54
.long 0x35cb4283,0x35cb1a27,0x35caefd6,0x35cac390,0x35c9570a,0x35c8fc89,0x35c89dab,0x35c83a73
.long 0x35c6a993,0x35c6096a,0x35c5619f,0x35c4b238,0x35c33cb1,0x35c243ef,0x35c13f79,0x35c02f5f
.long 0x35bf13b1,0x35bdb017,0x35bc3c09,0x35bab7a7,0x35ba3296,0x35b852c1,0x35b65d28,0x35b45208
.long 0x35b49e13,0x35b2319e,0x35afa9af,0x35ad06a9,0x35ae5b88,0x35ab5332,0x35a8296b,0x35a4ded4
.long 0x35a770fe,0x35a3bec8,0x359fe51e,0x359be4ed,0x359fe51e,0x359b7c6d,0x3596e669,0x35922466
.long 0x3597bf2e,0x359294e9,0x358d37c9,0x3587a9aa,0x358f0707,0x358911af,0x3582e487,0x35790428
.long 0x3585c511,0x357df9b6,0x356ff15b,0x356177b4,0x3578046f,0x3568c245,0x355901f0,0x3548cbf9
.long 0x35638fc3,0x35529394,0x35411588,0x352f2067,0x354e3fd4,0x353b8534,0x35284807,0x351495b2
.long 0x3538292a,0x3523afa2,0x350eb659,0x34f29b58,0x3521610f,0x350b2c30,0x34e8fc95,0x34bad62f
.long 0x3509fd76,0x34e429d0,0x34b37cdc,0x348222f8,0x34e429d0,0x34b108e1,0x347a57c9,0x341193e2
.long 0x34b37cdc,0x347a57c9,0x340c9200,0x32f142bd,0x348222f8,0x341193e2,0x32f142bd,0xb3aad33e
.long 0x3420975e,0x3320d559,0xb3a0c8f3,0xb4488ec2,0x33713846,0xb382a7d6,0xb43e9392,0xb49d5a2e
.long 0xb320d559,0xb42a97c7,0xb495f23f,0xb4d5a47e,0xb40c9200,0xb4899337,0xb4cbebe7,0xb5066f4c
.long 0xb4706739,0xb4bd4866,0xb5007bea,0xb521610f,0xb4a9aa67,0xb4f03484,0xb51a6c18,0xb53b8534
.long 0xb4da7db8,0xb51110bd,0xb533a83f,0xb554ba6c,0xb5053f42,0xb5296d1f,0xb54c12f5,0xb56ce099
.long 0x0,0x0,0x0,0x0,0x33a0c8f3,0x33aad33e,0x33b4dd20,0x33bee693
.long 0x3420975e,0x342a97c7,0x3434968b,0x343e9392,0x34706739,0x347f4f2b,0x348718ca,0x348e8710
.long 0x349fd168,0x34a9aa67,0x34b37cdc,0x34bd4866,0x34c70ca3,0x34d3371a,0x34df54d8,0x34eb6521
.long 0x34edcd1c,0x34fc30c0,0x35053f42,0x350c5a95,0x3509fd76,0x35123d69,0x351a6c18,0x3522888b
.long 0x351cbf44,0x3525fca2,0x352f2067,0x3538292a,0x352f2067,0x3539484b,0x35434c06,0x354d29a4
.long 0x35411588,0x354c12f5,0x3556df37,0x356177b4,0x35529394,0x355e4f8b,0x3569cab3,0x357501b2
.long 0x35638fc3,0x356ff15b,0x357bffb5,0x3583db51,0x3573ff99,0x3580760f,0x3586b804,0x358cc31e
.long 0x3581ec7b,0x35889a01,0x358f0707,0x35953084,0x35898908,0x35905ed9,0x3596e669,0x359d1c2c
.long 0x3590d0c3,0x3597bf2e,0x359e5003,0x35a47f35,0x3597bf2e,0x359eb5dd,0x35a53e0d,0x35ab5332
.long 0x359e5003,0x35a53e0d,0x35abab1e,0x35b19232,0x35a47f35,0x35ab5332,0x35b19232,0x35b736c7
.long 0x35aa48f4,0x35b0f10f,0x35b6eeae,0x35bc3c09,0x35afa9af,0x35b613bd,0x35bbbc62,0x35c09d9b
.long 0x35b49e13,0x35bab7a7,0x35bff78f,0x35c457ac,0x35b92313,0x35bed993,0x35c39ce8,0x35c76700
.long 0x35bd35e5,0x35c276a0,0x35c6a993,0x35c9c8ed,0x35c0d407,0x35c58c49,0x35c91b30,0x35cb7b60
.long 0x35c3fb3c,0x35c8186a,0x35caefd6,0x35cc7ce0,0x35c6a993,0x35ca193c,0x35cc2618,0x35cccc8e
.long 0x35c8dd65,0x35cb8d5a,0x35ccbd02,0x35cc6a23,0x35ca9556,0x35cc73c1,0x35ccb421,0x35cb55f5
.long 0x35cbd057,0x35cccbd0,0x35cc0b7a,0x35c990f4,0x35cc8da6,0x35cc954b,0x35cac390,0x35c71cab
.long 0x0,0x0,0x0,0x0,0x33c8ef90,0x33d2f811,0x33dd000f,0x33e70786
.long 0x34488ec2,0x34528804,0x345c7f3e,0x34667457,0x3495f23f,0x349d5a2e,0x34a4beb3,0x34ac1fa5
.long 0x34c70ca3,0x34d0c934,0x34da7db8,0x34e429d0,0x34f7673d,0x3501ad39,0x35079f03,0x350d88a2
.long 0x351369bb,0x351a6c18,0x3521610f,0x35284807,0x352a91ce,0x353286ed,0x353a66f9,0x35423103
.long 0x35411588,0x3549e41f,0x35529394,0x355b2291,0x3556df37,0x35606adb,0x3569cab3,0x3572fcea
.long 0x356bd9dd,0x35760334,0x357ff144,0x3584d0d5,0x357ff144,0x35854b1c,0x358a76bb,0x358f79fb
.long 0x35898908,0x358f0707,0x35945368,0x35996c52,0x359294e9,0x35982b04,0x359d832a,0x35a29b2e
.long 0x359b138d,0x35a0ad5c,0x35a5fb4c,0x35aafadc,0x35a2fcc6,0x35a88507,0x35adb1ef,0x35b280af
.long 0x35aa48f4,0x35afa9af,0x35b49e13,0x35b92313,0x35b0f10f,0x35b613bd,0x35bab7a7,0x35bed993
.long 0x35b6eeae,0x35bbbc62,0x35bff78f,0x35c39ce8,0x35bc3c09,0x35c09d9b,0x35c457ac,0x35c76700
.long 0x35c0d407,0x35c4b238,0x35c7d2e4,0x35ca3307,0x35c4b238,0x35c7f5e5,0x35ca6529,0x35cbfd6e
.long 0x35c7d2e4,0x35ca6529,0x35cc0b7a,0x35ccc3eb,0x35ca3307,0x35cbfd6e,0x35ccc3eb,0x35cc8582
.long 0x35cbd057,0x35ccbd02,0x35cc8da6,0x35cb4283,0x35cca946,0x35cca31b,0x35cb68e9,0x35c8fc89
.long 0x35ccbd02,0x35cbafd4,0x35c9570a,0x35c5b679,0x35cc0b7a,0x35c9e42e,0x35c65a74,0x35c17480
.long 0x35ca9556,0x35c74213,0x35c276a0,0x35bc3c09,0x35c85c01,0x35c3cc4e,0x35bdb017,0x35b613bd
.long 0x35c5619f,0x35bf868d,0x35b80c6c,0x35af0373,0x35c1a90f,0x35ba7558,0x35b19232,0x35a7142c
.long 0x35cccccd,0x35cccccd,0x35cccccd,0x35cccccd,0x35cc3ebe,0x35cc32aa,0x35cc2618,0x35cc1907
.long 0x35ca9556,0x35ca6529,0x35ca3307,0x35c9fef3,0x35c7d2e4,0x35c76700,0x35c6f6c8,0x35c68241
.long 0x35c3fb3c,0x35c33cb1,0x35c276a0,0x35c1a90f,0x35bf13b1,0x35bdec81,0x35bcb9e0,0x35bb7be1
.long 0x35b92313,0x35b77e6f,0x35b5c9e1,0x35b4058e,0x35b2319e,0x35affc2a,0x35adb1ef,0x35ab5332
.long 0x35aa48f4,0x35a770fe,0x35a47f35,0x35a1740f,0x35a1740f,0x359de9c7,0x359a40ae,0x3596797a
.long 0x3597bf2e,0x359374de,0x358f0707,0x358a76bb,0x358d37c9,0x35882200,0x3582e487,0x357b01cb
.long 0x3581ec7b,0x3578046f,0x356bd9dd,0x355f5d78,0x356bd9dd,0x355e4f8b,0x35506ab5,0x35423103
.long 0x35529394,0x35434c06,0x3533a83f,0x3523afa2,0x3538292a,0x35272288,0x3515c14d,0x35040ee5
.long 0x351cbf44,0x3509fd76,0x34edcd1c,0x34c70ca3,0x35007bea,0x34d8115e,0x34ae9479,0x34849e0a
.long 0x34c70ca3,0x349ae293,0x345c7f3e,0x34028d3d,0x348c0d4f,0x34399548,0x33b4dd20,0xb1a0d96b
.long 0x3420975e,0x33713846,0xb320d559,0xb40c9200,0x3320d559,0xb382a7d6,0xb42a97c7,0xb4899337
.long 0xb3a0c8f3,0xb43e9392,0xb495f23f,0xb4cbebe7,0xb4488ec2,0xb49d5a2e,0xb4d5a47e,0xb5066f4c
.long 0xb49fd168,0xb4da7db8,0xb509fd76,0xb525fca2,0xb4da7db8,0xb50b2c30,0xb5284807,0xb5446691
.long 0xb509fd76,0xb5284807,0xb54580a2,0xb56177b4,0xb525fca2,0xb5446691,0xb56177b4,0xb57cfd04
.long 0xb5411588,0xb55f5d78,0xb57bffb5,0xb58b6318,0xb55b2291,0xb5790428,0xb58a76bb,0xb59752fa
.long 0xb573ff99,0xb5889a01,0xb5960c2f,0xb5a23933,0xb585c511,0xb593e451,0xb5a0ad5c,0xb5ac02a0
.long 0x35cccccd,0x35cccccd,0x35cccccd,0x35cccccd,0x35cc0b7a,0x35cbfd6e,0x35cbeee4,0x35cbdfdd
.long 0x35c9c8ed,0x35c990f4,0x35c9570a,0x35c91b30,0x35c6096a,0x35c58c49,0x35c50adf,0x35c4852f
.long 0x35c0d407,0x35bff78f,0x35bf13b1,0x35be2876,0x35ba3296,0x35b8de14,0x35b77e6f,0x35b613bd
.long 0x35b2319e,0x35b04e38,0x35ae5b88,0x35ac59b8,0x35a8e03a,0x35a65953,0x35a3bec8,0x35a110e7
.long 0x359e5003,0x359b138d,0x3597bf2e,0x35945368,0x359294e9,0x358e93bb,0x358a76bb,0x35863eb4
.long 0x3585c511,0x3580f32d,0x3578046f,0x356de6c2,0x356ff15b,0x35649af8,0x355901f0,0x354d29a4
.long 0x35529394,0x354580a2,0x3538292a,0x352a91ce,0x3533a83f,0x3524d655,0x3515c14d,0x35066f4c
.long 0x351369bb,0x3502de37,0x34e429d0,0x34c22b74,0x34e429d0,0x34bfba28,0x349ae293,0x346b6e11
.long 0x349fd168,0x34706739,0x3420975e,0x33a0c8f3,0x3434968b,0x33bee693,0x3220d93a,0xb396be44
.long 0x3320d559,0xb34907c8,0xb40c9200,0xb4667457,0xb3c8ef90,0xb4439166,0xb491007a,0xb4bfba28
.long 0xb4706739,0xb4a9aa67,0xb4da7db8,0xb5053f42,0xb4bd4866,0xb4f03484,0xb51110bd,0xb5296d1f
.long 0xb5007bea,0xb51a6c18,0xb533a83f,0xb54c12f5,0xb521610f,0xb53b8534,0xb554ba6c,0xb56ce099
.long 0xb5411588,0xb55b2291,0xb573ff99,0xb585c511,0xb55f5d78,0xb5790428,0xb5889a01,0xb593e451
.long 0xb57bffb5,0xb58a76bb,0xb5960c2f,0xb5a0ad5c,0xb58b6318,0xb59752fa,0xb5a23933,0xb5ac02a0
.long 0xb597bf2e,0xb5a2fcc6,0xb5ad06a9,0xb5b5c9e1,0xb5a2fcc6,0xb5ad5c81,0xb5b65d28,0xb5bdec81
.long 0xb5ad06a9,0xb5b65d28,0xb5be2876,0xb5c457ac,0xb5b5c9e1,0xb5bdec81,0xb5c457ac,0xb5c8fc89
.long 0x0,0x0,0x0,0x0,0x33f10e6e,0x33fb14c1,0x34028d3d,0x34078fc8
.long 0x34706739,0x347a57c9,0x348222f8,0x348718ca,0x34b37cdc,0x34bad62f,0x34c22b74,0x34c97c83
.long 0x34edcd1c,0x34f7673d,0x35007bea,0x35053f42,0x351369bb,0x351941f2,0x351f10ee,0x3524d655
.long 0x352f2067,0x3535e995,0x353ca2fc,0x35434c06,0x3549e41f,0x35517f65,0x355901f0,0x35606adb
.long 0x35638fc3,0x356bd9dd,0x3573ff99,0x357bffb5,0x357bffb5,0x358268a9,0x3586b804,0x358aed14
.long 0x35898908,0x358e2017,0x359294e9,0x3596e669,0x35945368,0x35990197,0x359d832a,0x35a1d6d2
.long 0x359e5003,0x35a2fcc6,0x35a770fe,0x35abab1e,0x35a770fe,0x35ac02a0,0x35b04e38,0x35b45208
.long 0x35afa9af,0x35b4058e,0x35b80c6c,0x35bbbc62,0x35b6eeae,0x35baf983,0x35be9eff,0x35c1dd26
.long 0x35bd35e5,0x35c0d407,0x35c3fb3c,0x35c6a993,0x35c276a0,0x35c58c49,0x35c8186a,0x35ca193c
.long 0x35c6a993,0x35c91b30,0x35caefd6,0x35cc2618,0x35c9c8ed,0x35cb7b60,0x35cc7ce0,0x35cccc8e
.long 0x35cbd057,0x35cca946,0x35ccbd02,0x35cc0b7a,0x35ccbd02,0x35cca31b,0x35cbafd4,0x35c9e42e
.long 0x35cc8da6,0x35cb68e9,0x35c9570a,0x35c65a74,0x35cb4283,0x35c8fc89,0x35c5b679,0x35c17480
.long 0x35c8dd65,0x35c5619f,0x35c0d407,0x35bb3aec,0x35c5619f,0x35c09d9b,0x35bab7a7,0x35b3b8a6
.long 0x35c0d407,0x35bab7a7,0x35b36b4e,0x35aafadc,0x35bb3aec,0x35b3b8a6,0x35aafadc,0x35a110e7
.long 0x35b49e13,0x35abab1e,0x35a1740f,0x35960c2f,0x35ad06a9,0x35a29b2e,0x3596e669,0x358a000c
.long 0x35a47f35,0x3598967c,0x358b6318,0x357a0347,0x359b138d,0x358dac1c,0x357df9b6,0x355e4f8b
.long 0x0,0x0,0x0,0x0,0x340c9200,0x341193e2,0x34169569,0x341b9694
.long 0x348c0d4f,0x3491007a,0x3495f23f,0x349ae293,0x34d0c934,0x34d8115e,0x34df54d8,0x34e6937a
.long 0x3509fd76,0x350eb659,0x351369bb,0x3518176e,0x352a91ce,0x35304301,0x3535e995,0x353b8534
.long 0x3549e41f,0x35506ab5,0x3556df37,0x355d4116,0x3567b948,0x356eec58,0x35760334,0x357cfd04
.long 0x3581ec7b,0x3585c511,0x35898908,0x358d37c9,0x358f0707,0x35930511,0x3596e669,0x359aaa4d
.long 0x359b138d,0x359f1b54,0x35a2fcc6,0x35a6b6f3,0x35a5fb4c,0x35a9ef63,0x35adb1ef,0x35b141d7
.long 0x35afa9af,0x35b36b4e,0x35b6eeae,0x35ba3296,0x35b80c6c,0x35bb7be1,0x35be9eff,0x35c17480
.long 0x35bf13b1,0x35c210c7,0x35c4b238,0x35c6f6c8,0x35c4b238,0x35c71cab,0x35c91b30,0x35caacb2
.long 0x35c8dd65,0x35ca9556,0x35cbd057,0x35cc8da6,0x35cb8d5a,0x35cc73c1,0x35cccbd0,0x35cc954b
.long 0x35ccbd02,0x35ccb421,0x35cc0b7a,0x35cac390,0x35cc6a23,0x35cb55f5,0x35c990f4,0x35c71cab
.long 0x35ca9556,0x35c85c01,0x35c5619f,0x35c1a90f,0x35c74213,0x35c3cc4e,0x35bf868d,0x35ba7558
.long 0x35c276a0,0x35bdb017,0x35b80c6c,0x35b19232,0x35bc3c09,0x35b613bd,0x35af0373,0x35a7142c
.long 0x35b49e13,0x35ad06a9,0x35a47f35,0x359b138d,0x35abab1e,0x35a29b2e,0x3598967c,0x358dac1c
.long 0x35a1740f,0x3596e669,0x358b6318,0x357df9b6,0x35960c2f,0x358a000c,0x357a0347,0x355e4f8b
.long 0x35898908,0x3578046f,0x355b2291,0x353ca2fc,0x3578046f,0x355a1284,0x353a66f9,0x351941f2
.long 0x355b2291,0x353a66f9,0x3518176e,0x34e8fc95,0x353ca2fc,0x351941f2,0x34e8fc95,0x349d5a2e
.long 0x35cccccd,0x35cbd057,0x35c8dd65,0x35c3fb3c,0x35cccccd,0x35cbc054,0x35c89dab,0x35c36d09
.long 0x35cccccd,0x35cbafd4,0x35c85c01,0x35c2da99,0x35cccccd,0x35cb9ed5,0x35c8186a,0x35c243ef
.long 0x35cccccd,0x35cb8d5a,0x35c7d2e4,0x35c1a90f,0x35cccccd,0x35cb7b60,0x35c78b72,0x35c109fb
.long 0x35cccccd,0x35cb68e9,0x35c74213,0x35c066b8,0x35cccccd,0x35cb55f5,0x35c6f6c8,0x35bfbf49
.long 0x35cccccd,0x35cb4283,0x35c6a993,0x35bf13b1,0x35cccccd,0x35cb2e94,0x35c65a74,0x35be63f5
.long 0x35cccccd,0x35cb1a27,0x35c6096a,0x35bdb017,0x35cccccd,0x35cb053d,0x35c5b679,0x35bcf81d
.long 0x35cccccd,0x35caefd6,0x35c5619f,0x35bc3c09,0x35cccccd,0x35cad9f2,0x35c50adf,0x35bb7be1
.long 0x35cccccd,0x35cac390,0x35c4b238,0x35bab7a7,0x35cccccd,0x35caacb2,0x35c457ac,0x35b9ef61
.long 0x35cccccd,0x35ca9556,0x35c3fb3c,0x35b92313,0x35cccccd,0x35ca7d7e,0x35c39ce8,0x35b852c1
.long 0x35cccccd,0x35ca6529,0x35c33cb1,0x35b77e6f,0x35cccccd,0x35ca4c56,0x35c2da99,0x35b6a623
.long 0x35cccccd,0x35ca3307,0x35c276a0,0x35b5c9e1,0x35cccccd,0x35ca193c,0x35c210c7,0x35b4e9ae
.long 0x35cccccd,0x35c9fef3,0x35c1a90f,0x35b4058e,0x35cccccd,0x35c9e42e,0x35c13f79,0x35b31d87
.long 0x35cccccd,0x35c9c8ed,0x35c0d407,0x35b2319e,0x35cccccd,0x35c9ad2f,0x35c066b8,0x35b141d7
.long 0x35cccccd,0x35c990f4,0x35bff78f,0x35b04e38,0x35cccccd,0x35c9743e,0x35bf868d,0x35af56c7
.long 0x35cccccd,0x35c9570a,0x35bf13b1,0x35ae5b88,0x35cccccd,0x35c9395b,0x35be9eff,0x35ad5c81
.long 0x35cccccd,0x35c91b30,0x35be2876,0x35ac59b8,0x35cccccd,0x35c8fc89,0x35bdb017,0x35ab5332
.long 0x35bd35e5,0x35b49e13,0x35aa48f4,0x359e5003,0x35bc3c09,0x35b31d87,0x35a8296b,0x359b7c6d
.long 0x35bb3aec,0x35b19232,0x35a5fb4c,0x3598967c,0x35ba3296,0x35affc2a,0x35a3bec8,0x35959e88
.long 0x35b92313,0x35ae5b88,0x35a1740f,0x359294e9,0x35b80c6c,0x35acb065,0x359f1b54,0x358f79fb
.long 0x35b6eeae,0x35aafadc,0x359cb4cd,0x358c4e1d,0x35b5c9e1,0x35a93b06,0x359a40ae,0x358911af
.long 0x35b49e13,0x35a770fe,0x3597bf2e,0x3585c511,0x35b36b4e,0x35a59ce0,0x35953084,0x358268a9
.long 0x35b2319e,0x35a3bec8,0x359294e9,0x357df9b6,0x35b0f10f,0x35a1d6d2,0x358fec97,0x3577041e
.long 0x35afa9af,0x359fe51e,0x358d37c9,0x356ff15b,0x35ae5b88,0x359de9c7,0x358a76bb,0x3568c245
.long 0x35ad06a9,0x359be4ed,0x3587a9aa,0x356177b4,0x35abab1e,0x3599d6b0,0x3584d0d5,0x355a1284
.long 0x35aa48f4,0x3597bf2e,0x3581ec7b,0x35529394,0x35a8e03a,0x35959e88,0x357df9b6,0x354afbc9
.long 0x35a770fe,0x359374de,0x3578046f,0x35434c06,0x35a5fb4c,0x35914253,0x3571f9a5,0x353b8534
.long 0x35a47f35,0x358f0707,0x356bd9dd,0x3533a83f,0x35a2fcc6,0x358cc31e,0x3565a5a1,0x352bb614
.long 0x35a1740f,0x358a76bb,0x355f5d78,0x3523afa2,0x359fe51e,0x35882200,0x355901f0,0x351b95de
.long 0x359e5003,0x3585c511,0x35529394,0x351369bb,0x359cb4cd,0x35836014,0x354c12f5,0x350b2c30
.long 0x359b138d,0x3580f32d,0x354580a2,0x3502de37,0x35996c52,0x357cfd04,0x353edd2d,0x34f50196
.long 0x3597bf2e,0x3578046f,0x3538292a,0x34e429d0,0x35960c2f,0x3572fcea,0x3531652e,0x34d3371a
.long 0x35945368,0x356de6c2,0x352a91ce,0x34c22b74,0x359294e9,0x3568c245,0x3523afa2,0x34b108e1
.long 0x0,0x3420975e,0x349fd168,0x34edcd1c,0x0,0x342597c6,0x34a4beb3,0x34f50196
.long 0x0,0x342a97c7,0x34a9aa67,0x34fc30c0,0x0,0x342f9760,0x34ae9479,0x3501ad39
.long 0x0,0x3434968b,0x34b37cdc,0x35053f42,0x0,0x34399548,0x34b86384,0x3508ce67
.long 0x0,0x343e9392,0x34bd4866,0x350c5a95,0x0,0x34439166,0x34c22b74,0x350fe3b7
.long 0x0,0x34488ec2,0x34c70ca3,0x351369bb,0x0,0x344d8ba2,0x34cbebe7,0x3516ec8c
.long 0x0,0x34528804,0x34d0c934,0x351a6c18,0x0,0x345783e3,0x34d5a47e,0x351de84a
.long 0x0,0x345c7f3e,0x34da7db8,0x3521610f,0x0,0x34617a10,0x34df54d8,0x3524d655
.long 0x0,0x34667457,0x34e429d0,0x35284807,0x0,0x346b6e11,0x34e8fc95,0x352bb614
.long 0x0,0x34706739,0x34edcd1c,0x352f2067,0x0,0x34755fcc,0x34f29b58,0x353286ed
.long 0x0,0x347a57c9,0x34f7673d,0x3535e995,0x0,0x347f4f2b,0x34fc30c0,0x3539484b
.long 0x0,0x348222f8,0x35007bea,0x353ca2fc,0x0,0x34849e0a,0x3502de37,0x353ff996
.long 0x0,0x348718ca,0x35053f42,0x35434c06,0x0,0x34899337,0x35079f03,0x35469a3a
.long 0x0,0x348c0d4f,0x3509fd76,0x3549e41f,0x0,0x348e8710,0x350c5a95,0x354d29a4
.long 0x0,0x3491007a,0x350eb659,0x35506ab5,0x0,0x3493798a,0x351110bd,0x3553a742
.long 0x0,0x3495f23f,0x351369bb,0x3556df37,0x0,0x34986a98,0x3515c14d,0x355a1284
.long 0x0,0x349ae293,0x3518176e,0x355d4116,0x0,0x349d5a2e,0x351a6c18,0x35606adb
.long 0x351cbf44,0x35411588,0x35638fc3,0x3581ec7b,0x3521610f,0x35469a3a,0x3569cab3,0x35854b1c
.long 0x3525fca2,0x354c12f5,0x356ff15b,0x35889a01,0x352a91ce,0x35517f65,0x35760334,0x358bd8c6
.long 0x352f2067,0x3556df37,0x357bffb5,0x358f0707,0x3533a83f,0x355c3217,0x3580f32d,0x35922466
.long 0x3538292a,0x356177b4,0x3583db51,0x35953084,0x353ca2fc,0x3566afbb,0x3586b804,0x35982b04
.long 0x35411588,0x356bd9dd,0x35898908,0x359b138d,0x354580a2,0x3570f5cb,0x358c4e1d,0x359de9c7
.long 0x3549e41f,0x35760334,0x358f0707,0x35a0ad5c,0x354e3fd4,0x357b01cb,0x3591b389,0x35a35df9
.long 0x35529394,0x357ff144,0x35945368,0x35a5fb4c,0x3556df37,0x358268a9,0x3596e669,0x35a88507
.long 0x355b2291,0x3584d0d5,0x35996c52,0x35aafadc,0x355f5d78,0x35873101,0x359be4ed,0x35ad5c81
.long 0x35638fc3,0x35898908,0x359e5003,0x35afa9af,0x3567b948,0x358bd8c6,0x35a0ad5c,0x35b1e21f
.long 0x356bd9dd,0x358e2017,0x35a2fcc6,0x35b4058e,0x356ff15b,0x35905ed9,0x35a53e0d,0x35b613bd
.long 0x3573ff99,0x359294e9,0x35a770fe,0x35b80c6c,0x3578046f,0x3594c224,0x35a99568,0x35b9ef61
.long 0x357bffb5,0x3596e669,0x35abab1e,0x35bbbc62,0x357ff144,0x35990197,0x35adb1ef,0x35bd7339
.long 0x3581ec7b,0x359b138d,0x35afa9af,0x35bf13b1,0x3583db51,0x359d1c2c,0x35b19232,0x35c09d9b
.long 0x3585c511,0x359f1b54,0x35b36b4e,0x35c210c7,0x3587a9aa,0x35a110e7,0x35b534da,0x35c36d09
.long 0x35898908,0x35a2fcc6,0x35b6eeae,0x35c4b238,0x358b6318,0x35a4ded4,0x35b898a3,0x35c5e02f
.long 0x358d37c9,0x35a6b6f3,0x35ba3296,0x35c6f6c8,0x358f0707,0x35a88507,0x35bbbc62,0x35c7f5e5
.long 0x3590d0c3,0x3581ec7b,0x35638fc3,0x35411588,0x358d37c9,0x357b01cb,0x355901f0,0x3534c922
.long 0x35898908,0x3571f9a5,0x354e3fd4,0x35284807,0x3585c511,0x3568c245,0x35434c06,0x351b95de
.long 0x3581ec7b,0x355f5d78,0x3538292a,0x350eb659,0x357bffb5,0x3555cd14,0x352cd9f0,0x3501ad39
.long 0x3573ff99,0x354c12f5,0x3521610f,0x34e8fc95,0x356bd9dd,0x35423103,0x3515c14d,0x34ce5acd
.long 0x35638fc3,0x3538292a,0x3509fd76,0x34b37cdc,0x355b2291,0x352dfd61,0x34fc30c0,0x34986a98
.long 0x35529394,0x3523afa2,0x34e429d0,0x347a57c9,0x3549e41f,0x351941f2,0x34cbebe7,0x34439166
.long 0x35411588,0x350eb659,0x34b37cdc,0x340c9200,0x3538292a,0x35040ee5,0x349ae293,0x33aad33e
.long 0x352f2067,0x34f29b58,0x348222f8,0x32f142bd,0x3525fca2,0x34dce98c,0x34528804,0xb2c90dd6
.long 0x351cbf44,0x34c70ca3,0x3420975e,0xb3a0c8f3,0x351369bb,0x34b108e1,0x33dd000f,0xb4078fc8
.long 0x3509fd76,0x349ae293,0x33713846,0xb43e9392,0x35007bea,0x34849e0a,0x3220d93a,0xb4755fcc
.long 0x34edcd1c,0x345c7f3e,0xb320d559,0xb495f23f,0x34da7db8,0x342f9760,0xb3b4dd20,0xb4b108e1
.long 0x34c70ca3,0x34028d3d,0xb40c9200,0xb4cbebe7,0x34b37cdc,0x33aad33e,0xb43e9392,0xb4e6937a
.long 0x349fd168,0x3320d559,0xb4706739,0xb5007bea,0x348c0d4f,0xb1a0d96b,0xb491007a,0xb50d88a2
.long 0x34706739,0xb34907c8,0xb4a9aa67,0xb51a6c18,0x34488ec2,0xb3bee693,0xb4c22b74,0xb5272288
.long 0x3420975e,0xb40c9200,0xb4da7db8,0xb533a83f,0x33f10e6e,0xb4399548,0xb4f29b58,0xb53ff996
.long 0x33a0c8f3,0xb4667457,0xb5053f42,0xb54c12f5,0x3320d559,0xb4899337,0xb51110bd,0xb557f0d6
.long 0x351cbf44,0x34edcd1c,0x349fd168,0x3420975e,0x350eb659,0x34ce5acd,0x347a57c9,0x33aad33e
.long 0x35007bea,0x34ae9479,0x3434968b,0x3220d93a,0x34e429d0,0x348e8710,0x33dd000f,0xb382a7d6
.long 0x34c70ca3,0x345c7f3e,0x3320d559,0xb40c9200,0x34a9aa67,0x341b9694,0xb2f142bd,0xb45783e3
.long 0x348c0d4f,0x33b4dd20,0xb3c8ef90,0xb491007a,0x345c7f3e,0x32c90dd6,0xb42a97c7,0xb4b5f068
.long 0x3420975e,0xb320d559,0xb4706739,0xb4da7db8,0x33c8ef90,0xb3d2f811,0xb49ae293,0xb4fe9498
.long 0x3320d559,0xb42a97c7,0xb4bd4866,0xb51110bd,0xb2a0d873,0xb46b6e11,0xb4df54d8,0xb522888b
.long 0xb3a0c8f3,0xb495f23f,0xb5007bea,0xb533a83f,0xb40c9200,0xb4b5f068,0xb51110bd,0xb5446691
.long 0xb4488ec2,0xb4d5a47e,0xb521610f,0xb554ba6c,0xb48222f8,0xb4f50196,0xb531652e,0xb5649af8
.long 0xb49fd168,0xb509fd76,0xb5411588,0xb573ff99,0xb4bd4866,0xb51941f2,0xb5506ab5,0xb5816ffc
.long 0xb4da7db8,0xb5284807,0xb55f5d78,0xb5889a01,0xb4f7673d,0xb5370998,0xb56de6c2,0xb58f79fb
.long 0xb509fd76,0xb54580a2,0xb57bffb5,0xb5960c2f,0xb518176e,0xb553a742,0xb584d0d5,0xb59c4d0e
.long 0xb525fca2,0xb56177b4,0xb58b6318,0xb5a23933,0xb533a83f,0xb56eec58,0xb591b389,0xb5a7cd68
.long 0xb5411588,0xb57bffb5,0xb597bf2e,0xb5ad06a9,0xb54e3fd4,0xb584563c,0xb59d832a,0xb5b1e21f
.long 0xb55b2291,0xb58a76bb,0xb5a2fcc6,0xb5b65d28,0xb567b948,0xb5905ed9,0xb5a8296b,0xb5ba7558
.long 0xb573ff99,0xb5960c2f,0xb5ad06a9,0xb5be2876,0xb57ff144,0xb59b7c6d,0xb5b19232,0xb5c17480
.long 0xb585c511,0xb5a0ad5c,0xb5b5c9e1,0xb5c457ac,0xb58b6318,0xb5a59ce0,0xb5b9abba,0xb5c6d06b
.long 0x3590d0c3,0x359e5003,0x35aa48f4,0x35b49e13,0x35945368,0x35a1d6d2,0x35adb1ef,0x35b7c5a7
.long 0x3597bf2e,0x35a53e0d,0x35b0f10f,0x35bab7a7,0x359b138d,0x35a88507,0x35b4058e,0x35bd7339
.long 0x359e5003,0x35abab1e,0x35b6eeae,0x35bff78f,0x35a1740f,0x35aeafb3,0x35b9abba,0x35c243ef
.long 0x35a47f35,0x35b19232,0x35bc3c09,0x35c457ac,0x35a770fe,0x35b45208,0x35be9eff,0x35c6322c
.long 0x35aa48f4,0x35b6eeae,0x35c0d407,0x35c7d2e4,0x35ad06a9,0x35b9679f,0x35c2da99,0x35c9395b
.long 0x35afa9af,0x35bbbc62,0x35c4b238,0x35ca6529,0x35b2319e,0x35bdec81,0x35c65a74,0x35cb55f5
.long 0x35b49e13,0x35bff78f,0x35c7d2e4,0x35cc0b7a,0x35b6eeae,0x35c1dd26,0x35c91b30,0x35cc8582
.long 0x35b92313,0x35c39ce8,0x35ca3307,0x35ccc3eb,0x35bb3aec,0x35c5367c,0x35cb1a27,0x35ccc6a2
.long 0x35bd35e5,0x35c6a993,0x35cbd057,0x35cc8da6,0x35bf13b1,0x35c7f5e5,0x35cc556c,0x35cc1907
.long 0x35c0d407,0x35c91b30,0x35cca946,0x35cb68e9,0x35c276a0,0x35ca193c,0x35cccbd0,0x35ca7d7e
.long 0x35c3fb3c,0x35caefd6,0x35ccbd02,0x35c9570a,0x35c5619f,0x35cb9ed5,0x35cc7ce0,0x35c7f5e5
.long 0x35c6a993,0x35cc2618,0x35cc0b7a,0x35c65a74,0x35c7d2e4,0x35cc8582,0x35cb68e9,0x35c4852f
.long 0x35c8dd65,0x35ccbd02,0x35ca9556,0x35c276a0,0x35c9c8ed,0x35cccc8e,0x35c990f4,0x35c02f5f
.long 0x35ca9556,0x35ccb421,0x35c85c01,0x35bdb017,0x35cb4283,0x35cc73c1,0x35c6f6c8,0x35baf983
.long 0x35cbd057,0x35cc0b7a,0x35c5619f,0x35b80c6c,0x35cc3ebe,0x35cb7b60,0x35c39ce8,0x35b4e9ae
.long 0x35cc8da6,0x35cac390,0x35c1a90f,0x35b19232,0x35ccbd02,0x35c9e42e,0x35bf868d,0x35ae06f1
.long 0x35bd35e5,0x35c3fb3c,0x35c8dd65,0x35cbd057,0x35bff78f,0x35c6322c,0x35ca6529,0x35cc8582
.long 0x35c276a0,0x35c8186a,0x35cb8d5a,0x35cccbd0,0x35c4b238,0x35c9ad2f,0x35cc556c,0x35cca31b
.long 0x35c6a993,0x35caefd6,0x35ccbd02,0x35cc0b7a,0x35c85c01,0x35cbdfdd,0x35ccc3eb,0x35cb053d
.long 0x35c9c8ed,0x35cc7ce0,0x35cc6a23,0x35c990f4,0x35caefd6,0x35ccc6a2,0x35cbafd4,0x35c7af69
.long 0x35cbd057,0x35ccbd02,0x35ca9556,0x35c5619f,0x35cc6a23,0x35cc6006,0x35c91b30,0x35c2a8d8
.long 0x35ccbd02,0x35cbafd4,0x35c74213,0x35bf868d,0x35ccc8da,0x35caacb2,0x35c50adf,0x35bbfc70
.long 0x35cc8da6,0x35c9570a,0x35c276a0,0x35b80c6c,0x35cc0b7a,0x35c7af69,0x35bf868d,0x35b3b8a6
.long 0x35cb4283,0x35c5b679,0x35bc3c09,0x35af0373,0x35ca3307,0x35c36d09,0x35b898a3,0x35a9ef63
.long 0x35c8dd65,0x35c0d407,0x35b49e13,0x35a47f35,0x35c74213,0x35bdec81,0x35b04e38,0x359eb5dd
.long 0x35c5619f,0x35bab7a7,0x35abab1e,0x3598967c,0x35c33cb1,0x35b736c7,0x35a6b6f3,0x35922466
.long 0x35c0d407,0x35b36b4e,0x35a1740f,0x358b6318,0x35be2876,0x35af56c7,0x359be4ed,0x3584563c
.long 0x35bb3aec,0x35aafadc,0x35960c2f,0x357a0347,0x35b80c6c,0x35a65953,0x358fec97,0x356ad291
.long 0x35b49e13,0x35a1740f,0x35898908,0x355b2291,0x35b0f10f,0x359c4d0e,0x3582e487,0x354afbc9
.long 0x35ad06a9,0x3596e669,0x3578046f,0x353a66f9,0x35a8e03a,0x35914253,0x3569cab3,0x35296d1f
.long 0x35a47f35,0x358b6318,0x355b2291,0x3518176e,0x359fe51e,0x35854b1c,0x354c12f5,0x35066f4c
.long 0x359b138d,0x357df9b6,0x353ca2fc,0x34e8fc95,0x35960c2f,0x3570f5cb,0x352cd9f0,0x34c49c48
.long 0x0,0xb420975e,0xb49fd168,0xb4edcd1c,0xb3a0c8f3,0xb4755fcc,0xb4cbebe7,0xb50d88a2
.long 0xb420975e,0xb4a4beb3,0xb4f7673d,0xb523afa2,0xb4706739,0xb4ce5acd,0xb51110bd,0xb539484b
.long 0xb49fd168,0xb4f7673d,0xb525fca2,0xb54e3fd4,0xb4c70ca3,0xb50fe3b7,0xb53a66f9,0xb5628401
.long 0xb4edcd1c,0xb523afa2,0xb54e3fd4,0xb5760334,0xb509fd76,0xb5370998,0xb56177b4,0xb584563c
.long 0xb51cbf44,0xb549e41f,0xb573ff99,0xb58d37c9,0xb52f2067,0xb55c3217,0xb582e487,0xb5959e88
.long 0xb5411588,0xb56de6c2,0xb58b6318,0xb59d832a,0xb5529394,0xb57ef5cc,0xb59374de,0xb5a4ded4
.long 0xb5638fc3,0xb587a9aa,0xb59b138d,0xb5abab1e,0xb573ff99,0xb58f79fb,0xb5a23933,0xb5b1e21f
.long 0xb581ec7b,0xb596e669,0xb5a8e03a,0xb5b77e6f,0xb5898908,0xb59de9c7,0xb5af0373,0xb5bc7b2f
.long 0xb590d0c3,0xb5a47f35,0xb5b49e13,0xb5c0d407,0xb597bf2e,0xb5aaa21d,0xb5b9abba,0xb5c4852f
.long 0xb59e5003,0xb5b04e38,0xb5be2876,0xb5c78b72,0xb5a47f35,0xb5b57f95,0xb5c210c7,0xb5c9e42e
.long 0xb5aa48f4,0xb5ba3296,0xb5c5619f,0xb5cb8d5a,0xb5afa9af,0xb5be63f5,0xb5c8186a,0xb5cc8582
.long 0xb5b49e13,0xb5c210c7,0xb5ca3307,0xb5cccbd0,0xb5b92313,0xb5c5367c,0xb5cbafd4,0xb5cc6006
.long 0xb5bd35e5,0xb5c7d2e4,0xb5cc8da6,0xb5cb4283,0xb5c0d407,0xb5c9e42e,0xb5cccbd0,0xb5c9743e
.long 0xb5c3fb3c,0xb5cb68e9,0xb5cc6a23,0xb5c6f6c8,0xb5c6a993,0xb5cc6006,0xb5cb68e9,0xb5c3cc4e
.long 0xb5c8dd65,0xb5ccc8da,0xb5c9c8ed,0xb5bff78f,0xb5ca9556,0xb5cca31b,0xb5c78b72,0xb5bb7be1
.long 0xb5cbd057,0xb5cbeee4,0xb5c4b238,0xb5b65d28,0xb5cc8da6,0xb5caacb2,0xb5c13f79,0xb5b09fda
.long 0xb51cbf44,0xb5411588,0xb5638fc3,0xb581ec7b,0xb533a83f,0xb557f0d6,0xb57a0347,0xb58cc31e
.long 0xb549e41f,0xb56de6c2,0xb587a9aa,0xb596e669,0xb55f5d78,0xb5816ffc,0xb591b389,0xb5a0496e
.long 0xb573ff99,0xb58b6318,0xb59b138d,0xb5a8e03a,0xb583db51,0xb594c224,0xb5a3bec8,0xb5b09fda
.long 0xb58d37c9,0xb59d832a,0xb5abab1e,0xb5b77e6f,0xb5960c2f,0xb5a59ce0,0xb5b2cf52,0xb5bd7339
.long 0xb59e5003,0xb5ad06a9,0xb5b92313,0xb5c276a0,0xb5a5fb4c,0xb5b3b8a6,0xb5be9eff,0xb5c68241
.long 0xb5ad06a9,0xb5b9abba,0xb5c33cb1,0xb5c990f4,0xb5b36b4e,0xb5bed993,0xb5c6f6c8,0xb5cb9ed5
.long 0xb5b92313,0xb5c33cb1,0xb5c9c8ed,0xb5cca946,0xb5be2876,0xb5c6d06b,0xb5cbafd4,0xb5ccaef3
.long 0xb5c276a0,0xb5c990f4,0xb5cca946,0xb5cbafd4,0xb5c6096a,0xb5cb7b60,0xb5ccb421,0xb5c9ad2f
.long 0xb5c8dd65,0xb5cc8da6,0xb5cbd057,0xb5c6a993,0xb5caefd6,0xb5ccc6a2,0xb5c9fef3,0xb5c2a8d8
.long 0xb5cc3ebe,0xb5cc2618,0xb5c74213,0xb5bdb017,0xb5ccc8da,0xb5caacb2,0xb5c39ce8,0xb5b7c5a7
.long 0xb5cc8da6,0xb5c85c01,0xb5bf13b1,0xb5b0f10f,0xb5cb8d5a,0xb5c5367c,0xb5b9abba,0xb5a93b06
.long 0xb5c9c8ed,0xb5c13f79,0xb5b36b4e,0xb5a0ad5c,0xb5c74213,0xb5bc7b2f,0xb5ac59b8,0xb59752fa
.long 0xb5c3fb3c,0xb5b6eeae,0xb5a47f35,0xb58d37c9,0xb5bff78f,0xb5b09fda,0xb59be4ed,0xb58268a9
.long 0xb5bb3aec,0xb5a99568,0xb59294e9,0xb56de6c2,0xb5b5c9e1,0xb5a1d6d2,0xb5889a01,0xb555cd14
.long 0xb5afa9af,0xb5996c52,0xb57bffb5,0xb53ca2fc,0xb5a8e03a,0xb5905ed9,0xb565a5a1,0xb522888b
.long 0xb5a1740f,0xb586b804,0xb54e3fd4,0xb5079f03,0xb5996c52,0xb5790428,0xb535e995,0xb4d8115e
.long 0x35cccccd,0x35cbd057,0x35c8dd65,0x35c3fb3c,0x35cc8da6,0x35ca7d7e,0x35c65a74,0x35c02f5f
.long 0x35cbd057,0x35c89dab,0x35c33cb1,0x35bbbc62,0x35ca9556,0x35c6322c,0x35bf868d,0x35b6a623
.long 0x35c8dd65,0x35c33cb1,0x35bb3aec,0x35b0f10f,0x35c6a993,0x35bfbf49,0x35b65d28,0x35aaa21d
.long 0x35c3fb3c,0x35bbbc62,0x35b0f10f,0x35a3bec8,0x35c0d407,0x35b736c7,0x35aafadc,0x359c4d0e
.long 0x35bd35e5,0x35b2319e,0x35a47f35,0x35945368,0x35b92313,0x35acb065,0x359d832a,0x358bd8c6
.long 0x35b49e13,0x35a6b6f3,0x35960c2f,0x3582e487,0x35afa9af,0x35a0496e,0x358e2017,0x3572fcea
.long 0x35aa48f4,0x35996c52,0x3585c511,0x355f5d78,0x35a47f35,0x35922466,0x357a0347,0x354afbc9
.long 0x359e5003,0x358a76bb,0x3567b948,0x3535e995,0x3597bf2e,0x358268a9,0x3554ba6c,0x35203930
.long 0x3590d0c3,0x3573ff99,0x35411588,0x3509fd76,0x35898908,0x35628401,0x352cd9f0,0x34e6937a
.long 0x3581ec7b,0x35506ab5,0x3518176e,0x34b86384,0x3573ff99,0x353dc04f,0x3502de37,0x34899337
.long 0x35638fc3,0x352a91ce,0x34da7db8,0x3434968b,0x35529394,0x3516ec8c,0x34ae9479,0x33aad33e
.long 0x35411588,0x3502de37,0x348222f8,0xb220d93a,0x352f2067,0x34dce98c,0x342a97c7,0xb3d2f811
.long 0x351cbf44,0x34b37cdc,0x33a0c8f3,0xb4488ec2,0x3509fd76,0x34899337,0xb220d93a,0xb493798a
.long 0x34edcd1c,0x343e9392,0xb3c8ef90,0xb4c22b74,0x34c70ca3,0x33d2f811,0xb43e9392,0xb4f03484
.long 0x349fd168,0x32a0d873,0xb48c0d4f,0xb50eb659,0x34706739,0xb382a7d6,0xb4b86384,0xb524d655
.long 0x3420975e,0xb4169569,0xb4e429d0,0xb53a66f9,0x33a0c8f3,0xb46b6e11,0xb5079f03,0xb54f5584
.long 0x35bd35e5,0x35b49e13,0x35aa48f4,0x359e5003,0x35b80c6c,0x35ae06f1,0x35a23933,0x3594c224
.long 0x35b2319e,0x35a6b6f3,0x35996c52,0x358a76bb,0x35abab1e,0x359eb5dd,0x358fec97,0x357ef5cc
.long 0x35a47f35,0x35960c2f,0x3585c511,0x3567b948,0x359cb4cd,0x358cc31e,0x35760334,0x354f5584
.long 0x35945368,0x3582e487,0x355f5d78,0x3535e995,0x358b6318,0x3570f5cb,0x3547b357,0x351b95de
.long 0x3581ec7b,0x355b2291,0x352f2067,0x35007bea,0x356ff15b,0x35446691,0x3515c14d,0x34c97c83
.long 0x355b2291,0x352cd9f0,0x34f7673d,0x3491007a,0x354580a2,0x351495b2,0x34c22b74,0x342f9760
.long 0x352f2067,0x34f7673d,0x348c0d4f,0x33713846,0x3518176e,0x34c49c48,0x342a97c7,0xb35d204b
.long 0x35007bea,0x3491007a,0x33713846,0xb42a97c7,0x34d0c934,0x34399548,0xb34907c8,0xb48e8710
.long 0x349fd168,0x33a0c8f3,0xb420975e,0xb4c70ca3,0x345c7f3e,0xb2c90dd6,0xb48718ca,0xb4fe9498
.long 0x33f10e6e,0xb4028d3d,0xb4bd4866,0xb51a6c18,0x32a0d873,0xb46b6e11,0xb4f29b58,0xb534c922
.long 0xb3a0c8f3,0xb4a9aa67,0xb51369bb,0xb54e3fd4,0xb434968b,0xb4dce98c,0xb52cd9f0,0xb566afbb
.long 0xb48c0d4f,0xb5079f03,0xb54580a2,0xb57df9b6,0xb4bd4866,0xb5203930,0xb55d4116,0xb58a000c
.long 0xb4edcd1c,0xb538292a,0xb573ff99,0xb5945368,0xb50eb659,0xb54f5584,0xb584d0d5,0xb59de9c7
.long 0xb525fca2,0xb565a5a1,0xb58f0707,0xb5a6b6f3,0xb53ca2fc,0xb57b01cb,0xb598967c,0xb5aeafb3
.long 0xb5529394,0xb587a9aa,0xb5a1740f,0xb5b5c9e1,0xb567b948,0xb5914253,0xb5a99568,0xb5bbfc70
.long 0xb57bffb5,0xb59a40ae,0xb5b0f10f,0xb5c13f79,0xb587a9aa,0xb5a29b2e,0xb5b77e6f,0xb5c58c49
.long 0xb590d0c3,0xb59e5003,0xb5aa48f4,0xb5b49e13,0xb59b138d,0xb5a7cd68,0xb5b2cf52,0xb5bbfc70
.long 0xb5a47f35,0xb5b04e38,0xb5ba3296,0xb5c210c7,0xb5ad06a9,0xb5b7c5a7,0xb5c066b8,0xb5c6d06b
.long 0xb5b49e13,0xb5be2876,0xb5c5619f,0xb5ca3307,0xb5bb3aec,0xb5c36d09,0xb5c91b30,0xb5cc32aa
.long 0xb5c0d407,0xb5c78b72,0xb5cb8d5a,0xb5cccbd0,0xb5c5619f,0xb5ca7d7e,0xb5ccb421,0xb5cbfd6e
.long 0xb5c8dd65,0xb5cc3ebe,0xb5cc8da6,0xb5c9c8ed,0xb5cb4283,0xb5cccc8e,0xb5cb1a27,0xb5c6322c
.long 0xb5cc8da6,0xb5cc2618,0xb5c85c01,0xb5c13f79,0xb5ccbd02,0xb5ca4c56,0xb5c457ac,0xb5baf983
.long 0xb5cbd057,0xb5c74213,0xb5bf13b1,0xb5b36b4e,0xb5c9c8ed,0xb5c30be1,0xb5b898a3,0xb5aaa21d
.long 0xb5c6a993,0xb5bdb017,0xb5b0f10f,0xb5a0ad5c,0xb5c276a0,0xb5b736c7,0xb5a8296b,0xb5959e88
.long 0xb5bd35e5,0xb5afa9af,0xb59e5003,0xb5898908,0xb5b6eeae,0xb5a7142c,0xb59374de,0xb5790428
.long 0xb5afa9af,0xb59d832a,0xb587a9aa,0xb55d4116,0xb5a770fe,0xb5930511,0xb5760334,0xb53ff996
.long 0xb59e5003,0xb587a9aa,0xb55b2291,0xb521610f,0xb5945368,0xb577041e,0xb53edd2d,0xb501ad39
.long 0xb5898908,0xb55d4116,0xb521610f,0xb4c22b74,0xb57bffb5,0xb5423103,0xb502de37,0xb47f4f2b
.long 0xb5638fc3,0xb525fca2,0xb4c70ca3,0xb3f10e6e,0xb549e41f,0xb508ce67,0xb48718ca,0x3271455a
.long 0xb52f2067,0xb4d5a47e,0xb40c9200,0x34169569,0xb51369bb,0xb4986a98,0xb220d93a,0x348e8710
.long 0xb4edcd1c,0xb434968b,0x33f10e6e,0x34d0c934,0xb4b37cdc,0xb35d204b,0x347a57c9,0x3508ce67
.long 0xb4706739,0x338cb338,0x34bd4866,0x35284807,0xb3f10e6e,0x34439166,0x34fc30c0,0x35469a3a
.long 0xb5bd35e5,0xb5c3fb3c,0xb5c8dd65,0xb5cbd057,0xb5c33cb1,0xb5c87d14,0xb5cbafd4,0xb5cccc8e
.long 0xb5c7d2e4,0xb5cb68e9,0xb5ccc8da,0xb5cbeee4,0xb5caefd6,0xb5ccb8d1,0xb5cc2618,0xb5c9395b
.long 0xb5cc8da6,0xb5cc6a23,0xb5c9c8ed,0xb5c4b238,0xb5cca946,0xb5ca7d7e,0xb5c5b679,0xb5be63f5
.long 0xb5cb4283,0xb5c6f6c8,0xb5bff78f,0xb5b65d28,0xb5c85c01,0xb5c1dd26,0xb5b898a3,0xb5acb065
.long 0xb5c3fb3c,0xb5bb3aec,0xb5afa9af,0xb5a1740f,0xb5be2876,0xb5b31d87,0xb5a53e0d,0xb594c224
.long 0xb5b6eeae,0xb5a99568,0xb5996c52,0xb586b804,0xb5ae5b88,0xb59eb5dd,0xb58c4e1d,0xb56eec58
.long 0xb5a47f35,0xb59294e9,0xb57bffb5,0xb54e3fd4,0xb5996c52,0xb5854b1c,0xb55d4116,0xb52bb614
.long 0xb58d37c9,0xb56de6c2,0xb53ca2fc,0xb5079f03,0xb57ff144,0xb54f5584,0xb51a6c18,0xb4c49c48
.long 0xb5638fc3,0xb52f2067,0xb4edcd1c,0xb4706739,0xb54580a2,0xb50d88a2,0xb4a4beb3,0xb3aad33e
.long 0xb525fca2,0xb4d5a47e,0xb434968b,0x338cb338,0xb5053f42,0xb48e8710,0xb2f142bd,0x34617a10
.long 0xb4c70ca3,0xb40c9200,0x33f10e6e,0x34bd4866,0xb48222f8,0x31a0d96b,0x348718ca,0x35040ee5
.long 0xb3f10e6e,0x34169569,0x34d0c934,0x35284807,0x32a0d873,0x3493798a,0x350c5a95,0x354afbc9
.long 0x3420975e,0x34da7db8,0x352f2067,0x356bd9dd,0x3495f23f,0x350fe3b7,0x35506ab5,0x35854b1c
.long 0x34da7db8,0x3531652e,0x356ff15b,0x359374de,0x350eb659,0x35517f65,0x3586b804,0x35a0496e
.long 0x352f2067,0x356ff15b,0x35945368,0x35abab1e,0x354e3fd4,0x35863eb4,0x35a0ad5c,0x35b57f95
.long 0x356bd9dd,0x359374de,0x35abab1e,0x35bdb017,0x3583db51,0x359f806a,0x35b534da,0x35c429b0
.long 0x3590d0c3,0x3581ec7b,0x35638fc3,0x35411588,0x3585c511,0x356ad291,0x3547b357,0x3522888b
.long 0x3573ff99,0x35506ab5,0x352a91ce,0x3502de37,0x355b2291,0x3534c922,0x350c5a95,0x34c49c48
.long 0x35411588,0x3518176e,0x34da7db8,0x348222f8,0x3525fca2,0x34f50196,0x349ae293,0x33fb14c1
.long 0x3509fd76,0x34b86384,0x3434968b,0xb220d93a,0x34da7db8,0x34755fcc,0x334907c8,0xb41193e2
.long 0x349fd168,0x33f10e6e,0xb3a0c8f3,0xb48c0d4f,0x34488ec2,0xb1a0d96b,0xb4528804,0xb4ce5acd
.long 0x33a0c8f3,0xb4028d3d,0xb4a9aa67,0xb5079f03,0xb320d559,0xb47f4f2b,0xb4e8fc95,0xb5272288
.long 0xb420975e,0xb4bd4866,0xb51369bb,0xb54580a2,0xb48c0d4f,0xb4f9cc4b,0xb531652e,0xb5628401
.long 0xb4c70ca3,0xb51a6c18,0xb54e3fd4,0xb57df9b6,0xb5007bea,0xb5370998,0xb569cab3,0xb58bd8c6
.long 0xb51cbf44,0xb5529394,0xb581ec7b,0xb597bf2e,0xb538292a,0xb56ce099,0xb58e2017,0xb5a29b2e
.long 0xb5529394,0xb582e487,0xb5996c52,0xb5ac59b8,0xb56bd9dd,0xb58e93bb,0xb5a3bec8,0xb5b4e9ae
.long 0xb581ec7b,0xb5996c52,0xb5ad06a9,0xb5bc3c09,0xb58d37c9,0xb5a35df9,0xb5b534da,0xb5c243ef
.long 0xb597bf2e,0xb5ac59b8,0xb5bc3c09,0xb5c6f6c8,0xb5a1740f,0xb5b45208,0xb5c210c7,0xb5ca4c56
.long 0xb5aa48f4,0xb5bb3aec,0xb5c6a993,0xb5cc3ebe,0xb5b2319e,0xb5c109fb,0xb5c9fef3,0xb5ccca94
.long 0xb5b92313,0xb5c5b679,0xb5cc0b7a,0xb5cbeee4,0xb5bf13b1,0xb5c9395b,0xb5cccbd0,0xb5c9ad2f
.long 0xb5c3fb3c,0xb5cb8d5a,0xb5cc3ebe,0xb5c6096a,0xb5c7d2e4,0xb5ccaef3,0xb5ca6529,0xb5c109fb
.long 0xb5ca9556,0xb5cc9c72,0xb5c74213,0xb5bab7a7,0xb5cc3ebe,0xb5cb55f5,0xb5c2da99,0xb5b31d87
.long 0x351cbf44,0x34edcd1c,0x349fd168,0x3420975e,0x34f7673d,0x34a734c1,0x342a97c7,0x31a0d96b
.long 0x34b37cdc,0x343e9392,0x32a0d873,0xb4169569,0x345c7f3e,0x3334eec8,0xb4028d3d,0xb4986a98
.long 0x33a0c8f3,0xb3c8ef90,0xb48c0d4f,0xb4e429d0,0xb3713846,0xb4755fcc,0xb4d5a47e,0xb516ec8c
.long 0xb4488ec2,0xb4c22b74,0xb50eb659,0xb53a66f9,0xb4a9aa67,0xb5040ee5,0xb531652e,0xb55c3217
.long 0xb4edcd1c,0xb525fca2,0xb5529394,0xb57bffb5,0xb518176e,0xb5469a3a,0xb571f9a5,0xb58cc31e
.long 0xb538292a,0xb565a5a1,0xb587a9aa,0xb59a40ae,0xb556df37,0xb5816ffc,0xb5953084,0xb5a65953
.long 0xb573ff99,0xb58f0707,0xb5a1740f,0xb5b0f10f,0xb587a9aa,0xb59b7c6d,0xb5ac59b8,0xb5b9ef61
.long 0xb5945368,0xb5a6b6f3,0xb5b5c9e1,0xb5c13f79,0xb59fe51e,0xb5b09fda,0xb5bdb017,0xb5c6d06b
.long 0xb5aa48f4,0xb5b92313,0xb5c3fb3c,0xb5ca9556,0xb5b36b4e,0xb5c02f5f,0xb5c89dab,0xb5cc8582
.long 0xb5bb3aec,0xb5c5b679,0xb5cb8d5a,0xb5cc9c72,0xb5c1a90f,0xb5c9ad2f,0xb5ccc3eb,0xb5cad9f2
.long 0xb5c6a993,0xb5cc0b7a,0xb5cc3ebe,0xb5c74213,0xb5ca3307,0xb5cccc8e,0xb5c9fef3,0xb5c1dd26
.long 0xb5cc3ebe,0xb5cbeee4,0xb5c6096a,0xb5bab7a7,0xb5ccc8da,0xb5c9743e,0xb5c066b8,0xb5b1e21f
.long 0xb5cbd057,0xb5c5619f,0xb5b92313,0xb5a770fe,0xb5c9570a,0xb5bfbf49,0xb5b04e38,0xb59b7c6d
.long 0xb5c5619f,0xb5b898a3,0xb5a5fb4c,0xb58e2017,0xb5bff78f,0xb5affc2a,0xb59a40ae,0xb57ef5cc
.long 0xb5b92313,0xb5a5fb4c,0xb58d37c9,0xb55f5d78,0xb5b0f10f,0xb59aaa4d,0xb57df9b6,0xb53dc04f
.long 0xb5a770fe,0xb58e2017,0xb55f5d78,0xb51a6c18,0xb59cb4cd,0xb580760f,0xb53edd2d,0xb4eb6521
.long 0x80003f80,0x80003f80,0x80003f80,0x80003f80,0x80003f80,0xbe9e3f73,0xbf163f4f,0xbf4f3f16
.long 0x80003f80,0xbf163f4f,0xbf733e9e,0xbf73be9e,0x80003f80,0xbf4f3f16,0xbf73be9e,0xbe9ebf73
.long 0x80003f80,0xbf733e9e,0xbf16bf4f,0x3f16bf4f,0x80003f80,0xbf800000,0x8000bf80,0x3f800000
.long 0x80003f80,0xbf73be9e,0x3f16bf4f,0x3f163f4f,0x80003f80,0xbf4fbf16,0x3f73be9e,0xbe9e3f73
.long 0x80003f80,0xbf16bf4f,0x3f733e9e,0xbf733e9e,0x80003f80,0xbe9ebf73,0x3f163f4f,0xbf4fbf16
.long 0x80003f80,0x8000bf80,0x80003f80,0x8000bf80,0x80003f80,0x3e9ebf73,0xbf163f4f,0x3f4fbf16
.long 0x80003f80,0x3f16bf4f,0xbf733e9e,0x3f733e9e,0x80003f80,0x3f4fbf16,0xbf73be9e,0x3e9e3f73
.long 0x80003f80,0x3f73be9e,0xbf16bf4f,0xbf163f4f,0x80003f80,0x3f800000,0x8000bf80,0xbf800000
.long 0x80003f80,0x3f733e9e,0x3f16bf4f,0xbf16bf4f,0x80003f80,0x3f4f3f16,0x3f73be9e,0x3e9ebf73
.long 0x80003f80,0x3f163f4f,0x3f733e9e,0x3f73be9e,0x80003f80,0x3e9e3f73,0x3f163f4f,0x3f4f3f16
.long 0x0,0x0,0x0,0x0,0x0,0x0,0x0,0x0
.long 0x0,0x0,0x0,0x0,0x0,0x0,0x0,0x0
.long 0x0,0x0,0x0,0x0,0x0,0x0,0x0,0x0
.long 0x0,0x0,0x0,0x0,0x0,0x0,0x0,0x0
.long 0x0,0x0,0x0,0x0,0x0,0x0,0x0,0x0
.long 0x0,0x0,0x0,0x0,0x0,0x0,0x0,0x0
.long 0x80003f80,0x80003f80,0x80003f80,0x80003f80,0xbf733e9e,0xbf800000,0xbf73be9e,0xbf4fbf16
.long 0xbf16bf4f,0x8000bf80,0x3f16bf4f,0x3f73be9e,0x3f16bf4f,0x3f800000,0x3f163f4f,0xbe9e3f73
.long 0x3f733e9e,0x80003f80,0xbf733e9e,0xbf16bf4f,0x80003f80,0xbf800000,0x8000bf80,0x3f800000
.long 0xbf733e9e,0x8000bf80,0x3f733e9e,0xbf163f4f,0xbf16bf4f,0x3f800000,0xbf163f4f,0xbe9ebf73
.long 0x3f16bf4f,0x80003f80,0xbf16bf4f,0x3f733e9e,0x3f733e9e,0xbf800000,0x3f73be9e,0xbf4f3f16
.long 0x80003f80,0x8000bf80,0x80003f80,0x8000bf80,0xbf733e9e,0x3f800000,0xbf73be9e,0x3f4f3f16
.long 0xbf16bf4f,0x80003f80,0x3f16bf4f,0xbf733e9e,0x3f16bf4f,0xbf800000,0x3f163f4f,0x3e9ebf73
.long 0x3f733e9e,0x8000bf80,0xbf733e9e,0x3f163f4f,0x80003f80,0x3f800000,0x8000bf80,0xbf800000
.long 0xbf733e9e,0x80003f80,0x3f733e9e,0x3f16bf4f,0xbf16bf4f,0xbf800000,0xbf163f4f,0x3e9e3f73
.long 0x3f16bf4f,0x8000bf80,0xbf16bf4f,0xbf73be9e,0x3f733e9e,0x3f800000,0x3f73be9e,0x3f4fbf16
.long 0x0,0x0,0x0,0x0,0x0,0x0,0x0,0x0
.long 0x0,0x0,0x0,0x0,0x0,0x0,0x0,0x0
.long 0x0,0x0,0x0,0x0,0x0,0x0,0x0,0x0
.long 0x0,0x0,0x0,0x0,0x0,0x0,0x0,0x0
.long 0x0,0x0,0x0,0x0,0x0,0x0,0x0,0x0
.long 0x0,0x0,0x0,0x0,0x0,0x0,0x0,0x0
.long 0x3f800000,0x3f800000,0x3f800000,0x3f800000,0x3f800000,0x3f733e9e,0x3f4f3f16,0x3f163f4f
.long 0x3f800000,0x3f4f3f16,0x3e9e3f73,0xbe9e3f73,0x3f800000,0x3f163f4f,0xbe9e3f73,0xbf733e9e
.long 0x3f800000,0x3e9e3f73,0xbf4f3f16,0xbf4fbf16,0x3f800000,0x3f80,0xbf800000,0xbf80
.long 0x3f800000,0xbe9e3f73,0xbf4fbf16,0x3f4fbf16,0x3f800000,0xbf163f4f,0xbe9ebf73,0x3f733e9e
.long 0x3f800000,0xbf4f3f16,0x3e9ebf73,0x3e9e3f73,0x3f800000,0xbf733e9e,0x3f4fbf16,0xbf163f4f
.long 0x3f800000,0xbf800000,0x3f800000,0xbf800000,0x3f800000,0xbf73be9e,0x3f4f3f16,0xbf16bf4f
.long 0x3f800000,0xbf4fbf16,0x3e9e3f73,0x3e9ebf73,0x3f800000,0xbf16bf4f,0xbe9e3f73,0x3f73be9e
.long 0x3f800000,0xbe9ebf73,0xbf4f3f16,0x3f4f3f16,0x3f800000,0xbf80,0xbf800000,0x3f80
.long 0x3f800000,0x3e9ebf73,0xbf4fbf16,0xbf4f3f16,0x3f800000,0x3f16bf4f,0xbe9ebf73,0xbf73be9e
.long 0x3f800000,0x3f4fbf16,0x3e9ebf73,0xbe9ebf73,0x3f800000,0x3f73be9e,0x3f4fbf16,0x3f16bf4f
.long 0x0,0x0,0x0,0x0,0x0,0x0,0x0,0x0
.long 0x0,0x0,0x0,0x0,0x0,0x0,0x0,0x0
.long 0x0,0x0,0x0,0x0,0x0,0x0,0x0,0x0
.long 0x0,0x0,0x0,0x0,0x0,0x0,0x0,0x0
.long 0x0,0x0,0x0,0x0,0x0,0x0,0x0,0x0
.long 0x0,0x0,0x0,0x0,0x0,0x0,0x0,0x0
.long 0x3f800000,0x3f800000,0x3f800000,0x3f800000,0x3e9e3f73,0x3f80,0xbe9e3f73,0xbf163f4f
.long 0xbf4f3f16,0xbf800000,0xbf4fbf16,0xbe9ebf73,0xbf4fbf16,0xbf80,0x3f4fbf16,0x3f733e9e
.long 0x3e9ebf73,0x3f800000,0x3e9e3f73,0xbf4f3f16,0x3f800000,0x3f80,0xbf800000,0xbf80
.long 0x3e9e3f73,0xbf800000,0x3e9ebf73,0x3f4f3f16,0xbf4f3f16,0xbf80,0x3f4f3f16,0xbf733e9e
.long 0xbf4fbf16,0x3f800000,0xbf4f3f16,0x3e9ebf73,0x3e9ebf73,0x3f80,0xbe9ebf73,0x3f163f4f
.long 0x3f800000,0xbf800000,0x3f800000,0xbf800000,0x3e9e3f73,0xbf80,0xbe9e3f73,0x3f16bf4f
.long 0xbf4f3f16,0x3f800000,0xbf4fbf16,0x3e9e3f73,0xbf4fbf16,0x3f80,0x3f4fbf16,0xbf73be9e
.long 0x3e9ebf73,0xbf800000,0x3e9e3f73,0x3f4fbf16,0x3f800000,0xbf80,0xbf800000,0x3f80
.long 0x3e9e3f73,0x3f800000,0x3e9ebf73,0xbf4fbf16,0xbf4f3f16,0x3f80,0x3f4f3f16,0x3f73be9e
.long 0xbf4fbf16,0xbf800000,0xbf4f3f16,0xbe9e3f73,0x3e9ebf73,0xbf80,0xbe9ebf73,0xbf16bf4f
.long 0x0,0x0,0x0,0x0,0x0,0x0,0x0,0x0
.long 0x0,0x0,0x0,0x0,0x0,0x0,0x0,0x0
.long 0x0,0x0,0x0,0x0,0x0,0x0,0x0,0x0
.long 0x0,0x0,0x0,0x0,0x0,0x0,0x0,0x0
.long 0x0,0x0,0x0,0x0,0x0,0x0,0x0,0x0
.long 0x0,0x0,0x0,0x0,0x0,0x0,0x0,0x0
.long 0x80003f80,0x80003f80,0x3f800000,0x3f800000,0xbf16bf4f,0xbe9ebf73,0xbf4f3f16,0xbf733e9e
.long 0x3f733e9e,0x3f163f4f,0x3e9ebf73,0x3f4fbf16,0xbf733e9e,0xbf4fbf16,0x3e9e3f73,0xbf163f4f
.long 0x3f16bf4f,0x3f733e9e,0xbf4fbf16,0x3e9ebf73,0x80003f80,0xbf800000,0x3f800000,0x3f80
.long 0xbf16bf4f,0x3f73be9e,0xbf4f3f16,0xbe9ebf73,0x3f733e9e,0xbf4f3f16,0x3e9ebf73,0x3f163f4f
.long 0xbf733e9e,0x3f16bf4f,0x3e9e3f73,0xbf4fbf16,0x3f16bf4f,0xbe9e3f73,0xbf4fbf16,0x3f733e9e
.long 0x80003f80,0x8000bf80,0x3f800000,0xbf800000,0xbf16bf4f,0x3e9e3f73,0xbf4f3f16,0x3f73be9e
.long 0x3f733e9e,0xbf16bf4f,0x3e9ebf73,0xbf4f3f16,0xbf733e9e,0x3f4f3f16,0x3e9e3f73,0x3f16bf4f
.long 0x3f16bf4f,0xbf73be9e,0xbf4fbf16,0xbe9e3f73,0x80003f80,0x3f800000,0x3f800000,0xbf80
.long 0xbf16bf4f,0xbf733e9e,0xbf4f3f16,0x3e9e3f73,0x3f733e9e,0x3f4fbf16,0x3e9ebf73,0xbf16bf4f
.long 0xbf733e9e,0xbf163f4f,0x3e9e3f73,0x3f4f3f16,0x3f16bf4f,0x3e9ebf73,0xbf4fbf16,0xbf73be9e
.long 0x0,0x0,0x0,0x0,0x0,0x0,0x0,0x0
.long 0x0,0x0,0x0,0x0,0x0,0x0,0x0,0x0
.long 0x0,0x0,0x0,0x0,0x0,0x0,0x0,0x0
.long 0x0,0x0,0x0,0x0,0x0,0x0,0x0,0x0
.long 0x0,0x0,0x0,0x0,0x0,0x0,0x0,0x0
.long 0x0,0x0,0x0,0x0,0x0,0x0,0x0,0x0
.long 0x80003f80,0x0,0x3f800000,0x0,0x8000bf80,0x0,0xbf800000,0x0
.long 0x80003f80,0x0,0x3f800000,0x0,0x8000bf80,0x0,0xbf800000,0x0
.long 0x80003f80,0x0,0x3f800000,0x0,0x8000bf80,0x0,0xbf800000,0x0
.long 0x80003f80,0x0,0x3f800000,0x0,0x8000bf80,0x0,0xbf800000,0x0
.long 0x80003f80,0x0,0x3f800000,0x0,0x8000bf80,0x0,0xbf800000,0x0
.long 0x80003f80,0x0,0x3f800000,0x0,0x8000bf80,0x0,0xbf800000,0x0
.long 0x80003f80,0x0,0x3f800000,0x0,0x8000bf80,0x0,0xbf800000,0x0
.long 0x80003f80,0x0,0x3f800000,0x0,0x8000bf80,0x0,0xbf800000,0x0
.long 0x80003f80,0x0,0x3f800000,0x0,0x8000bf80,0x0,0xbf800000,0x0
.long 0x80003f80,0x0,0x3f800000,0x0,0x8000bf80,0x0,0xbf800000,0x0
.long 0x0,0x0,0x0,0x0,0x0,0x0,0x0,0x0
.long 0x0,0x0,0x0,0x0,0x0,0x0,0x0,0x0
.long 0x0,0x0,0x0,0x0,0x0,0x0,0x0,0x0
.long 0x0,0x0,0x0,0x0,0x0,0x0,0x0,0x0
.long 0x0,0x0,0x0,0x0,0x0,0x0,0x0,0x0
.long 0x0,0x0,0x0,0x0,0x0,0x0,0x0,0x0
.long 0x3f800000,0x3f800000,0x3f800000,0x3f800000,0x3f800000,0x3f7ffcd7,0x3f7ff35e,0x3f7fe394
.long 0x3f800000,0x3f7ff35e,0x3f7fcd79,0x3f7f8e56,0x3f800000,0x3f7fe394,0x3f7f8e56,0x3f7f0059
.long 0x3f800000,0x3f7fcd79,0x3f7f35f9,0x3f7e39bc,0x3f800000,0x3f7fb10f,0x3f7ec46d,0x3f7d3aac
.long 0x3f800000,0x3f7f8e56,0x3f7e39bc,0x3f7c0361,0x3f800000,0x3f7f654e,0x3f7d95f4,0x3f7a9421
.long 0x3f800000,0x3f7f35f9,0x3f7cd925,0x3f78ed3c,0x3f800000,0x3f7f0059,0x3f7c0361,0x3f770f11
.long 0x3f800000,0x3f7ec46d,0x3f7b14be,0x3f74fa0b,0x3f800000,0x3f7e8238,0x3f7a0d54,0x3f72ae9e
.long 0x3f800000,0x3f7e39bc,0x3f78ed3c,0x3f702d4f,0x3f800000,0x3f7deafa,0x3f77b493,0x3f6d76aa
.long 0x3f800000,0x3f7d95f4,0x3f766377,0x3f6a8b4b,0x3f800000,0x3f7d3aac,0x3f74fa0b,0x3f676bd8
.long 0x3f800000,0x3f7cd925,0x3f737871,0x3f641901,0x3f800000,0x3f7c7160,0x3f71decf,0x3f609384
.long 0x3f800000,0x3f7c0361,0x3f702d4f,0x3f5cdc29,0x3f800000,0x3f7b8f2a,0x3f6e641a,0x3f58f3c4
.long 0x3f800000,0x3f7b14be,0x3f6c835e,0x3f54db31,0x3f800000,0x3f7a9421,0x3f6a8b4b,0x3f50935b
.long 0x3f800000,0x3f7a0d54,0x3f687c12,0x3f4c1d35,0x3f800000,0x3f79805c,0x3f6655e7,0x3f4779bc
.long 0x3f800000,0x3f78ed3c,0x3f641901,0x3f42a9f7,0x3f800000,0x3f7853f8,0x3f61c598,0x3f3daef9
.long 0x3f800000,0x3f77b493,0x3f5f5be6,0x3f3889dc,0x3f800000,0x3f770f11,0x3f5cdc29,0x3f333bc6
.long 0x3f800000,0x3f766377,0x3f5a46a0,0x3f2dc5e3,0x3f800000,0x3f75b1c9,0x3f579b8c,0x3f28296a
.long 0x3f800000,0x3f74fa0b,0x3f54db31,0x3f226799,0x3f800000,0x3f743c41,0x3f5205d4,0x3f1c81b9
.long 0x3f800000,0x3f800000,0x3f800000,0x3f800000,0x3f7fcd79,0x3f7fb10f,0x3f7f8e56,0x3f7f654e
.long 0x3f7f35f9,0x3f7ec46d,0x3f7e39bc,0x3f7d95f4,0x3f7e39bc,0x3f7d3aac,0x3f7c0361,0x3f7a9421
.long 0x3f7cd925,0x3f7b14be,0x3f78ed3c,0x3f766377,0x3f7b14be,0x3f7853f8,0x3f74fa0b,0x3f710908
.long 0x3f78ed3c,0x3f74fa0b,0x3f702d4f,0x3f6a8b4b,0x3f766377,0x3f710908,0x3f6a8b4b,0x3f62f219
.long 0x3f737871,0x3f6c835e,0x3f641901,0x3f5a46a0,0x3f702d4f,0x3f676bd8,0x3f5cdc29,0x3f50935b
.long 0x3f6c835e,0x3f61c598,0x3f54db31,0x3f45e403,0x3f687c12,0x3f5b941a,0x3f4c1d35,0x3f3a4582
.long 0x3f641901,0x3f54db31,0x3f42a9f7,0x3f2dc5e3,0x3f5f5be6,0x3f4d9f02,0x3f3889dc,0x3f207440
.long 0x3f5a46a0,0x3f45e403,0x3f2dc5e3,0x3f1260b2,0x3f54db31,0x3f3daef9,0x3f226799,0x3f039c3d
.long 0x3f4f1bbd,0x3f3504f3,0x3f167918,0x3ee87171,0x3f490a88,0x3f2beb4a,0x3f0a04f8,0x3ec8917e
.long 0x3f42a9f7,0x3f226799,0x3efa2c90,0x3ea7bf25,0x3f3bfc8f,0x3f187fc0,0x3edf7108,0x3e862210
.long 0x3f3504f3,0x3f0e39da,0x3ec3ef15,0x3e47c5c2,0x3f2dc5e3,0x3f039c3d,0x3ea7bf25,0x3e0255f4
.long 0x3f26423a,0x3ef15aea,0x3e8afa3e,0x3d712283,0x3f1e7cf1,0x3edae880,0x3e5b73dc,0xbc20d8d2
.long 0x3f167918,0x3ec3ef15,0x3e20305b,0xbda0af2a,0x3f0e39da,0x3eac7cd4,0x3dc8bd36,0xbe164083
.long 0x3f05c277,0x3e94a031,0x3d20cee7,0xbe5b73dc,0x3efa2c90,0x3e78cfcc,0xbca0d6d6,0xbe8fcefe
.long 0x3ee87171,0x3e47c5c2,0xbda0af2a,0xbeb13641,0x3ed65a92,0x3e164083,0xbe0c4cf7,0xbed1c759
.long 0x3ec3ef15,0x3dc8bd36,0xbe47c5c2,0xbef15aea,0x3eb13641,0x3d48fb30,0xbe814693,0xbf07e565
.long 0x0,0x0,0x0,0x0,0x0,0x3c20d8d2,0x3ca0d6d6,0x3cf13d4c
.long 0x0,0x3ca0d6d6,0x3d20cee7,0x3d712283,0x0,0x3cf13d4c,0x3d712283,0x3db4b86a
.long 0x0,0x3d20cee7,0x3da0af2a,0x3df0b772,0x0,0x3d48fb30,0x3dc8bd36,0x3e164083
.long 0x0,0x3d712283,0x3df0b772,0x3e3403f1,0x0,0x3d8ca1f2,0x3e0c4cf7,0x3e519f65
.long 0x0,0x3da0af2a,0x3e20305b,0x3e6f0c4d,0x0,0x3db4b86a,0x3e3403f1,0x3e862210
.long 0x0,0x3dc8bd36,0x3e47c5c2,0x3e94a031,0x0,0x3ddcbd0d,0x3e5b73dc,0x3ea2fd52
.long 0x0,0x3df0b772,0x3e6f0c4d,0x3eb13641,0x0,0x3e0255f4,0x3e814693,0x3ebf47d7
.long 0x0,0x3e0c4cf7,0x3e8afa3e,0x3ecd2ef3,0x0,0x3e164083,0x3e94a031,0x3edae880
.long 0x0,0x3e20305b,0x3e9e377a,0x3ee87171,0x0,0x3e2a1c3f,0x3ea7bf25,0x3ef5c6c5
.long 0x0,0x3e3403f1,0x3eb13641,0x3f0172c3,0x0,0x3e3de731,0x3eba9be1,0x3f07e565
.long 0x0,0x3e47c5c2,0x3ec3ef15,0x3f0e39da,0x0,0x3e519f65,0x3ecd2ef3,0x3f146eba
.long 0x0,0x3e5b73dc,0x3ed65a92,0x3f1a82a4,0x0,0x3e6542e9,0x3edf7108,0x3f207440
.long 0x0,0x3e6f0c4d,0x3ee87171,0x3f26423a,0x0,0x3e78cfcc,0x3ef15aea,0x3f2beb4a
.long 0x0,0x3e814693,0x3efa2c90,0x3f316e2c,0x0,0x3e862210,0x3f0172c3,0x3f36c9a9
.long 0x0,0x3e8afa3e,0x3f05c277,0x3f3bfc8f,0x0,0x3e8fcefe,0x3f0a04f8,0x3f4105b8
.long 0x0,0x3e94a031,0x3f0e39da,0x3f45e403,0x0,0x3e996dba,0x3f1260b2,0x3f4a965e
.long 0x0,0x0,0x0,0x0,0x3d20cee7,0x3d48fb30,0x3d712283,0x3d8ca1f2
.long 0x3da0af2a,0x3dc8bd36,0x3df0b772,0x3e0c4cf7,0x3df0b772,0x3e164083,0x3e3403f1,0x3e519f65
.long 0x3e20305b,0x3e47c5c2,0x3e6f0c4d,0x3e8afa3e,0x3e47c5c2,0x3e78cfcc,0x3e94a031,0x3eac7cd4
.long 0x3e6f0c4d,0x3e94a031,0x3eb13641,0x3ecd2ef3,0x3e8afa3e,0x3eac7cd4,0x3ecd2ef3,0x3eece91a
.long 0x3e9e377a,0x3ec3ef15,0x3ee87171,0x3f05c277,0x3eb13641,0x3edae880,0x3f0172c3,0x3f146eba
.long 0x3ec3ef15,0x3ef15aea,0x3f0e39da,0x3f226799,0x3ed65a92,0x3f039c3d,0x3f1a82a4,0x3f2f9c32
.long 0x3ee87171,0x3f0e39da,0x3f26423a,0x3f3bfc8f,0x3efa2c90,0x3f187fc0,0x3f316e2c,0x3f4779bc
.long 0x3f05c277,0x3f226799,0x3f3bfc8f,0x3f5205d4,0x3f0e39da,0x3f2beb4a,0x3f45e403,0x3f5b941a
.long 0x3f167918,0x3f3504f3,0x3f4f1bbd,0x3f641901,0x3f1e7cf1,0x3f3daef9,0x3f579b8c,0x3f6b8a3d
.long 0x3f26423a,0x3f45e403,0x3f5f5be6,0x3f71decf,0x3f2dc5e3,0x3f4d9f02,0x3f6655e7,0x3f770f11
.long 0x3f3504f3,0x3f54db31,0x3f6c835e,0x3f7b14be,0x3f3bfc8f,0x3f5b941a,0x3f71decf,0x3f7deafa
.long 0x3f42a9f7,0x3f61c598,0x3f766377,0x3f7f8e56,0x3f490a88,0x3f676bd8,0x3f7a0d54,0x3f7ffcd7
.long 0x3f4f1bbd,0x3f6c835e,0x3f7cd925,0x3f7f35f9,0x3f54db31,0x3f710908,0x3f7ec46d,0x3f7d3aac
.long 0x3f5a46a0,0x3f74fa0b,0x3f7fcd79,0x3f7a0d54,0x3f5f5be6,0x3f7853f8,0x3f7ff35e,0x3f75b1c9
.long 0x3f641901,0x3f7b14be,0x3f7f35f9,0x3f702d4f,0x3f687c12,0x3f7d3aac,0x3f7d95f4,0x3f698690
.long 0x3f6c835e,0x3f7ec46d,0x3f7b14be,0x3f61c598,0x3f702d4f,0x3f7fb10f,0x3f77b493,0x3f58f3c4
.long 0x3f800000,0x3f800000,0x3f800000,0x3f800000,0x3f7f35f9,0x3f7f0059,0x3f7ec46d,0x3f7e8238
.long 0x3f7cd925,0x3f7c0361,0x3f7b14be,0x3f7a0d54,0x3f78ed3c,0x3f770f11,0x3f74fa0b,0x3f72ae9e
.long 0x3f737871,0x3f702d4f,0x3f6c835e,0x3f687c12,0x3f6c835e,0x3f676bd8,0x3f61c598,0x3f5b941a
.long 0x3f641901,0x3f5cdc29,0x3f54db31,0x3f4c1d35,0x3f5a46a0,0x3f50935b,0x3f45e403,0x3f3a4582
.long 0x3f4f1bbd,0x3f42a9f7,0x3f3504f3,0x3f26423a,0x3f42a9f7,0x3f333bc6,0x3f226799,0x3f104f0e
.long 0x3f3504f3,0x3f226799,0x3f0e39da,0x3ef15aea,0x3f26423a,0x3f104f0e,0x3ef15aea,0x3ebf47d7
.long 0x3f167918,0x3efa2c90,0x3ec3ef15,0x3e8afa3e,0x3f05c277,0x3ed1c759,0x3e94a031,0x3e2a1c3f
.long 0x3ee87171,0x3ea7bf25,0x3e47c5c2,0x3d712283,0x3ec3ef15,0x3e78cfcc,0x3dc8bd36,0xbd48fb30
.long 0x3e9e377a,0x3e20305b,0x0,0xbe20305b,0x3e6f0c4d,0x3d8ca1f2,0xbdc8bd36,0xbe862210
.long 0x3e20305b,0xbca0d6d6,0xbe47c5c2,0xbeba9be1,0x3da0af2a,0xbddcbd0d,0xbe94a031,0xbeece91a
.long 0x0,0xbe47c5c2,0xbec3ef15,0xbf0e39da,0xbda0af2a,0xbe8fcefe,0xbef15aea,0xbf2456f1
.long 0xbe20305b,0xbeba9be1,0xbf0e39da,0xbf3889dc,0xbe6f0c4d,0xbee3f40d,0xbf226799,0xbf4a965e
.long 0xbe9e377a,0xbf05c277,0xbf3504f3,0xbf5a46a0,0xbec3ef15,0xbf187fc0,0xbf45e403,0xbf676bd8
.long 0xbee87171,0xbf2a0c73,0xbf54db31,0xbf71decf,0xbf05c277,0xbf3a4582,0xbf61c598,0xbf79805c
.long 0xbf167918,0xbf490a88,0xbf6c835e,0xbf7e39bc,0xbf26423a,0xbf563e03,0xbf74fa0b,0xbf7ffcd7
.long 0xbf3504f3,0xbf61c598,0xbf7b14be,0xbf7ec46d,0xbf42a9f7,0xbf6b8a3d,0xbf7ec46d,0xbf7a9421
.long 0x3f800000,0x3f800000,0x3f800000,0x3f800000,0x3f7e39bc,0x3f7deafa,0x3f7d95f4,0x3f7d3aac
.long 0x3f78ed3c,0x3f77b493,0x3f766377,0x3f74fa0b,0x3f702d4f,0x3f6d76aa,0x3f6a8b4b,0x3f676bd8
.long 0x3f641901,0x3f5f5be6,0x3f5a46a0,0x3f54db31,0x3f54db31,0x3f4d9f02,0x3f45e403,0x3f3daef9
.long 0x3f42a9f7,0x3f3889dc,0x3f2dc5e3,0x3f226799,0x3f2dc5e3,0x3f207440,0x3f1260b2,0x3f039c3d
.long 0x3f167918,0x3f05c277,0x3ee87171,0x3ec3ef15,0x3efa2c90,0x3ed1c759,0x3ea7bf25,0x3e78cfcc
.long 0x3ec3ef15,0x3e94a031,0x3e47c5c2,0x3dc8bd36,0x3e8afa3e,0x3e2a1c3f,0x3d712283,0xbd48fb30
.long 0x3e20305b,0x3d20cee7,0xbda0af2a,0xbe47c5c2,0x3d20cee7,0xbdb4b86a,0xbe5b73dc,0xbeac7cd4
.long 0xbda0af2a,0xbe5b73dc,0xbeb13641,0xbef15aea,0xbe47c5c2,0xbeac7cd4,0xbef15aea,0xbf187fc0
.long 0xbe9e377a,0xbee87171,0xbf167918,0xbf3504f3,0xbed65a92,0xbf104f0e,0xbf316e2c,0xbf4d9f02
.long 0xbf05c277,0xbf2a0c73,0xbf490a88,0xbf61c598,0xbf1e7cf1,0xbf4105b8,0xbf5cdc29,0xbf710908
.long 0xbf3504f3,0xbf54db31,0xbf6c835e,0xbf7b14be,0xbf490a88,0xbf653a48,0xbf77b493,0xbf7fb10f
.long 0xbf5a46a0,0xbf71decf,0xbf7e39bc,0xbf7ec46d,0xbf687c12,0xbf7a9421,0xbf7ff35e,0xbf7853f8
.long 0xbf737871,0xbf7f35f9,0xbf7cd925,0xbf6c835e,0xbf7b14be,0xbf7fb10f,0xbf74fa0b,0xbf5b941a
.long 0xbf7f35f9,0xbf7c0361,0xbf687c12,0xbf45e403,0xbf7fcd79,0xbf743c41,0xbf579b8c,0xbf2beb4a
.long 0xbf7cd925,0xbf687c12,0xbf42a9f7,0xbf0e39da,0xbf766377,0xbf58f3c4,0xbf2a0c73,0xbedae880
.long 0xbf6c835e,0xbf45e403,0xbf0e39da,0xbe94a031,0xbf5f5be6,0xbf2f9c32,0xbedf7108,0xbe164083
.long 0x0,0x0,0x0,0x0,0x3da0af2a,0x3db4b86a,0x3dc8bd36,0x3ddcbd0d
.long 0x3e20305b,0x3e3403f1,0x3e47c5c2,0x3e5b73dc,0x3e6f0c4d,0x3e862210,0x3e94a031,0x3ea2fd52
.long 0x3e9e377a,0x3eb13641,0x3ec3ef15,0x3ed65a92,0x3ec3ef15,0x3edae880,0x3ef15aea,0x3f039c3d
.long 0x3ee87171,0x3f0172c3,0x3f0e39da,0x3f1a82a4,0x3f05c277,0x3f146eba,0x3f226799,0x3f2f9c32
.long 0x3f167918,0x3f26423a,0x3f3504f3,0x3f42a9f7,0x3f26423a,0x3f36c9a9,0x3f45e403,0x3f53731f
.long 0x3f3504f3,0x3f45e403,0x3f54db31,0x3f61c598,0x3f42a9f7,0x3f53731f,0x3f61c598,0x3f6d76aa
.long 0x3f4f1bbd,0x3f5f5be6,0x3f6c835e,0x3f766377,0x3f5a46a0,0x3f698690,0x3f74fa0b,0x3f7c7160
.long 0x3f641901,0x3f71decf,0x3f7b14be,0x3f7f8e56,0x3f6c835e,0x3f7853f8,0x3f7ec46d,0x3f7fb10f
.long 0x3f737871,0x3f7cd925,0x3f800000,0x3f7cd925,0x3f78ed3c,0x3f7f654e,0x3f7ec46d,0x3f770f11
.long 0x3f7cd925,0x3f7ff35e,0x3f7b14be,0x3f6e641a,0x3f7f35f9,0x3f7e8238,0x3f74fa0b,0x3f62f219
.long 0x3f800000,0x3f7b14be,0x3f6c835e,0x3f54db31,0x3f7f35f9,0x3f75b1c9,0x3f61c598,0x3f444969
.long 0x3f7cd925,0x3f6e641a,0x3f54db31,0x3f316e2c,0x3f78ed3c,0x3f653a48,0x3f45e403,0x3f1c81b9
.long 0x3f737871,0x3f5a46a0,0x3f3504f3,0x3f05c277,0x3f6c835e,0x3f4d9f02,0x3f226799,0x3edae880
.long 0x3f641901,0x3f3f5cb5,0x3f0e39da,0x3ea7bf25,0x3f5a46a0,0x3f2f9c32,0x3ef15aea,0x3e6542e9
.long 0x3f4f1bbd,0x3f1e7cf1,0x3ec3ef15,0x3df0b772,0x3f42a9f7,0x3f0c2124,0x3e94a031,0x3c20d8d2
.long 0x3f3504f3,0x3ef15aea,0x3e47c5c2,0xbdc8bd36,0x3f26423a,0x3ec8917e,0x3dc8bd36,0xbe519f65
.long 0x0,0x0,0x0,0x0,0x3df0b772,0x3e0255f4,0x3e0c4cf7,0x3e164083
.long 0x3e6f0c4d,0x3e814693,0x3e8afa3e,0x3e94a031,0x3eb13641,0x3ebf47d7,0x3ecd2ef3,0x3edae880
.long 0x3ee87171,0x3efa2c90,0x3f05c277,0x3f0e39da,0x3f0e39da,0x3f187fc0,0x3f226799,0x3f2beb4a
.long 0x3f26423a,0x3f316e2c,0x3f3bfc8f,0x3f45e403,0x3f3bfc8f,0x3f4779bc,0x3f5205d4,0x3f5b941a
.long 0x3f4f1bbd,0x3f5a46a0,0x3f641901,0x3f6c835e,0x3f5f5be6,0x3f698690,0x3f71decf,0x3f7853f8
.long 0x3f6c835e,0x3f74fa0b,0x3f7b14be,0x3f7ec46d,0x3f766377,0x3f7c7160,0x3f7f8e56,0x3f7fb10f
.long 0x3f7cd925,0x3f7fcd79,0x3f7f35f9,0x3f7b14be,0x3f7fcd79,0x3f7f0059,0x3f7a0d54,0x3f710908
.long 0x3f7f35f9,0x3f7a0d54,0x3f702d4f,0x3f61c598,0x3f7b14be,0x3f710908,0x3f61c598,0x3f4d9f02
.long 0x3f737871,0x3f641901,0x3f4f1bbd,0x3f3504f3,0x3f687c12,0x3f53731f,0x3f3889dc,0x3f187fc0
.long 0x3f5a46a0,0x3f3f5cb5,0x3f1e7cf1,0x3ef15aea,0x3f490a88,0x3f28296a,0x3f0172c3,0x3eac7cd4
.long 0x3f3504f3,0x3f0e39da,0x3ec3ef15,0x3e47c5c2,0x3f1e7cf1,0x3ee3f40d,0x3e814693,0x3d48fb30
.long 0x3f05c277,0x3ea7bf25,0x3df0b772,0xbdc8bd36,0x3ed65a92,0x3e519f65,0xbca0d6d6,0xbe78cfcc
.long 0x3e9e377a,0x3da0af2a,0xbe20305b,0xbec3ef15,0x3e47c5c2,0xbd48fb30,0xbe94a031,0xbf039c3d
.long 0x3da0af2a,0xbe3403f1,0xbed65a92,0xbf226799,0xbd20cee7,0xbe996dba,0xbf0a04f8,0xbf3daef9
.long 0xbe20305b,0xbed65a92,0xbf26423a,0xbf54db31,0xbe8afa3e,0xbf07e565,0xbf3f5cb5,0xbf676bd8
.long 0xbec3ef15,0xbf226799,0xbf54db31,0xbf74fa0b,0xbefa2c90,0xbf3a4582,0xbf6655e7,0xbf7d3aac
.long 0x3f800000,0x3f800000,0x3f800000,0x3f800000,0x3f7cd925,0x3f7c7160,0x3f7c0361,0x3f7b8f2a
.long 0x3f737871,0x3f71decf,0x3f702d4f,0x3f6e641a,0x3f641901,0x3f609384,0x3f5cdc29,0x3f58f3c4
.long 0x3f4f1bbd,0x3f490a88,0x3f42a9f7,0x3f3bfc8f,0x3f3504f3,0x3f2beb4a,0x3f226799,0x3f187fc0
.long 0x3f167918,0x3f0a04f8,0x3efa2c90,0x3edf7108,0x3ee87171,0x3ec8917e,0x3ea7bf25,0x3e862210
.long 0x3e9e377a,0x3e6f0c4d,0x3e20305b,0x3da0af2a,0x3e20305b,0x3d8ca1f2,0xbca0d6d6,0xbddcbd0d
.long 0x0,0xbdc8bd36,0xbe47c5c2,0xbe94a031,0xbe20305b,0xbe862210,0xbeba9be1,0xbeece91a
.long 0xbe9e377a,0xbed65a92,0xbf05c277,0xbf1e7cf1,0xbee87171,0xbf104f0e,0xbf2a0c73,0xbf4105b8
.long 0xbf167918,0xbf316e2c,0xbf490a88,0xbf5cdc29,0xbf3504f3,0xbf4d9f02,0xbf61c598,0xbf710908
.long 0xbf4f1bbd,0xbf641901,0xbf737871,0xbf7cd925,0xbf641901,0xbf743c41,0xbf7d95f4,0xbf7fe394
.long 0xbf737871,0xbf7d95f4,0xbf7fcd79,0xbf7a0d54,0xbf7cd925,0xbf7fe394,0xbf7a0d54,0xbf6b8a3d
.long 0xbf800000,0xbf7b14be,0xbf6c835e,0xbf54db31,0xbf7cd925,0xbf6f4ba8,0xbf579b8c,0xbf36c9a9
.long 0xbf737871,0xbf5cdc29,0xbf3bfc8f,0xbf1260b2,0xbf641901,0xbf444969,0xbf1a82a4,0xbed1c759
.long 0xbf4f1bbd,0xbf26423a,0xbee87171,0xbe6f0c4d,0xbf3504f3,0xbf039c3d,0xbe94a031,0xbd48fb30
.long 0xbf167918,0xbeba9be1,0xbdf0b772,0x3e0c4cf7,0xbee87171,0xbe519f65,0x3d712283,0x3ea2fd52
.long 0xbe9e377a,0xbd20cee7,0x3e6f0c4d,0x3efa2c90,0xbe20305b,0x3e0255f4,0x3ecd2ef3,0x3f2456f1
.long 0x0,0x3e94a031,0x3f0e39da,0x3f45e403,0x3e20305b,0x3ee3f40d,0x3f316e2c,0x3f609384
.long 0x3f800000,0x3f800000,0x3f800000,0x3f800000,0x3f7b14be,0x3f7a9421,0x3f7a0d54,0x3f79805c
.long 0x3f6c835e,0x3f6a8b4b,0x3f687c12,0x3f6655e7,0x3f54db31,0x3f50935b,0x3f4c1d35,0x3f4779bc
.long 0x3f3504f3,0x3f2dc5e3,0x3f26423a,0x3f1e7cf1,0x3f0e39da,0x3f039c3d,0x3ef15aea,0x3edae880
.long 0x3ec3ef15,0x3ea7bf25,0x3e8afa3e,0x3e5b73dc,0x3e47c5c2,0x3e0255f4,0x3d712283,0xbc20d8d2
.long 0x0,0xbda0af2a,0xbe20305b,0xbe6f0c4d,0xbe47c5c2,0xbe8fcefe,0xbeba9be1,0xbee3f40d
.long 0xbec3ef15,0xbef15aea,0xbf0e39da,0xbf226799,0xbf0e39da,0xbf2456f1,0xbf3889dc,0xbf4a965e
.long 0xbf3504f3,0xbf490a88,0xbf5a46a0,0xbf687c12,0xbf54db31,0xbf653a48,0xbf71decf,0xbf7a9421
.long 0xbf6c835e,0xbf77b493,0xbf7e39bc,0xbf7ff35e,0xbf7b14be,0xbf7fb10f,0xbf7ec46d,0xbf7853f8
.long 0xbf800000,0xbf7cd925,0xbf737871,0xbf641901,0xbf7b14be,0xbf6f4ba8,0xbf5cdc29,0xbf444969
.long 0xbf6c835e,0xbf579b8c,0xbf3bfc8f,0xbf1a82a4,0xbf54db31,0xbf36c9a9,0xbf1260b2,0xbed1c759
.long 0xbf3504f3,0xbf0e39da,0xbec3ef15,0xbe47c5c2,0xbf0e39da,0xbebf47d7,0xbe3403f1,0x3cf13d4c
.long 0xbec3ef15,0xbe3403f1,0x3d20cee7,0x3e814693,0xbe47c5c2,0x3cf13d4c,0x3e814693,0x3eece91a
.long 0x0,0x3e6f0c4d,0x3ee87171,0x3f26423a,0x3e47c5c2,0x3edae880,0x3f226799,0x3f4d9f02
.long 0x3ec3ef15,0x3f1a82a4,0x3f490a88,0x3f6a8b4b,0x3f0e39da,0x3f4105b8,0x3f6655e7,0x3f7b8f2a
.long 0x3f3504f3,0x3f5f5be6,0x3f78ed3c,0x3f7fcd79,0x3f54db31,0x3f743c41,0x3f7ff35e,0x3f770f11
.long 0x3f6c835e,0x3f7ec46d,0x3f7b14be,0x3f61c598,0x3f7b14be,0x3f7e8238,0x3f6a8b4b,0x3f4105b8
.long 0x0,0x0,0x0,0x0,0x3e20305b,0x3e2a1c3f,0x3e3403f1,0x3e3de731
.long 0x3e9e377a,0x3ea7bf25,0x3eb13641,0x3eba9be1,0x3ee87171,0x3ef5c6c5,0x3f0172c3,0x3f07e565
.long 0x3f167918,0x3f1e7cf1,0x3f26423a,0x3f2dc5e3,0x3f3504f3,0x3f3daef9,0x3f45e403,0x3f4d9f02
.long 0x3f4f1bbd,0x3f579b8c,0x3f5f5be6,0x3f6655e7,0x3f641901,0x3f6b8a3d,0x3f71decf,0x3f770f11
.long 0x3f737871,0x3f78ed3c,0x3f7cd925,0x3f7f35f9,0x3f7cd925,0x3f7f654e,0x3f7ff35e,0x3f7e8238
.long 0x3f800000,0x3f7ec46d,0x3f7b14be,0x3f74fa0b,0x3f7cd925,0x3f770f11,0x3f6e641a,0x3f62f219
.long 0x3f737871,0x3f687c12,0x3f5a46a0,0x3f490a88,0x3f641901,0x3f53731f,0x3f3f5cb5,0x3f28296a
.long 0x3f4f1bbd,0x3f3889dc,0x3f1e7cf1,0x3f0172c3,0x3f3504f3,0x3f187fc0,0x3ef15aea,0x3eac7cd4
.long 0x3f167918,0x3ee87171,0x3e9e377a,0x3e20305b,0x3ee87171,0x3e996dba,0x3e0c4cf7,0xbcf13d4c
.long 0x3e9e377a,0x3e0c4cf7,0xbd20cee7,0xbe5b73dc,0x3e20305b,0xbcf13d4c,0xbe5b73dc,0xbec8917e
.long 0x0,0xbe47c5c2,0xbec3ef15,0xbf0e39da,0xbe20305b,0xbeb5eb4f,0xbf0a04f8,0xbf333bc6
.long 0xbe9e377a,0xbf0172c3,0xbf2dc5e3,0xbf5205d4,0xbee87171,0xbf2456f1,0xbf4c1d35,0xbf698690
.long 0xbf167918,0xbf42a9f7,0xbf641901,0xbf78ed3c,0xbf3504f3,0xbf5b941a,0xbf74fa0b,0xbf7fb10f
.long 0xbf4f1bbd,0xbf6e641a,0xbf7e39bc,0xbf7d95f4,0xbf641901,0xbf7a9421,0xbf7f8e56,0xbf72ae9e
.long 0xbf737871,0xbf7fcd79,0xbf78ed3c,0xbf5f5be6,0xbf7cd925,0xbf7deafa,0xbf6a8b4b,0xbf444969
.long 0xbf800000,0xbf74fa0b,0xbf54db31,0xbf226799,0xbf7cd925,0xbf653a48,0xbf3889dc,0xbef5c6c5
.long 0x0,0x0,0x0,0x0,0x3e47c5c2,0x3e519f65,0x3e5b73dc,0x3e6542e9
.long 0x3ec3ef15,0x3ecd2ef3,0x3ed65a92,0x3edf7108,0x3f0e39da,0x3f146eba,0x3f1a82a4,0x3f207440
.long 0x3f3504f3,0x3f3bfc8f,0x3f42a9f7,0x3f490a88,0x3f54db31,0x3f5b941a,0x3f61c598,0x3f676bd8
.long 0x3f6c835e,0x3f71decf,0x3f766377,0x3f7a0d54,0x3f7b14be,0x3f7deafa,0x3f7f8e56,0x3f7ffcd7
.long 0x3f800000,0x3f7f35f9,0x3f7cd925,0x3f78ed3c,0x3f7b14be,0x3f75b1c9,0x3f6e641a,0x3f653a48
.long 0x3f6c835e,0x3f61c598,0x3f54db31,0x3f45e403,0x3f54db31,0x3f444969,0x3f316e2c,0x3f1c81b9
.long 0x3f3504f3,0x3f1e7cf1,0x3f05c277,0x3ed65a92,0x3f0e39da,0x3ee3f40d,0x3ea7bf25,0x3e519f65
.long 0x3ec3ef15,0x3e814693,0x3df0b772,0xbca0d6d6,0x3e47c5c2,0x3d48fb30,0xbdc8bd36,0xbe78cfcc
.long 0x0,0xbe20305b,0xbe9e377a,0xbee87171,0xbe47c5c2,0xbeb5eb4f,0xbf0172c3,0xbf2456f1
.long 0xbec3ef15,0xbf0a04f8,0xbf2dc5e3,0xbf4c1d35,0xbf0e39da,0xbf333bc6,0xbf5205d4,0xbf698690
.long 0xbf3504f3,0xbf54db31,0xbf6c835e,0xbf7b14be,0xbf54db31,0xbf6d76aa,0xbf7c0361,0xbf7fe394
.long 0xbf6c835e,0xbf7c0361,0xbf7fcd79,0xbf77b493,0xbf7b14be,0xbf7fe394,0xbf77b493,0xbf62f219
.long 0xbf800000,0xbf78ed3c,0xbf641901,0xbf42a9f7,0xbf7b14be,0xbf676bd8,0xbf45e403,0xbf187fc0
.long 0xbf6c835e,0xbf4c1d35,0xbf1e7cf1,0xbecd2ef3,0xbf54db31,0xbf28296a,0xbedf7108,0xbe3de731
.long 0xbf3504f3,0xbefa2c90,0xbe6f0c4d,0x3d20cee7,0xbf0e39da,0xbe996dba,0xbca0d6d6,0x3e862210
.long 0xbec3ef15,0xbdc8bd36,0x3e47c5c2,0x3ef15aea,0xbe47c5c2,0x3ddcbd0d,0x3ecd2ef3,0x3f28296a
.long 0x3f800000,0x3f800000,0x3f800000,0x3f800000,0x3f78ed3c,0x3f7853f8,0x3f77b493,0x3f770f11
.long 0x3f641901,0x3f61c598,0x3f5f5be6,0x3f5cdc29,0x3f42a9f7,0x3f3daef9,0x3f3889dc,0x3f333bc6
.long 0x3f167918,0x3f0e39da,0x3f05c277,0x3efa2c90,0x3ec3ef15,0x3eac7cd4,0x3e94a031,0x3e78cfcc
.long 0x3e20305b,0x3dc8bd36,0x3d20cee7,0xbca0d6d6,0xbda0af2a,0xbe164083,0xbe5b73dc,0xbe8fcefe
.long 0xbe9e377a,0xbec3ef15,0xbee87171,0xbf05c277,0xbf05c277,0xbf187fc0,0xbf2a0c73,0xbf3a4582
.long 0xbf3504f3,0xbf45e403,0xbf54db31,0xbf61c598,0xbf5a46a0,0xbf676bd8,0xbf71decf,0xbf79805c
.long 0xbf737871,0xbf7b14be,0xbf7f35f9,0xbf7fcd79,0xbf7f35f9,0xbf7fb10f,0xbf7c0361,0xbf743c41
.long 0xbf7cd925,0xbf74fa0b,0xbf687c12,0xbf579b8c,0xbf6c835e,0xbf5b941a,0xbf45e403,0xbf2beb4a
.long 0xbf4f1bbd,0xbf3504f3,0xbf167918,0xbee87171,0xbf26423a,0xbf039c3d,0xbeba9be1,0xbe519f65
.long 0xbee87171,0xbe94a031,0xbdf0b772,0x3d712283,0xbe6f0c4d,0xbd48fb30,0x3e0c4cf7,0x3ea2fd52
.long 0x0,0x3e47c5c2,0x3ec3ef15,0x3f0e39da,0x3e6f0c4d,0x3edae880,0x3f1a82a4,0x3f4105b8
.long 0x3ee87171,0x3f226799,0x3f490a88,0x3f6655e7,0x3f26423a,0x3f4d9f02,0x3f6a8b4b,0x3f7b8f2a
.long 0x3f4f1bbd,0x3f6c835e,0x3f7cd925,0x3f7f35f9,0x3f6c835e,0x3f7d3aac,0x3f7ec46d,0x3f710908
.long 0x3f7cd925,0x3f7ec46d,0x3f702d4f,0x3f5205d4,0x3f7f35f9,0x3f710908,0x3f5205d4,0x3f2456f1
.long 0x3f737871,0x3f54db31,0x3f26423a,0x3ed65a92,0x3f5a46a0,0x3f2beb4a,0x3edf7108,0x3e2a1c3f
.long 0x3f3504f3,0x3ef15aea,0x3e47c5c2,0xbdc8bd36,0x3f05c277,0x3e78cfcc,0xbd712283,0xbeb5eb4f
.long 0x3f800000,0x3f800000,0x3f800000,0x3f800000,0x3f766377,0x3f75b1c9,0x3f74fa0b,0x3f743c41
.long 0x3f5a46a0,0x3f579b8c,0x3f54db31,0x3f5205d4,0x3f2dc5e3,0x3f28296a,0x3f226799,0x3f1c81b9
.long 0x3ee87171,0x3ed65a92,0x3ec3ef15,0x3eb13641,0x3e47c5c2,0x3e164083,0x3dc8bd36,0x3d48fb30
.long 0xbda0af2a,0xbe0c4cf7,0xbe47c5c2,0xbe814693,0xbeb13641,0xbed1c759,0xbef15aea,0xbf07e565
.long 0xbf167918,0xbf26423a,0xbf3504f3,0xbf42a9f7,0xbf490a88,0xbf563e03,0xbf61c598,0xbf6b8a3d
.long 0xbf6c835e,0xbf74fa0b,0xbf7b14be,0xbf7ec46d,0xbf7e39bc,0xbf7ffcd7,0xbf7ec46d,0xbf7a9421
.long 0xbf7cd925,0xbf766377,0xbf6c835e,0xbf5f5be6,0xbf687c12,0xbf58f3c4,0xbf45e403,0xbf2f9c32
.long 0xbf42a9f7,0xbf2a0c73,0xbf0e39da,0xbedf7108,0xbf0e39da,0xbedae880,0xbe94a031,0xbe164083
.long 0xbe9e377a,0xbe20305b,0x0,0x3e20305b,0xbd20cee7,0x3e0255f4,0x3e94a031,0x3ee3f40d
.long 0x3e6f0c4d,0x3ecd2ef3,0x3f0e39da,0x3f316e2c,0x3efa2c90,0x3f2456f1,0x3f45e403,0x3f609384
.long 0x3f3504f3,0x3f54db31,0x3f6c835e,0x3f7b14be,0x3f5f5be6,0x3f743c41,0x3f7ec46d,0x3f7e8238
.long 0x3f78ed3c,0x3f7ff35e,0x3f7b14be,0x3f6a8b4b,0x3f7fcd79,0x3f770f11,0x3f61c598,0x3f4105b8
.long 0x3f737871,0x3f5a46a0,0x3f3504f3,0x3f05c277,0x3f54db31,0x3f2beb4a,0x3ef15aea,0x3e78cfcc
.long 0x3f26423a,0x3edf7108,0x3e47c5c2,0xbd712283,0x3ed65a92,0x3e2a1c3f,0xbdc8bd36,0xbeb5eb4f
.long 0x3e20305b,0xbdf0b772,0xbec3ef15,0xbf1e7cf1,0xbdf0b772,0xbec8917e,0xbf226799,0xbf53731f
.long 0xbec3ef15,0xbf226799,0xbf54db31,0xbf74fa0b,0xbf1e7cf1,0xbf53731f,0xbf74fa0b,0xbf7ffcd7
.long 0x0,0x0,0x0,0x0,0x3e6f0c4d,0x3e78cfcc,0x3e814693,0x3e862210
.long 0x3ee87171,0x3ef15aea,0x3efa2c90,0x3f0172c3,0x3f26423a,0x3f2beb4a,0x3f316e2c,0x3f36c9a9
.long 0x3f4f1bbd,0x3f54db31,0x3f5a46a0,0x3f5f5be6,0x3f6c835e,0x3f710908,0x3f74fa0b,0x3f7853f8
.long 0x3f7cd925,0x3f7ec46d,0x3f7fcd79,0x3f7ff35e,0x3f7f35f9,0x3f7d3aac,0x3f7a0d54,0x3f75b1c9
.long 0x3f737871,0x3f6c835e,0x3f641901,0x3f5a46a0,0x3f5a46a0,0x3f4d9f02,0x3f3f5cb5,0x3f2f9c32
.long 0x3f3504f3,0x3f226799,0x3f0e39da,0x3ef15aea,0x3f05c277,0x3edae880,0x3ea7bf25,0x3e6542e9
.long 0x3e9e377a,0x3e47c5c2,0x3da0af2a,0xbd20cee7,0x3da0af2a,0xbd48fb30,0xbe3403f1,0xbe996dba
.long 0xbe20305b,0xbe94a031,0xbed65a92,0xbf0a04f8,0xbec3ef15,0xbf039c3d,0xbf226799,0xbf3daef9
.long 0xbf167918,0xbf3504f3,0xbf4f1bbd,0xbf641901,0xbf42a9f7,0xbf5b941a,0xbf6e641a,0xbf7a9421
.long 0xbf641901,0xbf74fa0b,0xbf7e39bc,0xbf7f8e56,0xbf78ed3c,0xbf7fb10f,0xbf7d95f4,0xbf72ae9e
.long 0xbf800000,0xbf7b14be,0xbf6c835e,0xbf54db31,0xbf78ed3c,0xbf676bd8,0xbf4c1d35,0xbf28296a
.long 0xbf641901,0xbf45e403,0xbf1e7cf1,0xbedf7108,0xbf42a9f7,0xbf187fc0,0xbecd2ef3,0xbe3de731
.long 0xbf167918,0xbec3ef15,0xbe20305b,0x3da0af2a,0xbec3ef15,0xbe164083,0x3dc8bd36,0x3eac7cd4
.long 0xbe20305b,0x3dc8bd36,0x3eb13641,0x3f1260b2,0x3da0af2a,0x3eac7cd4,0x3f1260b2,0x3f444969
.long 0x3e9e377a,0x3f0e39da,0x3f42a9f7,0x3f687c12,0x3f05c277,0x3f3daef9,0x3f6655e7,0x3f7c7160
.long 0x3f3504f3,0x3f61c598,0x3f7b14be,0x3f7ec46d,0x3f5a46a0,0x3f7853f8,0x3f7f8e56,0x3f6f4ba8
.long 0x0,0x0,0x0,0x0,0x3e8afa3e,0x3e8fcefe,0x3e94a031,0x3e996dba
.long 0x3f05c277,0x3f0a04f8,0x3f0e39da,0x3f1260b2,0x3f3bfc8f,0x3f4105b8,0x3f45e403,0x3f4a965e
.long 0x3f641901,0x3f687c12,0x3f6c835e,0x3f702d4f,0x3f7b14be,0x3f7d3aac,0x3f7ec46d,0x3f7fb10f
.long 0x3f7f35f9,0x3f7d95f4,0x3f7b14be,0x3f77b493,0x3f702d4f,0x3f698690,0x3f61c598,0x3f58f3c4
.long 0x3f4f1bbd,0x3f42a9f7,0x3f3504f3,0x3f26423a,0x3f1e7cf1,0x3f0c2124,0x3ef15aea,0x3ec8917e
.long 0x3ec3ef15,0x3e94a031,0x3e47c5c2,0x3dc8bd36,0x3df0b772,0x3c20d8d2,0xbdc8bd36,0xbe519f65
.long 0xbe20305b,0xbe8afa3e,0xbec3ef15,0xbefa2c90,0xbed65a92,0xbf07e565,0xbf226799,0xbf3a4582
.long 0xbf26423a,0xbf3f5cb5,0xbf54db31,0xbf6655e7,0xbf54db31,0xbf676bd8,0xbf74fa0b,0xbf7d3aac
.long 0xbf737871,0xbf7cd925,0xbf800000,0xbf7cd925,0xbf7fcd79,0xbf7deafa,0xbf74fa0b,0xbf653a48
.long 0xbf78ed3c,0xbf6a8b4b,0xbf54db31,0xbf3889dc,0xbf5f5be6,0xbf444969,0xbf226799,0xbef5c6c5
.long 0xbf3504f3,0xbf0e39da,0xbec3ef15,0xbe47c5c2,0xbefa2c90,0xbe996dba,0xbdc8bd36,0x3ddcbd0d
.long 0xbe6f0c4d,0xbca0d6d6,0x3e47c5c2,0x3ecd2ef3,0x3d20cee7,0x3e862210,0x3ef15aea,0x3f28296a
.long 0x3e9e377a,0x3f05c277,0x3f3504f3,0x3f5a46a0,0x3f0e39da,0x3f3daef9,0x3f61c598,0x3f7853f8
.long 0x3f42a9f7,0x3f6655e7,0x3f7b14be,0x3f7f8e56,0x3f687c12,0x3f7c7160,0x3f7ec46d,0x3f6f4ba8
.long 0x3f7cd925,0x3f7e39bc,0x3f6c835e,0x3f490a88,0x3f7e39bc,0x3f6b8a3d,0x3f45e403,0x3f104f0e
.long 0x3f6c835e,0x3f45e403,0x3f0e39da,0x3e94a031,0x3f490a88,0x3f104f0e,0x3e94a031,0xbc20d8d2
.long 0x3ffff,0x3ffff,0x3ffff,0x3ffff,0x20040,0x22060,0x24080,0x260a0
.long 0x3ffff,0x3ffff,0x3ffff,0x3ffff,0x20241,0x22261,0x24281,0x262a1
.long 0x18000,0x1a010,0x1c020,0x1e030,0x20442,0x22462,0x24482,0x264a2
.long 0x18201,0x1a211,0x1c221,0x1e231,0x20643,0x22663,0x24683,0x266a3
.long 0x3ffff,0x3ffff,0x3ffff,0x3ffff,0x20844,0x22864,0x24884,0x268a4
.long 0x3ffff,0x3ffff,0x3ffff,0x3ffff,0x20a45,0x22a65,0x24a85,0x26aa5
.long 0x18402,0x1a412,0x1c422,0x1e432,0x20c46,0x22c66,0x24c86,0x26ca6
.long 0x18603,0x1a613,0x1c623,0x1e633,0x20e47,0x22e67,0x24e87,0x26ea7
.long 0x3ffff,0x3ffff,0x3ffff,0x3ffff,0x21048,0x23068,0x25088,0x270a8
.long 0x3ffff,0x3ffff,0x3ffff,0x3ffff,0x21249,0x23269,0x25289,0x272a9
.long 0x18804,0x1a814,0x1c824,0x1e834,0x2144a,0x2346a,0x2548a,0x274aa
.long 0x18a05,0x1aa15,0x1ca25,0x1ea35,0x2164b,0x2366b,0x2568b,0x276ab
.long 0x3ffff,0x3ffff,0x3ffff,0x3ffff,0x2184c,0x2386c,0x2588c,0x278ac
.long 0x3ffff,0x3ffff,0x3ffff,0x3ffff,0x21a4d,0x23a6d,0x25a8d,0x27aad
.long 0x18c06,0x1ac16,0x1cc26,0x1ec36,0x21c4e,0x23c6e,0x25c8e,0x27cae
.long 0x18e07,0x1ae17,0x1ce27,0x1ee37,0x21e4f,0x23e6f,0x25e8f,0x27eaf
.long 0x3ffff,0x3ffff,0x3ffff,0x3ffff,0x28050,0x3fe70,0x3fe90,0x3feb0
.long 0x3ffff,0x3ffff,0x3ffff,0x3ffff,0x3fe51,0x3fe71,0x3fe91,0x3feb1
.long 0x19008,0x1b018,0x1d028,0x1f038,0x3fe52,0x3fe72,0x3fe92,0x3feb2
.long 0x19209,0x1b219,0x1d229,0x1f239,0x3fe53,0x3fe73,0x3fe93,0x3feb3
.long 0x3ffff,0x3ffff,0x3ffff,0x3ffff,0x3fe54,0x3fe74,0x3fe94,0x3feb4
.long 0x3ffff,0x3ffff,0x3ffff,0x3ffff,0x3fe55,0x3fe75,0x3fe95,0x3feb5
.long 0x1940a,0x1b41a,0x1d42a,0x1f43a,0x3fe56,0x3fe76,0x3fe96,0x3feb6
.long 0x1960b,0x1b61b,0x1d62b,0x1f63b,0x3fe57,0x3fe77,0x3fe97,0x3feb7
.long 0x3ffff,0x3ffff,0x3ffff,0x3ffff,0x3fe58,0x3fe78,0x3fe98,0x3feb8
.long 0x3ffff,0x3ffff,0x3ffff,0x3ffff,0x3fe59,0x3fe79,0x3fe99,0x3feb9
.long 0x1980c,0x1b81c,0x1d82c,0x1f83c,0x3fe5a,0x3fe7a,0x3fe9a,0x3feba
.long 0x19a0d,0x1ba1d,0x1da2d,0x1fa3d,0x3fe5b,0x3fe7b,0x3fe9b,0x3febb
.long 0x3ffff,0x3ffff,0x3ffff,0x3ffff,0x3fe5c,0x3fe7c,0x3fe9c,0x3febc
.long 0x3ffff,0x3ffff,0x3ffff,0x3ffff,0x3fe5d,0x3fe7d,0x3fe9d,0x3febd
.long 0x19c0e,0x1bc1e,0x1dc2e,0x1fc3e,0x3fe5e,0x3fe7e,0x3fe9e,0x3febe
.long 0x19e0f,0x1be1f,0x1de2f,0x1fe3f,0x3fe5f,0x3fe7f,0x3fe9f,0x3febf
.long 0x3ffff,0x3ffff,0x3ffff,0x3ffff,0x28060,0x3fe80,0x3fea0,0x3fec0
.long 0x1c000,0x1f018,0x22030,0x25048,0x3fe61,0x3fe81,0x3fea1,0x3fec1
.long 0x1c201,0x1f219,0x22231,0x25249,0x3fe62,0x3fe82,0x3fea2,0x3fec2
.long 0x1c402,0x1f41a,0x22432,0x2544a,0x3fe63,0x3fe83,0x3fea3,0x3fec3
.long 0x3ffff,0x3ffff,0x3ffff,0x3ffff,0x3fe64,0x3fe84,0x3fea4,0x3fec4
.long 0x1c603,0x1f61b,0x22633,0x2564b,0x3fe65,0x3fe85,0x3fea5,0x3fec5
.long 0x1c804,0x1f81c,0x22834,0x2584c,0x3fe66,0x3fe86,0x3fea6,0x3fec6
.long 0x1ca05,0x1fa1d,0x22a35,0x25a4d,0x3fe67,0x3fe87,0x3fea7,0x3fec7
.long 0x3ffff,0x3ffff,0x3ffff,0x3ffff,0x3fe68,0x3fe88,0x3fea8,0x3fec8
.long 0x1cc06,0x1fc1e,0x22c36,0x25c4e,0x3fe69,0x3fe89,0x3fea9,0x3fec9
.long 0x1ce07,0x1fe1f,0x22e37,0x25e4f,0x3fe6a,0x3fe8a,0x3feaa,0x3feca
.long 0x1d008,0x20020,0x23038,0x26050,0x3fe6b,0x3fe8b,0x3feab,0x3fecb
.long 0x3ffff,0x3ffff,0x3ffff,0x3ffff,0x3fe6c,0x3fe8c,0x3feac,0x3fecc
.long 0x1d209,0x20221,0x23239,0x26251,0x3fe6d,0x3fe8d,0x3fead,0x3fecd
.long 0x1d40a,0x20422,0x2343a,0x26452,0x3fe6e,0x3fe8e,0x3feae,0x3fece
.long 0x1d60b,0x20623,0x2363b,0x26653,0x3fe6f,0x3fe8f,0x3feaf,0x3fecf
.long 0x3ffff,0x3ffff,0x3ffff,0x3ffff,0x3fe70,0x3fe90,0x3feb0,0x3fed0
.long 0x1d80c,0x20824,0x2383c,0x26854,0x3fe71,0x3fe91,0x3feb1,0x3fed1
.long 0x1da0d,0x20a25,0x23a3d,0x26a55,0x3fe72,0x3fe92,0x3feb2,0x3fed2
.long 0x1dc0e,0x20c26,0x23c3e,0x26c56,0x3fe73,0x3fe93,0x3feb3,0x3fed3
.long 0x3ffff,0x3ffff,0x3ffff,0x3ffff,0x3fe74,0x3fe94,0x3feb4,0x3fed4
.long 0x1de0f,0x20e27,0x23e3f,0x26e57,0x3fe75,0x3fe95,0x3feb5,0x3fed5
.long 0x1e010,0x21028,0x24040,0x27058,0x3fe76,0x3fe96,0x3feb6,0x3fed6
.long 0x1e211,0x21229,0x24241,0x27259,0x3fe77,0x3fe97,0x3feb7,0x3fed7
.long 0x3ffff,0x3ffff,0x3ffff,0x3ffff,0x3fe78,0x3fe98,0x3feb8,0x3fed8
.long 0x1e412,0x2142a,0x24442,0x2745a,0x3fe79,0x3fe99,0x3feb9,0x3fed9
.long 0x1e613,0x2162b,0x24643,0x2765b,0x3fe7a,0x3fe9a,0x3feba,0x3feda
.long 0x1e814,0x2182c,0x24844,0x2785c,0x3fe7b,0x3fe9b,0x3febb,0x3fedb
.long 0x3ffff,0x3ffff,0x3ffff,0x3ffff,0x3fe7c,0x3fe9c,0x3febc,0x3fedc
.long 0x1ea15,0x21a2d,0x24a45,0x27a5d,0x3fe7d,0x3fe9d,0x3febd,0x3fedd
.long 0x1ec16,0x21c2e,0x24c46,0x27c5e,0x3fe7e,0x3fe9e,0x3febe,0x3fede
.long 0x1ee17,0x21e2f,0x24e47,0x27e5f,0x3fe7f,0x3fe9f,0x3febf,0x3fedf
.size gated_mix__grouped_kv_mqa__spectral_gfnet__prompt_kernel_tbl, 90112
gated_mix__grouped_kv_mqa__spectral_gfnet__prompt_kernel_tblend:

.section .rodata,"a"
.p2align 6
.amdhsa_kernel gated_mix__grouped_kv_mqa__spectral_gfnet__prompt_kernel
  .amdhsa_next_free_vgpr 256
  .amdhsa_next_free_sgpr 102
  .amdhsa_accum_offset 256
  .amdhsa_group_segment_fixed_size 0
  .amdhsa_kernarg_size 96
  .amdhsa_user_sgpr_count 2
  .amdhsa_user_sgpr_kernarg_segment_ptr 1
  .amdhsa_system_sgpr_workgroup_id_x 1
  .amdhsa_float_denorm_mode_32 3
  .amdhsa_float_denorm_mode_16_64 3
.end_amdhsa_kernel
```
